```python
import torch

def _softmax(x, axis=-1):
    return torch.softmax(x, dim=axis)

def _gelu(x):
    return torch.nn.functional.gelu(x, approximate='tanh')

def _silu(x):
    return torch.nn.functional.silu(x)

def _sigmoid(x):
    return torch.sigmoid(x)

def _layernorm(x, axis=-1, eps=1e-05):
    m = x.mean(dim=axis, keepdim=True)
    v = x.var(dim=axis, keepdim=True, unbiased=False)
    return (x - m) / torch.sqrt(v + eps)

def _scatter_add(tgt, idx, src, axis=0):
    return tgt.clone().index_add_(axis, idx, src)

def _segment_sum(src, seg, n):
    out = torch.zeros((n,) + src.shape[1:], dtype=src.dtype)
    return out.index_add_(0, seg, src)

def _pad(x, pw):
    flat = tuple((v for pair in reversed(pw) for v in pair))
    return torch.nn.functional.pad(x, flat)
kernel_name = 'adaLN_cond__sliding_block_cached__mixer_channel_mlp__prompt'

def setup_inputs():

    _w = lambda a: (lambda t: t.to(torch.bfloat16) if t.is_floating_point() else t)(torch.as_tensor(a))

    def _A_setup():
        B, Sq, D = (1, 2048, 512)
        Hq, Hkv, Sk, Dh = (32, 8, 2048, 128)
        assert Hq % Hkv == 0, (Hq, Hkv)
        return {'x': _w((lambda *s: torch.randn(*s, dtype=torch.bfloat16) * 0.1)(B, Sq, D)), 'k_cache': _w((lambda *s: torch.randn(*s, dtype=torch.bfloat16) * 0.8)(B, Hkv, Sk, Dh)), 'v_cache': _w((lambda *s: torch.randn(*s, dtype=torch.bfloat16) * 1.6)(B, Hkv, Sk, Dh)), 'wq': _w((lambda *s: torch.randn(*s, dtype=torch.bfloat16) * 0.8)(D, Hq * Dh) * D ** (-0.5)), 'wo': _w((lambda *s: torch.randn(*s, dtype=torch.bfloat16) * 1.6)(Hq * Dh, D) * (Hq * Dh) ** (-0.5))}
    _A_in = _A_setup()

    def _B_setup():
        B, S, D, F = (1, 2048, 512, 1792)
        return {'x': _w((lambda *s: torch.randn(*s, dtype=torch.bfloat16) * 0.1)(B, S, D)), 'w1': _w((lambda *s: torch.randn(*s, dtype=torch.bfloat16) * 3.2)(D, F) * D ** (-0.5)), 'b1': _w((lambda *s: torch.randn(*s, dtype=torch.bfloat16) * 3.2)(F)), 'w2': _w((lambda *s: torch.randn(*s, dtype=torch.bfloat16) * 3.2)(F, D) * F ** (-0.5)), 'b2': _w((lambda *s: torch.randn(*s, dtype=torch.bfloat16) * 3.2)(D))}
    _B_in = _B_setup()
    return {'A_x': _A_in['x'], 'A_k_cache': _A_in['k_cache'], 'A_v_cache': _A_in['v_cache'], 'A_wq': _A_in['wq'], 'A_wo': _A_in['wo'], 'B_x': _B_in['x'], 'B_w1': _B_in['w1'], 'B_b1': _B_in['b1'], 'B_w2': _B_in['w2'], 'B_b2': _B_in['b2'], 'c': _w((lambda *s: torch.randn(*s, dtype=torch.bfloat16) * 0.2)(1, 512) * 8.0), 'w_mod': _w((lambda *s: torch.randn(*s, dtype=torch.bfloat16) * 0.2)(512, 6 * 512) * 512 ** (-0.5) * 8.0)}

def reference(A_x, A_k_cache, A_v_cache, A_wq, A_wo, B_x, B_w1, B_b1, B_w2, B_b2, c, w_mod):

    def _A_ref(x, k_cache, v_cache, wq, wo):
        B, Sq, D = x.shape
        Hq, Dh = (32, 128)
        Hkv, Sk = (k_cache.shape[1], k_cache.shape[2])
        W = min(4096, max(256, Sk // 4))
        rep = Hq // Hkv
        q = (lambda x, *d: x.permute(*d))((x @ wq).reshape(B, Sq, Hq, Dh), 0, 2, 1, 3)
        k = (lambda x, n, axis: torch.repeat_interleave(x, n, dim=axis))(k_cache[:, :, Sk - W:, :], rep, axis=1)
        v = (lambda x, n, axis: torch.repeat_interleave(x, n, dim=axis))(v_cache[:, :, Sk - W:, :], rep, axis=1)
        scores = torch.einsum('bhqd,bhkd->bhqk', q, k) * Dh ** (-0.5)
        p = _softmax(scores, axis=-1)
        o = torch.einsum('bhqk,bhkd->bhqd', p, v)
        return (lambda x, *d: x.permute(*d))(o, 0, 2, 1, 3).reshape(B, Sq, Hq * Dh) @ wo

    def _B_ref(x, w1, b1, w2, b2):
        y = _layernorm(x, axis=-1)
        h = _gelu(torch.einsum('bsd,df->bsf', y, w1) + b1)
        return torch.einsum('bsf,fd->bsd', h, w2) + b2
    x = A_x
    mod = (_silu(c) @ w_mod).reshape(c.shape[0], 6, 1, -1)
    sa, ca, ga, sb, cb, gb = (mod[:, 0].clone(), mod[:, 1].clone(), mod[:, 2].clone(), mod[:, 3].clone(), mod[:, 4].clone(), mod[:, 5].clone())
    h = _layernorm(x, axis=-1) * (1 + ca) + sa
    x = x + ga * _A_ref(h, A_k_cache, A_v_cache, A_wq, A_wo)
    h = _layernorm(x, axis=-1) * (1 + cb) + sb
    x = x + gb * _B_ref(h, B_w1, B_b1, B_w2, B_b2)
    return x
```

```asm
; @launch grid=(256,1,1) block=(256,1,1) lds=163840
.amdgcn_target "amdgcn-amd-amdhsa--gfx950"
.text
.globl adaLN_cond__sliding_block_cached__mixer_channel_mlp__prompt_kernel
.p2align 8
.type adaLN_cond__sliding_block_cached__mixer_channel_mlp__prompt_kernel,@function
adaLN_cond__sliding_block_cached__mixer_channel_mlp__prompt_kernel:
	s_load_dwordx16 s[64:79], s[0:1], 0
	s_load_dwordx8 s[80:87], s[0:1], 64
	s_load_dwordx4 s[88:91], s[0:1], 96
	s_load_dwordx2 s[92:93], s[0:1], 112
	s_cmp_ge_u32 s2, 256
	s_cbranch_scc1 L_exit
	s_getpc_b64 s[48:49]
L_pc:
	s_mov_b32 s50, L_codeend-L_pc
	s_mov_b32 s51, 0x20000
	s_bfe_u32 s60, s2, 0x30003
	s_lshl_b32 s60, s60, 13
	v_lshrrev_b32 v1, 6, v0
	v_and_b32 v3, 15, v0
	v_and_b32 v2, 63, v0
	v_lshlrev_b32_e64 v3, 7, v3
	v_lshl_or_b32 v4, v1, 11, v3
	buffer_load_dword a244, v4, s[48:51], s60 offen
	s_bfe_u32 s60, s2, 0x20001
	v_readfirstlane_b32 s56, v1
	s_lshr_b32 s61, s2, 3
	s_lshl_b32 s60, s60, 1
	s_and_b32 s62, s61, 1
	s_or_b32 s57, s60, s62
	s_lshr_b32 s59, s61, 1
	s_bfe_u32 s62, s2, 0x10000
	s_lshl_b32 s60, s62, 4
	s_or_b32 s58, s60, s59
	s_and_b32 s60, s2, 7
	s_lshl_b32 s62, s60, 5
	s_or_b32 s2, s62, s61
	s_lshl_b32 s60, s60, 2
	s_add_u32 s101, s60, s59
	s_and_b32 s61, s61, 0x19
	s_mov_b32 s3, 0
	v_lshrrev_b32 v4, 2, v0
	v_and_b32_e64 v5, 3, v0
	v_mul_u32_u24 v6, 49152, v4
	v_lshlrev_b32 v5, 4, v5
	s_lshl_b32 s60, s101, 6
	v_add3_u32 v6, v6, v5, s60
	v_lshlrev_b32 v5, 4, v4
	v_lshlrev_b32 v7, 4, v2
	s_lshl_b32 s62, s58, 2
	s_add_u32 s62, s62, s56
	s_lshl_b32 s62, s62, 1
	s_and_b32 s60, s57, 1
	s_or_b32 s62, s62, s60
	s_lshl_b32 s62, s62, 13
	s_waitcnt lgkmcnt(0)
	s_mov_b32 s48, s84
	s_and_b32 s49, s85, 0xffff
	s_mov_b32 s50, 1024
	s_mov_b32 s51, 0x20000
	s_mov_b32 s44, s86
	s_nop 0
	s_and_b32 s45, s87, 0xffff
	s_mov_b32 s46, 3145728
	s_mov_b32 s47, 0x20000
	s_mov_b32 s4, s64
	s_nop 0
	s_and_b32 s5, s65, 0xffff
	s_mov_b32 s6, 2097152
	s_mov_b32 s7, 0x20000
	s_lshl_b32 s60, s2, 1
	s_lshr_b32 s63, s56, 1
	s_add_u32 s60, s60, s63
	s_nop 0
	s_mul_i32 s60, s60, 6144
	s_and_b32 s63, s56, 1
	s_lshl_b32 s63, s63, 10
	s_add_u32 s60, s60, s63
	s_nop 0
	v_and_b32 v8, 0x380, v3
	buffer_load_dword a244, v8, s[44:47], s60 offen
	s_cmp_eq_u32 s61, 1
	s_cselect_b32 s3, 1, 0
	s_nop 0
	s_cbranch_scc0 L_np0
	buffer_load_dwordx4 v[8:11], v5, s[48:51], 0 offen
	s_mov_b32 s60, 0
	s_nop 0
	buffer_load_dwordx4 v[64:67], v6, s[44:47], s60 offen
	s_mov_b32 s60, 6144
	buffer_load_dwordx4 v[68:71], v6, s[44:47], s60 offen
	s_mov_b32 s60, 12288
	buffer_load_dwordx4 v[72:75], v6, s[44:47], s60 offen
	s_mov_b32 s60, 18432
	buffer_load_dwordx4 v[76:79], v6, s[44:47], s60 offen
	s_mov_b32 s60, 24576
	buffer_load_dwordx4 v[80:83], v6, s[44:47], s60 offen
	s_mov_b32 s60, 30720
	buffer_load_dwordx4 v[84:87], v6, s[44:47], s60 offen
	s_mov_b32 s60, 36864
	buffer_load_dwordx4 v[88:91], v6, s[44:47], s60 offen
	s_mov_b32 s60, 43008
	buffer_load_dwordx4 v[92:95], v6, s[44:47], s60 offen
	s_nop 0
	s_branch L_j0
L_np0:
	buffer_load_dwordx4 v[132:135], v7, s[4:7], s62 offen offset:0
	buffer_load_dwordx4 v[140:143], v7, s[4:7], s62 offen offset:1024
	buffer_load_dwordx4 v[148:151], v7, s[4:7], s62 offen offset:2048
	buffer_load_dwordx4 v[156:159], v7, s[4:7], s62 offen offset:3072
	s_xor_b32 s62, s62, 4096
	buffer_load_dwordx4 v[164:167], v7, s[4:7], s62 offen offset:0
	buffer_load_dwordx4 v[172:175], v7, s[4:7], s62 offen offset:1024
	buffer_load_dwordx4 v[180:183], v7, s[4:7], s62 offen offset:2048
	buffer_load_dwordx4 v[188:191], v7, s[4:7], s62 offen offset:3072
L_j0:
	s_mov_b32 s16, s70
	s_nop 0
	s_and_b32 s17, s71, 0xffff
	s_mov_b32 s18, 4194304
	s_mov_b32 s19, 0x20000
	s_mov_b32 s8, s66
	s_nop 0
	s_and_b32 s9, s67, 0xffff
	s_mov_b32 s10, 4194304
	s_mov_b32 s11, 0x20000
	s_mov_b32 s12, s68
	s_nop 0
	s_and_b32 s13, s69, 0xffff
	s_mov_b32 s14, 4194304
	s_mov_b32 s15, 0x20000
	v_lshrrev_b32 v12, 4, v2
	v_and_b32 v13, 15, v2
	v_lshlrev_b32 v12, 16, v12
	v_lshlrev_b32_e64 v13, 4, v13
	s_lshl_b32 s60, s57, 10
	s_lshl_b32 s61, s56, 8
	s_add_u32 s60, s60, s61
	v_add3_u32 v24, v12, v13, s60
	v_add_u32 v25, 8192, v24
	v_add_u32 v26, 16384, v24
	v_add_u32 v27, 24576, v24
	v_add_u32 v28, 32768, v24
	v_add_u32 v29, 40960, v24
	v_add_u32 v30, 49152, v24
	v_add_u32 v31, 57344, v24
	s_mov_b32 s96, 0x05040100
	s_mov_b32 s97, 0x07060302
	s_lshl_b32 s63, s59, 18
	s_cmp_lg_u32 s3, 0
	s_nop 0
	s_cbranch_scc1 L_j1
	buffer_load_dwordx4 v[32:35], v24, s[16:19], s63 offen
	buffer_load_dwordx4 v[36:39], v25, s[16:19], s63 offen
	buffer_load_dwordx4 v[40:43], v26, s[16:19], s63 offen
	buffer_load_dwordx4 v[44:47], v27, s[16:19], s63 offen
	buffer_load_dwordx4 v[48:51], v28, s[16:19], s63 offen
	buffer_load_dwordx4 v[52:55], v29, s[16:19], s63 offen
	buffer_load_dwordx4 v[56:59], v30, s[16:19], s63 offen
	buffer_load_dwordx4 v[60:63], v31, s[16:19], s63 offen
L_j1:
	s_mov_b32 s32, s92
	s_nop 0
	s_and_b32 s33, s93, 0xffff
	s_mov_b32 s34, 268435456
	s_mov_b32 s35, 0x20000
	s_mov_b32 s36, s90
	s_nop 0
	s_and_b32 s37, s91, 0xffff
	s_mov_b32 s38, 256
	s_mov_b32 s39, 0x20000
	s_mov_b32 s20, s72
	s_nop 0
	s_and_b32 s21, s73, 0xffff
	s_mov_b32 s22, 4194304
	s_mov_b32 s23, 0x20000
	s_mov_b32 s24, s76
	s_nop 0
	s_and_b32 s25, s77, 0xffff
	s_mov_b32 s26, 1835008
	s_mov_b32 s27, 0x20000
	s_mov_b32 s28, s80
	s_nop 0
	s_and_b32 s29, s81, 0xffff
	s_mov_b32 s30, 1835008
	s_mov_b32 s31, 0x20000
	s_mov_b32 s40, s88
	s_nop 0
	s_and_b32 s41, s89, 0xffff
	s_mov_b32 s42, 2097152
	s_mov_b32 s43, 0x20000
	s_mov_b64 s[52:53], s[78:79]
	s_mov_b64 s[54:55], s[82:83]
	v_mov_b32 v19, v7
	v_lshrrev_b32 v12, 4, v2
	v_and_b32 v16, 15, v2
	s_lshl_b32 s60, s56, 3
	v_add_u32 v12, s60, v12
	v_add_u32 v15, 0, v12
	v_and_b32 v15, 15, v15
	v_lshrrev_b32 v13, 1, v15
	v_xor_b32 v14, v13, v15
	v_and_b32 v13, 4, v13
	v_and_b32 v14, 4, v14
	v_and_b32 v17, 3, v15
	v_lshl_or_b32 v17, v14, 1, v17
	v_or_b32 v17, v17, v13
	v_xor_b32 v17, v17, v16
	v_lshlrev_b32_e64 v17, 4, v17
	v_lshl_or_b32 v17, v12, 8, v17
	v_accvgpr_write_b32 a160, v17
	v_and_b32 v15, 7, v15
	v_lshlrev_b32 v15, 1, v15
	v_xor_b32 v17, v15, v16
	v_lshlrev_b32 v17, 4, v17
	v_lshl_or_b32 v17, v12, 8, v17
	v_accvgpr_write_b32 a162, v17
	v_add_u32 v15, 4, v12
	v_and_b32 v15, 15, v15
	v_lshrrev_b32 v13, 1, v15
	v_xor_b32 v14, v13, v15
	v_and_b32 v13, 4, v13
	v_and_b32 v14, 4, v14
	v_and_b32_e64 v17, 3, v15
	v_lshl_or_b32 v17, v14, 1, v17
	v_or_b32 v17, v17, v13
	v_xor_b32 v17, v17, v16
	v_lshlrev_b32_e64 v17, 4, v17
	v_lshl_or_b32 v17, v12, 8, v17
	v_accvgpr_write_b32 a161, v17
	v_and_b32 v15, 7, v15
	v_lshlrev_b32 v15, 1, v15
	v_xor_b32 v17, v15, v16
	v_lshlrev_b32 v17, 4, v17
	v_lshl_or_b32 v17, v12, 8, v17
	v_accvgpr_write_b32 a163, v17
	v_lshrrev_b32 v13, 1, v16
	v_xor_b32 v14, v13, v16
	v_and_b32 v13, 4, v13
	v_and_b32 v14, 4, v14
	v_and_b32_e64 v15, 3, v16
	v_lshl_or_b32 v15, v14, 1, v15
	v_or_b32 v15, v15, v13
	v_lshrrev_b32 v12, 4, v2
	v_lshlrev_b32 v13, 2, v12
	v_xor_b32 v15, v15, v13
	v_lshlrev_b32_e64 v15, 4, v15
	v_lshl_or_b32 v15, v16, 8, v15
	v_add_u32 v17, 65536, v15
	v_accvgpr_write_b32 a164, v17
	v_lshrrev_b32 v12, 2, v2
	v_and_b32 v13, 7, v12
	v_and_b32 v14, 3, v2
	v_lshlrev_b32 v14, 3, v14
	v_lshl_or_b32 v14, v13, 5, v14
	v_lshl_or_b32 v14, v12, 8, v14
	v_add_u32 v17, 98304, v14
	v_accvgpr_write_b32 a165, v17
	v_mov_b32 v12, 0x3f803f80
	v_accvgpr_write_b32 a240, v12
	v_accvgpr_write_b32 a241, v12
	v_accvgpr_write_b32 a242, v12
	v_accvgpr_write_b32 a243, v12
	v_accvgpr_write_b32 a248, -1
	v_accvgpr_write_b32 a249, -1
	v_accvgpr_write_b32 a250, -1
	v_accvgpr_write_b32 a251, -1
	v_lshrrev_b32_e64 v12, 2, v2
	v_bfe_u32 v13, v2, 3, 2
	v_and_b32 v14, 3, v2
	v_lshlrev_b32 v14, 3, v14
	v_lshl_or_b32 v14, v13, 5, v14
	v_lshl_or_b32 v14, v12, 7, v14
	s_lshl_b32 s60, s56, 12
	v_add_u32 v14, s60, v14
	v_accvgpr_write_b32 a245, v14
	v_lshrrev_b32 v12, 3, v2
	v_lshrrev_b32 v13, 4, v2
	v_and_b32 v14, 7, v2
	v_lshlrev_b32 v13, 1, v13
	v_xor_b32 v14, v14, v13
	v_lshlrev_b32 v14, 4, v14
	v_accvgpr_write_b32 a247, v14
	s_lshl_b32 s60, s56, 8
	s_nop 0
	v_lshl_or_b32 v17, v12, 10, v14
	v_add_u32_e64 v17, s60, v17
	v_accvgpr_write_b32 a166, v17
	s_cmp_eq_u32 s3, 0
	s_cbranch_scc1 L_prodret
	s_lshl_b32 s60, s101, 7
	s_add_u32 s60, s32, s60
	s_addc_u32 s61, s33, 0
	s_nop 0
	s_load_dwordx16 s[64:79], s[60:61], 0 glc
	s_load_dwordx16 s[80:95], s[60:61], 64 glc
	v_and_b32_e64 v12, 3, v2
	v_bfe_u32 v13, v2, 4, 1
	v_lshrrev_b32 v14, 5, v2
	v_lshlrev_b32 v12, 5, v12
	v_lshlrev_b32 v13, 4, v13
	v_lshlrev_b32 v14, 3, v14
	s_lshl_b32 s100, s56, 7
	v_or_b32 v12, v12, v13
	v_add3_u32 v12, v12, v14, s100
	v_and_b32 v13, 15, v2
	v_lshlrev_b32 v13, 3, v13
	s_waitcnt vmcnt(8)
	v_lshlrev_b32 v32, 16, v8
	v_and_b32 v33, 0xffff0000, v8
	v_lshlrev_b32_e64 v34, 16, v9
	v_and_b32 v35, 0xffff0000, v9
	v_lshlrev_b32_e64 v36, 16, v10
	v_and_b32 v37, 0xffff0000, v10
	v_lshlrev_b32_e64 v38, 16, v11
	v_and_b32 v39, 0xffff0000, v11
	v_mul_f32 v48, 0xbfb8aa3b, v32
	v_mul_f32 v49, 0xbfb8aa3b, v33
	v_mul_f32 v50, 0xbfb8aa3b, v34
	v_mul_f32 v51, 0xbfb8aa3b, v35
	v_mul_f32 v52, 0xbfb8aa3b, v36
	v_mul_f32 v53, 0xbfb8aa3b, v37
	v_mul_f32 v54, 0xbfb8aa3b, v38
	v_mul_f32 v55, 0xbfb8aa3b, v39
	v_exp_f32 v48, v48
	v_exp_f32 v49, v49
	v_exp_f32 v50, v50
	v_exp_f32 v51, v51
	v_exp_f32 v52, v52
	v_exp_f32 v53, v53
	v_exp_f32 v54, v54
	v_exp_f32 v55, v55
	v_add_f32 v48, 1.0, v48
	v_add_f32 v49, 1.0, v49
	v_add_f32 v50, 1.0, v50
	v_add_f32 v51, 1.0, v51
	v_add_f32 v52, 1.0, v52
	v_add_f32 v53, 1.0, v53
	v_add_f32 v54, 1.0, v54
	v_add_f32 v55, 1.0, v55
	v_rcp_f32 v48, v48
	v_rcp_f32 v49, v49
	v_rcp_f32 v50, v50
	v_rcp_f32 v51, v51
	v_rcp_f32 v52, v52
	v_rcp_f32 v53, v53
	v_rcp_f32 v54, v54
	v_rcp_f32 v55, v55
	v_mul_f32 v32, v32, v48
	v_mul_f32 v33, v33, v49
	v_mul_f32 v34, v34, v50
	v_mul_f32 v35, v35, v51
	v_mul_f32 v36, v36, v52
	v_mul_f32 v37, v37, v53
	v_mul_f32 v38, v38, v54
	v_mul_f32 v39, v39, v55
	v_cvt_pk_bf16_f32 v8, v32, v33
	v_cvt_pk_bf16_f32 v9, v34, v35
	v_cvt_pk_bf16_f32 v10, v36, v37
	v_cvt_pk_bf16_f32 v11, v38, v39
	v_lshlrev_b32_e64 v32, 16, v8
	v_and_b32 v33, 0xffff0000, v8
	v_lshlrev_b32_e64 v34, 16, v9
	v_and_b32 v35, 0xffff0000, v9
	v_lshlrev_b32_e64 v36, 16, v10
	v_and_b32 v37, 0xffff0000, v10
	v_lshlrev_b32_e64 v38, 16, v11
	v_and_b32 v39, 0xffff0000, v11
	s_waitcnt vmcnt(7)
	s_nop 0
	buffer_load_dwordx4 v[132:135], v7, s[4:7], s62 offen offset:0
	v_lshlrev_b32_e64 v48, 16, v64
	v_and_b32 v49, 0xffff0000, v64
	v_lshlrev_b32_e64 v50, 16, v65
	v_and_b32 v51, 0xffff0000, v65
	v_lshlrev_b32_e64 v52, 16, v66
	v_and_b32 v53, 0xffff0000, v66
	v_lshlrev_b32_e64 v54, 16, v67
	v_and_b32 v55, 0xffff0000, v67
	v_pk_mul_f32 v[40:41], v[48:49], v[32:33] op_sel:[0,0] op_sel_hi:[1,0]
	v_pk_mul_f32 v[42:43], v[50:51], v[32:33] op_sel:[0,0] op_sel_hi:[1,0]
	v_pk_mul_f32 v[44:45], v[52:53], v[32:33] op_sel:[0,0] op_sel_hi:[1,0]
	v_pk_mul_f32 v[46:47], v[54:55], v[32:33] op_sel:[0,0] op_sel_hi:[1,0]
	s_waitcnt vmcnt(7)
	s_nop 0
	buffer_load_dwordx4 v[140:143], v7, s[4:7], s62 offen offset:1024
	v_lshlrev_b32_e64 v48, 16, v68
	v_and_b32 v49, 0xffff0000, v68
	v_lshlrev_b32_e64 v50, 16, v69
	v_and_b32 v51, 0xffff0000, v69
	v_lshlrev_b32_e64 v52, 16, v70
	v_and_b32 v53, 0xffff0000, v70
	v_lshlrev_b32_e64 v54, 16, v71
	v_and_b32 v55, 0xffff0000, v71
	v_pk_fma_f32 v[40:41], v[48:49], v[32:33], v[40:41] op_sel:[0,1,0] op_sel_hi:[1,1,1]
	v_pk_fma_f32 v[42:43], v[50:51], v[32:33], v[42:43] op_sel:[0,1,0] op_sel_hi:[1,1,1]
	v_pk_fma_f32 v[44:45], v[52:53], v[32:33], v[44:45] op_sel:[0,1,0] op_sel_hi:[1,1,1]
	v_pk_fma_f32 v[46:47], v[54:55], v[32:33], v[46:47] op_sel:[0,1,0] op_sel_hi:[1,1,1]
	s_waitcnt vmcnt(7)
	s_nop 0
	buffer_load_dwordx4 v[148:151], v7, s[4:7], s62 offen offset:2048
	v_lshlrev_b32_e64 v48, 16, v72
	v_and_b32 v49, 0xffff0000, v72
	v_lshlrev_b32_e64 v50, 16, v73
	v_and_b32 v51, 0xffff0000, v73
	v_lshlrev_b32_e64 v52, 16, v74
	v_and_b32 v53, 0xffff0000, v74
	v_lshlrev_b32_e64 v54, 16, v75
	v_and_b32 v55, 0xffff0000, v75
	v_pk_fma_f32 v[40:41], v[48:49], v[34:35], v[40:41] op_sel:[0,0,0] op_sel_hi:[1,0,1]
	v_pk_fma_f32 v[42:43], v[50:51], v[34:35], v[42:43] op_sel:[0,0,0] op_sel_hi:[1,0,1]
	v_pk_fma_f32 v[44:45], v[52:53], v[34:35], v[44:45] op_sel:[0,0,0] op_sel_hi:[1,0,1]
	v_pk_fma_f32 v[46:47], v[54:55], v[34:35], v[46:47] op_sel:[0,0,0] op_sel_hi:[1,0,1]
	s_waitcnt vmcnt(7)
	s_nop 0
	buffer_load_dwordx4 v[156:159], v7, s[4:7], s62 offen offset:3072
	v_lshlrev_b32_e64 v48, 16, v76
	v_and_b32 v49, 0xffff0000, v76
	v_lshlrev_b32_e64 v50, 16, v77
	v_and_b32 v51, 0xffff0000, v77
	v_lshlrev_b32_e64 v52, 16, v78
	v_and_b32 v53, 0xffff0000, v78
	v_lshlrev_b32_e64 v54, 16, v79
	v_and_b32 v55, 0xffff0000, v79
	v_pk_fma_f32 v[40:41], v[48:49], v[34:35], v[40:41] op_sel:[0,1,0] op_sel_hi:[1,1,1]
	v_pk_fma_f32 v[42:43], v[50:51], v[34:35], v[42:43] op_sel:[0,1,0] op_sel_hi:[1,1,1]
	v_pk_fma_f32 v[44:45], v[52:53], v[34:35], v[44:45] op_sel:[0,1,0] op_sel_hi:[1,1,1]
	v_pk_fma_f32 v[46:47], v[54:55], v[34:35], v[46:47] op_sel:[0,1,0] op_sel_hi:[1,1,1]
	s_waitcnt vmcnt(7)
	s_nop 0
	s_xor_b32 s62, s62, 4096
	buffer_load_dwordx4 v[164:167], v7, s[4:7], s62 offen offset:0
	v_lshlrev_b32_e64 v48, 16, v80
	v_and_b32 v49, 0xffff0000, v80
	v_lshlrev_b32_e64 v50, 16, v81
	v_and_b32 v51, 0xffff0000, v81
	v_lshlrev_b32_e64 v52, 16, v82
	v_and_b32 v53, 0xffff0000, v82
	v_lshlrev_b32_e64 v54, 16, v83
	v_and_b32 v55, 0xffff0000, v83
	v_pk_fma_f32 v[40:41], v[48:49], v[36:37], v[40:41] op_sel:[0,0,0] op_sel_hi:[1,0,1]
	v_pk_fma_f32 v[42:43], v[50:51], v[36:37], v[42:43] op_sel:[0,0,0] op_sel_hi:[1,0,1]
	v_pk_fma_f32 v[44:45], v[52:53], v[36:37], v[44:45] op_sel:[0,0,0] op_sel_hi:[1,0,1]
	v_pk_fma_f32 v[46:47], v[54:55], v[36:37], v[46:47] op_sel:[0,0,0] op_sel_hi:[1,0,1]
	s_waitcnt vmcnt(7)
	s_nop 0
	buffer_load_dwordx4 v[172:175], v7, s[4:7], s62 offen offset:1024
	v_lshlrev_b32_e64 v48, 16, v84
	v_and_b32 v49, 0xffff0000, v84
	v_lshlrev_b32_e64 v50, 16, v85
	v_and_b32 v51, 0xffff0000, v85
	v_lshlrev_b32_e64 v52, 16, v86
	v_and_b32 v53, 0xffff0000, v86
	v_lshlrev_b32_e64 v54, 16, v87
	v_and_b32 v55, 0xffff0000, v87
	v_pk_fma_f32 v[40:41], v[48:49], v[36:37], v[40:41] op_sel:[0,1,0] op_sel_hi:[1,1,1]
	v_pk_fma_f32 v[42:43], v[50:51], v[36:37], v[42:43] op_sel:[0,1,0] op_sel_hi:[1,1,1]
	v_pk_fma_f32 v[44:45], v[52:53], v[36:37], v[44:45] op_sel:[0,1,0] op_sel_hi:[1,1,1]
	v_pk_fma_f32 v[46:47], v[54:55], v[36:37], v[46:47] op_sel:[0,1,0] op_sel_hi:[1,1,1]
	s_waitcnt vmcnt(7)
	s_nop 0
	buffer_load_dwordx4 v[180:183], v7, s[4:7], s62 offen offset:2048
	v_lshlrev_b32_e64 v48, 16, v88
	v_and_b32 v49, 0xffff0000, v88
	v_lshlrev_b32_e64 v50, 16, v89
	v_and_b32 v51, 0xffff0000, v89
	v_lshlrev_b32_e64 v52, 16, v90
	v_and_b32 v53, 0xffff0000, v90
	v_lshlrev_b32_e64 v54, 16, v91
	v_and_b32 v55, 0xffff0000, v91
	v_pk_fma_f32 v[40:41], v[48:49], v[38:39], v[40:41] op_sel:[0,0,0] op_sel_hi:[1,0,1]
	v_pk_fma_f32 v[42:43], v[50:51], v[38:39], v[42:43] op_sel:[0,0,0] op_sel_hi:[1,0,1]
	v_pk_fma_f32 v[44:45], v[52:53], v[38:39], v[44:45] op_sel:[0,0,0] op_sel_hi:[1,0,1]
	v_pk_fma_f32 v[46:47], v[54:55], v[38:39], v[46:47] op_sel:[0,0,0] op_sel_hi:[1,0,1]
	s_waitcnt vmcnt(7)
	s_nop 0
	buffer_load_dwordx4 v[188:191], v7, s[4:7], s62 offen offset:3072
	v_lshlrev_b32_e64 v48, 16, v92
	v_and_b32 v49, 0xffff0000, v92
	v_lshlrev_b32_e64 v50, 16, v93
	v_and_b32 v51, 0xffff0000, v93
	v_lshlrev_b32_e64 v52, 16, v94
	v_and_b32 v53, 0xffff0000, v94
	v_lshlrev_b32_e64 v54, 16, v95
	v_and_b32 v55, 0xffff0000, v95
	v_pk_fma_f32 v[40:41], v[48:49], v[38:39], v[40:41] op_sel:[0,1,0] op_sel_hi:[1,1,1]
	v_pk_fma_f32 v[42:43], v[50:51], v[38:39], v[42:43] op_sel:[0,1,0] op_sel_hi:[1,1,1]
	v_pk_fma_f32 v[44:45], v[52:53], v[38:39], v[44:45] op_sel:[0,1,0] op_sel_hi:[1,1,1]
	v_pk_fma_f32 v[46:47], v[54:55], v[38:39], v[46:47] op_sel:[0,1,0] op_sel_hi:[1,1,1]
	s_mov_b32 s100, 1
	s_waitcnt lgkmcnt(0)
	s_min_u32 s60, s65, 31
	s_bitset1_b32 s100, s60
	v_add_f32_dpp v40, v40, v40 row_ror:4 row_mask:0xf bank_mask:0xf
	s_min_u32 s60, s67, 31
	s_bitset1_b32 s100, s60
	v_add_f32_dpp v41, v41, v41 row_ror:4 row_mask:0xf bank_mask:0xf
	s_min_u32 s60, s69, 31
	s_bitset1_b32 s100, s60
	v_add_f32_dpp v42, v42, v42 row_ror:4 row_mask:0xf bank_mask:0xf
	s_min_u32 s60, s71, 31
	s_bitset1_b32 s100, s60
	v_add_f32_dpp v43, v43, v43 row_ror:4 row_mask:0xf bank_mask:0xf
	s_min_u32 s60, s73, 31
	s_bitset1_b32 s100, s60
	v_add_f32_dpp v44, v44, v44 row_ror:4 row_mask:0xf bank_mask:0xf
	s_min_u32 s60, s75, 31
	s_bitset1_b32 s100, s60
	v_add_f32_dpp v45, v45, v45 row_ror:4 row_mask:0xf bank_mask:0xf
	s_min_u32 s60, s77, 31
	s_bitset1_b32 s100, s60
	v_add_f32_dpp v46, v46, v46 row_ror:4 row_mask:0xf bank_mask:0xf
	s_min_u32 s60, s79, 31
	s_bitset1_b32 s100, s60
	v_add_f32_dpp v47, v47, v47 row_ror:4 row_mask:0xf bank_mask:0xf
	s_min_u32 s60, s81, 31
	s_bitset1_b32 s100, s60
	v_add_f32_dpp v40, v40, v40 row_ror:8 row_mask:0xf bank_mask:0xf
	s_min_u32 s60, s83, 31
	s_bitset1_b32 s100, s60
	v_add_f32_dpp v41, v41, v41 row_ror:8 row_mask:0xf bank_mask:0xf
	s_min_u32 s60, s85, 31
	s_bitset1_b32 s100, s60
	v_add_f32_dpp v42, v42, v42 row_ror:8 row_mask:0xf bank_mask:0xf
	s_min_u32 s60, s87, 31
	s_bitset1_b32 s100, s60
	v_add_f32_dpp v43, v43, v43 row_ror:8 row_mask:0xf bank_mask:0xf
	s_min_u32 s60, s89, 31
	s_bitset1_b32 s100, s60
	v_add_f32_dpp v44, v44, v44 row_ror:8 row_mask:0xf bank_mask:0xf
	s_min_u32 s60, s91, 31
	s_bitset1_b32 s100, s60
	v_add_f32_dpp v45, v45, v45 row_ror:8 row_mask:0xf bank_mask:0xf
	s_min_u32 s60, s93, 31
	s_bitset1_b32 s100, s60
	v_add_f32_dpp v46, v46, v46 row_ror:8 row_mask:0xf bank_mask:0xf
	s_min_u32 s60, s95, 31
	s_bitset1_b32 s100, s60
	v_add_f32_dpp v47, v47, v47 row_ror:8 row_mask:0xf bank_mask:0xf
	s_ff0_i32_b32 s3, s100
	v_permlane16_swap_b32 v40, v44
	v_permlane16_swap_b32 v41, v45
	v_permlane16_swap_b32 v42, v46
	v_permlane16_swap_b32 v43, v47
	v_add_f32 v40, v40, v44
	v_add_f32 v41, v41, v45
	v_add_f32 v42, v42, v46
	v_add_f32 v43, v43, v47
	v_mov_b32 v14, s3
	v_permlane32_swap_b32 v40, v42
	v_permlane32_swap_b32 v41, v43
	v_add_f32 v40, v40, v42
	v_add_f32 v41, v41, v43
	ds_write_b64 v12, v[40:41]
	s_cmp_lg_u32 s56, 0
	s_cbranch_scc1 L_noann
	s_mov_b64 exec, 1
	s_nop 0
	buffer_store_byte v14, off, s[36:39], s2 sc1
	s_mov_b64 exec, -1
L_noann:
	s_waitcnt lgkmcnt(0)
	s_barrier
	s_cmp_lg_u32 s56, 3
	s_nop 0
	s_cbranch_scc1 L_prodwq
	ds_read_b64 v[48:49], v13 offset:0
	ds_read_b64 v[50:51], v13 offset:128
	ds_read_b64 v[52:53], v13 offset:256
	ds_read_b64 v[54:55], v13 offset:384
	v_mov_b32_e64 v41, s3
	s_lshl_b32 s60, s101, 7
	s_waitcnt lgkmcnt(0)
	v_pk_add_f32 v[48:49], v[48:49], v[50:51]
	v_pk_add_f32 v[52:53], v[52:53], v[54:55]
	v_pk_add_f32 v[48:49], v[48:49], v[52:53]
	v_cvt_pk_bf16_f32 v40, v48, v49
	s_mov_b64 exec, 0xffff
	buffer_store_dwordx2 v[40:41], v13, s[32:35], s60 offen sc1
	s_mov_b64 exec, -1
	s_nop 0
L_prodwq:
	buffer_load_dwordx4 v[32:35], v24, s[16:19], s63 offen
	buffer_load_dwordx4 v[36:39], v25, s[16:19], s63 offen
	buffer_load_dwordx4 v[40:43], v26, s[16:19], s63 offen
	buffer_load_dwordx4 v[44:47], v27, s[16:19], s63 offen
	buffer_load_dwordx4 v[48:51], v28, s[16:19], s63 offen
	buffer_load_dwordx4 v[52:55], v29, s[16:19], s63 offen
	buffer_load_dwordx4 v[56:59], v30, s[16:19], s63 offen
	buffer_load_dwordx4 v[60:63], v31, s[16:19], s63 offen
L_prodret:
	s_add_u32 s100, s63, 1048576
	s_and_b32 s100, s100, 0x3fffff
	s_lshl_b32 s101, s56, 11
	s_waitcnt vmcnt(15)
	s_xor_b32 s62, s62, 12288
	buffer_load_dwordx4 v[196:199], v19, s[4:7], s62 offen offset:0
	v_lshlrev_b32_e64 v128, 16, v132
	v_and_b32 v129, 0xffff0000, v132
	v_lshlrev_b32_e64 v130, 16, v133
	v_and_b32 v131, 0xffff0000, v133
	v_lshlrev_b32_e64 v132, 16, v134
	v_and_b32 v133, 0xffff0000, v134
	v_lshlrev_b32_e64 v134, 16, v135
	v_and_b32 v135, 0xffff0000, v135
	v_pk_add_f32 v[4:5], v[128:129], v[130:131]
	v_pk_mul_f32 v[6:7], v[128:129], v[128:129]
	v_pk_add_f32 v[4:5], v[4:5], v[132:133]
	v_pk_fma_f32 v[6:7], v[130:131], v[130:131], v[6:7]
	v_pk_add_f32 v[4:5], v[4:5], v[134:135]
	v_pk_fma_f32 v[6:7], v[132:133], v[132:133], v[6:7]
	v_add_f32_e64 v96, v4, v5
	v_pk_fma_f32 v[6:7], v[134:135], v[134:135], v[6:7]
	v_add_f32 v112, v6, v7
	s_waitcnt vmcnt(15)
	buffer_load_dwordx4 v[204:207], v19, s[4:7], s62 offen offset:1024
	v_lshlrev_b32_e64 v136, 16, v140
	v_and_b32 v137, 0xffff0000, v140
	v_lshlrev_b32_e64 v138, 16, v141
	v_and_b32 v139, 0xffff0000, v141
	v_lshlrev_b32_e64 v140, 16, v142
	v_and_b32 v141, 0xffff0000, v142
	v_lshlrev_b32_e64 v142, 16, v143
	v_and_b32 v143, 0xffff0000, v143
	v_pk_add_f32 v[20:21], v[136:137], v[138:139]
	v_pk_mul_f32 v[22:23], v[136:137], v[136:137]
	v_pk_add_f32 v[20:21], v[20:21], v[140:141]
	v_pk_fma_f32 v[22:23], v[138:139], v[138:139], v[22:23]
	v_pk_add_f32 v[20:21], v[20:21], v[142:143]
	v_pk_fma_f32 v[22:23], v[140:141], v[140:141], v[22:23]
	v_add_f32_e64 v97, v20, v21
	v_pk_fma_f32 v[22:23], v[142:143], v[142:143], v[22:23]
	v_add_f32 v113, v22, v23
	s_waitcnt vmcnt(15)
	buffer_load_dwordx4 v[212:215], v19, s[4:7], s62 offen offset:2048
	v_lshlrev_b32_e64 v144, 16, v148
	v_and_b32 v145, 0xffff0000, v148
	v_lshlrev_b32_e64 v146, 16, v149
	v_and_b32 v147, 0xffff0000, v149
	v_lshlrev_b32_e64 v148, 16, v150
	v_and_b32 v149, 0xffff0000, v150
	v_lshlrev_b32_e64 v150, 16, v151
	v_and_b32 v151, 0xffff0000, v151
	v_pk_add_f32 v[4:5], v[144:145], v[146:147]
	v_pk_mul_f32 v[6:7], v[144:145], v[144:145]
	v_pk_add_f32 v[4:5], v[4:5], v[148:149]
	v_pk_fma_f32 v[6:7], v[146:147], v[146:147], v[6:7]
	v_pk_add_f32 v[4:5], v[4:5], v[150:151]
	v_pk_fma_f32 v[6:7], v[148:149], v[148:149], v[6:7]
	v_add_f32_e64 v98, v4, v5
	v_pk_fma_f32 v[6:7], v[150:151], v[150:151], v[6:7]
	v_add_f32 v114, v6, v7
	s_waitcnt vmcnt(15)
	buffer_load_dwordx4 v[220:223], v19, s[4:7], s62 offen offset:3072
	v_lshlrev_b32_e64 v152, 16, v156
	v_and_b32 v153, 0xffff0000, v156
	v_lshlrev_b32_e64 v154, 16, v157
	v_and_b32 v155, 0xffff0000, v157
	v_lshlrev_b32_e64 v156, 16, v158
	v_and_b32 v157, 0xffff0000, v158
	v_lshlrev_b32_e64 v158, 16, v159
	v_and_b32 v159, 0xffff0000, v159
	v_pk_add_f32 v[20:21], v[152:153], v[154:155]
	v_pk_mul_f32 v[22:23], v[152:153], v[152:153]
	v_pk_add_f32 v[20:21], v[20:21], v[156:157]
	v_pk_fma_f32 v[22:23], v[154:155], v[154:155], v[22:23]
	v_pk_add_f32 v[20:21], v[20:21], v[158:159]
	v_pk_fma_f32 v[22:23], v[156:157], v[156:157], v[22:23]
	v_add_f32_e64 v99, v20, v21
	v_pk_fma_f32 v[22:23], v[158:159], v[158:159], v[22:23]
	v_add_f32 v115, v22, v23
	s_waitcnt vmcnt(15)
	s_xor_b32 s62, s62, 4096
	buffer_load_dwordx4 v[228:231], v19, s[4:7], s62 offen offset:0
	v_lshlrev_b32_e64 v160, 16, v164
	v_and_b32 v161, 0xffff0000, v164
	v_lshlrev_b32_e64 v162, 16, v165
	v_and_b32 v163, 0xffff0000, v165
	v_lshlrev_b32_e64 v164, 16, v166
	v_and_b32 v165, 0xffff0000, v166
	v_lshlrev_b32_e64 v166, 16, v167
	v_and_b32 v167, 0xffff0000, v167
	v_pk_add_f32 v[4:5], v[160:161], v[162:163]
	v_pk_mul_f32 v[6:7], v[160:161], v[160:161]
	v_pk_add_f32 v[4:5], v[4:5], v[164:165]
	v_pk_fma_f32 v[6:7], v[162:163], v[162:163], v[6:7]
	v_pk_add_f32 v[4:5], v[4:5], v[166:167]
	v_pk_fma_f32 v[6:7], v[164:165], v[164:165], v[6:7]
	v_add_f32_e64 v100, v4, v5
	v_pk_fma_f32 v[6:7], v[166:167], v[166:167], v[6:7]
	v_add_f32 v116, v6, v7
	s_waitcnt vmcnt(15)
	buffer_load_dwordx4 v[236:239], v19, s[4:7], s62 offen offset:1024
	v_lshlrev_b32_e64 v168, 16, v172
	v_and_b32 v169, 0xffff0000, v172
	v_lshlrev_b32_e64 v170, 16, v173
	v_and_b32 v171, 0xffff0000, v173
	v_lshlrev_b32_e64 v172, 16, v174
	v_and_b32 v173, 0xffff0000, v174
	v_lshlrev_b32_e64 v174, 16, v175
	v_and_b32 v175, 0xffff0000, v175
	v_pk_add_f32 v[20:21], v[168:169], v[170:171]
	v_pk_mul_f32 v[22:23], v[168:169], v[168:169]
	v_pk_add_f32 v[20:21], v[20:21], v[172:173]
	v_pk_fma_f32 v[22:23], v[170:171], v[170:171], v[22:23]
	v_pk_add_f32 v[20:21], v[20:21], v[174:175]
	v_pk_fma_f32 v[22:23], v[172:173], v[172:173], v[22:23]
	v_add_f32_e64 v101, v20, v21
	v_pk_fma_f32 v[22:23], v[174:175], v[174:175], v[22:23]
	v_add_f32 v117, v22, v23
	s_waitcnt vmcnt(15)
	buffer_load_dwordx4 v[244:247], v19, s[4:7], s62 offen offset:2048
	v_lshlrev_b32_e64 v176, 16, v180
	v_and_b32 v177, 0xffff0000, v180
	v_lshlrev_b32_e64 v178, 16, v181
	v_and_b32 v179, 0xffff0000, v181
	v_lshlrev_b32_e64 v180, 16, v182
	v_and_b32 v181, 0xffff0000, v182
	v_lshlrev_b32_e64 v182, 16, v183
	v_and_b32 v183, 0xffff0000, v183
	v_pk_add_f32 v[4:5], v[176:177], v[178:179]
	v_pk_mul_f32 v[6:7], v[176:177], v[176:177]
	v_pk_add_f32 v[4:5], v[4:5], v[180:181]
	v_pk_fma_f32 v[6:7], v[178:179], v[178:179], v[6:7]
	v_pk_add_f32 v[4:5], v[4:5], v[182:183]
	v_pk_fma_f32 v[6:7], v[180:181], v[180:181], v[6:7]
	v_add_f32_e64 v102, v4, v5
	v_pk_fma_f32 v[6:7], v[182:183], v[182:183], v[6:7]
	v_add_f32 v118, v6, v7
	s_waitcnt vmcnt(15)
	buffer_load_dwordx4 v[252:255], v19, s[4:7], s62 offen offset:3072
	v_lshlrev_b32_e64 v184, 16, v188
	v_and_b32 v185, 0xffff0000, v188
	v_lshlrev_b32_e64 v186, 16, v189
	v_and_b32 v187, 0xffff0000, v189
	v_lshlrev_b32_e64 v188, 16, v190
	v_and_b32 v189, 0xffff0000, v190
	v_lshlrev_b32_e64 v190, 16, v191
	v_and_b32 v191, 0xffff0000, v191
	v_pk_add_f32 v[20:21], v[184:185], v[186:187]
	v_pk_mul_f32 v[22:23], v[184:185], v[184:185]
	v_pk_add_f32 v[20:21], v[20:21], v[188:189]
	v_pk_fma_f32 v[22:23], v[186:187], v[186:187], v[22:23]
	v_pk_add_f32 v[20:21], v[20:21], v[190:191]
	v_pk_fma_f32 v[22:23], v[188:189], v[188:189], v[22:23]
	v_add_f32_e64 v103, v20, v21
	v_pk_fma_f32 v[22:23], v[190:191], v[190:191], v[22:23]
	v_add_f32 v119, v22, v23
	s_waitcnt vmcnt(7)
	v_lshlrev_b32_e64 v192, 16, v196
	v_and_b32 v193, 0xffff0000, v196
	v_lshlrev_b32_e64 v194, 16, v197
	v_and_b32 v195, 0xffff0000, v197
	v_lshlrev_b32_e64 v196, 16, v198
	v_and_b32 v197, 0xffff0000, v198
	v_lshlrev_b32_e64 v198, 16, v199
	v_and_b32 v199, 0xffff0000, v199
	v_pk_add_f32 v[4:5], v[192:193], v[194:195]
	v_pk_mul_f32 v[6:7], v[192:193], v[192:193]
	v_pk_add_f32 v[4:5], v[4:5], v[196:197]
	v_pk_fma_f32 v[6:7], v[194:195], v[194:195], v[6:7]
	v_pk_add_f32 v[4:5], v[4:5], v[198:199]
	v_pk_fma_f32 v[6:7], v[196:197], v[196:197], v[6:7]
	v_add_f32_e64 v104, v4, v5
	v_pk_fma_f32 v[6:7], v[198:199], v[198:199], v[6:7]
	v_add_f32_e64 v120, v6, v7
	s_add_u32 m0, s101, 65536
	s_nop 0
	s_nop 0
	buffer_load_dwordx4 v24, s[16:19], s100 offen lds
	s_waitcnt vmcnt(7)
	v_lshlrev_b32 v200, 16, v204
	v_and_b32 v201, 0xffff0000, v204
	v_lshlrev_b32_e64 v202, 16, v205
	v_and_b32 v203, 0xffff0000, v205
	v_lshlrev_b32_e64 v204, 16, v206
	v_and_b32 v205, 0xffff0000, v206
	v_lshlrev_b32_e64 v206, 16, v207
	v_and_b32 v207, 0xffff0000, v207
	v_pk_add_f32 v[20:21], v[200:201], v[202:203]
	v_pk_mul_f32 v[22:23], v[200:201], v[200:201]
	v_pk_add_f32 v[20:21], v[20:21], v[204:205]
	v_pk_fma_f32 v[22:23], v[202:203], v[202:203], v[22:23]
	v_pk_add_f32 v[20:21], v[20:21], v[206:207]
	v_pk_fma_f32 v[22:23], v[204:205], v[204:205], v[22:23]
	v_add_f32_e64 v105, v20, v21
	v_pk_fma_f32 v[22:23], v[206:207], v[206:207], v[22:23]
	v_add_f32_e64 v121, v22, v23
	s_add_u32 m0, s101, 66560
	s_nop 0
	s_nop 0
	buffer_load_dwordx4 v25, s[16:19], s100 offen lds
	s_waitcnt vmcnt(7)
	v_lshlrev_b32 v208, 16, v212
	v_and_b32 v209, 0xffff0000, v212
	v_lshlrev_b32_e64 v210, 16, v213
	v_and_b32 v211, 0xffff0000, v213
	v_lshlrev_b32_e64 v212, 16, v214
	v_and_b32 v213, 0xffff0000, v214
	v_lshlrev_b32_e64 v214, 16, v215
	v_and_b32 v215, 0xffff0000, v215
	v_pk_add_f32 v[4:5], v[208:209], v[210:211]
	v_pk_mul_f32 v[6:7], v[208:209], v[208:209]
	v_pk_add_f32 v[4:5], v[4:5], v[212:213]
	v_pk_fma_f32 v[6:7], v[210:211], v[210:211], v[6:7]
	v_pk_add_f32 v[4:5], v[4:5], v[214:215]
	v_pk_fma_f32 v[6:7], v[212:213], v[212:213], v[6:7]
	v_add_f32_e64 v106, v4, v5
	v_pk_fma_f32 v[6:7], v[214:215], v[214:215], v[6:7]
	v_add_f32_e64 v122, v6, v7
	s_add_u32 m0, s101, 73728
	s_nop 0
	s_nop 0
	buffer_load_dwordx4 v26, s[16:19], s100 offen lds
	s_waitcnt vmcnt(7)
	v_lshlrev_b32 v216, 16, v220
	v_and_b32 v217, 0xffff0000, v220
	v_lshlrev_b32_e64 v218, 16, v221
	v_and_b32 v219, 0xffff0000, v221
	v_lshlrev_b32_e64 v220, 16, v222
	v_and_b32 v221, 0xffff0000, v222
	v_lshlrev_b32_e64 v222, 16, v223
	v_and_b32 v223, 0xffff0000, v223
	v_pk_add_f32 v[20:21], v[216:217], v[218:219]
	v_pk_mul_f32 v[22:23], v[216:217], v[216:217]
	v_pk_add_f32 v[20:21], v[20:21], v[220:221]
	v_pk_fma_f32 v[22:23], v[218:219], v[218:219], v[22:23]
	v_pk_add_f32 v[20:21], v[20:21], v[222:223]
	v_pk_fma_f32 v[22:23], v[220:221], v[220:221], v[22:23]
	v_add_f32_e64 v107, v20, v21
	v_pk_fma_f32 v[22:23], v[222:223], v[222:223], v[22:23]
	v_add_f32_e64 v123, v22, v23
	s_add_u32 m0, s101, 74752
	s_nop 0
	s_nop 0
	buffer_load_dwordx4 v27, s[16:19], s100 offen lds
	s_waitcnt vmcnt(7)
	v_lshlrev_b32 v224, 16, v228
	v_and_b32 v225, 0xffff0000, v228
	v_lshlrev_b32_e64 v226, 16, v229
	v_and_b32 v227, 0xffff0000, v229
	v_lshlrev_b32_e64 v228, 16, v230
	v_and_b32 v229, 0xffff0000, v230
	v_lshlrev_b32_e64 v230, 16, v231
	v_and_b32 v231, 0xffff0000, v231
	v_pk_add_f32 v[4:5], v[224:225], v[226:227]
	v_pk_mul_f32 v[6:7], v[224:225], v[224:225]
	v_pk_add_f32 v[4:5], v[4:5], v[228:229]
	v_pk_fma_f32 v[6:7], v[226:227], v[226:227], v[6:7]
	v_pk_add_f32 v[4:5], v[4:5], v[230:231]
	v_pk_fma_f32 v[6:7], v[228:229], v[228:229], v[6:7]
	v_add_f32_e64 v108, v4, v5
	v_pk_fma_f32 v[6:7], v[230:231], v[230:231], v[6:7]
	v_add_f32_e64 v124, v6, v7
	s_add_u32 m0, s101, 81920
	s_nop 0
	s_nop 0
	buffer_load_dwordx4 v28, s[16:19], s100 offen lds
	s_waitcnt vmcnt(7)
	v_lshlrev_b32 v232, 16, v236
	v_and_b32 v233, 0xffff0000, v236
	v_lshlrev_b32_e64 v234, 16, v237
	v_and_b32 v235, 0xffff0000, v237
	v_lshlrev_b32_e64 v236, 16, v238
	v_and_b32 v237, 0xffff0000, v238
	v_lshlrev_b32_e64 v238, 16, v239
	v_and_b32 v239, 0xffff0000, v239
	v_pk_add_f32 v[20:21], v[232:233], v[234:235]
	v_pk_mul_f32 v[22:23], v[232:233], v[232:233]
	v_pk_add_f32 v[20:21], v[20:21], v[236:237]
	v_pk_fma_f32 v[22:23], v[234:235], v[234:235], v[22:23]
	v_pk_add_f32 v[20:21], v[20:21], v[238:239]
	v_pk_fma_f32 v[22:23], v[236:237], v[236:237], v[22:23]
	v_add_f32_e64 v109, v20, v21
	v_pk_fma_f32 v[22:23], v[238:239], v[238:239], v[22:23]
	v_add_f32_e64 v125, v22, v23
	s_add_u32 m0, s101, 82944
	s_nop 0
	s_nop 0
	buffer_load_dwordx4 v29, s[16:19], s100 offen lds
	s_waitcnt vmcnt(7)
	v_lshlrev_b32 v240, 16, v244
	v_and_b32 v241, 0xffff0000, v244
	v_lshlrev_b32_e64 v242, 16, v245
	v_and_b32 v243, 0xffff0000, v245
	v_lshlrev_b32_e64 v244, 16, v246
	v_and_b32 v245, 0xffff0000, v246
	v_lshlrev_b32_e64 v246, 16, v247
	v_and_b32 v247, 0xffff0000, v247
	v_pk_add_f32 v[4:5], v[240:241], v[242:243]
	v_pk_mul_f32 v[6:7], v[240:241], v[240:241]
	v_pk_add_f32 v[4:5], v[4:5], v[244:245]
	v_pk_fma_f32 v[6:7], v[242:243], v[242:243], v[6:7]
	v_pk_add_f32 v[4:5], v[4:5], v[246:247]
	v_pk_fma_f32 v[6:7], v[244:245], v[244:245], v[6:7]
	v_add_f32_e64 v110, v4, v5
	v_pk_fma_f32 v[6:7], v[246:247], v[246:247], v[6:7]
	v_add_f32_e64 v126, v6, v7
	s_add_u32 m0, s101, 90112
	s_nop 0
	s_nop 0
	buffer_load_dwordx4 v30, s[16:19], s100 offen lds
	s_waitcnt vmcnt(7)
	v_lshlrev_b32 v248, 16, v252
	v_and_b32 v249, 0xffff0000, v252
	v_lshlrev_b32_e64 v250, 16, v253
	v_and_b32 v251, 0xffff0000, v253
	v_lshlrev_b32_e64 v252, 16, v254
	v_and_b32 v253, 0xffff0000, v254
	v_lshlrev_b32_e64 v254, 16, v255
	v_and_b32 v255, 0xffff0000, v255
	v_pk_add_f32 v[20:21], v[248:249], v[250:251]
	v_pk_mul_f32 v[22:23], v[248:249], v[248:249]
	v_pk_add_f32 v[20:21], v[20:21], v[252:253]
	v_pk_fma_f32 v[22:23], v[250:251], v[250:251], v[22:23]
	v_pk_add_f32 v[20:21], v[20:21], v[254:255]
	v_pk_fma_f32 v[22:23], v[252:253], v[252:253], v[22:23]
	v_add_f32_e64 v111, v20, v21
	v_pk_fma_f32 v[22:23], v[254:255], v[254:255], v[22:23]
	v_add_f32_e64 v127, v22, v23
	s_add_u32 m0, s101, 91136
	s_nop 0
	s_nop 0
	buffer_load_dwordx4 v31, s[16:19], s100 offen lds
	s_add_u32 s100, s100, 262144
	s_and_b32 s100, s100, 0x3fffff
	s_lshl_b32 s62, s56, 12
	s_nop 0
	s_add_u32 s63, s63, 262144
	s_and_b32 s63, s63, 0x3fffff
	buffer_load_dwordx4 v[64:67], v24, s[16:19], s63 offen
	v_permlane32_swap_b32 v96, v104
	v_permlane32_swap_b32 v97, v105
	v_permlane32_swap_b32 v98, v106
	v_permlane32_swap_b32 v99, v107
	v_permlane32_swap_b32 v100, v108
	v_permlane32_swap_b32 v101, v109
	v_permlane32_swap_b32 v102, v110
	v_permlane32_swap_b32 v103, v111
	buffer_load_dwordx4 v[68:71], v25, s[16:19], s63 offen
	v_permlane32_swap_b32 v112, v120
	v_permlane32_swap_b32 v113, v121
	v_permlane32_swap_b32 v114, v122
	v_permlane32_swap_b32 v115, v123
	v_permlane32_swap_b32 v116, v124
	v_permlane32_swap_b32 v117, v125
	v_permlane32_swap_b32 v118, v126
	v_permlane32_swap_b32 v119, v127
	buffer_load_dwordx4 v[72:75], v26, s[16:19], s63 offen
	v_add_f32 v96, v96, v104
	v_add_f32 v97, v97, v105
	v_add_f32 v98, v98, v106
	v_add_f32 v99, v99, v107
	v_add_f32 v100, v100, v108
	v_add_f32 v101, v101, v109
	v_add_f32 v102, v102, v110
	v_add_f32 v103, v103, v111
	buffer_load_dwordx4 v[76:79], v27, s[16:19], s63 offen
	v_add_f32 v112, v112, v120
	v_add_f32 v113, v113, v121
	v_add_f32 v114, v114, v122
	v_add_f32 v115, v115, v123
	v_add_f32 v116, v116, v124
	v_add_f32 v117, v117, v125
	v_add_f32 v118, v118, v126
	v_add_f32 v119, v119, v127
	buffer_load_dwordx4 v[80:83], v28, s[16:19], s63 offen
	v_permlane16_swap_b32 v96, v100
	v_permlane16_swap_b32 v97, v101
	v_permlane16_swap_b32 v98, v102
	v_permlane16_swap_b32 v99, v103
	v_permlane16_swap_b32 v112, v116
	v_permlane16_swap_b32 v113, v117
	v_permlane16_swap_b32 v114, v118
	v_permlane16_swap_b32 v115, v119
	buffer_load_dwordx4 v[84:87], v29, s[16:19], s63 offen
	v_add_f32 v96, v96, v100
	v_add_f32 v97, v97, v101
	v_add_f32 v98, v98, v102
	v_add_f32 v99, v99, v103
	v_add_f32 v112, v112, v116
	v_add_f32 v113, v113, v117
	v_add_f32 v114, v114, v118
	v_add_f32 v115, v115, v119
	buffer_load_dwordx4 v[88:91], v30, s[16:19], s63 offen
	v_add_f32_dpp v96, v96, v96 row_ror:8 row_mask:0xf bank_mask:0xf
	v_add_f32_dpp v97, v97, v97 row_ror:8 row_mask:0xf bank_mask:0xf
	v_add_f32_dpp v98, v98, v98 row_ror:8 row_mask:0xf bank_mask:0xf
	v_add_f32_dpp v99, v99, v99 row_ror:8 row_mask:0xf bank_mask:0xf
	v_add_f32_dpp v112, v112, v112 row_ror:8 row_mask:0xf bank_mask:0xf
	v_add_f32_dpp v113, v113, v113 row_ror:8 row_mask:0xf bank_mask:0xf
	v_add_f32_dpp v114, v114, v114 row_ror:8 row_mask:0xf bank_mask:0xf
	v_add_f32_dpp v115, v115, v115 row_ror:8 row_mask:0xf bank_mask:0xf
	buffer_load_dwordx4 v[92:95], v31, s[16:19], s63 offen
	v_add_f32_dpp v96, v96, v96 row_ror:4 row_mask:0xf bank_mask:0xf
	v_add_f32_dpp v97, v97, v97 row_ror:4 row_mask:0xf bank_mask:0xf
	v_add_f32_dpp v98, v98, v98 row_ror:4 row_mask:0xf bank_mask:0xf
	v_add_f32_dpp v99, v99, v99 row_ror:4 row_mask:0xf bank_mask:0xf
	v_add_f32_dpp v112, v112, v112 row_ror:4 row_mask:0xf bank_mask:0xf
	v_add_f32_dpp v113, v113, v113 row_ror:4 row_mask:0xf bank_mask:0xf
	v_add_f32_dpp v114, v114, v114 row_ror:4 row_mask:0xf bank_mask:0xf
	v_add_f32_dpp v115, v115, v115 row_ror:4 row_mask:0xf bank_mask:0xf
	s_add_u32 m0, s101, 98304
	s_nop 0
	s_nop 0
	buffer_load_dwordx4 v24, s[16:19], s100 offen lds
	v_add_f32_dpp v96, v96, v96 row_ror:2 row_mask:0xf bank_mask:0xf
	v_add_f32_dpp v97, v97, v97 row_ror:2 row_mask:0xf bank_mask:0xf
	v_add_f32_dpp v98, v98, v98 row_ror:2 row_mask:0xf bank_mask:0xf
	v_add_f32_dpp v99, v99, v99 row_ror:2 row_mask:0xf bank_mask:0xf
	v_add_f32_dpp v112, v112, v112 row_ror:2 row_mask:0xf bank_mask:0xf
	v_add_f32_dpp v113, v113, v113 row_ror:2 row_mask:0xf bank_mask:0xf
	v_add_f32_dpp v114, v114, v114 row_ror:2 row_mask:0xf bank_mask:0xf
	v_add_f32_dpp v115, v115, v115 row_ror:2 row_mask:0xf bank_mask:0xf
	s_add_u32 m0, s101, 99328
	s_nop 0
	s_nop 0
	buffer_load_dwordx4 v25, s[16:19], s100 offen lds
	v_add_f32_dpp v96, v96, v96 row_ror:1 row_mask:0xf bank_mask:0xf
	v_add_f32_dpp v97, v97, v97 row_ror:1 row_mask:0xf bank_mask:0xf
	v_add_f32_dpp v98, v98, v98 row_ror:1 row_mask:0xf bank_mask:0xf
	v_add_f32_dpp v99, v99, v99 row_ror:1 row_mask:0xf bank_mask:0xf
	v_add_f32_dpp v112, v112, v112 row_ror:1 row_mask:0xf bank_mask:0xf
	v_add_f32_dpp v113, v113, v113 row_ror:1 row_mask:0xf bank_mask:0xf
	v_add_f32_dpp v114, v114, v114 row_ror:1 row_mask:0xf bank_mask:0xf
	v_add_f32_dpp v115, v115, v115 row_ror:1 row_mask:0xf bank_mask:0xf
	s_add_u32 m0, s101, 106496
	s_nop 0
	s_nop 0
	buffer_load_dwordx4 v26, s[16:19], s100 offen lds
	v_mul_f32 v96, 0x3b000000, v96
	v_mul_f32 v97, 0x3b000000, v97
	v_mul_f32 v98, 0x3b000000, v98
	v_mul_f32 v99, 0x3b000000, v99
	v_mul_f32 v100, v96, v96
	v_mul_f32 v101, v97, v97
	v_mul_f32 v102, v98, v98
	v_mul_f32 v103, v99, v99
	s_add_u32 m0, s101, 107520
	s_nop 0
	s_nop 0
	buffer_load_dwordx4 v27, s[16:19], s100 offen lds
	s_mov_b32 s60, 0x3b000000
	v_fma_f32 v100, v112, s60, -v100
	v_fma_f32 v101, v113, s60, -v101
	v_fma_f32 v102, v114, s60, -v102
	v_fma_f32 v103, v115, s60, -v103
	v_max_f32 v100, 0, v100
	v_max_f32 v101, 0, v101
	v_max_f32_e64 v102, 0, v102
	s_add_u32 m0, s101, 114688
	s_nop 0
	s_nop 0
	buffer_load_dwordx4 v28, s[16:19], s100 offen lds
	v_max_f32_e64 v103, 0, v103
	v_add_f32 v100, 0x3727c5ac, v100
	v_add_f32 v101, 0x3727c5ac, v101
	v_add_f32 v102, 0x3727c5ac, v102
	v_add_f32 v103, 0x3727c5ac, v103
	v_rsq_f32 v100, v100
	v_rsq_f32 v101, v101
	v_rsq_f32_e64 v102, v102
	s_add_u32 m0, s101, 115712
	s_nop 0
	s_nop 0
	buffer_load_dwordx4 v29, s[16:19], s100 offen lds
	v_rsq_f32_e64 v103, v103
	v_mul_f32 v96, -v96, v100
	v_mul_f32 v97, -v97, v101
	v_mul_f32 v98, -v98, v102
	v_mul_f32 v99, -v99, v103
	v_readlane_b32 s64, v100, 0
	v_readlane_b32 s65, v96, 0
	v_readlane_b32 s66, v101, 0
	s_add_u32 m0, s101, 122880
	s_nop 0
	s_nop 0
	buffer_load_dwordx4 v30, s[16:19], s100 offen lds
	v_readlane_b32 s67, v97, 0
	v_readlane_b32 s68, v102, 0
	v_readlane_b32 s69, v98, 0
	v_readlane_b32 s70, v103, 0
	v_readlane_b32 s71, v99, 0
	v_readlane_b32 s72, v100, 16
	v_readlane_b32 s73, v96, 16
	v_readlane_b32 s74, v101, 16
	s_add_u32 m0, s101, 123904
	s_nop 0
	s_nop 0
	buffer_load_dwordx4 v31, s[16:19], s100 offen lds
	v_readlane_b32 s75, v97, 16
	v_readlane_b32 s76, v102, 16
	v_readlane_b32 s77, v98, 16
	v_readlane_b32 s78, v103, 16
	v_readlane_b32 s79, v99, 16
	v_readlane_b32 s80, v100, 32
	v_readlane_b32 s81, v96, 32
	v_readlane_b32 s82, v101, 32
	v_readlane_b32 s83, v97, 32
	v_readlane_b32 s84, v102, 32
	v_readlane_b32 s85, v98, 32
	v_readlane_b32 s86, v103, 32
	v_readlane_b32 s87, v99, 32
	v_readlane_b32 s88, v100, 48
	v_readlane_b32 s89, v96, 48
	v_readlane_b32 s90, v101, 48
	v_readlane_b32 s91, v97, 48
	v_readlane_b32 s92, v102, 48
	v_readlane_b32 s93, v98, 48
	v_readlane_b32 s94, v103, 48
	v_readlane_b32 s95, v99, 48
	v_lshlrev_b32_e64 v1, 4, v0
	v_and_b32 v3, 0xe0, v0
	v_bfe_u32 v4, v0, 3, 2
	v_lshl_or_b32 v3, v4, 1, v3
	v_or_b32_e64 v3, 1, v3
	buffer_load_dwordx4 v[4:7], v1, s[32:35], 0 offen sc1
	buffer_load_ubyte v8, v3, s[36:39], 0 offen sc1
	s_add_u32 s100, s100, 262144
	s_and_b32 s100, s100, 0x3fffff
	s_add_u32 m0, s62, 131072
	s_nop 0
	s_nop 0
	buffer_load_dwordx4 v24, s[16:19], s100 offen lds
	v_pk_fma_f32 v[128:129], v[128:129], s[64:65], s[64:65] op_sel:[0,0,1] op_sel_hi:[1,0,1]
	v_pk_fma_f32 v[130:131], v[130:131], s[64:65], s[64:65] op_sel:[0,0,1] op_sel_hi:[1,0,1]
	v_pk_fma_f32 v[132:133], v[132:133], s[64:65], s[64:65] op_sel:[0,0,1] op_sel_hi:[1,0,1]
	v_pk_fma_f32 v[134:135], v[134:135], s[64:65], s[64:65] op_sel:[0,0,1] op_sel_hi:[1,0,1]
	v_pk_fma_f32 v[136:137], v[136:137], s[66:67], s[66:67] op_sel:[0,0,1] op_sel_hi:[1,0,1]
	v_pk_fma_f32 v[138:139], v[138:139], s[66:67], s[66:67] op_sel:[0,0,1] op_sel_hi:[1,0,1]
	v_pk_fma_f32 v[140:141], v[140:141], s[66:67], s[66:67] op_sel:[0,0,1] op_sel_hi:[1,0,1]
	v_pk_fma_f32 v[142:143], v[142:143], s[66:67], s[66:67] op_sel:[0,0,1] op_sel_hi:[1,0,1]
	s_add_u32 m0, s62, 132096
	s_nop 0
	s_nop 0
	buffer_load_dwordx4 v25, s[16:19], s100 offen lds
	v_pk_fma_f32 v[144:145], v[144:145], s[68:69], s[68:69] op_sel:[0,0,1] op_sel_hi:[1,0,1]
	v_pk_fma_f32 v[146:147], v[146:147], s[68:69], s[68:69] op_sel:[0,0,1] op_sel_hi:[1,0,1]
	v_pk_fma_f32 v[148:149], v[148:149], s[68:69], s[68:69] op_sel:[0,0,1] op_sel_hi:[1,0,1]
	v_pk_fma_f32 v[150:151], v[150:151], s[68:69], s[68:69] op_sel:[0,0,1] op_sel_hi:[1,0,1]
	v_pk_fma_f32 v[152:153], v[152:153], s[70:71], s[70:71] op_sel:[0,0,1] op_sel_hi:[1,0,1]
	v_pk_fma_f32 v[154:155], v[154:155], s[70:71], s[70:71] op_sel:[0,0,1] op_sel_hi:[1,0,1]
	v_pk_fma_f32 v[156:157], v[156:157], s[70:71], s[70:71] op_sel:[0,0,1] op_sel_hi:[1,0,1]
	v_pk_fma_f32 v[158:159], v[158:159], s[70:71], s[70:71] op_sel:[0,0,1] op_sel_hi:[1,0,1]
	s_add_u32 m0, s62, 133120
	s_nop 0
	s_nop 0
	buffer_load_dwordx4 v26, s[16:19], s100 offen lds
	v_pk_fma_f32 v[160:161], v[160:161], s[72:73], s[72:73] op_sel:[0,0,1] op_sel_hi:[1,0,1]
	v_pk_fma_f32 v[162:163], v[162:163], s[72:73], s[72:73] op_sel:[0,0,1] op_sel_hi:[1,0,1]
	v_pk_fma_f32 v[164:165], v[164:165], s[72:73], s[72:73] op_sel:[0,0,1] op_sel_hi:[1,0,1]
	v_pk_fma_f32 v[166:167], v[166:167], s[72:73], s[72:73] op_sel:[0,0,1] op_sel_hi:[1,0,1]
	v_pk_fma_f32 v[168:169], v[168:169], s[74:75], s[74:75] op_sel:[0,0,1] op_sel_hi:[1,0,1]
	v_pk_fma_f32 v[170:171], v[170:171], s[74:75], s[74:75] op_sel:[0,0,1] op_sel_hi:[1,0,1]
	v_pk_fma_f32 v[172:173], v[172:173], s[74:75], s[74:75] op_sel:[0,0,1] op_sel_hi:[1,0,1]
	v_pk_fma_f32 v[174:175], v[174:175], s[74:75], s[74:75] op_sel:[0,0,1] op_sel_hi:[1,0,1]
	s_add_u32 m0, s62, 134144
	s_nop 0
	s_nop 0
	buffer_load_dwordx4 v27, s[16:19], s100 offen lds
	v_pk_fma_f32 v[176:177], v[176:177], s[76:77], s[76:77] op_sel:[0,0,1] op_sel_hi:[1,0,1]
	v_pk_fma_f32 v[178:179], v[178:179], s[76:77], s[76:77] op_sel:[0,0,1] op_sel_hi:[1,0,1]
	v_pk_fma_f32 v[180:181], v[180:181], s[76:77], s[76:77] op_sel:[0,0,1] op_sel_hi:[1,0,1]
	v_pk_fma_f32 v[182:183], v[182:183], s[76:77], s[76:77] op_sel:[0,0,1] op_sel_hi:[1,0,1]
	v_pk_fma_f32 v[184:185], v[184:185], s[78:79], s[78:79] op_sel:[0,0,1] op_sel_hi:[1,0,1]
	v_pk_fma_f32 v[186:187], v[186:187], s[78:79], s[78:79] op_sel:[0,0,1] op_sel_hi:[1,0,1]
	v_pk_fma_f32 v[188:189], v[188:189], s[78:79], s[78:79] op_sel:[0,0,1] op_sel_hi:[1,0,1]
	v_pk_fma_f32 v[190:191], v[190:191], s[78:79], s[78:79] op_sel:[0,0,1] op_sel_hi:[1,0,1]
	s_add_u32 m0, s62, 147456
	s_nop 0
	s_nop 0
	buffer_load_dwordx4 v28, s[16:19], s100 offen lds
	v_pk_fma_f32 v[192:193], v[192:193], s[80:81], s[80:81] op_sel:[0,0,1] op_sel_hi:[1,0,1]
	v_pk_fma_f32 v[194:195], v[194:195], s[80:81], s[80:81] op_sel:[0,0,1] op_sel_hi:[1,0,1]
	v_pk_fma_f32 v[196:197], v[196:197], s[80:81], s[80:81] op_sel:[0,0,1] op_sel_hi:[1,0,1]
	v_pk_fma_f32 v[198:199], v[198:199], s[80:81], s[80:81] op_sel:[0,0,1] op_sel_hi:[1,0,1]
	v_pk_fma_f32 v[200:201], v[200:201], s[82:83], s[82:83] op_sel:[0,0,1] op_sel_hi:[1,0,1]
	v_pk_fma_f32 v[202:203], v[202:203], s[82:83], s[82:83] op_sel:[0,0,1] op_sel_hi:[1,0,1]
	v_pk_fma_f32 v[204:205], v[204:205], s[82:83], s[82:83] op_sel:[0,0,1] op_sel_hi:[1,0,1]
	v_pk_fma_f32 v[206:207], v[206:207], s[82:83], s[82:83] op_sel:[0,0,1] op_sel_hi:[1,0,1]
	s_add_u32 m0, s62, 148480
	s_nop 0
	s_nop 0
	buffer_load_dwordx4 v29, s[16:19], s100 offen lds
	v_pk_fma_f32 v[208:209], v[208:209], s[84:85], s[84:85] op_sel:[0,0,1] op_sel_hi:[1,0,1]
	v_pk_fma_f32 v[210:211], v[210:211], s[84:85], s[84:85] op_sel:[0,0,1] op_sel_hi:[1,0,1]
	v_pk_fma_f32 v[212:213], v[212:213], s[84:85], s[84:85] op_sel:[0,0,1] op_sel_hi:[1,0,1]
	v_pk_fma_f32 v[214:215], v[214:215], s[84:85], s[84:85] op_sel:[0,0,1] op_sel_hi:[1,0,1]
	v_pk_fma_f32 v[216:217], v[216:217], s[86:87], s[86:87] op_sel:[0,0,1] op_sel_hi:[1,0,1]
	v_pk_fma_f32 v[218:219], v[218:219], s[86:87], s[86:87] op_sel:[0,0,1] op_sel_hi:[1,0,1]
	v_pk_fma_f32 v[220:221], v[220:221], s[86:87], s[86:87] op_sel:[0,0,1] op_sel_hi:[1,0,1]
	v_pk_fma_f32 v[222:223], v[222:223], s[86:87], s[86:87] op_sel:[0,0,1] op_sel_hi:[1,0,1]
	s_add_u32 m0, s62, 149504
	s_nop 0
	s_nop 0
	buffer_load_dwordx4 v30, s[16:19], s100 offen lds
	v_pk_fma_f32 v[224:225], v[224:225], s[88:89], s[88:89] op_sel:[0,0,1] op_sel_hi:[1,0,1]
	v_pk_fma_f32 v[226:227], v[226:227], s[88:89], s[88:89] op_sel:[0,0,1] op_sel_hi:[1,0,1]
	v_pk_fma_f32 v[228:229], v[228:229], s[88:89], s[88:89] op_sel:[0,0,1] op_sel_hi:[1,0,1]
	v_pk_fma_f32 v[230:231], v[230:231], s[88:89], s[88:89] op_sel:[0,0,1] op_sel_hi:[1,0,1]
	v_pk_fma_f32 v[232:233], v[232:233], s[90:91], s[90:91] op_sel:[0,0,1] op_sel_hi:[1,0,1]
	v_pk_fma_f32 v[234:235], v[234:235], s[90:91], s[90:91] op_sel:[0,0,1] op_sel_hi:[1,0,1]
	v_pk_fma_f32 v[236:237], v[236:237], s[90:91], s[90:91] op_sel:[0,0,1] op_sel_hi:[1,0,1]
	v_pk_fma_f32 v[238:239], v[238:239], s[90:91], s[90:91] op_sel:[0,0,1] op_sel_hi:[1,0,1]
	s_add_u32 m0, s62, 150528
	s_nop 0
	s_nop 0
	buffer_load_dwordx4 v31, s[16:19], s100 offen lds
	v_pk_fma_f32 v[240:241], v[240:241], s[92:93], s[92:93] op_sel:[0,0,1] op_sel_hi:[1,0,1]
	v_pk_fma_f32 v[242:243], v[242:243], s[92:93], s[92:93] op_sel:[0,0,1] op_sel_hi:[1,0,1]
	v_pk_fma_f32 v[244:245], v[244:245], s[92:93], s[92:93] op_sel:[0,0,1] op_sel_hi:[1,0,1]
	v_pk_fma_f32 v[246:247], v[246:247], s[92:93], s[92:93] op_sel:[0,0,1] op_sel_hi:[1,0,1]
	v_pk_fma_f32 v[248:249], v[248:249], s[94:95], s[94:95] op_sel:[0,0,1] op_sel_hi:[1,0,1]
	v_pk_fma_f32 v[250:251], v[250:251], s[94:95], s[94:95] op_sel:[0,0,1] op_sel_hi:[1,0,1]
	v_pk_fma_f32 v[252:253], v[252:253], s[94:95], s[94:95] op_sel:[0,0,1] op_sel_hi:[1,0,1]
	v_pk_fma_f32 v[254:255], v[254:255], s[94:95], s[94:95] op_sel:[0,0,1] op_sel_hi:[1,0,1]
	v_lshrrev_b32 v23, 2, v2
	v_subrev_u32 v23, s59, v23
	v_and_b32 v23, 15, v23
	v_and_b32 v22, 1, v23
	v_lshlrev_b32_e64 v23, 12, v23
	v_lshl_or_b32 v23, v22, 6, v23
	v_and_b32_e64 v22, 3, v2
	v_lshl_or_b32 v23, v22, 8, v23
	v_lshl_or_b32 v23, v22, 4, v23
	s_lshl_b32 s60, s56, 3
	s_and_b32 s61, s57, 1
	s_or_b32 s60, s60, s61
	s_lshl_b32 s60, s60, 7
	v_or_b32 v23, s60, v23
	v_add_u32 v21, s62, v19
	v_lshrrev_b32 v20, 5, v2
	v_and_b32 v22, 31, v2
	v_lshlrev_b32_e64 v20, 12, v20
	v_lshl_or_b32 v20, v22, 5, v20
	s_lshl_b32 s60, s56, 10
	v_add_u32 v20, s60, v20
	s_mov_b32 s100, 32768
	s_cmp_ge_u32 s56, 2
	s_cselect_b32 s62, 1.0, 0
	s_mov_b32 s64, s63
	s_waitcnt vmcnt(8)
	v_and_b32 v8, 31, v8
	v_cmp_ne_u32 vcc, v5, v8
	v_cmp_ne_u32 s[60:61], v7, v8
	v_cmp_eq_u32 s[78:79], 0, v8
	s_nop 1
	s_or_b64 vcc, vcc, s[60:61]
	s_or_b64 vcc, vcc, s[78:79]
	s_cbranch_vccz L_polld
L_poll:
	buffer_load_dwordx4 v[4:7], v1, s[32:35], 0 offen sc1
	buffer_load_ubyte v8, v3, s[36:39], 0 offen sc1
	s_waitcnt vmcnt(0)
	v_and_b32 v8, 31, v8
	v_cmp_ne_u32_e64 vcc, v5, v8
	v_cmp_ne_u32 s[60:61], v7, v8
	v_cmp_eq_u32 s[78:79], 0, v8
	s_nop 1
	s_or_b64 vcc, vcc, s[60:61]
	s_or_b64 vcc, vcc, s[78:79]
	s_cbranch_vccz L_polld
	s_sub_u32 s100, s100, 1
	s_cmp_lg_u32 s100, 0
	s_cbranch_scc1 L_poll
L_polld:
	v_lshlrev_b32 v8, 16, v4
	v_and_b32 v9, 0xffff0000, v4
	v_lshlrev_b32_e64 v10, 16, v6
	v_and_b32 v11, 0xffff0000, v6
	v_add_f32 v8, s62, v8
	v_add_f32 v9, s62, v9
	v_add_f32 v10, s62, v10
	v_add_f32 v11, s62, v11
	v_cvt_pk_bf16_f32 v4, v8, v9
	v_cvt_pk_bf16_f32 v6, v10, v11
	v_lshlrev_b32_e64 v8, 16, v4
	v_and_b32 v9, 0xffff0000, v4
	v_lshlrev_b32_e64 v10, 16, v6
	v_and_b32 v11, 0xffff0000, v6
	v_mul_f32 v8, 0x3e0293ee, v8
	v_mul_f32 v9, 0x3e0293ee, v9
	v_mul_f32 v10, 0x3e0293ee, v10
	v_mul_f32 v11, 0x3e0293ee, v11
	ds_write_b128 v21, v[8:11] offset:0
	ds_write_b128 v21, v[8:11] offset:1024
	ds_write_b128 v21, v[8:11] offset:2048
	ds_write_b128 v21, v[8:11] offset:3072
	s_waitcnt lgkmcnt(0)
	s_barrier
	ds_read_b128 v[4:7], v20
	ds_read_b128 v[12:15], v20 offset:8192
	ds_read_b128 v[8:11], v20 offset:16
	ds_read_b128 v[16:19], v20 offset:8208
	s_waitcnt lgkmcnt(0)
	s_nop 0
	s_add_u32 s64, s64, 262144
	s_and_b32 s64, s64, 0x3fffff
	v_pk_fma_f32 v[128:129], v[128:129], v[12:13], v[4:5]
	v_pk_fma_f32 v[130:131], v[130:131], v[14:15], v[6:7]
	v_pk_fma_f32 v[132:133], v[132:133], v[16:17], v[8:9]
	v_pk_fma_f32 v[134:135], v[134:135], v[18:19], v[10:11]
	buffer_load_dwordx4 v[96:99], v24, s[16:19], s64 offen
	v_cvt_pk_bf16_f32 v128, v128, v129
	v_cvt_pk_bf16_f32 v129, v130, v131
	v_cvt_pk_bf16_f32 v130, v132, v133
	v_cvt_pk_bf16_f32 v131, v134, v135
	v_pk_fma_f32 v[136:137], v[136:137], v[12:13], v[4:5]
	v_pk_fma_f32 v[138:139], v[138:139], v[14:15], v[6:7]
	v_pk_fma_f32 v[140:141], v[140:141], v[16:17], v[8:9]
	v_pk_fma_f32 v[142:143], v[142:143], v[18:19], v[10:11]
	ds_write_b128 v23, v[128:131]
	buffer_load_dwordx4 v[100:103], v25, s[16:19], s64 offen
	v_xor_b32_e64 v21, 16, v23
	v_cvt_pk_bf16_f32 v136, v136, v137
	v_cvt_pk_bf16_f32 v137, v138, v139
	v_cvt_pk_bf16_f32 v138, v140, v141
	v_cvt_pk_bf16_f32 v139, v142, v143
	v_pk_fma_f32 v[144:145], v[144:145], v[12:13], v[4:5]
	v_pk_fma_f32 v[146:147], v[146:147], v[14:15], v[6:7]
	v_pk_fma_f32 v[148:149], v[148:149], v[16:17], v[8:9]
	v_pk_fma_f32 v[150:151], v[150:151], v[18:19], v[10:11]
	ds_write_b128 v21, v[136:139]
	buffer_load_dwordx4 v[104:107], v26, s[16:19], s64 offen
	v_xor_b32_e64 v20, 32, v23
	v_cvt_pk_bf16_f32 v144, v144, v145
	v_cvt_pk_bf16_f32 v145, v146, v147
	v_cvt_pk_bf16_f32 v146, v148, v149
	v_cvt_pk_bf16_f32 v147, v150, v151
	v_pk_fma_f32 v[152:153], v[152:153], v[12:13], v[4:5]
	v_pk_fma_f32 v[154:155], v[154:155], v[14:15], v[6:7]
	v_pk_fma_f32 v[156:157], v[156:157], v[16:17], v[8:9]
	v_pk_fma_f32 v[158:159], v[158:159], v[18:19], v[10:11]
	ds_write_b128 v20, v[144:147]
	buffer_load_dwordx4 v[108:111], v27, s[16:19], s64 offen
	v_xor_b32_e64 v21, 48, v23
	v_cvt_pk_bf16_f32 v152, v152, v153
	v_cvt_pk_bf16_f32 v153, v154, v155
	v_cvt_pk_bf16_f32 v154, v156, v157
	v_cvt_pk_bf16_f32 v155, v158, v159
	v_pk_fma_f32 v[160:161], v[160:161], v[12:13], v[4:5]
	v_pk_fma_f32 v[162:163], v[162:163], v[14:15], v[6:7]
	v_pk_fma_f32 v[164:165], v[164:165], v[16:17], v[8:9]
	v_pk_fma_f32 v[166:167], v[166:167], v[18:19], v[10:11]
	ds_write_b128 v21, v[152:155]
	buffer_load_dwordx4 v[112:115], v28, s[16:19], s64 offen
	v_xor_b32_e64 v20, 64, v23
	v_cvt_pk_bf16_f32 v160, v160, v161
	v_cvt_pk_bf16_f32 v161, v162, v163
	v_cvt_pk_bf16_f32 v162, v164, v165
	v_cvt_pk_bf16_f32 v163, v166, v167
	v_pk_fma_f32 v[168:169], v[168:169], v[12:13], v[4:5]
	v_pk_fma_f32 v[170:171], v[170:171], v[14:15], v[6:7]
	v_pk_fma_f32 v[172:173], v[172:173], v[16:17], v[8:9]
	v_pk_fma_f32 v[174:175], v[174:175], v[18:19], v[10:11]
	ds_write_b128 v20, v[160:163]
	buffer_load_dwordx4 v[116:119], v29, s[16:19], s64 offen
	v_xor_b32 v21, 80, v23
	v_cvt_pk_bf16_f32 v168, v168, v169
	v_cvt_pk_bf16_f32 v169, v170, v171
	v_cvt_pk_bf16_f32 v170, v172, v173
	v_cvt_pk_bf16_f32 v171, v174, v175
	v_pk_fma_f32 v[176:177], v[176:177], v[12:13], v[4:5]
	v_pk_fma_f32 v[178:179], v[178:179], v[14:15], v[6:7]
	v_pk_fma_f32 v[180:181], v[180:181], v[16:17], v[8:9]
	v_pk_fma_f32 v[182:183], v[182:183], v[18:19], v[10:11]
	ds_write_b128 v21, v[168:171]
	buffer_load_dwordx4 v[120:123], v30, s[16:19], s64 offen
	v_xor_b32 v20, 96, v23
	v_cvt_pk_bf16_f32 v176, v176, v177
	v_cvt_pk_bf16_f32 v177, v178, v179
	v_cvt_pk_bf16_f32 v178, v180, v181
	v_cvt_pk_bf16_f32 v179, v182, v183
	v_pk_fma_f32 v[184:185], v[184:185], v[12:13], v[4:5]
	v_pk_fma_f32 v[186:187], v[186:187], v[14:15], v[6:7]
	v_pk_fma_f32 v[188:189], v[188:189], v[16:17], v[8:9]
	v_pk_fma_f32 v[190:191], v[190:191], v[18:19], v[10:11]
	ds_write_b128 v20, v[176:179]
	buffer_load_dwordx4 v[124:127], v31, s[16:19], s64 offen
	v_xor_b32 v21, 112, v23
	v_cvt_pk_bf16_f32 v184, v184, v185
	v_cvt_pk_bf16_f32 v185, v186, v187
	v_cvt_pk_bf16_f32 v186, v188, v189
	v_cvt_pk_bf16_f32 v187, v190, v191
	v_pk_fma_f32 v[192:193], v[192:193], v[12:13], v[4:5]
	v_pk_fma_f32 v[194:195], v[194:195], v[14:15], v[6:7]
	v_pk_fma_f32 v[196:197], v[196:197], v[16:17], v[8:9]
	v_pk_fma_f32 v[198:199], v[198:199], v[18:19], v[10:11]
	s_waitcnt lgkmcnt(3)
	s_nop 0
	s_add_u32 s64, s64, 262144
	s_and_b32 s64, s64, 0x3fffff
	ds_write_b128 v21, v[184:187]
	buffer_load_dwordx4 v[128:131], v24, s[16:19], s64 offen
	v_xor_b32 v20, 128, v23
	v_cvt_pk_bf16_f32 v192, v192, v193
	v_cvt_pk_bf16_f32 v193, v194, v195
	v_cvt_pk_bf16_f32 v194, v196, v197
	v_cvt_pk_bf16_f32 v195, v198, v199
	v_pk_fma_f32 v[200:201], v[200:201], v[12:13], v[4:5]
	v_pk_fma_f32 v[202:203], v[202:203], v[14:15], v[6:7]
	v_pk_fma_f32 v[204:205], v[204:205], v[16:17], v[8:9]
	v_pk_fma_f32 v[206:207], v[206:207], v[18:19], v[10:11]
	ds_write_b128 v20, v[192:195]
	buffer_load_dwordx4 v[132:135], v25, s[16:19], s64 offen
	v_xor_b32 v21, 144, v23
	v_cvt_pk_bf16_f32 v200, v200, v201
	v_cvt_pk_bf16_f32 v201, v202, v203
	v_cvt_pk_bf16_f32 v202, v204, v205
	v_cvt_pk_bf16_f32 v203, v206, v207
	v_pk_fma_f32 v[208:209], v[208:209], v[12:13], v[4:5]
	v_pk_fma_f32 v[210:211], v[210:211], v[14:15], v[6:7]
	v_pk_fma_f32 v[212:213], v[212:213], v[16:17], v[8:9]
	v_pk_fma_f32 v[214:215], v[214:215], v[18:19], v[10:11]
	ds_write_b128 v21, v[200:203]
	buffer_load_dwordx4 v[136:139], v26, s[16:19], s64 offen
	v_xor_b32 v20, 160, v23
	v_cvt_pk_bf16_f32 v208, v208, v209
	v_cvt_pk_bf16_f32 v209, v210, v211
	v_cvt_pk_bf16_f32 v210, v212, v213
	v_cvt_pk_bf16_f32 v211, v214, v215
	v_pk_fma_f32 v[216:217], v[216:217], v[12:13], v[4:5]
	v_pk_fma_f32 v[218:219], v[218:219], v[14:15], v[6:7]
	v_pk_fma_f32 v[220:221], v[220:221], v[16:17], v[8:9]
	v_pk_fma_f32 v[222:223], v[222:223], v[18:19], v[10:11]
	ds_write_b128 v20, v[208:211]
	buffer_load_dwordx4 v[140:143], v27, s[16:19], s64 offen
	v_xor_b32 v21, 176, v23
	v_cvt_pk_bf16_f32 v216, v216, v217
	v_cvt_pk_bf16_f32 v217, v218, v219
	v_cvt_pk_bf16_f32 v218, v220, v221
	v_cvt_pk_bf16_f32 v219, v222, v223
	v_pk_fma_f32 v[224:225], v[224:225], v[12:13], v[4:5]
	v_pk_fma_f32 v[226:227], v[226:227], v[14:15], v[6:7]
	v_pk_fma_f32 v[228:229], v[228:229], v[16:17], v[8:9]
	v_pk_fma_f32 v[230:231], v[230:231], v[18:19], v[10:11]
	ds_write_b128 v21, v[216:219]
	buffer_load_dwordx4 v[144:147], v28, s[16:19], s64 offen
	v_xor_b32 v20, 192, v23
	v_cvt_pk_bf16_f32 v224, v224, v225
	v_cvt_pk_bf16_f32 v225, v226, v227
	v_cvt_pk_bf16_f32 v226, v228, v229
	v_cvt_pk_bf16_f32 v227, v230, v231
	v_pk_fma_f32 v[232:233], v[232:233], v[12:13], v[4:5]
	v_pk_fma_f32 v[234:235], v[234:235], v[14:15], v[6:7]
	v_pk_fma_f32 v[236:237], v[236:237], v[16:17], v[8:9]
	v_pk_fma_f32 v[238:239], v[238:239], v[18:19], v[10:11]
	ds_write_b128 v20, v[224:227]
	buffer_load_dwordx4 v[148:151], v29, s[16:19], s64 offen
	v_xor_b32 v21, 208, v23
	v_cvt_pk_bf16_f32 v232, v232, v233
	v_cvt_pk_bf16_f32 v233, v234, v235
	v_cvt_pk_bf16_f32 v234, v236, v237
	v_cvt_pk_bf16_f32 v235, v238, v239
	v_pk_fma_f32 v[240:241], v[240:241], v[12:13], v[4:5]
	v_pk_fma_f32 v[242:243], v[242:243], v[14:15], v[6:7]
	v_pk_fma_f32 v[244:245], v[244:245], v[16:17], v[8:9]
	v_pk_fma_f32 v[246:247], v[246:247], v[18:19], v[10:11]
	ds_write_b128 v21, v[232:235]
	buffer_load_dwordx4 v[152:155], v30, s[16:19], s64 offen
	v_xor_b32 v20, 224, v23
	v_cvt_pk_bf16_f32 v240, v240, v241
	v_cvt_pk_bf16_f32 v241, v242, v243
	v_cvt_pk_bf16_f32 v242, v244, v245
	v_cvt_pk_bf16_f32 v243, v246, v247
	v_pk_fma_f32 v[248:249], v[248:249], v[12:13], v[4:5]
	v_pk_fma_f32 v[250:251], v[250:251], v[14:15], v[6:7]
	v_pk_fma_f32 v[252:253], v[252:253], v[16:17], v[8:9]
	v_pk_fma_f32 v[254:255], v[254:255], v[18:19], v[10:11]
	ds_write_b128 v20, v[240:243]
	buffer_load_dwordx4 v[156:159], v31, s[16:19], s64 offen
	v_xor_b32 v21, 240, v23
	v_cvt_pk_bf16_f32 v248, v248, v249
	v_cvt_pk_bf16_f32 v249, v250, v251
	v_cvt_pk_bf16_f32 v250, v252, v253
	v_cvt_pk_bf16_f32 v251, v254, v255
	ds_write_b128 v21, v[248:251]
	v_lshrrev_b32 v6, 4, v2
	v_xor_b32 v4, v2, v6
	v_lshlrev_b32 v4, 4, v4
	v_xor_b32_e64 v5, 64, v4
	s_lshl_b32 s69, s56, 11
	s_lshl_b32 s68, s56, 12
	s_lshl_b32 s67, s58, 3
	s_add_u32 s67, s67, s57
	s_lshl_b32 s67, s67, 18
	s_add_u32 s67, s67, 134217728
	s_mov_b32 s66, s67
	s_nop 0
	s_mul_i32 s60, s56, 34816
	s_add_u32 s66, s66, s60
	s_mov_b32 s73, s66
	v_lshlrev_b32_e64 v6, 4, v2
	s_add_u32 s64, s64, 786432
	s_add_u32 s60, s69, 65536
	s_add_u32 s61, s68, 131072
	v_lshlrev_b32 v7, 4, v2
	s_waitcnt lgkmcnt(0)
	v_add_u32 v254, s60, v7
	v_add_u32 v255, s61, v7
	v_perm_b32 v224, v36, v32, s96
	v_perm_b32 v225, v44, v40, s96
	v_perm_b32 v226, v52, v48, s96
	v_perm_b32 v227, v60, v56, s96
	v_perm_b32 v228, v36, v32, s97
	v_perm_b32 v229, v44, v40, s97
	v_perm_b32 v230, v52, v48, s97
	v_perm_b32 v231, v60, v56, s97
	s_barrier
	s_nop 0
	ds_read_b128 a[128:131], v4 offset:0
	ds_read_b128 a[132:135], v4 offset:1024
	ds_read_b128 a[136:139], v4 offset:2048
	ds_read_b128 a[140:143], v4 offset:3072
	s_waitcnt lgkmcnt(0)
	s_nop 0
	v_mfma_f32_16x16x32_bf16 v[192:195], v[224:227], a[128:131], 0
	v_perm_b32 v232, v37, v33, s96
	v_perm_b32 v233, v45, v41, s96
	v_mfma_f32_16x16x32_bf16 a[4:7], v[224:227], a[132:135], 0
	v_perm_b32 v234, v53, v49, s96
	v_perm_b32 v235, v61, v57, s96
	v_mfma_f32_16x16x32_bf16 a[8:11], v[224:227], a[136:139], 0
	v_mfma_f32_16x16x32_bf16 a[12:15], v[224:227], a[140:143], 0
	s_lshl_b32 s65, s57, 19
	s_nop 0
	v_perm_b32 v236, v37, v33, s97
	v_perm_b32 v237, v45, v41, s97
	v_mfma_f32_16x16x32_bf16 v[196:199], v[228:231], a[128:131], 0
	s_add_u32 s65, s65, 393216
	v_perm_b32 v238, v53, v49, s97
	v_perm_b32 v239, v61, v57, s97
	v_mfma_f32_16x16x32_bf16 a[20:23], v[228:231], a[132:135], 0
	ds_read_b128 a[144:147], v5 offset:4096
	ds_read_b128 a[148:151], v5 offset:5120
	v_mfma_f32_16x16x32_bf16 a[24:27], v[228:231], a[136:139], 0
	v_mfma_f32_16x16x32_bf16 a[28:31], v[228:231], a[140:143], 0
	ds_read_b128 a[152:155], v5 offset:6144
	ds_read_b128 a[156:159], v5 offset:7168
	v_mfma_f32_16x16x32_bf16 v[200:203], v[232:235], a[128:131], 0
	s_add_u32 s82, s65, 8192
	v_perm_b32 v224, v38, v34, s96
	v_perm_b32 v225, v46, v42, s96
	v_mfma_f32_16x16x32_bf16 a[36:39], v[232:235], a[132:135], 0
	s_lshl_b32 s70, s57, 19
	s_nop 0
	v_perm_b32 v226, v54, v50, s96
	v_perm_b32 v227, v62, v58, s96
	v_mfma_f32_16x16x32_bf16 a[40:43], v[232:235], a[136:139], 0
	s_lshl_b32 s60, s59, 2
	v_and_b32 v240, 15, v2
	v_lshlrev_b32_e64 v240, 7, v240
	v_mfma_f32_16x16x32_bf16 a[44:47], v[232:235], a[140:143], 0
	s_mul_i32 s71, s57, 448
	v_perm_b32 v228, v38, v34, s97
	v_perm_b32 v229, v46, v42, s97
	v_mfma_f32_16x16x32_bf16 v[204:207], v[236:239], a[128:131], 0
	s_mul_i32 s72, s57, 229376
	v_perm_b32 v230, v54, v50, s97
	v_perm_b32 v231, v62, v58, s97
	v_mfma_f32_16x16x32_bf16 a[52:55], v[236:239], a[132:135], 0
	s_add_u32 s60, s60, s56
	s_lshl_b32 s60, s60, 11
	s_lshl_b32 s61, s57, 19
	s_nop 0
	v_mfma_f32_16x16x32_bf16 a[56:59], v[236:239], a[136:139], 0
	s_add_u32 s60, s60, s61
	s_nop 0
	s_add_u32 s60, s60, 393216
	v_mfma_f32_16x16x32_bf16 a[60:63], v[236:239], a[140:143], 0
	buffer_load_dword a244, v240, s[8:11], s60 offen
	v_mfma_f32_16x16x32_bf16 v[208:211], v[224:227], a[128:131], 0
	s_mov_b32 s101, 0
	s_nop 0
	v_perm_b32 v232, v39, v35, s96
	v_perm_b32 v233, v47, v43, s96
	v_mfma_f32_16x16x32_bf16 a[68:71], v[224:227], a[132:135], 0
	s_mov_b32 s83, s70
	s_nop 0
	v_perm_b32 v234, v55, v51, s96
	v_perm_b32 v235, v63, v59, s96
	v_mfma_f32_16x16x32_bf16 a[72:75], v[224:227], a[136:139], 0
	buffer_load_dword a244, v240, s[12:15], s60 offen
	v_mfma_f32_16x16x32_bf16 a[76:79], v[224:227], a[140:143], 0
	s_mov_b32 s84, s68
	s_nop 0
	v_perm_b32 v236, v39, v35, s97
	v_perm_b32 v237, v47, v43, s97
	v_mfma_f32_16x16x32_bf16 v[212:215], v[228:231], a[128:131], 0
	s_mov_b32 s85, 32768
	v_perm_b32 v238, v55, v51, s97
	v_perm_b32 v239, v63, v59, s97
	v_mfma_f32_16x16x32_bf16 a[84:87], v[228:231], a[132:135], 0
	v_lshrrev_b32_e64 v242, 3, v2
	v_mul_u32_u24 v250, 12288, v242
	v_mfma_f32_16x16x32_bf16 a[88:91], v[228:231], a[136:139], 0
	v_and_b32_e64 v241, 7, v2
	v_lshl_add_u32 v250, v241, 4, v250
	v_mfma_f32_16x16x32_bf16 a[92:95], v[228:231], a[140:143], 0
	s_lshr_b32 s60, s2, 5
	v_lshlrev_b32 v242, 2, v242
	v_mfma_f32_16x16x32_bf16 v[216:219], v[232:235], a[128:131], 0
	s_or_b32 s3, s3, 0x80
	v_perm_b32 v224, v68, v64, s96
	v_perm_b32 v225, v76, v72, s96
	v_mfma_f32_16x16x32_bf16 a[100:103], v[232:235], a[132:135], 0
	s_mov_b32 s51, 0x20000
	v_perm_b32 v226, v84, v80, s96
	v_perm_b32 v227, v92, v88, s96
	v_mfma_f32_16x16x32_bf16 a[104:107], v[232:235], a[136:139], 0
	s_lshl_b32 s60, s60, 2
	s_add_u32 s60, s60, s56
	s_mul_i32 s62, s60, 98304
	v_mfma_f32_16x16x32_bf16 a[108:111], v[232:235], a[140:143], 0
	s_lshl_b32 s78, s58, 2
	s_nop 0
	v_perm_b32 v228, v68, v64, s97
	v_perm_b32 v229, v76, v72, s97
	v_mfma_f32_16x16x32_bf16 v[220:223], v[236:239], a[128:131], 0
	s_add_u32 s78, s78, s56
	s_nop 0
	v_perm_b32 v230, v84, v80, s97
	v_perm_b32 v231, v92, v88, s97
	v_mfma_f32_16x16x32_bf16 a[116:119], v[236:239], a[132:135], 0
	s_lshl_b32 s60, s60, 5
	s_and_b32 s61, s2, 31
	s_lshl_b32 s61, s61, 7
	s_nop 0
	v_mfma_f32_16x16x32_bf16 a[120:123], v[236:239], a[136:139], 0
	s_add_u32 s62, s62, s61
	s_nop 0
	s_add_u32 s62, s62, 2048
	s_add_u32 s61, s62, 6144
	v_mfma_f32_16x16x32_bf16 a[124:127], v[236:239], a[140:143], 0
	s_waitcnt lgkmcnt(0)
	s_nop 0
	v_mfma_f32_16x16x32_bf16 v[192:195], v[224:227], a[144:147], v[192:195]
	v_perm_b32 v232, v69, v65, s96
	v_perm_b32 v233, v77, v73, s96
	v_mfma_f32_16x16x32_bf16 a[4:7], v[224:227], a[148:151], a[4:7]
	v_perm_b32 v234, v85, v81, s96
	v_perm_b32 v235, v93, v89, s96
	v_mfma_f32_16x16x32_bf16 a[8:11], v[224:227], a[152:155], a[8:11]
	v_mfma_f32_16x16x32_bf16 a[12:15], v[224:227], a[156:159], a[12:15]
	s_lshl_b32 s78, s78, 3
	s_nop 0
	v_perm_b32 v236, v69, v65, s97
	v_perm_b32 v237, v77, v73, s97
	v_mfma_f32_16x16x32_bf16 v[196:199], v[228:231], a[144:147], v[196:199]
	s_add_u32 s78, s78, s57
	s_nop 0
	v_perm_b32 v238, v85, v81, s97
	v_perm_b32 v239, v93, v89, s97
	v_mfma_f32_16x16x32_bf16 a[20:23], v[228:231], a[148:151], a[20:23]
	ds_read_b128 a[128:131], v4 offset:8192
	ds_read_b128 a[132:135], v4 offset:9216
	v_mfma_f32_16x16x32_bf16 a[24:27], v[228:231], a[152:155], a[24:27]
	v_mfma_f32_16x16x32_bf16 a[28:31], v[228:231], a[156:159], a[28:31]
	ds_read_b128 a[136:139], v4 offset:10240
	ds_read_b128 a[140:143], v4 offset:11264
	v_mfma_f32_16x16x32_bf16 v[200:203], v[232:235], a[144:147], v[200:203]
	s_lshl_b32 s86, s78, 11
	s_nop 0
	v_perm_b32 v224, v70, v66, s96
	v_perm_b32 v225, v78, v74, s96
	v_mfma_f32_16x16x32_bf16 a[36:39], v[232:235], a[148:151], a[36:39]
	s_lshl_b32 s87, s56, 7
	s_nop 0
	v_perm_b32 v226, v86, v82, s96
	v_perm_b32 v227, v94, v90, s96
	v_mfma_f32_16x16x32_bf16 a[40:43], v[232:235], a[152:155], a[40:43]
	buffer_load_dwordx4 a[224:227], v250, s[44:47], s62 offen
	v_mfma_f32_16x16x32_bf16 a[44:47], v[232:235], a[156:159], a[44:47]
	s_add_u32 s87, s87, s71
	s_nop 0
	v_perm_b32 v228, v70, v66, s97
	v_perm_b32 v229, v78, v74, s97
	v_mfma_f32_16x16x32_bf16 v[204:207], v[236:239], a[144:147], v[204:207]
	v_perm_b32 v230, v86, v82, s97
	v_perm_b32 v231, v94, v90, s97
	v_mfma_f32_16x16x32_bf16 a[52:55], v[236:239], a[148:151], a[52:55]
	ds_read_b128 v[160:163], v254 offset:0
	ds_read_b128 v[164:167], v254 offset:1024
	v_mfma_f32_16x16x32_bf16 a[56:59], v[236:239], a[152:155], a[56:59]
	buffer_load_dwordx4 a[228:231], v250, s[44:47], s61 offen
	v_mfma_f32_16x16x32_bf16 a[60:63], v[236:239], a[156:159], a[60:63]
	ds_read_b128 v[168:171], v254 offset:8192
	ds_read_b128 v[172:175], v254 offset:9216
	v_mfma_f32_16x16x32_bf16 v[208:211], v[224:227], a[144:147], v[208:211]
	s_mov_b32 s88, 4096
	v_perm_b32 v232, v71, v67, s96
	v_perm_b32 v233, v79, v75, s96
	v_mfma_f32_16x16x32_bf16 a[68:71], v[224:227], a[148:151], a[68:71]
	s_mov_b32 s90, 0x3f80
	v_perm_b32 v234, v87, v83, s96
	v_perm_b32 v235, v95, v91, s96
	v_mfma_f32_16x16x32_bf16 a[72:75], v[224:227], a[152:155], a[72:75]
	buffer_load_dword a232, v242, s[48:51], s60 offen
	v_mfma_f32_16x16x32_bf16 a[76:79], v[224:227], a[156:159], a[76:79]
	s_mov_b32 s91, 0x3f800000
	s_nop 0
	v_perm_b32 v236, v71, v67, s97
	v_perm_b32 v237, v79, v75, s97
	v_mfma_f32_16x16x32_bf16 v[212:215], v[228:231], a[144:147], v[212:215]
	s_and_b32 s78, s2, 31
	s_nop 0
	v_perm_b32 v238, v87, v83, s97
	v_perm_b32 v239, v95, v91, s97
	v_mfma_f32_16x16x32_bf16 a[84:87], v[228:231], a[148:151], a[84:87]
	ds_read_b128 v[176:179], v254 offset:16384
	ds_read_b128 v[180:183], v254 offset:17408
	v_mfma_f32_16x16x32_bf16 a[88:91], v[228:231], a[152:155], a[88:91]
	v_accvgpr_read_b32 v20, a160
	v_accvgpr_read_b32 v21, a161
	v_mfma_f32_16x16x32_bf16 a[92:95], v[228:231], a[156:159], a[92:95]
	s_waitcnt vmcnt(13)
	s_nop 0
	v_accvgpr_read_b32 v22, a162
	v_accvgpr_read_b32 v23, a163
	v_mfma_f32_16x16x32_bf16 v[216:219], v[232:235], a[144:147], v[216:219]
	s_lshl_b32 s78, s78, 11
	s_nop 0
	v_perm_b32 v224, v100, v96, s96
	v_perm_b32 v225, v108, v104, s96
	v_mfma_f32_16x16x32_bf16 a[100:103], v[232:235], a[148:151], a[100:103]
	s_lshr_b32 s93, s2, 5
	s_nop 0
	v_perm_b32 v226, v116, v112, s96
	v_perm_b32 v227, v124, v120, s96
	v_mfma_f32_16x16x32_bf16 a[104:107], v[232:235], a[152:155], a[104:107]
	v_accvgpr_read_b32 v8, a164
	v_accvgpr_read_b32 v12, a165
	v_mfma_f32_16x16x32_bf16 a[108:111], v[232:235], a[156:159], a[108:111]
	s_lshl_b32 s93, s93, 8
	s_nop 0
	v_perm_b32 v228, v100, v96, s97
	v_perm_b32 v229, v108, v104, s97
	v_mfma_f32_16x16x32_bf16 v[220:223], v[236:239], a[144:147], v[220:223]
	s_add_u32 s93, s93, s78
	s_nop 0
	v_perm_b32 v230, v116, v112, s97
	v_perm_b32 v231, v124, v120, s97
	v_mfma_f32_16x16x32_bf16 a[116:119], v[236:239], a[148:151], a[116:119]
	ds_read_b128 v[184:187], v254 offset:24576
	ds_read_b128 v[188:191], v254 offset:25600
	v_mfma_f32_16x16x32_bf16 a[120:123], v[236:239], a[152:155], a[120:123]
	v_accvgpr_read_b32 v253, a166
	v_xor_b32_e64 v9, 16, v8
	v_mfma_f32_16x16x32_bf16 a[124:127], v[236:239], a[156:159], a[124:127]
	s_waitcnt lgkmcnt(8)
	v_xor_b32 v10, 32, v8
	v_xor_b32_e64 v11, 48, v8
	v_mfma_f32_16x16x32_bf16 v[192:195], v[224:227], a[128:131], v[192:195]
	v_perm_b32 v232, v101, v97, s96
	v_perm_b32 v233, v109, v105, s96
	v_mfma_f32_16x16x32_bf16 a[4:7], v[224:227], a[132:135], a[4:7]
	v_perm_b32 v234, v117, v113, s96
	v_perm_b32 v235, v125, v121, s96
	v_mfma_f32_16x16x32_bf16 a[8:11], v[224:227], a[136:139], a[8:11]
	v_mfma_f32_16x16x32_bf16 a[12:15], v[224:227], a[140:143], a[12:15]
	s_add_u32 s93, s93, 65536
	v_perm_b32 v236, v101, v97, s97
	v_perm_b32 v237, v109, v105, s97
	v_mfma_f32_16x16x32_bf16 v[196:199], v[228:231], a[128:131], v[196:199]
	s_bfe_u32 s78, s2, 65539
	v_perm_b32 v238, v117, v113, s97
	v_perm_b32 v239, v125, v121, s97
	v_mfma_f32_16x16x32_bf16 a[20:23], v[228:231], a[132:135], a[20:23]
	ds_read_b128 a[144:147], v5 offset:12288
	ds_read_b128 a[148:151], v5 offset:13312
	v_mfma_f32_16x16x32_bf16 a[24:27], v[228:231], a[136:139], a[24:27]
	v_mfma_f32_16x16x32_bf16 a[28:31], v[228:231], a[140:143], a[28:31]
	ds_read_b128 a[152:155], v5 offset:14336
	ds_read_b128 a[156:159], v5 offset:15360
	v_mfma_f32_16x16x32_bf16 v[200:203], v[232:235], a[128:131], v[200:203]
	s_lshl_b32 s78, s78, 11
	s_nop 0
	v_perm_b32 v224, v102, v98, s96
	v_perm_b32 v225, v110, v106, s96
	v_mfma_f32_16x16x32_bf16 a[36:39], v[232:235], a[132:135], a[36:39]
	s_add_u32 s89, s78, 4096
	v_perm_b32 v226, v118, v114, s96
	v_perm_b32 v227, v126, v122, s96
	v_mfma_f32_16x16x32_bf16 a[40:43], v[232:235], a[136:139], a[40:43]
	v_xor_b32 v13, 32, v12
	v_xor_b32 v14, 64, v12
	v_mfma_f32_16x16x32_bf16 a[44:47], v[232:235], a[140:143], a[44:47]
	s_bfe_u32 s78, s2, 131078
	v_perm_b32 v228, v102, v98, s97
	v_perm_b32 v229, v110, v106, s97
	v_mfma_f32_16x16x32_bf16 v[204:207], v[236:239], a[128:131], v[204:207]
	v_perm_b32 v230, v118, v114, s97
	v_perm_b32 v231, v126, v122, s97
	v_mfma_f32_16x16x32_bf16 a[52:55], v[236:239], a[132:135], a[52:55]
	ds_read_b128 v[32:35], v254 offset:32768
	ds_read_b128 v[36:39], v254 offset:33792
	v_mfma_f32_16x16x32_bf16 a[56:59], v[236:239], a[136:139], a[56:59]
	v_xor_b32 v15, 96, v12
	v_xor_b32 v16, 128, v12
	v_mfma_f32_16x16x32_bf16 a[60:63], v[236:239], a[140:143], a[60:63]
	ds_read_b128 v[40:43], v254 offset:40960
	ds_read_b128 v[44:47], v254 offset:41984
	v_mfma_f32_16x16x32_bf16 v[208:211], v[224:227], a[128:131], v[208:211]
	s_lshl_b32 s78, s78, 9
	s_nop 0
	v_perm_b32 v232, v103, v99, s96
	v_perm_b32 v233, v111, v107, s96
	v_mfma_f32_16x16x32_bf16 a[68:71], v[224:227], a[132:135], a[68:71]
	s_add_u32 s89, s78, s89
	s_nop 0
	v_perm_b32 v234, v119, v115, s96
	v_perm_b32 v235, v127, v123, s96
	v_mfma_f32_16x16x32_bf16 a[72:75], v[224:227], a[136:139], a[72:75]
	v_xor_b32 v17, 160, v12
	v_xor_b32 v18, 192, v12
	v_mfma_f32_16x16x32_bf16 a[76:79], v[224:227], a[140:143], a[76:79]
	s_bfe_u32 s78, s2, 131076
	v_perm_b32 v236, v103, v99, s97
	v_perm_b32 v237, v111, v107, s97
	v_mfma_f32_16x16x32_bf16 v[212:215], v[228:231], a[128:131], v[212:215]
	s_lshl_b32 s78, s78, 7
	s_nop 0
	v_perm_b32 v238, v119, v115, s97
	v_perm_b32 v239, v127, v123, s97
	v_mfma_f32_16x16x32_bf16 a[84:87], v[228:231], a[132:135], a[84:87]
	ds_read_b128 v[48:51], v254 offset:49152
	ds_read_b128 v[52:55], v254 offset:50176
	v_mfma_f32_16x16x32_bf16 a[88:91], v[228:231], a[136:139], a[88:91]
	s_lshl_b32 s60, s56, 14
	s_nop 0
	s_add_u32 s60, s60, 65536
	v_xor_b32 v19, 224, v12
	v_mfma_f32_16x16x32_bf16 a[92:95], v[228:231], a[140:143], a[92:95]
	s_waitcnt vmcnt(5)
	v_add_u32 v1, s60, v6
	v_mfma_f32_16x16x32_bf16 v[216:219], v[232:235], a[128:131], v[216:219]
	s_add_u32 s89, s78, s89
	s_nop 0
	v_perm_b32 v224, v132, v128, s96
	v_perm_b32 v225, v140, v136, s96
	v_mfma_f32_16x16x32_bf16 a[100:103], v[232:235], a[132:135], a[100:103]
	s_bfe_u32 s78, s2, 65538
	v_perm_b32 v226, v148, v144, s96
	v_perm_b32 v227, v156, v152, s96
	v_mfma_f32_16x16x32_bf16 a[104:107], v[232:235], a[136:139], a[104:107]
	v_mfma_f32_16x16x32_bf16 a[108:111], v[232:235], a[140:143], a[108:111]
	s_lshl_b32 s78, s78, 6
	s_nop 0
	v_perm_b32 v228, v132, v128, s97
	v_perm_b32 v229, v140, v136, s97
	v_mfma_f32_16x16x32_bf16 v[220:223], v[236:239], a[128:131], v[220:223]
	s_add_u32 s89, s78, s89
	s_nop 0
	v_perm_b32 v230, v148, v144, s97
	v_perm_b32 v231, v156, v152, s97
	v_mfma_f32_16x16x32_bf16 a[116:119], v[236:239], a[132:135], a[116:119]
	ds_read_b128 v[56:59], v254 offset:57344
	ds_read_b128 v[60:63], v254 offset:58368
	v_mfma_f32_16x16x32_bf16 a[120:123], v[236:239], a[136:139], a[120:123]
	v_mfma_f32_16x16x32_bf16 a[124:127], v[236:239], a[140:143], a[124:127]
	s_waitcnt lgkmcnt(8)
	s_nop 0
	v_mfma_f32_16x16x32_bf16 v[192:195], v[224:227], a[144:147], v[192:195]
	s_add_u32 s64, s64, 262144
	v_perm_b32 v232, v133, v129, s96
	v_perm_b32 v233, v141, v137, s96
	v_mfma_f32_16x16x32_bf16 a[4:7], v[224:227], a[148:151], a[4:7]
	s_and_b32 s64, s64, 0x3fffff
	v_perm_b32 v234, v149, v145, s96
	v_perm_b32 v235, v157, v153, s96
	v_mfma_f32_16x16x32_bf16 a[8:11], v[224:227], a[152:155], a[8:11]
	buffer_load_dwordx4 v[96:99], v24, s[16:19], s64 offen
	v_mfma_f32_16x16x32_bf16 a[12:15], v[224:227], a[156:159], a[12:15]
	s_bfe_u32 s78, s2, 65536
	v_perm_b32 v236, v133, v129, s97
	v_perm_b32 v237, v141, v137, s97
	v_mfma_f32_16x16x32_bf16 v[196:199], v[228:231], a[144:147], v[196:199]
	s_lshl_b32 s78, s78, 5
	s_nop 0
	v_perm_b32 v238, v149, v145, s97
	v_perm_b32 v239, v157, v153, s97
	v_mfma_f32_16x16x32_bf16 a[20:23], v[228:231], a[148:151], a[20:23]
	ds_read_b128 a[128:131], v4 offset:16384
	ds_read_b128 a[132:135], v4 offset:17408
	v_mfma_f32_16x16x32_bf16 a[24:27], v[228:231], a[152:155], a[24:27]
	buffer_load_dwordx4 v[100:103], v25, s[16:19], s64 offen
	v_mfma_f32_16x16x32_bf16 a[28:31], v[228:231], a[156:159], a[28:31]
	ds_read_b128 a[136:139], v4 offset:18432
	ds_read_b128 a[140:143], v4 offset:19456
	v_mfma_f32_16x16x32_bf16 v[200:203], v[232:235], a[144:147], v[200:203]
	s_add_u32 s89, s78, s89
	s_nop 0
	v_perm_b32 v224, v134, v130, s96
	v_perm_b32 v225, v142, v138, s96
	v_mfma_f32_16x16x32_bf16 a[36:39], v[232:235], a[148:151], a[36:39]
	s_bfe_u32 s78, s2, 65537
	v_perm_b32 v226, v150, v146, s96
	v_perm_b32 v227, v158, v154, s96
	v_mfma_f32_16x16x32_bf16 a[40:43], v[232:235], a[152:155], a[40:43]
	buffer_load_dwordx4 v[104:107], v26, s[16:19], s64 offen
	v_mfma_f32_16x16x32_bf16 a[44:47], v[232:235], a[156:159], a[44:47]
	s_lshl_b32 s78, s78, 3
	s_nop 0
	v_perm_b32 v228, v134, v130, s97
	v_perm_b32 v229, v142, v138, s97
	v_mfma_f32_16x16x32_bf16 v[204:207], v[236:239], a[144:147], v[204:207]
	v_perm_b32 v230, v150, v146, s97
	v_perm_b32 v231, v158, v154, s97
	v_mfma_f32_16x16x32_bf16 a[52:55], v[236:239], a[148:151], a[52:55]
	ds_read_b128 v[64:67], v255 offset:0
	ds_read_b128 v[68:71], v255 offset:1024
	v_mfma_f32_16x16x32_bf16 a[56:59], v[236:239], a[152:155], a[56:59]
	buffer_load_dwordx4 v[108:111], v27, s[16:19], s64 offen
	v_mfma_f32_16x16x32_bf16 a[60:63], v[236:239], a[156:159], a[60:63]
	ds_read_b128 v[72:75], v255 offset:2048
	ds_read_b128 v[76:79], v255 offset:3072
	v_mfma_f32_16x16x32_bf16 v[208:211], v[224:227], a[144:147], v[208:211]
	s_add_u32 s89, s78, s89
	s_nop 0
	v_perm_b32 v232, v135, v131, s96
	v_perm_b32 v233, v143, v139, s96
	v_mfma_f32_16x16x32_bf16 a[68:71], v[224:227], a[148:151], a[68:71]
	v_perm_b32 v234, v151, v147, s96
	v_perm_b32 v235, v159, v155, s96
	v_mfma_f32_16x16x32_bf16 a[72:75], v[224:227], a[152:155], a[72:75]
	buffer_load_dwordx4 v[112:115], v28, s[16:19], s64 offen
	v_mfma_f32_16x16x32_bf16 a[76:79], v[224:227], a[156:159], a[76:79]
	v_perm_b32 v236, v135, v131, s97
	v_perm_b32 v237, v143, v139, s97
	v_mfma_f32_16x16x32_bf16 v[212:215], v[228:231], a[144:147], v[212:215]
	v_perm_b32 v238, v151, v147, s97
	v_perm_b32 v239, v159, v155, s97
	v_mfma_f32_16x16x32_bf16 a[84:87], v[228:231], a[148:151], a[84:87]
	ds_read_b128 v[80:83], v255 offset:16384
	ds_read_b128 v[84:87], v255 offset:17408
	v_mfma_f32_16x16x32_bf16 a[88:91], v[228:231], a[152:155], a[88:91]
	buffer_load_dwordx4 v[116:119], v29, s[16:19], s64 offen
	v_mfma_f32_16x16x32_bf16 a[92:95], v[228:231], a[156:159], a[92:95]
	v_mfma_f32_16x16x32_bf16 v[216:219], v[232:235], a[144:147], v[216:219]
	v_perm_b32 v224, v164, v160, s96
	v_perm_b32 v225, v172, v168, s96
	v_mfma_f32_16x16x32_bf16 a[100:103], v[232:235], a[148:151], a[100:103]
	v_perm_b32 v226, v180, v176, s96
	v_perm_b32 v227, v188, v184, s96
	v_mfma_f32_16x16x32_bf16 a[104:107], v[232:235], a[152:155], a[104:107]
	buffer_load_dwordx4 v[120:123], v30, s[16:19], s64 offen
	v_mfma_f32_16x16x32_bf16 a[108:111], v[232:235], a[156:159], a[108:111]
	v_perm_b32 v228, v164, v160, s97
	v_perm_b32 v229, v172, v168, s97
	v_mfma_f32_16x16x32_bf16 v[220:223], v[236:239], a[144:147], v[220:223]
	v_perm_b32 v230, v180, v176, s97
	v_perm_b32 v231, v188, v184, s97
	v_mfma_f32_16x16x32_bf16 a[116:119], v[236:239], a[148:151], a[116:119]
	ds_read_b128 v[88:91], v255 offset:18432
	ds_read_b128 v[92:95], v255 offset:19456
	v_mfma_f32_16x16x32_bf16 a[120:123], v[236:239], a[152:155], a[120:123]
	buffer_load_dwordx4 v[124:127], v31, s[16:19], s64 offen
	v_mfma_f32_16x16x32_bf16 a[124:127], v[236:239], a[156:159], a[124:127]
	s_waitcnt lgkmcnt(8)
	s_nop 0
	v_mfma_f32_16x16x32_bf16 v[192:195], v[224:227], a[128:131], v[192:195]
	s_add_u32 s64, s64, 262144
	v_perm_b32 v232, v165, v161, s96
	v_perm_b32 v233, v173, v169, s96
	v_mfma_f32_16x16x32_bf16 a[4:7], v[224:227], a[132:135], a[4:7]
	s_and_b32 s64, s64, 0x3fffff
	v_perm_b32 v234, v181, v177, s96
	v_perm_b32 v235, v189, v185, s96
	v_mfma_f32_16x16x32_bf16 a[8:11], v[224:227], a[136:139], a[8:11]
	buffer_load_dwordx4 v[128:131], v24, s[16:19], s64 offen
	v_mfma_f32_16x16x32_bf16 a[12:15], v[224:227], a[140:143], a[12:15]
	v_perm_b32 v236, v165, v161, s97
	v_perm_b32 v237, v173, v169, s97
	v_mfma_f32_16x16x32_bf16 v[196:199], v[228:231], a[128:131], v[196:199]
	v_perm_b32 v238, v181, v177, s97
	v_perm_b32 v239, v189, v185, s97
	v_mfma_f32_16x16x32_bf16 a[20:23], v[228:231], a[132:135], a[20:23]
	ds_read_b128 a[144:147], v5 offset:20480
	ds_read_b128 a[148:151], v5 offset:21504
	v_mfma_f32_16x16x32_bf16 a[24:27], v[228:231], a[136:139], a[24:27]
	buffer_load_dwordx4 v[132:135], v25, s[16:19], s64 offen
	v_mfma_f32_16x16x32_bf16 a[28:31], v[228:231], a[140:143], a[28:31]
	ds_read_b128 a[152:155], v5 offset:22528
	ds_read_b128 a[156:159], v5 offset:23552
	v_mfma_f32_16x16x32_bf16 v[200:203], v[232:235], a[128:131], v[200:203]
	v_perm_b32 v224, v166, v162, s96
	v_perm_b32 v225, v174, v170, s96
	v_mfma_f32_16x16x32_bf16 a[36:39], v[232:235], a[132:135], a[36:39]
	v_perm_b32 v226, v182, v178, s96
	v_perm_b32 v227, v190, v186, s96
	v_mfma_f32_16x16x32_bf16 a[40:43], v[232:235], a[136:139], a[40:43]
	buffer_load_dwordx4 v[136:139], v26, s[16:19], s64 offen
	v_mfma_f32_16x16x32_bf16 a[44:47], v[232:235], a[140:143], a[44:47]
	v_perm_b32 v228, v166, v162, s97
	v_perm_b32 v229, v174, v170, s97
	v_mfma_f32_16x16x32_bf16 v[204:207], v[236:239], a[128:131], v[204:207]
	v_perm_b32 v230, v182, v178, s97
	v_perm_b32 v231, v190, v186, s97
	v_mfma_f32_16x16x32_bf16 a[52:55], v[236:239], a[132:135], a[52:55]
	v_mfma_f32_16x16x32_bf16 a[56:59], v[236:239], a[136:139], a[56:59]
	buffer_load_dwordx4 v[140:143], v27, s[16:19], s64 offen
	v_mfma_f32_16x16x32_bf16 a[60:63], v[236:239], a[140:143], a[60:63]
	v_mfma_f32_16x16x32_bf16 v[208:211], v[224:227], a[128:131], v[208:211]
	v_perm_b32 v232, v167, v163, s96
	v_perm_b32 v233, v175, v171, s96
	v_mfma_f32_16x16x32_bf16 a[68:71], v[224:227], a[132:135], a[68:71]
	v_perm_b32 v234, v183, v179, s96
	v_perm_b32 v235, v191, v187, s96
	v_mfma_f32_16x16x32_bf16 a[72:75], v[224:227], a[136:139], a[72:75]
	buffer_load_dwordx4 v[144:147], v28, s[16:19], s64 offen
	v_mfma_f32_16x16x32_bf16 a[76:79], v[224:227], a[140:143], a[76:79]
	v_perm_b32 v236, v167, v163, s97
	v_perm_b32 v237, v175, v171, s97
	v_mfma_f32_16x16x32_bf16 v[212:215], v[228:231], a[128:131], v[212:215]
	v_perm_b32 v238, v183, v179, s97
	v_perm_b32 v239, v191, v187, s97
	v_mfma_f32_16x16x32_bf16 a[84:87], v[228:231], a[132:135], a[84:87]
	v_mfma_f32_16x16x32_bf16 a[88:91], v[228:231], a[136:139], a[88:91]
	buffer_load_dwordx4 v[148:151], v29, s[16:19], s64 offen
	v_mfma_f32_16x16x32_bf16 a[92:95], v[228:231], a[140:143], a[92:95]
	v_mfma_f32_16x16x32_bf16 v[216:219], v[232:235], a[128:131], v[216:219]
	v_perm_b32 v224, v36, v32, s96
	v_perm_b32 v225, v44, v40, s96
	v_mfma_f32_16x16x32_bf16 a[100:103], v[232:235], a[132:135], a[100:103]
	v_perm_b32 v226, v52, v48, s96
	v_perm_b32 v227, v60, v56, s96
	v_mfma_f32_16x16x32_bf16 a[104:107], v[232:235], a[136:139], a[104:107]
	buffer_load_dwordx4 v[152:155], v30, s[16:19], s64 offen
	v_mfma_f32_16x16x32_bf16 a[108:111], v[232:235], a[140:143], a[108:111]
	v_perm_b32 v228, v36, v32, s97
	v_perm_b32 v229, v44, v40, s97
	v_mfma_f32_16x16x32_bf16 v[220:223], v[236:239], a[128:131], v[220:223]
	v_perm_b32 v230, v52, v48, s97
	v_perm_b32 v231, v60, v56, s97
	v_mfma_f32_16x16x32_bf16 a[116:119], v[236:239], a[132:135], a[116:119]
	v_mfma_f32_16x16x32_bf16 a[120:123], v[236:239], a[136:139], a[120:123]
	buffer_load_dwordx4 v[156:159], v31, s[16:19], s64 offen
	v_mfma_f32_16x16x32_bf16 a[124:127], v[236:239], a[140:143], a[124:127]
	s_waitcnt lgkmcnt(0)
	s_nop 0
	v_mfma_f32_16x16x32_bf16 v[192:195], v[224:227], a[144:147], v[192:195]
	s_add_u32 s64, s64, 262144
	v_perm_b32 v232, v37, v33, s96
	v_perm_b32 v233, v45, v41, s96
	v_mfma_f32_16x16x32_bf16 a[4:7], v[224:227], a[148:151], a[4:7]
	s_and_b32 s64, s64, 0x3fffff
	v_perm_b32 v234, v53, v49, s96
	v_perm_b32 v235, v61, v57, s96
	v_mfma_f32_16x16x32_bf16 a[8:11], v[224:227], a[152:155], a[8:11]
	buffer_load_dwordx4 v[160:163], v24, s[16:19], s64 offen
	v_mfma_f32_16x16x32_bf16 a[12:15], v[224:227], a[156:159], a[12:15]
	s_mov_b32 s44, s54
	s_nop 0
	v_perm_b32 v236, v37, v33, s97
	v_perm_b32 v237, v45, v41, s97
	v_mfma_f32_16x16x32_bf16 v[196:199], v[228:231], a[144:147], v[196:199]
	s_and_b32 s45, s55, 0xffff
	v_perm_b32 v238, v53, v49, s97
	v_perm_b32 v239, v61, v57, s97
	v_mfma_f32_16x16x32_bf16 a[20:23], v[228:231], a[148:151], a[20:23]
	ds_read_b128 a[128:131], v4 offset:24576
	ds_read_b128 a[132:135], v4 offset:25600
	v_mfma_f32_16x16x32_bf16 a[24:27], v[228:231], a[152:155], a[24:27]
	buffer_load_dwordx4 v[164:167], v25, s[16:19], s64 offen
	v_mfma_f32_16x16x32_bf16 a[28:31], v[228:231], a[156:159], a[28:31]
	ds_read_b128 a[136:139], v4 offset:26624
	ds_read_b128 a[140:143], v4 offset:27648
	v_mfma_f32_16x16x32_bf16 v[200:203], v[232:235], a[144:147], v[200:203]
	s_mov_b32 s46, 1024
	v_perm_b32 v224, v38, v34, s96
	v_perm_b32 v225, v46, v42, s96
	v_mfma_f32_16x16x32_bf16 a[36:39], v[232:235], a[148:151], a[36:39]
	s_mov_b32 s47, 0x20000
	v_perm_b32 v226, v54, v50, s96
	v_perm_b32 v227, v62, v58, s96
	v_mfma_f32_16x16x32_bf16 a[40:43], v[232:235], a[152:155], a[40:43]
	buffer_load_dwordx4 v[168:171], v26, s[16:19], s64 offen
	v_mfma_f32_16x16x32_bf16 a[44:47], v[232:235], a[156:159], a[44:47]
	s_mov_b32 s48, s52
	s_nop 0
	v_perm_b32 v228, v38, v34, s97
	v_perm_b32 v229, v46, v42, s97
	v_mfma_f32_16x16x32_bf16 v[204:207], v[236:239], a[144:147], v[204:207]
	s_and_b32 s49, s53, 0xffff
	v_perm_b32 v230, v54, v50, s97
	v_perm_b32 v231, v62, v58, s97
	v_mfma_f32_16x16x32_bf16 a[52:55], v[236:239], a[148:151], a[52:55]
	v_mfma_f32_16x16x32_bf16 a[56:59], v[236:239], a[152:155], a[56:59]
	buffer_load_dwordx4 v[172:175], v27, s[16:19], s64 offen
	v_mfma_f32_16x16x32_bf16 a[60:63], v[236:239], a[156:159], a[60:63]
	v_mfma_f32_16x16x32_bf16 v[208:211], v[224:227], a[144:147], v[208:211]
	s_mov_b32 s50, 3584
	v_perm_b32 v232, v39, v35, s96
	v_perm_b32 v233, v47, v43, s96
	v_mfma_f32_16x16x32_bf16 a[68:71], v[224:227], a[148:151], a[68:71]
	v_perm_b32 v234, v55, v51, s96
	v_perm_b32 v235, v63, v59, s96
	v_mfma_f32_16x16x32_bf16 a[72:75], v[224:227], a[152:155], a[72:75]
	buffer_load_dwordx4 v[176:179], v28, s[16:19], s64 offen
	v_mfma_f32_16x16x32_bf16 a[76:79], v[224:227], a[156:159], a[76:79]
	v_perm_b32 v236, v39, v35, s97
	v_perm_b32 v237, v47, v43, s97
	v_mfma_f32_16x16x32_bf16 v[212:215], v[228:231], a[144:147], v[212:215]
	v_perm_b32 v238, v55, v51, s97
	v_perm_b32 v239, v63, v59, s97
	v_mfma_f32_16x16x32_bf16 a[84:87], v[228:231], a[148:151], a[84:87]
	v_mfma_f32_16x16x32_bf16 a[88:91], v[228:231], a[152:155], a[88:91]
	buffer_load_dwordx4 v[180:183], v29, s[16:19], s64 offen
	v_mfma_f32_16x16x32_bf16 a[92:95], v[228:231], a[156:159], a[92:95]
	v_mfma_f32_16x16x32_bf16 v[216:219], v[232:235], a[144:147], v[216:219]
	v_perm_b32 v224, v68, v64, s96
	v_perm_b32 v225, v76, v72, s96
	v_mfma_f32_16x16x32_bf16 a[100:103], v[232:235], a[148:151], a[100:103]
	v_perm_b32 v226, v84, v80, s96
	v_perm_b32 v227, v92, v88, s96
	v_mfma_f32_16x16x32_bf16 a[104:107], v[232:235], a[152:155], a[104:107]
	buffer_load_dwordx4 v[184:187], v30, s[16:19], s64 offen
	v_mfma_f32_16x16x32_bf16 a[108:111], v[232:235], a[156:159], a[108:111]
	v_perm_b32 v228, v68, v64, s97
	v_perm_b32 v229, v76, v72, s97
	v_mfma_f32_16x16x32_bf16 v[220:223], v[236:239], a[144:147], v[220:223]
	v_perm_b32 v230, v84, v80, s97
	v_perm_b32 v231, v92, v88, s97
	v_mfma_f32_16x16x32_bf16 a[116:119], v[236:239], a[148:151], a[116:119]
	v_mfma_f32_16x16x32_bf16 a[120:123], v[236:239], a[152:155], a[120:123]
	buffer_load_dwordx4 v[188:191], v31, s[16:19], s64 offen
	v_mfma_f32_16x16x32_bf16 a[124:127], v[236:239], a[156:159], a[124:127]
	s_waitcnt lgkmcnt(0)
	s_nop 0
	v_mfma_f32_16x16x32_bf16 v[192:195], v[224:227], a[128:131], v[192:195]
	s_add_u32 s64, s64, 262144
	v_perm_b32 v232, v69, v65, s96
	v_perm_b32 v233, v77, v73, s96
	v_mfma_f32_16x16x32_bf16 a[4:7], v[224:227], a[132:135], a[4:7]
	s_and_b32 s64, s64, 0x3fffff
	v_perm_b32 v234, v85, v81, s96
	v_perm_b32 v235, v93, v89, s96
	v_mfma_f32_16x16x32_bf16 a[8:11], v[224:227], a[136:139], a[8:11]
	buffer_load_dwordx4 v[32:35], v24, s[16:19], s64 offen
	v_mfma_f32_16x16x32_bf16 a[12:15], v[224:227], a[140:143], a[12:15]
	v_perm_b32 v236, v69, v65, s97
	v_perm_b32 v237, v77, v73, s97
	v_mfma_f32_16x16x32_bf16 v[196:199], v[228:231], a[128:131], v[196:199]
	v_perm_b32 v238, v85, v81, s97
	v_perm_b32 v239, v93, v89, s97
	v_mfma_f32_16x16x32_bf16 a[20:23], v[228:231], a[132:135], a[20:23]
	ds_read_b128 a[144:147], v5 offset:28672
	ds_read_b128 a[148:151], v5 offset:29696
	v_mfma_f32_16x16x32_bf16 a[24:27], v[228:231], a[136:139], a[24:27]
	buffer_load_dwordx4 v[36:39], v25, s[16:19], s64 offen
	v_mfma_f32_16x16x32_bf16 a[28:31], v[228:231], a[140:143], a[28:31]
	ds_read_b128 a[152:155], v5 offset:30720
	ds_read_b128 a[156:159], v5 offset:31744
	v_mfma_f32_16x16x32_bf16 v[200:203], v[232:235], a[128:131], v[200:203]
	v_perm_b32 v224, v70, v66, s96
	v_perm_b32 v225, v78, v74, s96
	v_mfma_f32_16x16x32_bf16 a[36:39], v[232:235], a[132:135], a[36:39]
	v_perm_b32 v226, v86, v82, s96
	v_perm_b32 v227, v94, v90, s96
	v_mfma_f32_16x16x32_bf16 a[40:43], v[232:235], a[136:139], a[40:43]
	buffer_load_dwordx4 v[40:43], v26, s[16:19], s64 offen
	v_mfma_f32_16x16x32_bf16 a[44:47], v[232:235], a[140:143], a[44:47]
	v_perm_b32 v228, v70, v66, s97
	v_perm_b32 v229, v78, v74, s97
	v_mfma_f32_16x16x32_bf16 v[204:207], v[236:239], a[128:131], v[204:207]
	v_perm_b32 v230, v86, v82, s97
	v_perm_b32 v231, v94, v90, s97
	v_mfma_f32_16x16x32_bf16 a[52:55], v[236:239], a[132:135], a[52:55]
	v_mfma_f32_16x16x32_bf16 a[56:59], v[236:239], a[136:139], a[56:59]
	buffer_load_dwordx4 v[44:47], v27, s[16:19], s64 offen
	v_mfma_f32_16x16x32_bf16 a[60:63], v[236:239], a[140:143], a[60:63]
	v_mfma_f32_16x16x32_bf16 v[208:211], v[224:227], a[128:131], v[208:211]
	v_perm_b32 v232, v71, v67, s96
	v_perm_b32 v233, v79, v75, s96
	v_mfma_f32_16x16x32_bf16 a[68:71], v[224:227], a[132:135], a[68:71]
	v_perm_b32 v234, v87, v83, s96
	v_perm_b32 v235, v95, v91, s96
	v_mfma_f32_16x16x32_bf16 a[72:75], v[224:227], a[136:139], a[72:75]
	buffer_load_dwordx4 v[48:51], v28, s[16:19], s64 offen
	v_mfma_f32_16x16x32_bf16 a[76:79], v[224:227], a[140:143], a[76:79]
	v_perm_b32 v236, v71, v67, s97
	v_perm_b32 v237, v79, v75, s97
	v_mfma_f32_16x16x32_bf16 v[212:215], v[228:231], a[128:131], v[212:215]
	v_perm_b32 v238, v87, v83, s97
	v_perm_b32 v239, v95, v91, s97
	v_mfma_f32_16x16x32_bf16 a[84:87], v[228:231], a[132:135], a[84:87]
	v_mfma_f32_16x16x32_bf16 a[88:91], v[228:231], a[136:139], a[88:91]
	buffer_load_dwordx4 v[52:55], v29, s[16:19], s64 offen
	v_mfma_f32_16x16x32_bf16 a[92:95], v[228:231], a[140:143], a[92:95]
	s_waitcnt vmcnt(22)
	s_nop 0
	v_mfma_f32_16x16x32_bf16 v[216:219], v[232:235], a[128:131], v[216:219]
	v_perm_b32 v224, v100, v96, s96
	v_perm_b32 v225, v108, v104, s96
	v_mfma_f32_16x16x32_bf16 a[100:103], v[232:235], a[132:135], a[100:103]
	v_perm_b32 v226, v116, v112, s96
	v_perm_b32 v227, v124, v120, s96
	v_mfma_f32_16x16x32_bf16 a[104:107], v[232:235], a[136:139], a[104:107]
	buffer_load_dwordx4 v[56:59], v30, s[16:19], s64 offen
	v_mfma_f32_16x16x32_bf16 a[108:111], v[232:235], a[140:143], a[108:111]
	v_perm_b32 v228, v100, v96, s97
	v_perm_b32 v229, v108, v104, s97
	v_mfma_f32_16x16x32_bf16 v[220:223], v[236:239], a[128:131], v[220:223]
	v_perm_b32 v230, v116, v112, s97
	v_perm_b32 v231, v124, v120, s97
	v_mfma_f32_16x16x32_bf16 a[116:119], v[236:239], a[132:135], a[116:119]
	v_mfma_f32_16x16x32_bf16 a[120:123], v[236:239], a[136:139], a[120:123]
	buffer_load_dwordx4 v[60:63], v31, s[16:19], s64 offen
	v_mfma_f32_16x16x32_bf16 a[124:127], v[236:239], a[140:143], a[124:127]
	s_waitcnt lgkmcnt(0)
	s_nop 0
	v_mfma_f32_16x16x32_bf16 v[192:195], v[224:227], a[144:147], v[192:195]
	s_add_u32 s64, s64, 262144
	v_perm_b32 v232, v101, v97, s96
	v_perm_b32 v233, v109, v105, s96
	v_mfma_f32_16x16x32_bf16 a[4:7], v[224:227], a[148:151], a[4:7]
	s_and_b32 s64, s64, 0x3fffff
	v_perm_b32 v234, v117, v113, s96
	v_perm_b32 v235, v125, v121, s96
	v_mfma_f32_16x16x32_bf16 a[8:11], v[224:227], a[152:155], a[8:11]
	buffer_load_dwordx4 v[64:67], v24, s[16:19], s64 offen
	v_mfma_f32_16x16x32_bf16 a[12:15], v[224:227], a[156:159], a[12:15]
	v_perm_b32 v236, v101, v97, s97
	v_perm_b32 v237, v109, v105, s97
	v_mfma_f32_16x16x32_bf16 v[196:199], v[228:231], a[144:147], v[196:199]
	v_perm_b32 v238, v117, v113, s97
	v_perm_b32 v239, v125, v121, s97
	v_mfma_f32_16x16x32_bf16 a[20:23], v[228:231], a[148:151], a[20:23]
	ds_read_b128 a[128:131], v4 offset:32768
	ds_read_b128 a[132:135], v4 offset:33792
	v_mfma_f32_16x16x32_bf16 a[24:27], v[228:231], a[152:155], a[24:27]
	buffer_load_dwordx4 v[68:71], v25, s[16:19], s64 offen
	v_mfma_f32_16x16x32_bf16 a[28:31], v[228:231], a[156:159], a[28:31]
	ds_read_b128 a[136:139], v4 offset:34816
	ds_read_b128 a[140:143], v4 offset:35840
	v_mfma_f32_16x16x32_bf16 v[200:203], v[232:235], a[144:147], v[200:203]
	v_perm_b32 v224, v102, v98, s96
	v_perm_b32 v225, v110, v106, s96
	v_mfma_f32_16x16x32_bf16 a[36:39], v[232:235], a[148:151], a[36:39]
	v_perm_b32 v226, v118, v114, s96
	v_perm_b32 v227, v126, v122, s96
	v_mfma_f32_16x16x32_bf16 a[40:43], v[232:235], a[152:155], a[40:43]
	buffer_load_dwordx4 v[72:75], v26, s[16:19], s64 offen
	v_mfma_f32_16x16x32_bf16 a[44:47], v[232:235], a[156:159], a[44:47]
	v_perm_b32 v228, v102, v98, s97
	v_perm_b32 v229, v110, v106, s97
	v_mfma_f32_16x16x32_bf16 v[204:207], v[236:239], a[144:147], v[204:207]
	v_perm_b32 v230, v118, v114, s97
	v_perm_b32 v231, v126, v122, s97
	v_mfma_f32_16x16x32_bf16 a[52:55], v[236:239], a[148:151], a[52:55]
	v_mfma_f32_16x16x32_bf16 a[56:59], v[236:239], a[152:155], a[56:59]
	buffer_load_dwordx4 v[76:79], v27, s[16:19], s64 offen
	v_mfma_f32_16x16x32_bf16 a[60:63], v[236:239], a[156:159], a[60:63]
	v_mfma_f32_16x16x32_bf16 v[208:211], v[224:227], a[144:147], v[208:211]
	v_perm_b32 v232, v103, v99, s96
	v_perm_b32 v233, v111, v107, s96
	v_mfma_f32_16x16x32_bf16 a[68:71], v[224:227], a[148:151], a[68:71]
	v_perm_b32 v234, v119, v115, s96
	v_perm_b32 v235, v127, v123, s96
	v_mfma_f32_16x16x32_bf16 a[72:75], v[224:227], a[152:155], a[72:75]
	buffer_load_dwordx4 v[80:83], v28, s[16:19], s64 offen
	v_mfma_f32_16x16x32_bf16 a[76:79], v[224:227], a[156:159], a[76:79]
	v_perm_b32 v236, v103, v99, s97
	v_perm_b32 v237, v111, v107, s97
	v_mfma_f32_16x16x32_bf16 v[212:215], v[228:231], a[144:147], v[212:215]
	v_perm_b32 v238, v119, v115, s97
	v_perm_b32 v239, v127, v123, s97
	v_mfma_f32_16x16x32_bf16 a[84:87], v[228:231], a[148:151], a[84:87]
	v_mfma_f32_16x16x32_bf16 a[88:91], v[228:231], a[152:155], a[88:91]
	buffer_load_dwordx4 v[84:87], v29, s[16:19], s64 offen
	v_mfma_f32_16x16x32_bf16 a[92:95], v[228:231], a[156:159], a[92:95]
	s_waitcnt vmcnt(22)
	s_nop 0
	v_mfma_f32_16x16x32_bf16 v[216:219], v[232:235], a[144:147], v[216:219]
	v_perm_b32 v224, v132, v128, s96
	v_perm_b32 v225, v140, v136, s96
	v_mfma_f32_16x16x32_bf16 a[100:103], v[232:235], a[148:151], a[100:103]
	v_perm_b32 v226, v148, v144, s96
	v_perm_b32 v227, v156, v152, s96
	v_mfma_f32_16x16x32_bf16 a[104:107], v[232:235], a[152:155], a[104:107]
	buffer_load_dwordx4 v[88:91], v30, s[16:19], s64 offen
	v_mfma_f32_16x16x32_bf16 a[108:111], v[232:235], a[156:159], a[108:111]
	v_perm_b32 v228, v132, v128, s97
	v_perm_b32 v229, v140, v136, s97
	v_mfma_f32_16x16x32_bf16 v[220:223], v[236:239], a[144:147], v[220:223]
	v_perm_b32 v230, v148, v144, s97
	v_perm_b32 v231, v156, v152, s97
	v_mfma_f32_16x16x32_bf16 a[116:119], v[236:239], a[148:151], a[116:119]
	v_mfma_f32_16x16x32_bf16 a[120:123], v[236:239], a[152:155], a[120:123]
	buffer_load_dwordx4 v[92:95], v31, s[16:19], s64 offen
	v_mfma_f32_16x16x32_bf16 a[124:127], v[236:239], a[156:159], a[124:127]
	s_waitcnt lgkmcnt(0)
	s_nop 0
	v_mfma_f32_16x16x32_bf16 v[192:195], v[224:227], a[128:131], v[192:195]
	s_add_u32 s64, s64, 262144
	v_perm_b32 v232, v133, v129, s96
	v_perm_b32 v233, v141, v137, s96
	v_mfma_f32_16x16x32_bf16 a[4:7], v[224:227], a[132:135], a[4:7]
	s_and_b32 s64, s64, 0x3fffff
	v_perm_b32 v234, v149, v145, s96
	v_perm_b32 v235, v157, v153, s96
	v_mfma_f32_16x16x32_bf16 a[8:11], v[224:227], a[136:139], a[8:11]
	buffer_load_dwordx4 v[96:99], v24, s[16:19], s64 offen
	v_mfma_f32_16x16x32_bf16 a[12:15], v[224:227], a[140:143], a[12:15]
	v_perm_b32 v236, v133, v129, s97
	v_perm_b32 v237, v141, v137, s97
	v_mfma_f32_16x16x32_bf16 v[196:199], v[228:231], a[128:131], v[196:199]
	v_perm_b32 v238, v149, v145, s97
	v_perm_b32 v239, v157, v153, s97
	v_mfma_f32_16x16x32_bf16 a[20:23], v[228:231], a[132:135], a[20:23]
	ds_read_b128 a[144:147], v5 offset:36864
	ds_read_b128 a[148:151], v5 offset:37888
	v_mfma_f32_16x16x32_bf16 a[24:27], v[228:231], a[136:139], a[24:27]
	buffer_load_dwordx4 v[100:103], v25, s[16:19], s64 offen
	v_mfma_f32_16x16x32_bf16 a[28:31], v[228:231], a[140:143], a[28:31]
	ds_read_b128 a[152:155], v5 offset:38912
	ds_read_b128 a[156:159], v5 offset:39936
	v_mfma_f32_16x16x32_bf16 v[200:203], v[232:235], a[128:131], v[200:203]
	v_perm_b32 v224, v134, v130, s96
	v_perm_b32 v225, v142, v138, s96
	v_mfma_f32_16x16x32_bf16 a[36:39], v[232:235], a[132:135], a[36:39]
	v_perm_b32 v226, v150, v146, s96
	v_perm_b32 v227, v158, v154, s96
	v_mfma_f32_16x16x32_bf16 a[40:43], v[232:235], a[136:139], a[40:43]
	buffer_load_dwordx4 v[104:107], v26, s[16:19], s64 offen
	v_mfma_f32_16x16x32_bf16 a[44:47], v[232:235], a[140:143], a[44:47]
	v_perm_b32 v228, v134, v130, s97
	v_perm_b32 v229, v142, v138, s97
	v_mfma_f32_16x16x32_bf16 v[204:207], v[236:239], a[128:131], v[204:207]
	v_perm_b32 v230, v150, v146, s97
	v_perm_b32 v231, v158, v154, s97
	v_mfma_f32_16x16x32_bf16 a[52:55], v[236:239], a[132:135], a[52:55]
	v_accvgpr_read_b32 v240, a232
	v_lshlrev_b32_e64 v248, 16, v240
	v_mfma_f32_16x16x32_bf16 a[56:59], v[236:239], a[136:139], a[56:59]
	buffer_load_dwordx4 v[108:111], v27, s[16:19], s64 offen
	v_mfma_f32_16x16x32_bf16 a[60:63], v[236:239], a[140:143], a[60:63]
	v_and_b32 v249, 0xffff0000, v240
	v_mul_f32 v240, 0xbfb8aa3b, v248
	v_mfma_f32_16x16x32_bf16 v[208:211], v[224:227], a[128:131], v[208:211]
	v_perm_b32 v232, v135, v131, s96
	v_perm_b32 v233, v143, v139, s96
	v_mfma_f32_16x16x32_bf16 a[68:71], v[224:227], a[132:135], a[68:71]
	v_perm_b32 v234, v151, v147, s96
	v_perm_b32 v235, v159, v155, s96
	v_mfma_f32_16x16x32_bf16 a[72:75], v[224:227], a[136:139], a[72:75]
	buffer_load_dwordx4 v[112:115], v28, s[16:19], s64 offen
	v_mfma_f32_16x16x32_bf16 a[76:79], v[224:227], a[140:143], a[76:79]
	v_perm_b32 v236, v135, v131, s97
	v_perm_b32 v237, v143, v139, s97
	v_mfma_f32_16x16x32_bf16 v[212:215], v[228:231], a[128:131], v[212:215]
	v_perm_b32 v238, v151, v147, s97
	v_perm_b32 v239, v159, v155, s97
	v_mfma_f32_16x16x32_bf16 a[84:87], v[228:231], a[132:135], a[84:87]
	v_mul_f32 v241, 0xbfb8aa3b, v249
	v_mfma_f32_16x16x32_bf16 a[88:91], v[228:231], a[136:139], a[88:91]
	buffer_load_dwordx4 v[116:119], v29, s[16:19], s64 offen
	v_mfma_f32_16x16x32_bf16 a[92:95], v[228:231], a[140:143], a[92:95]
	s_waitcnt vmcnt(22)
	v_exp_f32 v240, v240
	v_mfma_f32_16x16x32_bf16 v[216:219], v[232:235], a[128:131], v[216:219]
	v_perm_b32 v224, v164, v160, s96
	v_perm_b32 v225, v172, v168, s96
	v_mfma_f32_16x16x32_bf16 a[100:103], v[232:235], a[132:135], a[100:103]
	v_perm_b32 v226, v180, v176, s96
	v_perm_b32 v227, v188, v184, s96
	v_mfma_f32_16x16x32_bf16 a[104:107], v[232:235], a[136:139], a[104:107]
	buffer_load_dwordx4 v[120:123], v30, s[16:19], s64 offen
	v_mfma_f32_16x16x32_bf16 a[108:111], v[232:235], a[140:143], a[108:111]
	v_perm_b32 v228, v164, v160, s97
	v_perm_b32 v229, v172, v168, s97
	v_mfma_f32_16x16x32_bf16 v[220:223], v[236:239], a[128:131], v[220:223]
	v_perm_b32 v230, v180, v176, s97
	v_perm_b32 v231, v188, v184, s97
	v_mfma_f32_16x16x32_bf16 a[116:119], v[236:239], a[132:135], a[116:119]
	v_exp_f32_e64 v241, v241
	v_mfma_f32_16x16x32_bf16 a[120:123], v[236:239], a[136:139], a[120:123]
	buffer_load_dwordx4 v[124:127], v31, s[16:19], s64 offen
	v_mfma_f32_16x16x32_bf16 a[124:127], v[236:239], a[140:143], a[124:127]
	s_waitcnt lgkmcnt(0)
	v_add_f32 v240, 1.0, v240
	v_add_f32_e64 v241, 1.0, v241
	v_mfma_f32_16x16x32_bf16 v[192:195], v[224:227], a[144:147], v[192:195]
	s_add_u32 s64, s64, 262144
	v_perm_b32 v232, v165, v161, s96
	v_perm_b32 v233, v173, v169, s96
	v_mfma_f32_16x16x32_bf16 a[4:7], v[224:227], a[148:151], a[4:7]
	s_and_b32 s64, s64, 0x3fffff
	v_perm_b32 v234, v181, v177, s96
	v_perm_b32 v235, v189, v185, s96
	v_mfma_f32_16x16x32_bf16 a[8:11], v[224:227], a[152:155], a[8:11]
	buffer_load_dwordx4 v[128:131], v24, s[16:19], s64 offen
	v_mfma_f32_16x16x32_bf16 a[12:15], v[224:227], a[156:159], a[12:15]
	v_perm_b32 v236, v165, v161, s97
	v_perm_b32 v237, v173, v169, s97
	v_mfma_f32_16x16x32_bf16 v[196:199], v[228:231], a[144:147], v[196:199]
	v_perm_b32 v238, v181, v177, s97
	v_perm_b32 v239, v189, v185, s97
	v_mfma_f32_16x16x32_bf16 a[20:23], v[228:231], a[148:151], a[20:23]
	ds_read_b128 a[128:131], v4 offset:40960
	ds_read_b128 a[132:135], v4 offset:41984
	v_mfma_f32_16x16x32_bf16 a[24:27], v[228:231], a[152:155], a[24:27]
	buffer_load_dwordx4 v[132:135], v25, s[16:19], s64 offen
	v_mfma_f32_16x16x32_bf16 a[28:31], v[228:231], a[156:159], a[28:31]
	ds_read_b128 a[136:139], v4 offset:43008
	ds_read_b128 a[140:143], v4 offset:44032
	v_mfma_f32_16x16x32_bf16 v[200:203], v[232:235], a[144:147], v[200:203]
	v_perm_b32 v224, v166, v162, s96
	v_perm_b32 v225, v174, v170, s96
	v_mfma_f32_16x16x32_bf16 a[36:39], v[232:235], a[148:151], a[36:39]
	v_perm_b32 v226, v182, v178, s96
	v_perm_b32 v227, v190, v186, s96
	v_mfma_f32_16x16x32_bf16 a[40:43], v[232:235], a[152:155], a[40:43]
	buffer_load_dwordx4 v[136:139], v26, s[16:19], s64 offen
	v_mfma_f32_16x16x32_bf16 a[44:47], v[232:235], a[156:159], a[44:47]
	v_perm_b32 v228, v166, v162, s97
	v_perm_b32 v229, v174, v170, s97
	v_mfma_f32_16x16x32_bf16 v[204:207], v[236:239], a[144:147], v[204:207]
	v_perm_b32 v230, v182, v178, s97
	v_perm_b32 v231, v190, v186, s97
	v_mfma_f32_16x16x32_bf16 a[52:55], v[236:239], a[148:151], a[52:55]
	v_rcp_f32_e64 v240, v240
	v_mfma_f32_16x16x32_bf16 a[56:59], v[236:239], a[152:155], a[56:59]
	buffer_load_dwordx4 v[140:143], v27, s[16:19], s64 offen
	v_mfma_f32_16x16x32_bf16 a[60:63], v[236:239], a[156:159], a[60:63]
	v_rcp_f32_e64 v241, v241
	v_mfma_f32_16x16x32_bf16 v[208:211], v[224:227], a[144:147], v[208:211]
	v_perm_b32 v232, v167, v163, s96
	v_perm_b32 v233, v175, v171, s96
	v_mfma_f32_16x16x32_bf16 a[68:71], v[224:227], a[148:151], a[68:71]
	v_perm_b32 v234, v183, v179, s96
	v_perm_b32 v235, v191, v187, s96
	v_mfma_f32_16x16x32_bf16 a[72:75], v[224:227], a[152:155], a[72:75]
	buffer_load_dwordx4 v[144:147], v28, s[16:19], s64 offen
	v_mfma_f32_16x16x32_bf16 a[76:79], v[224:227], a[156:159], a[76:79]
	v_perm_b32 v236, v167, v163, s97
	v_perm_b32 v237, v175, v171, s97
	v_mfma_f32_16x16x32_bf16 v[212:215], v[228:231], a[144:147], v[212:215]
	v_perm_b32 v238, v183, v179, s97
	v_perm_b32 v239, v191, v187, s97
	v_mfma_f32_16x16x32_bf16 a[84:87], v[228:231], a[148:151], a[84:87]
	v_mul_f32 v248, v248, v240
	v_mul_f32 v249, v249, v241
	v_mfma_f32_16x16x32_bf16 a[88:91], v[228:231], a[152:155], a[88:91]
	buffer_load_dwordx4 v[148:151], v29, s[16:19], s64 offen
	v_mfma_f32_16x16x32_bf16 a[92:95], v[228:231], a[156:159], a[92:95]
	s_waitcnt vmcnt(22)
	s_nop 0
	v_cvt_pk_bf16_f32 v240, v248, v249
	v_lshlrev_b32_e64 v248, 16, v240
	v_mfma_f32_16x16x32_bf16 v[216:219], v[232:235], a[144:147], v[216:219]
	v_perm_b32 v224, v36, v32, s96
	v_perm_b32 v225, v44, v40, s96
	v_mfma_f32_16x16x32_bf16 a[100:103], v[232:235], a[148:151], a[100:103]
	v_perm_b32 v226, v52, v48, s96
	v_perm_b32 v227, v60, v56, s96
	v_mfma_f32_16x16x32_bf16 a[104:107], v[232:235], a[152:155], a[104:107]
	buffer_load_dwordx4 v[152:155], v30, s[16:19], s64 offen
	v_mfma_f32_16x16x32_bf16 a[108:111], v[232:235], a[156:159], a[108:111]
	v_perm_b32 v228, v36, v32, s97
	v_perm_b32 v229, v44, v40, s97
	v_mfma_f32_16x16x32_bf16 v[220:223], v[236:239], a[144:147], v[220:223]
	v_perm_b32 v230, v52, v48, s97
	v_perm_b32 v231, v60, v56, s97
	v_mfma_f32_16x16x32_bf16 a[116:119], v[236:239], a[148:151], a[116:119]
	v_and_b32 v249, 0xffff0000, v240
	v_mfma_f32_16x16x32_bf16 a[120:123], v[236:239], a[152:155], a[120:123]
	buffer_load_dwordx4 v[156:159], v31, s[16:19], s64 offen
	v_mfma_f32_16x16x32_bf16 a[124:127], v[236:239], a[156:159], a[124:127]
	s_waitcnt lgkmcnt(0)
	s_nop 0
	v_mfma_f32_16x16x32_bf16 v[192:195], v[224:227], a[128:131], v[192:195]
	s_add_u32 s64, s64, 262144
	v_perm_b32 v232, v37, v33, s96
	v_perm_b32 v233, v45, v41, s96
	v_mfma_f32_16x16x32_bf16 a[4:7], v[224:227], a[132:135], a[4:7]
	s_and_b32 s64, s64, 0x3fffff
	v_perm_b32 v234, v53, v49, s96
	v_perm_b32 v235, v61, v57, s96
	v_mfma_f32_16x16x32_bf16 a[8:11], v[224:227], a[136:139], a[8:11]
	buffer_load_dwordx4 v[160:163], v24, s[16:19], s64 offen
	v_mfma_f32_16x16x32_bf16 a[12:15], v[224:227], a[140:143], a[12:15]
	v_perm_b32 v236, v37, v33, s97
	v_perm_b32 v237, v45, v41, s97
	v_mfma_f32_16x16x32_bf16 v[196:199], v[228:231], a[128:131], v[196:199]
	v_perm_b32 v238, v53, v49, s97
	v_perm_b32 v239, v61, v57, s97
	v_mfma_f32_16x16x32_bf16 a[20:23], v[228:231], a[132:135], a[20:23]
	ds_read_b128 a[144:147], v5 offset:45056
	ds_read_b128 a[148:151], v5 offset:46080
	v_mfma_f32_16x16x32_bf16 a[24:27], v[228:231], a[136:139], a[24:27]
	buffer_load_dwordx4 v[164:167], v25, s[16:19], s64 offen
	v_mfma_f32_16x16x32_bf16 a[28:31], v[228:231], a[140:143], a[28:31]
	ds_read_b128 a[152:155], v5 offset:47104
	ds_read_b128 a[156:159], v5 offset:48128
	v_mfma_f32_16x16x32_bf16 v[200:203], v[232:235], a[128:131], v[200:203]
	v_perm_b32 v224, v38, v34, s96
	v_perm_b32 v225, v46, v42, s96
	v_mfma_f32_16x16x32_bf16 a[36:39], v[232:235], a[132:135], a[36:39]
	v_perm_b32 v226, v54, v50, s96
	v_perm_b32 v227, v62, v58, s96
	v_mfma_f32_16x16x32_bf16 a[40:43], v[232:235], a[136:139], a[40:43]
	buffer_load_dwordx4 v[168:171], v26, s[16:19], s64 offen
	v_mfma_f32_16x16x32_bf16 a[44:47], v[232:235], a[140:143], a[44:47]
	v_perm_b32 v228, v38, v34, s97
	v_perm_b32 v229, v46, v42, s97
	v_mfma_f32_16x16x32_bf16 v[204:207], v[236:239], a[128:131], v[204:207]
	v_perm_b32 v230, v54, v50, s97
	v_perm_b32 v231, v62, v58, s97
	v_mfma_f32_16x16x32_bf16 a[52:55], v[236:239], a[132:135], a[52:55]
	v_mfma_f32_16x16x32_bf16 a[56:59], v[236:239], a[136:139], a[56:59]
	buffer_load_dwordx4 v[172:175], v27, s[16:19], s64 offen
	v_mfma_f32_16x16x32_bf16 a[60:63], v[236:239], a[140:143], a[60:63]
	v_mfma_f32_16x16x32_bf16 v[208:211], v[224:227], a[128:131], v[208:211]
	v_perm_b32 v232, v39, v35, s96
	v_perm_b32 v233, v47, v43, s96
	v_mfma_f32_16x16x32_bf16 a[68:71], v[224:227], a[132:135], a[68:71]
	v_perm_b32 v234, v55, v51, s96
	v_perm_b32 v235, v63, v59, s96
	v_mfma_f32_16x16x32_bf16 a[72:75], v[224:227], a[136:139], a[72:75]
	buffer_load_dwordx4 v[176:179], v28, s[16:19], s64 offen
	v_mfma_f32_16x16x32_bf16 a[76:79], v[224:227], a[140:143], a[76:79]
	v_perm_b32 v236, v39, v35, s97
	v_perm_b32 v237, v47, v43, s97
	v_mfma_f32_16x16x32_bf16 v[212:215], v[228:231], a[128:131], v[212:215]
	v_perm_b32 v238, v55, v51, s97
	v_perm_b32 v239, v63, v59, s97
	v_mfma_f32_16x16x32_bf16 a[84:87], v[228:231], a[132:135], a[84:87]
	v_mfma_f32_16x16x32_bf16 a[88:91], v[228:231], a[136:139], a[88:91]
	buffer_load_dwordx4 v[180:183], v29, s[16:19], s64 offen
	v_mfma_f32_16x16x32_bf16 a[92:95], v[228:231], a[140:143], a[92:95]
	s_waitcnt vmcnt(22)
	s_nop 0
	v_mfma_f32_16x16x32_bf16 v[216:219], v[232:235], a[128:131], v[216:219]
	v_perm_b32 v224, v68, v64, s96
	v_perm_b32 v225, v76, v72, s96
	v_mfma_f32_16x16x32_bf16 a[100:103], v[232:235], a[132:135], a[100:103]
	v_perm_b32 v226, v84, v80, s96
	v_perm_b32 v227, v92, v88, s96
	v_mfma_f32_16x16x32_bf16 a[104:107], v[232:235], a[136:139], a[104:107]
	buffer_load_dwordx4 v[184:187], v30, s[16:19], s64 offen
	v_mfma_f32_16x16x32_bf16 a[108:111], v[232:235], a[140:143], a[108:111]
	v_perm_b32 v228, v68, v64, s97
	v_perm_b32 v229, v76, v72, s97
	v_mfma_f32_16x16x32_bf16 v[220:223], v[236:239], a[128:131], v[220:223]
	v_perm_b32 v230, v84, v80, s97
	v_perm_b32 v231, v92, v88, s97
	v_mfma_f32_16x16x32_bf16 a[116:119], v[236:239], a[132:135], a[116:119]
	v_mfma_f32_16x16x32_bf16 a[120:123], v[236:239], a[136:139], a[120:123]
	buffer_load_dwordx4 v[188:191], v31, s[16:19], s64 offen
	v_mfma_f32_16x16x32_bf16 a[124:127], v[236:239], a[140:143], a[124:127]
	s_waitcnt lgkmcnt(0)
	s_nop 0
	v_mfma_f32_16x16x32_bf16 v[192:195], v[224:227], a[144:147], v[192:195]
	s_add_u32 s64, s64, 262144
	v_perm_b32 v232, v69, v65, s96
	v_perm_b32 v233, v77, v73, s96
	v_mfma_f32_16x16x32_bf16 a[4:7], v[224:227], a[148:151], a[4:7]
	s_and_b32 s64, s64, 0x3fffff
	v_perm_b32 v234, v85, v81, s96
	v_perm_b32 v235, v93, v89, s96
	v_mfma_f32_16x16x32_bf16 a[8:11], v[224:227], a[152:155], a[8:11]
	buffer_load_dwordx4 v[32:35], v24, s[16:19], s64 offen
	v_mfma_f32_16x16x32_bf16 a[12:15], v[224:227], a[156:159], a[12:15]
	v_perm_b32 v236, v69, v65, s97
	v_perm_b32 v237, v77, v73, s97
	v_mfma_f32_16x16x32_bf16 v[196:199], v[228:231], a[144:147], v[196:199]
	v_perm_b32 v238, v85, v81, s97
	v_perm_b32 v239, v93, v89, s97
	v_mfma_f32_16x16x32_bf16 a[20:23], v[228:231], a[148:151], a[20:23]
	ds_read_b128 a[128:131], v4 offset:49152
	ds_read_b128 a[132:135], v4 offset:50176
	v_mfma_f32_16x16x32_bf16 a[24:27], v[228:231], a[152:155], a[24:27]
	buffer_load_dwordx4 v[36:39], v25, s[16:19], s64 offen
	v_mfma_f32_16x16x32_bf16 a[28:31], v[228:231], a[156:159], a[28:31]
	ds_read_b128 a[136:139], v4 offset:51200
	ds_read_b128 a[140:143], v4 offset:52224
	v_mfma_f32_16x16x32_bf16 v[200:203], v[232:235], a[144:147], v[200:203]
	v_perm_b32 v224, v70, v66, s96
	v_perm_b32 v225, v78, v74, s96
	v_mfma_f32_16x16x32_bf16 a[36:39], v[232:235], a[148:151], a[36:39]
	v_perm_b32 v226, v86, v82, s96
	v_perm_b32 v227, v94, v90, s96
	v_mfma_f32_16x16x32_bf16 a[40:43], v[232:235], a[152:155], a[40:43]
	buffer_load_dwordx4 v[40:43], v26, s[16:19], s64 offen
	v_mfma_f32_16x16x32_bf16 a[44:47], v[232:235], a[156:159], a[44:47]
	v_perm_b32 v228, v70, v66, s97
	v_perm_b32 v229, v78, v74, s97
	v_mfma_f32_16x16x32_bf16 v[204:207], v[236:239], a[144:147], v[204:207]
	v_perm_b32 v230, v86, v82, s97
	v_perm_b32 v231, v94, v90, s97
	v_mfma_f32_16x16x32_bf16 a[52:55], v[236:239], a[148:151], a[52:55]
	v_mfma_f32_16x16x32_bf16 a[56:59], v[236:239], a[152:155], a[56:59]
	buffer_load_dwordx4 v[44:47], v27, s[16:19], s64 offen
	v_mfma_f32_16x16x32_bf16 a[60:63], v[236:239], a[156:159], a[60:63]
	v_mfma_f32_16x16x32_bf16 v[208:211], v[224:227], a[144:147], v[208:211]
	v_perm_b32 v232, v71, v67, s96
	v_perm_b32 v233, v79, v75, s96
	v_mfma_f32_16x16x32_bf16 a[68:71], v[224:227], a[148:151], a[68:71]
	v_perm_b32 v234, v87, v83, s96
	v_perm_b32 v235, v95, v91, s96
	v_mfma_f32_16x16x32_bf16 a[72:75], v[224:227], a[152:155], a[72:75]
	buffer_load_dwordx4 v[48:51], v28, s[16:19], s64 offen
	v_mfma_f32_16x16x32_bf16 a[76:79], v[224:227], a[156:159], a[76:79]
	v_perm_b32 v236, v71, v67, s97
	v_perm_b32 v237, v79, v75, s97
	v_mfma_f32_16x16x32_bf16 v[212:215], v[228:231], a[144:147], v[212:215]
	v_perm_b32 v238, v87, v83, s97
	v_perm_b32 v239, v95, v91, s97
	v_mfma_f32_16x16x32_bf16 a[84:87], v[228:231], a[148:151], a[84:87]
	v_mfma_f32_16x16x32_bf16 a[88:91], v[228:231], a[152:155], a[88:91]
	buffer_load_dwordx4 v[52:55], v29, s[16:19], s64 offen
	v_mfma_f32_16x16x32_bf16 a[92:95], v[228:231], a[156:159], a[92:95]
	s_waitcnt vmcnt(22)
	s_nop 0
	v_mfma_f32_16x16x32_bf16 v[216:219], v[232:235], a[144:147], v[216:219]
	v_perm_b32 v224, v100, v96, s96
	v_perm_b32 v225, v108, v104, s96
	v_mfma_f32_16x16x32_bf16 a[100:103], v[232:235], a[148:151], a[100:103]
	v_perm_b32 v226, v116, v112, s96
	v_perm_b32 v227, v124, v120, s96
	v_mfma_f32_16x16x32_bf16 a[104:107], v[232:235], a[152:155], a[104:107]
	buffer_load_dwordx4 v[56:59], v30, s[16:19], s64 offen
	v_mfma_f32_16x16x32_bf16 a[108:111], v[232:235], a[156:159], a[108:111]
	v_perm_b32 v228, v100, v96, s97
	v_perm_b32 v229, v108, v104, s97
	v_mfma_f32_16x16x32_bf16 v[220:223], v[236:239], a[144:147], v[220:223]
	v_perm_b32 v230, v116, v112, s97
	v_perm_b32 v231, v124, v120, s97
	v_mfma_f32_16x16x32_bf16 a[116:119], v[236:239], a[148:151], a[116:119]
	v_mfma_f32_16x16x32_bf16 a[120:123], v[236:239], a[152:155], a[120:123]
	buffer_load_dwordx4 v[60:63], v31, s[16:19], s64 offen
	v_mfma_f32_16x16x32_bf16 a[124:127], v[236:239], a[156:159], a[124:127]
	s_waitcnt lgkmcnt(0)
	s_nop 0
	v_mfma_f32_16x16x32_bf16 v[192:195], v[224:227], a[128:131], v[192:195]
	v_perm_b32 v232, v101, v97, s96
	v_perm_b32 v233, v109, v105, s96
	v_mfma_f32_16x16x32_bf16 a[4:7], v[224:227], a[132:135], a[4:7]
	s_add_u32 m0, s69, 65536
	v_perm_b32 v234, v117, v113, s96
	v_perm_b32 v235, v125, v121, s96
	v_mfma_f32_16x16x32_bf16 a[8:11], v[224:227], a[136:139], a[8:11]
	buffer_load_dwordx4 v20, s[8:11], s65 offen lds
	v_mfma_f32_16x16x32_bf16 a[12:15], v[224:227], a[140:143], a[12:15]
	v_perm_b32 v236, v101, v97, s97
	v_perm_b32 v237, v109, v105, s97
	v_mfma_f32_16x16x32_bf16 v[196:199], v[228:231], a[128:131], v[196:199]
	v_perm_b32 v238, v117, v113, s97
	v_perm_b32 v239, v125, v121, s97
	v_mfma_f32_16x16x32_bf16 a[20:23], v[228:231], a[132:135], a[20:23]
	ds_read_b128 a[144:147], v5 offset:53248
	ds_read_b128 a[148:151], v5 offset:54272
	v_mfma_f32_16x16x32_bf16 a[24:27], v[228:231], a[136:139], a[24:27]
	buffer_load_dwordx4 v21, s[8:11], s65 offen offset:1024 lds
	v_mfma_f32_16x16x32_bf16 a[28:31], v[228:231], a[140:143], a[28:31]
	ds_read_b128 a[152:155], v5 offset:55296
	ds_read_b128 a[156:159], v5 offset:56320
	v_mfma_f32_16x16x32_bf16 v[200:203], v[232:235], a[128:131], v[200:203]
	v_perm_b32 v224, v102, v98, s96
	v_perm_b32 v225, v110, v106, s96
	v_mfma_f32_16x16x32_bf16 a[36:39], v[232:235], a[132:135], a[36:39]
	s_add_u32 m0, s69, 98304
	v_perm_b32 v226, v118, v114, s96
	v_perm_b32 v227, v126, v122, s96
	v_mfma_f32_16x16x32_bf16 a[40:43], v[232:235], a[136:139], a[40:43]
	buffer_load_dwordx4 v22, s[12:15], s65 offen lds
	v_mfma_f32_16x16x32_bf16 a[44:47], v[232:235], a[140:143], a[44:47]
	v_perm_b32 v228, v102, v98, s97
	v_perm_b32 v229, v110, v106, s97
	v_mfma_f32_16x16x32_bf16 v[204:207], v[236:239], a[128:131], v[204:207]
	v_perm_b32 v230, v118, v114, s97
	v_perm_b32 v231, v126, v122, s97
	v_mfma_f32_16x16x32_bf16 a[52:55], v[236:239], a[132:135], a[52:55]
	buffer_load_dwordx4 v23, s[12:15], s65 offen offset:1024 lds
	v_mfma_f32_16x16x32_bf16 a[56:59], v[236:239], a[136:139], a[56:59]
	s_add_u32 m0, s69, 73728
	v_accvgpr_read_b32 v240, a224
	v_mfma_f32_16x16x32_bf16 a[60:63], v[236:239], a[140:143], a[60:63]
	v_accvgpr_read_b32 v241, a225
	v_accvgpr_read_b32 v242, a226
	v_mfma_f32_16x16x32_bf16 v[208:211], v[224:227], a[128:131], v[208:211]
	v_perm_b32 v232, v103, v99, s96
	v_perm_b32 v233, v111, v107, s96
	v_mfma_f32_16x16x32_bf16 a[68:71], v[224:227], a[132:135], a[68:71]
	v_perm_b32 v234, v119, v115, s96
	v_perm_b32 v235, v127, v123, s96
	v_mfma_f32_16x16x32_bf16 a[72:75], v[224:227], a[136:139], a[72:75]
	buffer_load_dwordx4 v20, s[8:11], s82 offen lds
	v_mfma_f32_16x16x32_bf16 a[76:79], v[224:227], a[140:143], a[76:79]
	v_perm_b32 v236, v103, v99, s97
	v_perm_b32 v237, v111, v107, s97
	v_mfma_f32_16x16x32_bf16 v[212:215], v[228:231], a[128:131], v[212:215]
	v_perm_b32 v238, v119, v115, s97
	v_perm_b32 v239, v127, v123, s97
	v_mfma_f32_16x16x32_bf16 a[84:87], v[228:231], a[132:135], a[84:87]
	buffer_load_dwordx4 v21, s[8:11], s82 offen offset:1024 lds
	v_mfma_f32_16x16x32_bf16 a[88:91], v[228:231], a[136:139], a[88:91]
	s_add_u32 m0, s69, 106496
	v_accvgpr_read_b32 v243, a227
	v_accvgpr_read_b32 v244, a228
	v_mfma_f32_16x16x32_bf16 a[92:95], v[228:231], a[140:143], a[92:95]
	s_waitcnt vmcnt(22)
	s_nop 0
	v_accvgpr_read_b32 v245, a229
	v_accvgpr_read_b32 v246, a230
	v_mfma_f32_16x16x32_bf16 v[216:219], v[232:235], a[128:131], v[216:219]
	v_perm_b32 v224, v132, v128, s96
	v_perm_b32 v225, v140, v136, s96
	v_mfma_f32_16x16x32_bf16 a[100:103], v[232:235], a[132:135], a[100:103]
	v_perm_b32 v226, v148, v144, s96
	v_perm_b32 v227, v156, v152, s96
	v_mfma_f32_16x16x32_bf16 a[104:107], v[232:235], a[136:139], a[104:107]
	buffer_load_dwordx4 v22, s[12:15], s82 offen lds
	v_mfma_f32_16x16x32_bf16 a[108:111], v[232:235], a[140:143], a[108:111]
	v_perm_b32 v228, v132, v128, s97
	v_perm_b32 v229, v140, v136, s97
	v_mfma_f32_16x16x32_bf16 v[220:223], v[236:239], a[128:131], v[220:223]
	v_perm_b32 v230, v148, v144, s97
	v_perm_b32 v231, v156, v152, s97
	v_mfma_f32_16x16x32_bf16 a[116:119], v[236:239], a[132:135], a[116:119]
	buffer_load_dwordx4 v23, s[12:15], s82 offen offset:1024 lds
	v_mfma_f32_16x16x32_bf16 a[120:123], v[236:239], a[136:139], a[120:123]
	s_add_u32 s65, s65, 16384
	s_add_u32 s82, s82, 16384
	s_add_u32 m0, s69, 81920
	v_mfma_f32_16x16x32_bf16 a[124:127], v[236:239], a[140:143], a[124:127]
	s_waitcnt lgkmcnt(0)
	s_nop 0
	v_accvgpr_read_b32 v247, a231
	v_lshlrev_b32_e64 v64, 16, v240
	v_mfma_f32_16x16x32_bf16 v[192:195], v[224:227], a[144:147], v[192:195]
	v_perm_b32 v232, v133, v129, s96
	v_perm_b32 v233, v141, v137, s96
	v_mfma_f32_16x16x32_bf16 a[4:7], v[224:227], a[148:151], a[4:7]
	v_perm_b32 v234, v149, v145, s96
	v_perm_b32 v235, v157, v153, s96
	v_mfma_f32_16x16x32_bf16 a[8:11], v[224:227], a[152:155], a[8:11]
	buffer_load_dwordx4 v20, s[8:11], s65 offen lds
	v_mfma_f32_16x16x32_bf16 a[12:15], v[224:227], a[156:159], a[12:15]
	v_perm_b32 v236, v133, v129, s97
	v_perm_b32 v237, v141, v137, s97
	v_mfma_f32_16x16x32_bf16 v[196:199], v[228:231], a[144:147], v[196:199]
	v_perm_b32 v238, v149, v145, s97
	v_perm_b32 v239, v157, v153, s97
	v_mfma_f32_16x16x32_bf16 a[20:23], v[228:231], a[148:151], a[20:23]
	ds_read_b128 a[128:131], v4 offset:57344
	ds_read_b128 a[132:135], v4 offset:58368
	v_mfma_f32_16x16x32_bf16 a[24:27], v[228:231], a[152:155], a[24:27]
	buffer_load_dwordx4 v21, s[8:11], s65 offen offset:1024 lds
	v_mfma_f32_16x16x32_bf16 a[28:31], v[228:231], a[156:159], a[28:31]
	ds_read_b128 a[136:139], v4 offset:59392
	ds_read_b128 a[140:143], v4 offset:60416
	v_mfma_f32_16x16x32_bf16 v[200:203], v[232:235], a[144:147], v[200:203]
	v_perm_b32 v224, v134, v130, s96
	v_perm_b32 v225, v142, v138, s96
	v_mfma_f32_16x16x32_bf16 a[36:39], v[232:235], a[148:151], a[36:39]
	s_add_u32 m0, s69, 114688
	v_perm_b32 v226, v150, v146, s96
	v_perm_b32 v227, v158, v154, s96
	v_mfma_f32_16x16x32_bf16 a[40:43], v[232:235], a[152:155], a[40:43]
	buffer_load_dwordx4 v22, s[12:15], s65 offen lds
	v_mfma_f32_16x16x32_bf16 a[44:47], v[232:235], a[156:159], a[44:47]
	v_perm_b32 v228, v134, v130, s97
	v_perm_b32 v229, v142, v138, s97
	v_mfma_f32_16x16x32_bf16 v[204:207], v[236:239], a[144:147], v[204:207]
	v_perm_b32 v230, v150, v146, s97
	v_perm_b32 v231, v158, v154, s97
	v_mfma_f32_16x16x32_bf16 a[52:55], v[236:239], a[148:151], a[52:55]
	buffer_load_dwordx4 v23, s[12:15], s65 offen offset:1024 lds
	v_mfma_f32_16x16x32_bf16 a[56:59], v[236:239], a[152:155], a[56:59]
	s_add_u32 m0, s69, 90112
	v_and_b32 v65, 0xffff0000, v240
	v_lshlrev_b32_e64 v66, 16, v241
	v_mfma_f32_16x16x32_bf16 a[60:63], v[236:239], a[156:159], a[60:63]
	v_and_b32 v67, 0xffff0000, v241
	v_lshlrev_b32_e64 v68, 16, v242
	v_mfma_f32_16x16x32_bf16 v[208:211], v[224:227], a[144:147], v[208:211]
	v_perm_b32 v232, v135, v131, s96
	v_perm_b32 v233, v143, v139, s96
	v_mfma_f32_16x16x32_bf16 a[68:71], v[224:227], a[148:151], a[68:71]
	v_perm_b32 v234, v151, v147, s96
	v_perm_b32 v235, v159, v155, s96
	v_mfma_f32_16x16x32_bf16 a[72:75], v[224:227], a[152:155], a[72:75]
	buffer_load_dwordx4 v20, s[8:11], s82 offen lds
	v_mfma_f32_16x16x32_bf16 a[76:79], v[224:227], a[156:159], a[76:79]
	v_perm_b32 v236, v135, v131, s97
	v_perm_b32 v237, v143, v139, s97
	v_mfma_f32_16x16x32_bf16 v[212:215], v[228:231], a[144:147], v[212:215]
	v_perm_b32 v238, v151, v147, s97
	v_perm_b32 v239, v159, v155, s97
	v_mfma_f32_16x16x32_bf16 a[84:87], v[228:231], a[148:151], a[84:87]
	buffer_load_dwordx4 v21, s[8:11], s82 offen offset:1024 lds
	v_mfma_f32_16x16x32_bf16 a[88:91], v[228:231], a[152:155], a[88:91]
	s_add_u32 m0, s69, 122880
	v_and_b32 v69, 0xffff0000, v242
	v_lshlrev_b32_e64 v70, 16, v243
	v_mfma_f32_16x16x32_bf16 a[92:95], v[228:231], a[156:159], a[92:95]
	s_waitcnt vmcnt(22)
	s_nop 0
	v_and_b32 v71, 0xffff0000, v243
	v_mul_f32_e64 v72, v64, v248
	v_mfma_f32_16x16x32_bf16 v[216:219], v[232:235], a[144:147], v[216:219]
	v_perm_b32 v224, v164, v160, s96
	v_perm_b32 v225, v172, v168, s96
	v_mfma_f32_16x16x32_bf16 a[100:103], v[232:235], a[148:151], a[100:103]
	v_perm_b32 v226, v180, v176, s96
	v_perm_b32 v227, v188, v184, s96
	v_mfma_f32_16x16x32_bf16 a[104:107], v[232:235], a[152:155], a[104:107]
	buffer_load_dwordx4 v22, s[12:15], s82 offen lds
	v_mfma_f32_16x16x32_bf16 a[108:111], v[232:235], a[156:159], a[108:111]
	v_perm_b32 v228, v164, v160, s97
	v_perm_b32 v229, v172, v168, s97
	v_mfma_f32_16x16x32_bf16 v[220:223], v[236:239], a[144:147], v[220:223]
	v_perm_b32 v230, v180, v176, s97
	v_perm_b32 v231, v188, v184, s97
	v_mfma_f32_16x16x32_bf16 a[116:119], v[236:239], a[148:151], a[116:119]
	buffer_load_dwordx4 v23, s[12:15], s82 offen offset:1024 lds
	v_mfma_f32_16x16x32_bf16 a[120:123], v[236:239], a[152:155], a[120:123]
	s_add_u32 s65, s65, 16384
	s_add_u32 s82, s82, 16384
	v_mul_f32_e64 v73, v65, v248
	v_mfma_f32_16x16x32_bf16 a[124:127], v[236:239], a[156:159], a[124:127]
	s_waitcnt lgkmcnt(0)
	v_mul_f32 v74, v66, v248
	v_mul_f32_e64 v75, v67, v248
	v_mfma_f32_16x16x32_bf16 v[192:195], v[224:227], a[128:131], v[192:195]
	v_perm_b32 v232, v165, v161, s96
	v_perm_b32 v233, v173, v169, s96
	v_mfma_f32_16x16x32_bf16 a[4:7], v[224:227], a[132:135], a[4:7]
	v_perm_b32 v234, v181, v177, s96
	v_perm_b32 v235, v189, v185, s96
	v_mfma_f32_16x16x32_bf16 a[8:11], v[224:227], a[136:139], a[8:11]
	v_mul_f32 v76, v68, v248
	v_mul_f32 v77, v69, v248
	v_mfma_f32_16x16x32_bf16 a[12:15], v[224:227], a[140:143], a[12:15]
	v_perm_b32 v236, v165, v161, s97
	v_perm_b32 v237, v173, v169, s97
	v_mfma_f32_16x16x32_bf16 v[196:199], v[228:231], a[128:131], v[196:199]
	v_perm_b32 v238, v181, v177, s97
	v_perm_b32 v239, v189, v185, s97
	v_mfma_f32_16x16x32_bf16 a[20:23], v[228:231], a[132:135], a[20:23]
	ds_read_b128 a[144:147], v5 offset:61440
	ds_read_b128 a[148:151], v5 offset:62464
	v_mfma_f32_16x16x32_bf16 a[24:27], v[228:231], a[136:139], a[24:27]
	v_mul_f32 v78, v70, v248
	v_mul_f32 v79, v71, v248
	v_mfma_f32_16x16x32_bf16 a[28:31], v[228:231], a[140:143], a[28:31]
	ds_read_b128 a[152:155], v5 offset:63488
	ds_read_b128 a[156:159], v5 offset:64512
	v_mfma_f32_16x16x32_bf16 v[200:203], v[232:235], a[128:131], v[200:203]
	v_perm_b32 v224, v166, v162, s96
	v_perm_b32 v225, v174, v170, s96
	v_mfma_f32_16x16x32_bf16 a[36:39], v[232:235], a[132:135], a[36:39]
	v_perm_b32 v226, v182, v178, s96
	v_perm_b32 v227, v190, v186, s96
	v_mfma_f32_16x16x32_bf16 a[40:43], v[232:235], a[136:139], a[40:43]
	v_lshlrev_b32_e64 v64, 16, v244
	v_and_b32 v65, 0xffff0000, v244
	v_mfma_f32_16x16x32_bf16 a[44:47], v[232:235], a[140:143], a[44:47]
	v_perm_b32 v228, v166, v162, s97
	v_perm_b32 v229, v174, v170, s97
	v_mfma_f32_16x16x32_bf16 v[204:207], v[236:239], a[128:131], v[204:207]
	v_perm_b32 v230, v182, v178, s97
	v_perm_b32 v231, v190, v186, s97
	v_mfma_f32_16x16x32_bf16 a[52:55], v[236:239], a[132:135], a[52:55]
	v_lshlrev_b32_e64 v66, 16, v245
	v_and_b32 v67, 0xffff0000, v245
	v_mfma_f32_16x16x32_bf16 a[56:59], v[236:239], a[136:139], a[56:59]
	v_lshlrev_b32_e64 v68, 16, v246
	v_and_b32 v69, 0xffff0000, v246
	v_mfma_f32_16x16x32_bf16 a[60:63], v[236:239], a[140:143], a[60:63]
	v_lshlrev_b32_e64 v70, 16, v247
	v_and_b32 v71, 0xffff0000, v247
	v_mfma_f32_16x16x32_bf16 v[208:211], v[224:227], a[128:131], v[208:211]
	v_perm_b32 v232, v167, v163, s96
	v_perm_b32 v233, v175, v171, s96
	v_mfma_f32_16x16x32_bf16 a[68:71], v[224:227], a[132:135], a[68:71]
	v_perm_b32 v234, v183, v179, s96
	v_perm_b32 v235, v191, v187, s96
	v_mfma_f32_16x16x32_bf16 a[72:75], v[224:227], a[136:139], a[72:75]
	v_fmac_f32 v72, v64, v249
	v_fmac_f32 v73, v65, v249
	v_mfma_f32_16x16x32_bf16 a[76:79], v[224:227], a[140:143], a[76:79]
	v_perm_b32 v236, v167, v163, s97
	v_perm_b32 v237, v175, v171, s97
	v_mfma_f32_16x16x32_bf16 v[212:215], v[228:231], a[128:131], v[212:215]
	v_perm_b32 v238, v183, v179, s97
	v_perm_b32 v239, v191, v187, s97
	v_mfma_f32_16x16x32_bf16 a[84:87], v[228:231], a[132:135], a[84:87]
	v_fmac_f32 v74, v66, v249
	v_fmac_f32 v75, v67, v249
	v_mfma_f32_16x16x32_bf16 a[88:91], v[228:231], a[136:139], a[88:91]
	v_fmac_f32 v76, v68, v249
	v_fmac_f32 v77, v69, v249
	v_mfma_f32_16x16x32_bf16 a[92:95], v[228:231], a[140:143], a[92:95]
	s_waitcnt vmcnt(16)
	v_fmac_f32 v78, v70, v249
	v_fmac_f32_e64 v79, v71, v249
	v_mfma_f32_16x16x32_bf16 v[216:219], v[232:235], a[128:131], v[216:219]
	v_perm_b32 v224, v36, v32, s96
	v_perm_b32 v225, v44, v40, s96
	v_mfma_f32_16x16x32_bf16 a[100:103], v[232:235], a[132:135], a[100:103]
	v_perm_b32 v226, v52, v48, s96
	v_perm_b32 v227, v60, v56, s96
	v_mfma_f32_16x16x32_bf16 a[104:107], v[232:235], a[136:139], a[104:107]
	s_add_u32 s60, s68, 131072
	v_lshrrev_b32_e64 v80, 4, v2
	v_lshl_add_u32 v80, v80, 3, s60
	v_mfma_f32_16x16x32_bf16 a[108:111], v[232:235], a[140:143], a[108:111]
	v_perm_b32 v228, v36, v32, s97
	v_perm_b32 v229, v44, v40, s97
	v_mfma_f32_16x16x32_bf16 v[220:223], v[236:239], a[128:131], v[220:223]
	v_perm_b32 v230, v52, v48, s97
	v_perm_b32 v231, v60, v56, s97
	v_mfma_f32_16x16x32_bf16 a[116:119], v[236:239], a[132:135], a[116:119]
	v_and_b32_e64 v7, 7, v2
	v_lshl_add_u32 v80, v7, 5, v80
	v_mfma_f32_16x16x32_bf16 a[120:123], v[236:239], a[136:139], a[120:123]
	v_permlane32_swap_b32 v72, v76
	v_permlane32_swap_b32 v73, v77
	v_mfma_f32_16x16x32_bf16 a[124:127], v[236:239], a[140:143], a[124:127]
	s_waitcnt lgkmcnt(0)
	v_permlane32_swap_b32 v74, v78
	v_permlane32_swap_b32 v75, v79
	s_nop 0
	v_mfma_f32_16x16x32_bf16 v[192:195], v[224:227], a[144:147], v[192:195]
	v_perm_b32 v232, v37, v33, s96
	v_perm_b32 v233, v45, v41, s96
	v_mfma_f32_16x16x32_bf16 a[4:7], v[224:227], a[148:151], a[4:7]
	v_perm_b32 v234, v53, v49, s96
	v_perm_b32 v235, v61, v57, s96
	v_mfma_f32_16x16x32_bf16 a[8:11], v[224:227], a[152:155], a[8:11]
	v_add_f32 v72, v72, v76
	v_add_f32 v73, v73, v77
	v_mfma_f32_16x16x32_bf16 a[12:15], v[224:227], a[156:159], a[12:15]
	v_perm_b32 v236, v37, v33, s97
	v_perm_b32 v237, v45, v41, s97
	v_mfma_f32_16x16x32_bf16 v[196:199], v[228:231], a[144:147], v[196:199]
	v_perm_b32 v238, v53, v49, s97
	v_perm_b32 v239, v61, v57, s97
	v_mfma_f32_16x16x32_bf16 a[20:23], v[228:231], a[148:151], a[20:23]
	v_add_f32 v74, v74, v78
	v_add_f32 v75, v75, v79
	v_mfma_f32_16x16x32_bf16 a[24:27], v[228:231], a[152:155], a[24:27]
	v_lshlrev_b32 v7, 2, v2
	v_permlane16_swap_b32 v72, v74
	v_mfma_f32_16x16x32_bf16 a[28:31], v[228:231], a[156:159], a[28:31]
	v_permlane16_swap_b32 v73, v75
	v_add_f32 v72, v72, v74
	v_mfma_f32_16x16x32_bf16 v[200:203], v[232:235], a[144:147], v[200:203]
	v_perm_b32 v224, v38, v34, s96
	v_perm_b32 v225, v46, v42, s96
	v_mfma_f32_16x16x32_bf16 a[36:39], v[232:235], a[148:151], a[36:39]
	v_perm_b32 v226, v54, v50, s96
	v_perm_b32 v227, v62, v58, s96
	v_mfma_f32_16x16x32_bf16 a[40:43], v[232:235], a[152:155], a[40:43]
	v_add_f32_e64 v73, v73, v75
	v_add_u32 v84, 131072, v7
	v_mfma_f32_16x16x32_bf16 a[44:47], v[232:235], a[156:159], a[44:47]
	v_perm_b32 v228, v38, v34, s97
	v_perm_b32 v229, v46, v42, s97
	v_mfma_f32_16x16x32_bf16 v[204:207], v[236:239], a[144:147], v[204:207]
	v_perm_b32 v230, v54, v50, s97
	v_perm_b32 v231, v62, v58, s97
	v_mfma_f32_16x16x32_bf16 a[52:55], v[236:239], a[148:151], a[52:55]
	v_add_f32_dpp v72, v72, v72 row_ror:8 row_mask:0xf bank_mask:0xf
	v_add_f32_dpp v73, v73, v73 row_ror:8 row_mask:0xf bank_mask:0xf
	v_mfma_f32_16x16x32_bf16 a[56:59], v[236:239], a[152:155], a[56:59]
	ds_write_b64 v80, v[72:73]
	v_and_b32_e64 v85, 2, v0
	v_mfma_f32_16x16x32_bf16 a[60:63], v[236:239], a[156:159], a[60:63]
	v_and_b32 v86, 4, v0
	v_lshlrev_b32 v85, 1, v85
	v_mfma_f32_16x16x32_bf16 v[208:211], v[224:227], a[144:147], v[208:211]
	v_perm_b32 v232, v39, v35, s96
	v_perm_b32 v233, v47, v43, s96
	v_mfma_f32_16x16x32_bf16 a[68:71], v[224:227], a[148:151], a[68:71]
	v_perm_b32 v234, v55, v51, s96
	v_perm_b32 v235, v63, v59, s96
	v_mfma_f32_16x16x32_bf16 a[72:75], v[224:227], a[152:155], a[72:75]
	v_lshl_or_b32 v85, v86, 2, v85
	v_and_b32_e64 v86, 1, v0
	v_mfma_f32_16x16x32_bf16 a[76:79], v[224:227], a[156:159], a[76:79]
	v_perm_b32 v236, v39, v35, s97
	v_perm_b32 v237, v47, v43, s97
	v_mfma_f32_16x16x32_bf16 v[212:215], v[228:231], a[144:147], v[212:215]
	v_perm_b32 v238, v55, v51, s97
	v_perm_b32 v239, v63, v59, s97
	v_mfma_f32_16x16x32_bf16 a[84:87], v[228:231], a[148:151], a[84:87]
	v_lshl_or_b32 v85, v86, 30, v85
	v_bfe_u32 v81, v0, 2, 3
	v_mfma_f32_16x16x32_bf16 a[88:91], v[228:231], a[152:155], a[88:91]
	v_and_b32 v82, 3, v0
	v_lshlrev_b32 v81, 10, v81
	v_mfma_f32_16x16x32_bf16 a[92:95], v[228:231], a[156:159], a[92:95]
	s_lshl_b32 s62, s59, 2
	s_add_u32 s62, s62, s56
	v_lshl_or_b32 v81, v82, 8, v81
	v_mfma_f32_16x16x32_bf16 v[216:219], v[232:235], a[144:147], v[216:219]
	s_lshl_b32 s61, s62, 13
	s_add_u32 s61, s61, s70
	v_mfma_f32_16x16x32_bf16 a[100:103], v[232:235], a[148:151], a[100:103]
	buffer_load_dword a244, v81, s[20:23], s61 offen offset:0
	v_mfma_f32_16x16x32_bf16 a[104:107], v[232:235], a[152:155], a[104:107]
	v_bfe_u32 v81, v0, 2, 3
	v_and_b32_e64 v82, 3, v0
	v_mfma_f32_16x16x32_bf16 a[108:111], v[232:235], a[156:159], a[108:111]
	s_lshl_b32 s62, s59, 2
	v_lshlrev_b32 v81, 10, v81
	v_lshl_or_b32 v81, v82, 8, v81
	v_mfma_f32_16x16x32_bf16 v[220:223], v[236:239], a[144:147], v[220:223]
	s_add_u32 s62, s62, s56
	s_lshl_b32 s61, s62, 13
	s_add_u32 s61, s61, s70
	s_nop 0
	v_mfma_f32_16x16x32_bf16 a[116:119], v[236:239], a[148:151], a[116:119]
	buffer_load_dword a244, v81, s[20:23], s61 offen offset:128
	v_mfma_f32_16x16x32_bf16 a[120:123], v[236:239], a[152:155], a[120:123]
	v_mfma_f32_16x16x32_bf16 a[124:127], v[236:239], a[156:159], a[124:127]
	s_nop 1
	s_waitcnt vmcnt(10) lgkmcnt(0)
	s_barrier
	s_nop 0
	ds_read_b32 v128, v84 offset:0
	ds_read_b32 v129, v84 offset:4096
	ds_read_b32 v130, v84 offset:8192
	ds_read_b32 v131, v84 offset:12288
	ds_read_b128 a[160:163], v8 offset:0
	ds_read_b128 a[176:179], v8 offset:4096
	ds_read_b128 a[164:167], v9 offset:0
	ds_read_b128 a[180:183], v9 offset:4096
	ds_read_b128 a[168:171], v10 offset:0
	ds_read_b128 a[184:187], v10 offset:4096
	ds_read_b128 a[172:175], v11 offset:0
	ds_read_b128 a[188:191], v11 offset:4096
	v_mov_b32_e64 v2, v253
	v_add_u32 v3, 7168, v253
	v_add_u32 v4, 14336, v253
	v_add_u32 v5, 21504, v253
	v_cvt_pk_bf16_f32 v64, v192, v196
	v_cvt_pk_bf16_f32 v65, v200, v204
	v_cvt_pk_bf16_f32 v66, v208, v212
	v_cvt_pk_bf16_f32 v67, v216, v220
	v_cvt_pk_bf16_f32 v80, v193, v197
	v_cvt_pk_bf16_f32 v81, v201, v205
	v_cvt_pk_bf16_f32 v82, v209, v213
	v_cvt_pk_bf16_f32 v83, v217, v221
	v_cvt_pk_bf16_f32 v96, v194, v198
	v_cvt_pk_bf16_f32 v97, v202, v206
	v_cvt_pk_bf16_f32 v98, v210, v214
	v_cvt_pk_bf16_f32 v99, v218, v222
	v_cvt_pk_bf16_f32 v112, v195, v199
	v_cvt_pk_bf16_f32 v113, v203, v207
	v_cvt_pk_bf16_f32 v114, v211, v215
	v_cvt_pk_bf16_f32 v115, v219, v223
	ds_read_b128 a[192:195], v8 offset:8192
	ds_read_b128 a[208:211], v8 offset:12288
	ds_read_b128 a[196:199], v9 offset:8192
	ds_read_b128 a[212:215], v9 offset:12288
	ds_read_b128 a[200:203], v10 offset:8192
	ds_read_b128 a[216:219], v10 offset:12288
	ds_read_b128 a[204:207], v11 offset:8192
	ds_read_b128 a[220:223], v11 offset:12288
	s_waitcnt lgkmcnt(15)
	v_add_f32 v128, v128, v129
	v_add_f32 v130, v130, v131
	v_add_f32 v128, v128, v130
	buffer_store_dword a248, v85, s[32:35], s89 offen sc1
	buffer_store_dword v128, v7, s[32:35], s93 offen sc1
	s_waitcnt lgkmcnt(8)
	s_nop 0
	v_mfma_f32_16x16x32_bf16 v[140:143], a[160:163], v[64:67], 0
	v_accvgpr_read_b32 v32, a4
	v_accvgpr_read_b32 v33, a20
	v_accvgpr_read_b32 v34, a36
	v_accvgpr_read_b32 v35, a52
	v_cvt_pk_bf16_f32 v68, v32, v33
	v_cvt_pk_bf16_f32 v69, v34, v35
	v_mfma_f32_16x16x32_bf16 v[156:159], a[176:179], v[64:67], 0
	v_accvgpr_read_b32 v36, a68
	v_accvgpr_read_b32 v37, a84
	v_accvgpr_read_b32 v38, a100
	v_accvgpr_read_b32 v39, a116
	v_cvt_pk_bf16_f32 v70, v36, v37
	v_cvt_pk_bf16_f32 v71, v38, v39
	v_mfma_f32_16x16x32_bf16 v[140:143], a[164:167], v[80:83], v[140:143]
	v_accvgpr_read_b32 v40, a5
	v_accvgpr_read_b32 v41, a21
	v_accvgpr_read_b32 v42, a37
	v_accvgpr_read_b32 v43, a53
	v_cvt_pk_bf16_f32 v84, v40, v41
	v_cvt_pk_bf16_f32 v85, v42, v43
	v_mfma_f32_16x16x32_bf16 v[156:159], a[180:183], v[80:83], v[156:159]
	v_accvgpr_read_b32 v44, a69
	v_accvgpr_read_b32 v45, a85
	v_accvgpr_read_b32 v46, a101
	v_accvgpr_read_b32 v47, a117
	v_cvt_pk_bf16_f32 v86, v44, v45
	v_cvt_pk_bf16_f32 v87, v46, v47
	v_mfma_f32_16x16x32_bf16 v[140:143], a[168:171], v[96:99], v[140:143]
	v_accvgpr_read_b32 v32, a6
	v_accvgpr_read_b32 v33, a22
	v_accvgpr_read_b32 v34, a38
	v_accvgpr_read_b32 v35, a54
	v_cvt_pk_bf16_f32 v100, v32, v33
	v_cvt_pk_bf16_f32 v101, v34, v35
	v_mfma_f32_16x16x32_bf16 v[156:159], a[184:187], v[96:99], v[156:159]
	v_accvgpr_read_b32 v36, a70
	v_accvgpr_read_b32 v37, a86
	v_accvgpr_read_b32 v38, a102
	v_accvgpr_read_b32 v39, a118
	v_cvt_pk_bf16_f32 v102, v36, v37
	v_cvt_pk_bf16_f32 v103, v38, v39
	v_mfma_f32_16x16x32_bf16 v[140:143], a[172:175], v[112:115], v[140:143]
	v_accvgpr_read_b32 v40, a7
	v_accvgpr_read_b32 v41, a23
	v_accvgpr_read_b32 v42, a39
	v_accvgpr_read_b32 v43, a55
	v_cvt_pk_bf16_f32 v116, v40, v41
	v_cvt_pk_bf16_f32 v117, v42, v43
	v_mfma_f32_16x16x32_bf16 v[156:159], a[188:191], v[112:115], v[156:159]
	v_accvgpr_read_b32 v44, a71
	v_accvgpr_read_b32 v45, a87
	v_accvgpr_read_b32 v46, a103
	v_accvgpr_read_b32 v47, a119
	v_cvt_pk_bf16_f32 v118, v44, v45
	v_cvt_pk_bf16_f32 v119, v46, v47
	v_mfma_f32_16x16x32_bf16 v[172:175], a[160:163], v[68:71], 0
	v_accvgpr_read_b32 v32, a8
	v_accvgpr_read_b32 v33, a24
	v_accvgpr_read_b32 v34, a40
	v_accvgpr_read_b32 v35, a56
	v_cvt_pk_bf16_f32 v72, v32, v33
	v_cvt_pk_bf16_f32 v73, v34, v35
	v_mfma_f32_16x16x32_bf16 v[188:191], a[176:179], v[68:71], 0
	v_accvgpr_read_b32 v36, a72
	v_accvgpr_read_b32 v37, a88
	v_accvgpr_read_b32 v38, a104
	v_accvgpr_read_b32 v39, a120
	v_cvt_pk_bf16_f32 v74, v36, v37
	v_cvt_pk_bf16_f32 v75, v38, v39
	v_mfma_f32_16x16x32_bf16 v[172:175], a[164:167], v[84:87], v[172:175]
	v_accvgpr_read_b32 v40, a9
	v_accvgpr_read_b32 v41, a25
	v_accvgpr_read_b32 v42, a41
	v_accvgpr_read_b32 v43, a57
	v_cvt_pk_bf16_f32 v88, v40, v41
	v_cvt_pk_bf16_f32 v89, v42, v43
	v_mfma_f32_16x16x32_bf16 v[188:191], a[180:183], v[84:87], v[188:191]
	v_accvgpr_read_b32 v44, a73
	v_accvgpr_read_b32 v45, a89
	v_accvgpr_read_b32 v46, a105
	v_accvgpr_read_b32 v47, a121
	v_cvt_pk_bf16_f32 v90, v44, v45
	v_cvt_pk_bf16_f32 v91, v46, v47
	v_mfma_f32_16x16x32_bf16 v[172:175], a[168:171], v[100:103], v[172:175]
	v_accvgpr_read_b32 v32, a10
	v_accvgpr_read_b32 v33, a26
	v_accvgpr_read_b32 v34, a42
	v_accvgpr_read_b32 v35, a58
	v_cvt_pk_bf16_f32 v104, v32, v33
	v_cvt_pk_bf16_f32 v105, v34, v35
	v_mfma_f32_16x16x32_bf16 v[188:191], a[184:187], v[100:103], v[188:191]
	v_accvgpr_read_b32 v36, a74
	v_accvgpr_read_b32 v37, a90
	v_accvgpr_read_b32 v38, a106
	v_accvgpr_read_b32 v39, a122
	v_cvt_pk_bf16_f32 v106, v36, v37
	v_cvt_pk_bf16_f32 v107, v38, v39
	v_mfma_f32_16x16x32_bf16 v[172:175], a[172:175], v[116:119], v[172:175]
	v_accvgpr_read_b32 v40, a11
	v_accvgpr_read_b32 v41, a27
	v_accvgpr_read_b32 v42, a43
	v_accvgpr_read_b32 v43, a59
	v_cvt_pk_bf16_f32 v120, v40, v41
	v_cvt_pk_bf16_f32 v121, v42, v43
	v_mfma_f32_16x16x32_bf16 v[188:191], a[188:191], v[116:119], v[188:191]
	v_accvgpr_read_b32 v44, a75
	v_accvgpr_read_b32 v45, a91
	v_accvgpr_read_b32 v46, a107
	v_accvgpr_read_b32 v47, a123
	v_cvt_pk_bf16_f32 v122, v44, v45
	v_cvt_pk_bf16_f32 v123, v46, v47
	v_mfma_f32_16x16x32_bf16 v[204:207], a[160:163], v[72:75], 0
	v_accvgpr_read_b32 v32, a12
	v_accvgpr_read_b32 v33, a28
	v_accvgpr_read_b32 v34, a44
	v_accvgpr_read_b32 v35, a60
	v_cvt_pk_bf16_f32 v76, v32, v33
	v_cvt_pk_bf16_f32 v77, v34, v35
	v_mfma_f32_16x16x32_bf16 v[220:223], a[176:179], v[72:75], 0
	v_accvgpr_read_b32 v36, a76
	v_accvgpr_read_b32 v37, a92
	v_accvgpr_read_b32 v38, a108
	v_accvgpr_read_b32 v39, a124
	v_cvt_pk_bf16_f32 v78, v36, v37
	v_cvt_pk_bf16_f32 v79, v38, v39
	v_mfma_f32_16x16x32_bf16 v[204:207], a[164:167], v[88:91], v[204:207]
	v_accvgpr_read_b32 v40, a13
	v_accvgpr_read_b32 v41, a29
	v_accvgpr_read_b32 v42, a45
	v_accvgpr_read_b32 v43, a61
	v_cvt_pk_bf16_f32 v92, v40, v41
	v_cvt_pk_bf16_f32 v93, v42, v43
	v_mfma_f32_16x16x32_bf16 v[220:223], a[180:183], v[88:91], v[220:223]
	v_accvgpr_read_b32 v44, a77
	v_accvgpr_read_b32 v45, a93
	v_accvgpr_read_b32 v46, a109
	v_accvgpr_read_b32 v47, a125
	v_cvt_pk_bf16_f32 v94, v44, v45
	v_cvt_pk_bf16_f32 v95, v46, v47
	v_mfma_f32_16x16x32_bf16 v[204:207], a[168:171], v[104:107], v[204:207]
	v_accvgpr_read_b32 v32, a14
	v_accvgpr_read_b32 v33, a30
	v_accvgpr_read_b32 v34, a46
	v_accvgpr_read_b32 v35, a62
	v_cvt_pk_bf16_f32 v108, v32, v33
	v_cvt_pk_bf16_f32 v109, v34, v35
	v_mfma_f32_16x16x32_bf16 v[220:223], a[184:187], v[104:107], v[220:223]
	v_accvgpr_read_b32 v36, a78
	v_accvgpr_read_b32 v37, a94
	v_accvgpr_read_b32 v38, a110
	v_accvgpr_read_b32 v39, a126
	v_cvt_pk_bf16_f32 v110, v36, v37
	v_cvt_pk_bf16_f32 v111, v38, v39
	v_mfma_f32_16x16x32_bf16 v[204:207], a[172:175], v[120:123], v[204:207]
	v_accvgpr_read_b32 v40, a15
	v_accvgpr_read_b32 v41, a31
	v_accvgpr_read_b32 v42, a47
	v_accvgpr_read_b32 v43, a63
	v_cvt_pk_bf16_f32 v124, v40, v41
	v_cvt_pk_bf16_f32 v125, v42, v43
	v_mfma_f32_16x16x32_bf16 v[220:223], a[188:191], v[120:123], v[220:223]
	v_accvgpr_read_b32 v44, a79
	v_accvgpr_read_b32 v45, a95
	v_accvgpr_read_b32 v46, a111
	v_accvgpr_read_b32 v47, a127
	v_cvt_pk_bf16_f32 v126, v44, v45
	v_cvt_pk_bf16_f32 v127, v46, v47
	ds_read_b64_tr_b16 a[0:1], v12 offset:0
	ds_read_b64_tr_b16 a[2:3], v12 offset:4096
	ds_read_b64_tr_b16 a[4:5], v13 offset:0
	ds_read_b64_tr_b16 a[6:7], v13 offset:4096
	ds_read_b64_tr_b16 a[8:9], v14 offset:0
	ds_read_b64_tr_b16 a[10:11], v14 offset:4096
	ds_read_b64_tr_b16 a[12:13], v15 offset:0
	ds_read_b64_tr_b16 a[14:15], v15 offset:4096
	ds_read_b64_tr_b16 a[16:17], v16 offset:0
	ds_read_b64_tr_b16 a[18:19], v16 offset:4096
	ds_read_b64_tr_b16 a[20:21], v17 offset:0
	ds_read_b64_tr_b16 a[22:23], v17 offset:4096
	ds_read_b64_tr_b16 a[24:25], v18 offset:0
	ds_read_b64_tr_b16 a[26:27], v18 offset:4096
	ds_read_b64_tr_b16 a[28:29], v19 offset:0
	ds_read_b64_tr_b16 a[30:31], v19 offset:4096
	v_mfma_f32_16x16x32_bf16 v[236:239], a[160:163], v[76:79], 0
	v_max3_f32 v48, v140, v141, v142
	v_max3_f32 v52, v172, v173, v174
	v_max3_f32 v49, v143, v156, v157
	v_max3_f32 v53, v175, v188, v189
	v_max3_f32 v48, v48, v158, v159
	v_max3_f32 v52, v52, v190, v191
	v_mfma_f32_16x16x32_bf16 v[252:255], a[176:179], v[76:79], 0
	v_max_f32 v48, v48, v49
	v_max_f32 v52, v52, v53
	v_mov_b32 v49, v48
	v_mov_b32 v53, v52
	s_nop 0
	v_permlane16_swap_b32 v48, v49
	v_mfma_f32_16x16x32_bf16 v[236:239], a[164:167], v[92:95], v[236:239]
	v_permlane16_swap_b32 v52, v53
	v_max_f32 v48, v48, v49
	v_max_f32 v52, v52, v53
	v_mov_b32 v49, v48
	v_mov_b32 v53, v52
	s_nop 0
	v_mfma_f32_16x16x32_bf16 v[252:255], a[180:183], v[92:95], v[252:255]
	v_permlane32_swap_b32 v48, v49
	v_permlane32_swap_b32 v52, v53
	v_max_f32 v48, v48, v49
	v_max_f32 v52, v52, v53
	v_mul_f32 v48, -1.0, v48
	v_mul_f32 v52, -1.0, v52
	v_mfma_f32_16x16x32_bf16 v[236:239], a[168:171], v[108:111], v[236:239]
	v_mov_b32 v49, v48
	v_mov_b32 v53, v52
	v_mov_b32 v50, v48
	v_mov_b32 v54, v52
	v_mov_b32 v51, v48
	v_mov_b32 v55, v52
	v_mfma_f32_16x16x32_bf16 v[252:255], a[184:187], v[108:111], v[252:255]
	v_mfma_f32_16x16x32_bf16 v[236:239], a[172:175], v[124:127], v[236:239]
	v_mfma_f32_16x16x32_bf16 v[252:255], a[188:191], v[124:127], v[252:255]
	v_bfe_u32 v32, v0, 4, 2
	v_bfe_u32 v33, v0, 3, 1
	v_and_b32 v34, 3, v0
	v_lshlrev_b32 v35, 8, v32
	v_lshl_or_b32 v35, v33, 6, v35
	v_lshl_or_b32 v35, v34, 3, v35
	v_lshlrev_b32_e64 v32, 3, v32
	buffer_load_dwordx2 a[104:105], v35, s[44:47], 0 offen offset:0
	buffer_load_dwordx2 a[106:107], v35, s[44:47], 0 offen offset:32
	buffer_load_dwordx2 a[108:109], v35, s[44:47], 0 offen offset:128
	buffer_load_dwordx2 a[110:111], v35, s[44:47], 0 offen offset:160
	v_bfe_u32 v33, v0, 2, 1
	v_lshl_or_b32 v33, v33, 10, v35
	buffer_load_dwordx2 a[112:113], v32, s[48:51], s87 offen offset:0
	buffer_load_dwordx2 a[114:115], v32, s[48:51], s87 offen offset:32
	buffer_load_dwordx2 a[116:117], v32, s[48:51], s87 offen offset:64
	buffer_load_dwordx2 a[118:119], v32, s[48:51], s87 offen offset:96
	buffer_load_dwordx2 a[96:97], v33, s[4:7], s86 offen offset:0
	buffer_load_dwordx2 a[98:99], v33, s[4:7], s86 offen offset:32
	buffer_load_dwordx2 a[100:101], v33, s[4:7], s86 offen offset:128
	buffer_load_dwordx2 a[102:103], v33, s[4:7], s86 offen offset:160
	v_accvgpr_write_b32 a120, v33
	v_add_f32 v140, v140, v48
	v_add_f32 v141, v141, v48
	v_add_f32 v142, v142, v48
	v_add_f32 v143, v143, v48
	v_add_f32 v156, v156, v48
	v_add_f32 v157, v157, v48
	v_add_f32 v158, v158, v48
	v_add_f32 v159, v159, v48
	v_exp_f32 v140, v140
	v_exp_f32 v141, v141
	v_exp_f32 v142, v142
	v_exp_f32 v143, v143
	v_exp_f32 v156, v156
	v_exp_f32 v157, v157
	v_exp_f32 v158, v158
	v_exp_f32_e64 v159, v159
	s_nop 0
	v_cvt_pk_bf16_f32 v24, v140, v141
	v_cvt_pk_bf16_f32 v25, v142, v143
	v_cvt_pk_bf16_f32 v26, v156, v157
	v_cvt_pk_bf16_f32 v27, v158, v159
	v_max3_f32 v56, v204, v205, v206
	v_max3_f32 v60, v236, v237, v238
	v_max3_f32 v57, v207, v220, v221
	v_max3_f32 v61, v239, v252, v253
	v_max3_f32 v56, v56, v222, v223
	v_max3_f32 v60, v60, v254, v255
	v_max_f32 v56, v56, v57
	v_max_f32 v60, v60, v61
	v_mov_b32 v57, v56
	v_mov_b32 v61, v60
	s_nop 0
	v_permlane16_swap_b32 v56, v57
	v_permlane16_swap_b32 v60, v61
	v_max_f32 v56, v56, v57
	v_max_f32 v60, v60, v61
	v_mov_b32 v57, v56
	v_mov_b32 v61, v60
	s_nop 0
	v_permlane32_swap_b32 v56, v57
	v_permlane32_swap_b32 v60, v61
	v_max_f32 v56, v56, v57
	v_max_f32 v60, v60, v61
	v_mul_f32 v56, -1.0, v56
	v_mul_f32 v60, -1.0, v60
	v_mov_b32 v57, v56
	v_mov_b32 v61, v60
	v_mov_b32 v58, v56
	v_mov_b32 v62, v60
	v_mov_b32 v59, v56
	v_mov_b32 v63, v60
	s_waitcnt lgkmcnt(0)
	s_nop 1
	v_mfma_f32_16x16x32_bf16 v[128:131], a[0:3], v[24:27], 0
	v_add_f32 v172, v172, v52
	v_add_f32 v173, v173, v52
	v_add_f32 v174, v174, v52
	v_add_f32 v175, v175, v52
	v_mfma_f32_16x16x32_bf16 v[144:147], a[4:7], v[24:27], 0
	ds_read_b64_tr_b16 a[32:33], v12 offset:8192
	ds_read_b64_tr_b16 a[34:35], v12 offset:12288
	v_add_f32 v188, v188, v52
	v_add_f32 v189, v189, v52
	v_mfma_f32_16x16x32_bf16 v[160:163], a[8:11], v[24:27], 0
	v_add_f32 v190, v190, v52
	v_add_f32 v191, v191, v52
	v_exp_f32_e64 v172, v172
	v_mfma_f32_16x16x32_bf16 v[176:179], a[12:15], v[24:27], 0
	buffer_store_dwordx4 a[248:251], v6, s[32:35], s73 offen sc1
	s_add_u32 s73, s73, 1024
	v_exp_f32_e64 v173, v173
	v_mfma_f32_16x16x32_bf16 v[192:195], a[16:19], v[24:27], 0
	v_exp_f32_e64 v174, v174
	v_mfma_f32_16x16x32_bf16 v[208:211], a[20:23], v[24:27], 0
	v_cvt_pk_bf16_f32 v28, v172, v173
	v_exp_f32_e64 v175, v175
	v_mfma_f32_16x16x32_bf16 v[224:227], a[24:27], v[24:27], 0
	v_exp_f32_e64 v188, v188
	v_mfma_f32_16x16x32_bf16 v[240:243], a[28:31], v[24:27], 0
	v_cvt_pk_bf16_f32 v29, v174, v175
	v_exp_f32 v189, v189
	v_exp_f32 v190, v190
	v_mfma_f32_16x16x32_bf16 a[224:227], a[240:243], v[24:27], 0
	v_cvt_pk_bf16_f32 v30, v188, v189
	v_exp_f32 v191, v191
	s_nop 0
	v_cvt_pk_bf16_f32 v31, v190, v191
	s_nop 1
	s_nop 0
	v_mfma_f32_16x16x32_bf16 v[132:135], a[0:3], v[28:31], 0
	v_add_f32 v204, v204, v56
	v_add_f32 v205, v205, v56
	v_add_f32 v206, v206, v56
	v_add_f32 v207, v207, v56
	v_mfma_f32_16x16x32_bf16 v[148:151], a[4:7], v[28:31], 0
	ds_read_b64_tr_b16 a[36:37], v13 offset:8192
	ds_read_b64_tr_b16 a[38:39], v13 offset:12288
	v_add_f32 v220, v220, v56
	v_add_f32 v221, v221, v56
	v_mfma_f32_16x16x32_bf16 v[164:167], a[8:11], v[28:31], 0
	v_add_f32 v222, v222, v56
	v_add_f32 v223, v223, v56
	v_exp_f32_e64 v204, v204
	v_mfma_f32_16x16x32_bf16 v[180:183], a[12:15], v[28:31], 0
	buffer_store_dwordx4 a[248:251], v6, s[32:35], s73 offen sc1
	s_add_u32 s73, s73, 1024
	v_exp_f32_e64 v205, v205
	v_mfma_f32_16x16x32_bf16 v[196:199], a[16:19], v[28:31], 0
	v_exp_f32_e64 v206, v206
	v_mfma_f32_16x16x32_bf16 v[212:215], a[20:23], v[28:31], 0
	v_cvt_pk_bf16_f32 v24, v204, v205
	v_exp_f32_e64 v207, v207
	v_mfma_f32_16x16x32_bf16 v[228:231], a[24:27], v[28:31], 0
	v_exp_f32_e64 v220, v220
	v_mfma_f32_16x16x32_bf16 v[244:247], a[28:31], v[28:31], 0
	v_cvt_pk_bf16_f32 v25, v206, v207
	v_exp_f32 v221, v221
	v_exp_f32 v222, v222
	v_mfma_f32_16x16x32_bf16 a[228:231], a[240:243], v[28:31], 0
	v_cvt_pk_bf16_f32 v26, v220, v221
	v_exp_f32 v223, v223
	s_nop 0
	v_cvt_pk_bf16_f32 v27, v222, v223
	v_mfma_f32_16x16x32_bf16 v[32:35], a[192:195], v[64:67], v[48:51]
	v_add_f32 v236, v236, v60
	v_add_f32 v237, v237, v60
	v_add_f32_e64 v238, v238, v60
	v_mfma_f32_16x16x32_bf16 v[36:39], a[208:211], v[64:67], v[48:51]
	ds_read_b64_tr_b16 a[40:41], v14 offset:8192
	ds_read_b64_tr_b16 a[42:43], v14 offset:12288
	v_add_f32_e64 v239, v239, v60
	v_mfma_f32_16x16x32_bf16 v[32:35], a[196:199], v[80:83], v[32:35]
	v_add_f32 v252, v252, v60
	v_add_f32 v253, v253, v60
	v_mfma_f32_16x16x32_bf16 v[36:39], a[212:215], v[80:83], v[36:39]
	ds_read_b64_tr_b16 a[44:45], v15 offset:8192
	ds_read_b64_tr_b16 a[46:47], v15 offset:12288
	v_mfma_f32_16x16x32_bf16 v[32:35], a[200:203], v[96:99], v[32:35]
	v_add_f32 v254, v254, v60
	v_add_f32 v255, v255, v60
	v_mfma_f32_16x16x32_bf16 v[36:39], a[216:219], v[96:99], v[36:39]
	ds_read_b64_tr_b16 a[48:49], v16 offset:8192
	ds_read_b64_tr_b16 a[50:51], v16 offset:12288
	v_mfma_f32_16x16x32_bf16 v[32:35], a[204:207], v[112:115], v[32:35]
	v_exp_f32_e64 v236, v236
	v_mfma_f32_16x16x32_bf16 v[36:39], a[220:223], v[112:115], v[36:39]
	buffer_store_dwordx4 a[248:251], v6, s[32:35], s73 offen sc1
	s_add_u32 s73, s73, 1024
	v_mfma_f32_16x16x32_bf16 v[136:139], a[0:3], v[24:27], 0
	v_exp_f32_e64 v237, v237
	v_mfma_f32_16x16x32_bf16 v[152:155], a[4:7], v[24:27], 0
	v_exp_f32_e64 v238, v238
	v_mfma_f32_16x16x32_bf16 v[168:171], a[8:11], v[24:27], 0
	v_cvt_pk_bf16_f32 v28, v236, v237
	v_exp_f32_e64 v239, v239
	v_mfma_f32_16x16x32_bf16 v[184:187], a[12:15], v[24:27], 0
	v_exp_f32_e64 v252, v252
	v_mfma_f32_16x16x32_bf16 v[200:203], a[16:19], v[24:27], 0
	v_cvt_pk_bf16_f32 v29, v238, v239
	v_mfma_f32_16x16x32_bf16 v[216:219], a[20:23], v[24:27], 0
	v_exp_f32_e64 v253, v253
	v_mfma_f32_16x16x32_bf16 v[232:235], a[24:27], v[24:27], 0
	v_exp_f32_e64 v254, v254
	v_mfma_f32_16x16x32_bf16 v[248:251], a[28:31], v[24:27], 0
	v_cvt_pk_bf16_f32 v30, v252, v253
	v_exp_f32_e64 v255, v255
	v_mfma_f32_16x16x32_bf16 a[232:235], a[240:243], v[24:27], 0
	s_nop 0
	s_nop 0
	v_cvt_pk_bf16_f32 v31, v254, v255
	v_mfma_f32_16x16x32_bf16 v[40:43], a[192:195], v[68:71], v[52:55]
	v_exp_f32_e64 v32, v32
	v_mfma_f32_16x16x32_bf16 v[44:47], a[208:211], v[68:71], v[52:55]
	ds_read_b64_tr_b16 a[52:53], v17 offset:8192
	ds_read_b64_tr_b16 a[54:55], v17 offset:12288
	v_mfma_f32_16x16x32_bf16 v[40:43], a[196:199], v[84:87], v[40:43]
	v_exp_f32_e64 v33, v33
	v_mfma_f32_16x16x32_bf16 v[44:47], a[212:215], v[84:87], v[44:47]
	ds_read_b64_tr_b16 a[56:57], v18 offset:8192
	ds_read_b64_tr_b16 a[58:59], v18 offset:12288
	v_mfma_f32_16x16x32_bf16 v[40:43], a[200:203], v[100:103], v[40:43]
	v_exp_f32_e64 v34, v34
	v_mfma_f32_16x16x32_bf16 v[44:47], a[216:219], v[100:103], v[44:47]
	ds_read_b64_tr_b16 a[60:61], v19 offset:8192
	ds_read_b64_tr_b16 a[62:63], v19 offset:12288
	v_mfma_f32_16x16x32_bf16 v[40:43], a[204:207], v[116:119], v[40:43]
	v_exp_f32_e64 v35, v35
	v_mfma_f32_16x16x32_bf16 v[44:47], a[220:223], v[116:119], v[44:47]
	v_cvt_pk_bf16_f32 v24, v32, v33
	v_cvt_pk_bf16_f32 v25, v34, v35
	v_mfma_f32_16x16x32_bf16 v[140:143], a[0:3], v[28:31], 0
	v_exp_f32_e64 v36, v36
	v_mfma_f32_16x16x32_bf16 v[156:159], a[4:7], v[28:31], 0
	buffer_store_dwordx4 a[248:251], v6, s[32:35], s73 offen sc1
	v_mfma_f32_16x16x32_bf16 v[172:175], a[8:11], v[28:31], 0
	s_add_u32 s73, s73, 1024
	v_exp_f32_e64 v37, v37
	v_mfma_f32_16x16x32_bf16 v[188:191], a[12:15], v[28:31], 0
	v_mfma_f32_16x16x32_bf16 v[204:207], a[16:19], v[28:31], 0
	v_exp_f32_e64 v38, v38
	v_mfma_f32_16x16x32_bf16 v[220:223], a[20:23], v[28:31], 0
	v_mfma_f32_16x16x32_bf16 v[236:239], a[24:27], v[28:31], 0
	v_exp_f32_e64 v39, v39
	v_mfma_f32_16x16x32_bf16 v[252:255], a[28:31], v[28:31], 0
	v_cvt_pk_bf16_f32 v26, v36, v37
	v_cvt_pk_bf16_f32 v27, v38, v39
	v_mfma_f32_16x16x32_bf16 a[236:239], a[240:243], v[28:31], 0
	s_mov_b32 s74, 3
	s_waitcnt vmcnt(20)
	s_mov_b32 s16, s32
	s_mov_b32 s17, s33
	s_mov_b32 s18, 268435456
	s_mov_b32 s92, 1024
.p2align 6
L_attn:
	s_waitcnt vmcnt(9) lgkmcnt(0)
	s_barrier
	s_add_u32 m0, s69, 65536
	v_mfma_f32_16x16x32_bf16 v[32:35], a[192:195], v[72:75], v[56:59]
	v_exp_f32_e64 v40, v40
	v_mfma_f32_16x16x32_bf16 v[36:39], a[208:211], v[72:75], v[56:59]
	ds_read_b128 a[160:163], v8 offset:16384
	ds_read_b128 a[176:179], v8 offset:20480
	v_mfma_f32_16x16x32_bf16 v[32:35], a[196:199], v[88:91], v[32:35]
	v_exp_f32_e64 v41, v41
	v_mfma_f32_16x16x32_bf16 v[36:39], a[212:215], v[88:91], v[36:39]
	ds_read_b128 a[164:167], v9 offset:16384
	ds_read_b128 a[180:183], v9 offset:20480
	v_mfma_f32_16x16x32_bf16 v[32:35], a[200:203], v[104:107], v[32:35]
	v_exp_f32_e64 v42, v42
	v_mfma_f32_16x16x32_bf16 v[36:39], a[216:219], v[104:107], v[36:39]
	ds_read_b64_tr_b16 a[0:1], v12 offset:16384
	ds_read_b64_tr_b16 a[2:3], v12 offset:20480
	v_mfma_f32_16x16x32_bf16 v[32:35], a[204:207], v[120:123], v[32:35]
	v_exp_f32_e64 v43, v43
	v_mfma_f32_16x16x32_bf16 v[36:39], a[220:223], v[120:123], v[36:39]
	v_cvt_pk_bf16_f32 v28, v40, v41
	v_cvt_pk_bf16_f32 v29, v42, v43
	v_mfma_f32_16x16x32_bf16 v[128:131], a[32:35], v[24:27], v[128:131]
	v_exp_f32_e64 v44, v44
	v_mfma_f32_16x16x32_bf16 v[144:147], a[36:39], v[24:27], v[144:147]
	buffer_load_dwordx4 v20, s[8:11], s65 offen lds
	v_mfma_f32_16x16x32_bf16 v[160:163], a[40:43], v[24:27], v[160:163]
	v_exp_f32_e64 v45, v45
	v_mfma_f32_16x16x32_bf16 v[176:179], a[44:47], v[24:27], v[176:179]
	buffer_load_dwordx4 v21, s[8:11], s65 offen offset:1024 lds
	v_mfma_f32_16x16x32_bf16 v[192:195], a[48:51], v[24:27], v[192:195]
	s_add_u32 m0, s69, 98304
	v_exp_f32_e64 v46, v46
	v_mfma_f32_16x16x32_bf16 v[208:211], a[52:55], v[24:27], v[208:211]
	buffer_load_dwordx4 v22, s[12:15], s65 offen lds
	v_mfma_f32_16x16x32_bf16 v[224:227], a[56:59], v[24:27], v[224:227]
	v_exp_f32_e64 v47, v47
	v_mfma_f32_16x16x32_bf16 v[240:243], a[60:63], v[24:27], v[240:243]
	v_cvt_pk_bf16_f32 v30, v44, v45
	v_cvt_pk_bf16_f32 v31, v46, v47
	v_mfma_f32_16x16x32_bf16 a[224:227], a[240:243], v[24:27], a[224:227]
	buffer_load_dwordx4 v23, s[12:15], s65 offen offset:1024 lds
	v_mfma_f32_16x16x32_bf16 v[40:43], a[192:195], v[76:79], v[60:63]
	s_add_u32 m0, s69, 73728
	v_exp_f32_e64 v32, v32
	v_mfma_f32_16x16x32_bf16 v[44:47], a[208:211], v[76:79], v[60:63]
	ds_read_b128 a[168:171], v10 offset:16384
	ds_read_b128 a[184:187], v10 offset:20480
	v_mfma_f32_16x16x32_bf16 v[40:43], a[196:199], v[92:95], v[40:43]
	v_exp_f32_e64 v33, v33
	v_mfma_f32_16x16x32_bf16 v[44:47], a[212:215], v[92:95], v[44:47]
	ds_read_b128 a[172:175], v11 offset:16384
	ds_read_b128 a[188:191], v11 offset:20480
	v_mfma_f32_16x16x32_bf16 v[40:43], a[200:203], v[108:111], v[40:43]
	v_exp_f32_e64 v34, v34
	v_mfma_f32_16x16x32_bf16 v[44:47], a[216:219], v[108:111], v[44:47]
	ds_read_b64_tr_b16 a[4:5], v13 offset:16384
	ds_read_b64_tr_b16 a[6:7], v13 offset:20480
	v_mfma_f32_16x16x32_bf16 v[40:43], a[204:207], v[124:127], v[40:43]
	v_exp_f32_e64 v35, v35
	v_mfma_f32_16x16x32_bf16 v[44:47], a[220:223], v[124:127], v[44:47]
	v_cvt_pk_bf16_f32 v24, v32, v33
	v_cvt_pk_bf16_f32 v25, v34, v35
	v_mfma_f32_16x16x32_bf16 v[132:135], a[32:35], v[28:31], v[132:135]
	v_exp_f32_e64 v36, v36
	v_mfma_f32_16x16x32_bf16 v[148:151], a[36:39], v[28:31], v[148:151]
	buffer_load_dwordx4 v20, s[8:11], s82 offen lds
	v_mfma_f32_16x16x32_bf16 v[164:167], a[40:43], v[28:31], v[164:167]
	v_exp_f32_e64 v37, v37
	v_mfma_f32_16x16x32_bf16 v[180:183], a[44:47], v[28:31], v[180:183]
	buffer_load_dwordx4 v21, s[8:11], s82 offen offset:1024 lds
	v_mfma_f32_16x16x32_bf16 v[196:199], a[48:51], v[28:31], v[196:199]
	s_add_u32 m0, s69, 106496
	v_exp_f32_e64 v38, v38
	v_mfma_f32_16x16x32_bf16 v[212:215], a[52:55], v[28:31], v[212:215]
	buffer_load_dwordx4 v22, s[12:15], s82 offen lds
	v_mfma_f32_16x16x32_bf16 v[228:231], a[56:59], v[28:31], v[228:231]
	s_waitcnt lgkmcnt(2)
	v_exp_f32 v39, v39
	v_mfma_f32_16x16x32_bf16 v[244:247], a[60:63], v[28:31], v[244:247]
	v_cvt_pk_bf16_f32 v26, v36, v37
	v_cvt_pk_bf16_f32 v27, v38, v39
	v_mfma_f32_16x16x32_bf16 a[228:231], a[240:243], v[28:31], a[228:231]
	buffer_load_dwordx4 v23, s[12:15], s82 offen offset:1024 lds
	v_mfma_f32_16x16x32_bf16 v[32:35], a[160:163], v[64:67], v[48:51]
	s_add_u32 s65, s65, 16384
	v_exp_f32_e64 v40, v40
	v_mfma_f32_16x16x32_bf16 v[36:39], a[176:179], v[64:67], v[48:51]
	s_add_u32 s82, s82, 16384
	ds_read_b64_tr_b16 a[8:9], v14 offset:16384
	ds_read_b64_tr_b16 a[10:11], v14 offset:20480
	v_mfma_f32_16x16x32_bf16 v[32:35], a[164:167], v[80:83], v[32:35]
	s_add_u32 m0, s84, 0
	v_exp_f32 v41, v41
	v_mfma_f32_16x16x32_bf16 v[36:39], a[180:183], v[80:83], v[36:39]
	ds_read_b64_tr_b16 a[12:13], v15 offset:16384
	ds_read_b64_tr_b16 a[14:15], v15 offset:20480
	v_mfma_f32_16x16x32_bf16 v[32:35], a[168:171], v[96:99], v[32:35]
	v_exp_f32_e64 v42, v42
	v_mfma_f32_16x16x32_bf16 v[36:39], a[184:187], v[96:99], v[36:39]
	ds_read_b64_tr_b16 a[16:17], v16 offset:16384
	ds_read_b64_tr_b16 a[18:19], v16 offset:20480
	v_mfma_f32_16x16x32_bf16 v[32:35], a[172:175], v[112:115], v[32:35]
	v_exp_f32_e64 v43, v43
	v_mfma_f32_16x16x32_bf16 v[36:39], a[188:191], v[112:115], v[36:39]
	v_cvt_pk_bf16_f32 v28, v40, v41
	v_cvt_pk_bf16_f32 v29, v42, v43
	v_mfma_f32_16x16x32_bf16 v[136:139], a[32:35], v[24:27], v[136:139]
	v_exp_f32_e64 v44, v44
	v_mfma_f32_16x16x32_bf16 v[152:155], a[36:39], v[24:27], v[152:155]
	buffer_store_dwordx4 a[248:251], v6, s[16:19], s73 offen sc1
	v_mfma_f32_16x16x32_bf16 v[168:171], a[40:43], v[24:27], v[168:171]
	s_add_u32 s73, s73, s92
	v_exp_f32 v45, v45
	v_mfma_f32_16x16x32_bf16 v[184:187], a[44:47], v[24:27], v[184:187]
	buffer_load_dwordx4 v2, s[20:23], s83 offen offset:0 lds
	v_mfma_f32_16x16x32_bf16 v[200:203], a[48:51], v[24:27], v[200:203]
	v_exp_f32_e64 v46, v46
	v_mfma_f32_16x16x32_bf16 v[216:219], a[52:55], v[24:27], v[216:219]
	v_mfma_f32_16x16x32_bf16 v[232:235], a[56:59], v[24:27], v[232:235]
	v_exp_f32_e64 v47, v47
	v_mfma_f32_16x16x32_bf16 v[248:251], a[60:63], v[24:27], v[248:251]
	v_cvt_pk_bf16_f32 v30, v44, v45
	v_cvt_pk_bf16_f32 v31, v46, v47
	v_mfma_f32_16x16x32_bf16 a[232:235], a[240:243], v[24:27], a[232:235]
	v_mfma_f32_16x16x32_bf16 v[40:43], a[160:163], v[68:71], v[52:55]
	v_exp_f32_e64 v32, v32
	v_mfma_f32_16x16x32_bf16 v[44:47], a[176:179], v[68:71], v[52:55]
	ds_read_b64_tr_b16 a[20:21], v17 offset:16384
	ds_read_b64_tr_b16 a[22:23], v17 offset:20480
	v_mfma_f32_16x16x32_bf16 v[40:43], a[164:167], v[84:87], v[40:43]
	v_exp_f32_e64 v33, v33
	v_mfma_f32_16x16x32_bf16 v[44:47], a[180:183], v[84:87], v[44:47]
	ds_read_b64_tr_b16 a[24:25], v18 offset:16384
	ds_read_b64_tr_b16 a[26:27], v18 offset:20480
	v_mfma_f32_16x16x32_bf16 v[40:43], a[168:171], v[100:103], v[40:43]
	v_exp_f32_e64 v34, v34
	v_mfma_f32_16x16x32_bf16 v[44:47], a[184:187], v[100:103], v[44:47]
	ds_read_b64_tr_b16 a[28:29], v19 offset:16384
	ds_read_b64_tr_b16 a[30:31], v19 offset:20480
	v_mfma_f32_16x16x32_bf16 v[40:43], a[172:175], v[116:119], v[40:43]
	v_exp_f32_e64 v35, v35
	v_mfma_f32_16x16x32_bf16 v[44:47], a[188:191], v[116:119], v[44:47]
	v_cvt_pk_bf16_f32 v24, v32, v33
	v_cvt_pk_bf16_f32 v25, v34, v35
	v_mfma_f32_16x16x32_bf16 v[140:143], a[32:35], v[28:31], v[140:143]
	v_exp_f32_e64 v36, v36
	v_mfma_f32_16x16x32_bf16 v[156:159], a[36:39], v[28:31], v[156:159]
	buffer_store_dwordx4 a[248:251], v6, s[16:19], s73 offen sc1
	v_mfma_f32_16x16x32_bf16 v[172:175], a[40:43], v[28:31], v[172:175]
	s_add_u32 s73, s73, s92
	v_exp_f32 v37, v37
	v_mfma_f32_16x16x32_bf16 v[188:191], a[44:47], v[28:31], v[188:191]
	buffer_load_dwordx4 v3, s[20:23], s83 offen offset:1024 lds
	v_mfma_f32_16x16x32_bf16 v[204:207], a[48:51], v[28:31], v[204:207]
	v_exp_f32_e64 v38, v38
	v_mfma_f32_16x16x32_bf16 v[220:223], a[52:55], v[28:31], v[220:223]
	v_mfma_f32_16x16x32_bf16 v[236:239], a[56:59], v[28:31], v[236:239]
	s_waitcnt lgkmcnt(0)
	v_exp_f32 v39, v39
	v_mfma_f32_16x16x32_bf16 v[252:255], a[60:63], v[28:31], v[252:255]
	v_cvt_pk_bf16_f32 v26, v36, v37
	v_cvt_pk_bf16_f32 v27, v38, v39
	v_mfma_f32_16x16x32_bf16 a[236:239], a[240:243], v[28:31], a[236:239]
	v_mfma_f32_16x16x32_bf16 v[32:35], a[160:163], v[72:75], v[56:59]
	v_exp_f32_e64 v40, v40
	v_mfma_f32_16x16x32_bf16 v[36:39], a[176:179], v[72:75], v[56:59]
	ds_read_b128 a[192:195], v8 offset:24576
	ds_read_b128 a[208:211], v8 offset:28672
	v_mfma_f32_16x16x32_bf16 v[32:35], a[164:167], v[88:91], v[32:35]
	v_exp_f32_e64 v41, v41
	v_mfma_f32_16x16x32_bf16 v[36:39], a[180:183], v[88:91], v[36:39]
	ds_read_b128 a[196:199], v9 offset:24576
	ds_read_b128 a[212:215], v9 offset:28672
	v_mfma_f32_16x16x32_bf16 v[32:35], a[168:171], v[104:107], v[32:35]
	v_exp_f32_e64 v42, v42
	v_mfma_f32_16x16x32_bf16 v[36:39], a[184:187], v[104:107], v[36:39]
	ds_read_b64_tr_b16 a[32:33], v12 offset:24576
	ds_read_b64_tr_b16 a[34:35], v12 offset:28672
	v_mfma_f32_16x16x32_bf16 v[32:35], a[172:175], v[120:123], v[32:35]
	v_exp_f32_e64 v43, v43
	v_mfma_f32_16x16x32_bf16 v[36:39], a[188:191], v[120:123], v[36:39]
	v_cvt_pk_bf16_f32 v28, v40, v41
	v_cvt_pk_bf16_f32 v29, v42, v43
	v_mfma_f32_16x16x32_bf16 v[128:131], a[0:3], v[24:27], v[128:131]
	v_exp_f32_e64 v44, v44
	v_mfma_f32_16x16x32_bf16 v[144:147], a[4:7], v[24:27], v[144:147]
	buffer_store_dwordx4 a[248:251], v6, s[16:19], s73 offen sc1
	v_mfma_f32_16x16x32_bf16 v[160:163], a[8:11], v[24:27], v[160:163]
	s_add_u32 s73, s73, s92
	v_exp_f32 v45, v45
	v_mfma_f32_16x16x32_bf16 v[176:179], a[12:15], v[24:27], v[176:179]
	buffer_load_dwordx4 v4, s[20:23], s83 offen offset:2048 lds
	v_mfma_f32_16x16x32_bf16 v[192:195], a[16:19], v[24:27], v[192:195]
	v_exp_f32_e64 v46, v46
	v_mfma_f32_16x16x32_bf16 v[208:211], a[20:23], v[24:27], v[208:211]
	v_mfma_f32_16x16x32_bf16 v[224:227], a[24:27], v[24:27], v[224:227]
	v_exp_f32_e64 v47, v47
	v_mfma_f32_16x16x32_bf16 v[240:243], a[28:31], v[24:27], v[240:243]
	v_cvt_pk_bf16_f32 v30, v44, v45
	v_cvt_pk_bf16_f32 v31, v46, v47
	v_mfma_f32_16x16x32_bf16 a[224:227], a[240:243], v[24:27], a[224:227]
	v_mfma_f32_16x16x32_bf16 v[40:43], a[160:163], v[76:79], v[60:63]
	v_exp_f32_e64 v32, v32
	v_mfma_f32_16x16x32_bf16 v[44:47], a[176:179], v[76:79], v[60:63]
	ds_read_b128 a[200:203], v10 offset:24576
	ds_read_b128 a[216:219], v10 offset:28672
	v_mfma_f32_16x16x32_bf16 v[40:43], a[164:167], v[92:95], v[40:43]
	v_exp_f32_e64 v33, v33
	v_mfma_f32_16x16x32_bf16 v[44:47], a[180:183], v[92:95], v[44:47]
	ds_read_b128 a[204:207], v11 offset:24576
	ds_read_b128 a[220:223], v11 offset:28672
	v_mfma_f32_16x16x32_bf16 v[40:43], a[168:171], v[108:111], v[40:43]
	v_exp_f32_e64 v34, v34
	v_mfma_f32_16x16x32_bf16 v[44:47], a[184:187], v[108:111], v[44:47]
	ds_read_b64_tr_b16 a[36:37], v13 offset:24576
	ds_read_b64_tr_b16 a[38:39], v13 offset:28672
	v_mfma_f32_16x16x32_bf16 v[40:43], a[172:175], v[124:127], v[40:43]
	v_exp_f32_e64 v35, v35
	v_mfma_f32_16x16x32_bf16 v[44:47], a[188:191], v[124:127], v[44:47]
	v_cvt_pk_bf16_f32 v24, v32, v33
	v_cvt_pk_bf16_f32 v25, v34, v35
	v_mfma_f32_16x16x32_bf16 v[132:135], a[0:3], v[28:31], v[132:135]
	v_exp_f32_e64 v36, v36
	v_mfma_f32_16x16x32_bf16 v[148:151], a[4:7], v[28:31], v[148:151]
	buffer_store_dwordx4 a[248:251], v6, s[16:19], s73 offen sc1
	v_mfma_f32_16x16x32_bf16 v[164:167], a[8:11], v[28:31], v[164:167]
	s_add_u32 s73, s73, s92
	v_exp_f32 v37, v37
	v_mfma_f32_16x16x32_bf16 v[180:183], a[12:15], v[28:31], v[180:183]
	buffer_load_dwordx4 v5, s[20:23], s83 offen offset:3072 lds
	v_mfma_f32_16x16x32_bf16 v[196:199], a[16:19], v[28:31], v[196:199]
	v_exp_f32_e64 v38, v38
	v_mfma_f32_16x16x32_bf16 v[212:215], a[20:23], v[28:31], v[212:215]
	v_mfma_f32_16x16x32_bf16 v[228:231], a[24:27], v[28:31], v[228:231]
	s_waitcnt lgkmcnt(2)
	v_exp_f32 v39, v39
	v_mfma_f32_16x16x32_bf16 v[244:247], a[28:31], v[28:31], v[244:247]
	v_cvt_pk_bf16_f32 v26, v36, v37
	v_cvt_pk_bf16_f32 v27, v38, v39
	v_mfma_f32_16x16x32_bf16 a[228:231], a[240:243], v[28:31], a[228:231]
	v_mfma_f32_16x16x32_bf16 v[32:35], a[192:195], v[64:67], v[48:51]
	v_exp_f32_e64 v40, v40
	v_mfma_f32_16x16x32_bf16 v[36:39], a[208:211], v[64:67], v[48:51]
	ds_read_b64_tr_b16 a[40:41], v14 offset:24576
	ds_read_b64_tr_b16 a[42:43], v14 offset:28672
	v_mfma_f32_16x16x32_bf16 v[32:35], a[196:199], v[80:83], v[32:35]
	v_exp_f32_e64 v41, v41
	v_mfma_f32_16x16x32_bf16 v[36:39], a[212:215], v[80:83], v[36:39]
	ds_read_b64_tr_b16 a[44:45], v15 offset:24576
	ds_read_b64_tr_b16 a[46:47], v15 offset:28672
	v_mfma_f32_16x16x32_bf16 v[32:35], a[200:203], v[96:99], v[32:35]
	v_exp_f32_e64 v42, v42
	v_mfma_f32_16x16x32_bf16 v[36:39], a[216:219], v[96:99], v[36:39]
	ds_read_b64_tr_b16 a[48:49], v16 offset:24576
	ds_read_b64_tr_b16 a[50:51], v16 offset:28672
	v_mfma_f32_16x16x32_bf16 v[32:35], a[204:207], v[112:115], v[32:35]
	v_exp_f32_e64 v43, v43
	v_mfma_f32_16x16x32_bf16 v[36:39], a[220:223], v[112:115], v[36:39]
	v_cvt_pk_bf16_f32 v28, v40, v41
	v_cvt_pk_bf16_f32 v29, v42, v43
	v_mfma_f32_16x16x32_bf16 v[136:139], a[0:3], v[24:27], v[136:139]
	v_exp_f32_e64 v44, v44
	v_mfma_f32_16x16x32_bf16 v[152:155], a[4:7], v[24:27], v[152:155]
	buffer_store_dwordx4 a[248:251], v6, s[16:19], s73 offen sc1
	v_mfma_f32_16x16x32_bf16 v[168:171], a[8:11], v[24:27], v[168:171]
	s_add_u32 s73, s73, s92
	v_exp_f32 v45, v45
	v_mfma_f32_16x16x32_bf16 v[184:187], a[12:15], v[24:27], v[184:187]
	v_mfma_f32_16x16x32_bf16 v[200:203], a[16:19], v[24:27], v[200:203]
	v_exp_f32_e64 v46, v46
	v_mfma_f32_16x16x32_bf16 v[216:219], a[20:23], v[24:27], v[216:219]
	v_mfma_f32_16x16x32_bf16 v[232:235], a[24:27], v[24:27], v[232:235]
	v_exp_f32_e64 v47, v47
	v_mfma_f32_16x16x32_bf16 v[248:251], a[28:31], v[24:27], v[248:251]
	v_cvt_pk_bf16_f32 v30, v44, v45
	v_cvt_pk_bf16_f32 v31, v46, v47
	v_mfma_f32_16x16x32_bf16 a[232:235], a[240:243], v[24:27], a[232:235]
	v_mfma_f32_16x16x32_bf16 v[40:43], a[192:195], v[68:71], v[52:55]
	s_add_u32 s83, s83, 32768
	v_exp_f32_e64 v32, v32
	v_mfma_f32_16x16x32_bf16 v[44:47], a[208:211], v[68:71], v[52:55]
	ds_read_b64_tr_b16 a[52:53], v17 offset:24576
	ds_read_b64_tr_b16 a[54:55], v17 offset:28672
	v_mfma_f32_16x16x32_bf16 v[40:43], a[196:199], v[84:87], v[40:43]
	v_exp_f32_e64 v33, v33
	v_mfma_f32_16x16x32_bf16 v[44:47], a[212:215], v[84:87], v[44:47]
	ds_read_b64_tr_b16 a[56:57], v18 offset:24576
	ds_read_b64_tr_b16 a[58:59], v18 offset:28672
	v_mfma_f32_16x16x32_bf16 v[40:43], a[200:203], v[100:103], v[40:43]
	v_exp_f32_e64 v34, v34
	v_mfma_f32_16x16x32_bf16 v[44:47], a[216:219], v[100:103], v[44:47]
	ds_read_b64_tr_b16 a[60:61], v19 offset:24576
	ds_read_b64_tr_b16 a[62:63], v19 offset:28672
	v_mfma_f32_16x16x32_bf16 v[40:43], a[204:207], v[116:119], v[40:43]
	v_exp_f32_e64 v35, v35
	v_mfma_f32_16x16x32_bf16 v[44:47], a[220:223], v[116:119], v[44:47]
	v_cvt_pk_bf16_f32 v24, v32, v33
	v_cvt_pk_bf16_f32 v25, v34, v35
	v_mfma_f32_16x16x32_bf16 v[140:143], a[0:3], v[28:31], v[140:143]
	v_exp_f32_e64 v36, v36
	v_mfma_f32_16x16x32_bf16 v[156:159], a[4:7], v[28:31], v[156:159]
	v_mfma_f32_16x16x32_bf16 v[172:175], a[8:11], v[28:31], v[172:175]
	v_exp_f32_e64 v37, v37
	v_mfma_f32_16x16x32_bf16 v[188:191], a[12:15], v[28:31], v[188:191]
	v_mfma_f32_16x16x32_bf16 v[204:207], a[16:19], v[28:31], v[204:207]
	v_exp_f32_e64 v38, v38
	v_mfma_f32_16x16x32_bf16 v[220:223], a[20:23], v[28:31], v[220:223]
	v_mfma_f32_16x16x32_bf16 v[236:239], a[24:27], v[28:31], v[236:239]
	v_exp_f32_e64 v39, v39
	v_mfma_f32_16x16x32_bf16 v[252:255], a[28:31], v[28:31], v[252:255]
	v_cvt_pk_bf16_f32 v26, v36, v37
	v_cvt_pk_bf16_f32 v27, v38, v39
	v_mfma_f32_16x16x32_bf16 a[236:239], a[240:243], v[28:31], a[236:239]
	s_waitcnt vmcnt(9) lgkmcnt(0)
	s_barrier
	s_add_u32 m0, s69, 81920
	v_mfma_f32_16x16x32_bf16 v[32:35], a[192:195], v[72:75], v[56:59]
	v_exp_f32_e64 v40, v40
	v_mfma_f32_16x16x32_bf16 v[36:39], a[208:211], v[72:75], v[56:59]
	ds_read_b128 a[160:163], v8 offset:0
	ds_read_b128 a[176:179], v8 offset:4096
	v_mfma_f32_16x16x32_bf16 v[32:35], a[196:199], v[88:91], v[32:35]
	v_exp_f32_e64 v41, v41
	v_mfma_f32_16x16x32_bf16 v[36:39], a[212:215], v[88:91], v[36:39]
	ds_read_b128 a[164:167], v9 offset:0
	ds_read_b128 a[180:183], v9 offset:4096
	v_mfma_f32_16x16x32_bf16 v[32:35], a[200:203], v[104:107], v[32:35]
	v_exp_f32_e64 v42, v42
	v_mfma_f32_16x16x32_bf16 v[36:39], a[216:219], v[104:107], v[36:39]
	ds_read_b64_tr_b16 a[0:1], v12 offset:0
	ds_read_b64_tr_b16 a[2:3], v12 offset:4096
	v_mfma_f32_16x16x32_bf16 v[32:35], a[204:207], v[120:123], v[32:35]
	v_exp_f32_e64 v43, v43
	v_mfma_f32_16x16x32_bf16 v[36:39], a[220:223], v[120:123], v[36:39]
	v_cvt_pk_bf16_f32 v28, v40, v41
	v_cvt_pk_bf16_f32 v29, v42, v43
	v_mfma_f32_16x16x32_bf16 v[128:131], a[32:35], v[24:27], v[128:131]
	v_exp_f32_e64 v44, v44
	v_mfma_f32_16x16x32_bf16 v[144:147], a[36:39], v[24:27], v[144:147]
	buffer_load_dwordx4 v20, s[8:11], s65 offen lds
	v_mfma_f32_16x16x32_bf16 v[160:163], a[40:43], v[24:27], v[160:163]
	v_exp_f32_e64 v45, v45
	v_mfma_f32_16x16x32_bf16 v[176:179], a[44:47], v[24:27], v[176:179]
	buffer_load_dwordx4 v21, s[8:11], s65 offen offset:1024 lds
	v_mfma_f32_16x16x32_bf16 v[192:195], a[48:51], v[24:27], v[192:195]
	s_add_u32 m0, s69, 114688
	v_exp_f32_e64 v46, v46
	v_mfma_f32_16x16x32_bf16 v[208:211], a[52:55], v[24:27], v[208:211]
	buffer_load_dwordx4 v22, s[12:15], s65 offen lds
	v_mfma_f32_16x16x32_bf16 v[224:227], a[56:59], v[24:27], v[224:227]
	v_exp_f32_e64 v47, v47
	v_mfma_f32_16x16x32_bf16 v[240:243], a[60:63], v[24:27], v[240:243]
	v_cvt_pk_bf16_f32 v30, v44, v45
	v_cvt_pk_bf16_f32 v31, v46, v47
	v_mfma_f32_16x16x32_bf16 a[224:227], a[240:243], v[24:27], a[224:227]
	buffer_load_dwordx4 v23, s[12:15], s65 offen offset:1024 lds
	v_mfma_f32_16x16x32_bf16 v[40:43], a[192:195], v[76:79], v[60:63]
	s_add_u32 m0, s69, 90112
	v_exp_f32_e64 v32, v32
	v_mfma_f32_16x16x32_bf16 v[44:47], a[208:211], v[76:79], v[60:63]
	ds_read_b128 a[168:171], v10 offset:0
	ds_read_b128 a[184:187], v10 offset:4096
	v_mfma_f32_16x16x32_bf16 v[40:43], a[196:199], v[92:95], v[40:43]
	v_exp_f32_e64 v33, v33
	v_mfma_f32_16x16x32_bf16 v[44:47], a[212:215], v[92:95], v[44:47]
	ds_read_b128 a[172:175], v11 offset:0
	ds_read_b128 a[188:191], v11 offset:4096
	v_mfma_f32_16x16x32_bf16 v[40:43], a[200:203], v[108:111], v[40:43]
	v_exp_f32_e64 v34, v34
	v_mfma_f32_16x16x32_bf16 v[44:47], a[216:219], v[108:111], v[44:47]
	ds_read_b64_tr_b16 a[4:5], v13 offset:0
	ds_read_b64_tr_b16 a[6:7], v13 offset:4096
	v_mfma_f32_16x16x32_bf16 v[40:43], a[204:207], v[124:127], v[40:43]
	v_exp_f32_e64 v35, v35
	v_mfma_f32_16x16x32_bf16 v[44:47], a[220:223], v[124:127], v[44:47]
	v_cvt_pk_bf16_f32 v24, v32, v33
	v_cvt_pk_bf16_f32 v25, v34, v35
	v_mfma_f32_16x16x32_bf16 v[132:135], a[32:35], v[28:31], v[132:135]
	v_exp_f32_e64 v36, v36
	v_mfma_f32_16x16x32_bf16 v[148:151], a[36:39], v[28:31], v[148:151]
	buffer_load_dwordx4 v20, s[8:11], s82 offen lds
	v_mfma_f32_16x16x32_bf16 v[164:167], a[40:43], v[28:31], v[164:167]
	v_exp_f32_e64 v37, v37
	v_mfma_f32_16x16x32_bf16 v[180:183], a[44:47], v[28:31], v[180:183]
	buffer_load_dwordx4 v21, s[8:11], s82 offen offset:1024 lds
	v_mfma_f32_16x16x32_bf16 v[196:199], a[48:51], v[28:31], v[196:199]
	s_add_u32 m0, s69, 122880
	v_exp_f32_e64 v38, v38
	v_mfma_f32_16x16x32_bf16 v[212:215], a[52:55], v[28:31], v[212:215]
	buffer_load_dwordx4 v22, s[12:15], s82 offen lds
	v_mfma_f32_16x16x32_bf16 v[228:231], a[56:59], v[28:31], v[228:231]
	s_waitcnt lgkmcnt(2)
	v_exp_f32 v39, v39
	v_mfma_f32_16x16x32_bf16 v[244:247], a[60:63], v[28:31], v[244:247]
	v_cvt_pk_bf16_f32 v26, v36, v37
	v_cvt_pk_bf16_f32 v27, v38, v39
	v_mfma_f32_16x16x32_bf16 a[228:231], a[240:243], v[28:31], a[228:231]
	buffer_load_dwordx4 v23, s[12:15], s82 offen offset:1024 lds
	v_mfma_f32_16x16x32_bf16 v[32:35], a[160:163], v[64:67], v[48:51]
	s_add_u32 s65, s65, 16384
	v_exp_f32_e64 v40, v40
	v_mfma_f32_16x16x32_bf16 v[36:39], a[176:179], v[64:67], v[48:51]
	s_add_u32 s82, s82, 16384
	ds_read_b64_tr_b16 a[8:9], v14 offset:0
	ds_read_b64_tr_b16 a[10:11], v14 offset:4096
	v_mfma_f32_16x16x32_bf16 v[32:35], a[164:167], v[80:83], v[32:35]
	s_add_u32 m0, s84, 16384
	v_exp_f32_e64 v41, v41
	v_mfma_f32_16x16x32_bf16 v[36:39], a[180:183], v[80:83], v[36:39]
	ds_read_b64_tr_b16 a[12:13], v15 offset:0
	ds_read_b64_tr_b16 a[14:15], v15 offset:4096
	v_mfma_f32_16x16x32_bf16 v[32:35], a[168:171], v[96:99], v[32:35]
	v_exp_f32_e64 v42, v42
	v_mfma_f32_16x16x32_bf16 v[36:39], a[184:187], v[96:99], v[36:39]
	ds_read_b64_tr_b16 a[16:17], v16 offset:0
	ds_read_b64_tr_b16 a[18:19], v16 offset:4096
	v_mfma_f32_16x16x32_bf16 v[32:35], a[172:175], v[112:115], v[32:35]
	v_exp_f32_e64 v43, v43
	v_mfma_f32_16x16x32_bf16 v[36:39], a[188:191], v[112:115], v[36:39]
	v_cvt_pk_bf16_f32 v28, v40, v41
	v_cvt_pk_bf16_f32 v29, v42, v43
	v_mfma_f32_16x16x32_bf16 v[136:139], a[32:35], v[24:27], v[136:139]
	v_exp_f32_e64 v44, v44
	v_mfma_f32_16x16x32_bf16 v[152:155], a[36:39], v[24:27], v[152:155]
	buffer_store_dwordx4 a[248:251], v6, s[16:19], s73 offen sc1
	v_mfma_f32_16x16x32_bf16 v[168:171], a[40:43], v[24:27], v[168:171]
	s_add_u32 s73, s73, s92
	v_exp_f32 v45, v45
	v_mfma_f32_16x16x32_bf16 v[184:187], a[44:47], v[24:27], v[184:187]
	buffer_load_dwordx4 v2, s[20:23], s83 offen offset:0 lds
	v_mfma_f32_16x16x32_bf16 v[200:203], a[48:51], v[24:27], v[200:203]
	v_exp_f32_e64 v46, v46
	v_mfma_f32_16x16x32_bf16 v[216:219], a[52:55], v[24:27], v[216:219]
	v_mfma_f32_16x16x32_bf16 v[232:235], a[56:59], v[24:27], v[232:235]
	v_exp_f32_e64 v47, v47
	v_mfma_f32_16x16x32_bf16 v[248:251], a[60:63], v[24:27], v[248:251]
	v_cvt_pk_bf16_f32 v30, v44, v45
	v_cvt_pk_bf16_f32 v31, v46, v47
	v_mfma_f32_16x16x32_bf16 a[232:235], a[240:243], v[24:27], a[232:235]
	v_mfma_f32_16x16x32_bf16 v[40:43], a[160:163], v[68:71], v[52:55]
	v_exp_f32_e64 v32, v32
	v_mfma_f32_16x16x32_bf16 v[44:47], a[176:179], v[68:71], v[52:55]
	ds_read_b64_tr_b16 a[20:21], v17 offset:0
	ds_read_b64_tr_b16 a[22:23], v17 offset:4096
	v_mfma_f32_16x16x32_bf16 v[40:43], a[164:167], v[84:87], v[40:43]
	v_exp_f32_e64 v33, v33
	v_mfma_f32_16x16x32_bf16 v[44:47], a[180:183], v[84:87], v[44:47]
	ds_read_b64_tr_b16 a[24:25], v18 offset:0
	ds_read_b64_tr_b16 a[26:27], v18 offset:4096
	v_mfma_f32_16x16x32_bf16 v[40:43], a[168:171], v[100:103], v[40:43]
	v_exp_f32_e64 v34, v34
	v_mfma_f32_16x16x32_bf16 v[44:47], a[184:187], v[100:103], v[44:47]
	ds_read_b64_tr_b16 a[28:29], v19 offset:0
	ds_read_b64_tr_b16 a[30:31], v19 offset:4096
	v_mfma_f32_16x16x32_bf16 v[40:43], a[172:175], v[116:119], v[40:43]
	v_exp_f32_e64 v35, v35
	v_mfma_f32_16x16x32_bf16 v[44:47], a[188:191], v[116:119], v[44:47]
	v_cvt_pk_bf16_f32 v24, v32, v33
	v_cvt_pk_bf16_f32 v25, v34, v35
	v_mfma_f32_16x16x32_bf16 v[140:143], a[32:35], v[28:31], v[140:143]
	v_exp_f32_e64 v36, v36
	v_mfma_f32_16x16x32_bf16 v[156:159], a[36:39], v[28:31], v[156:159]
	buffer_store_dwordx4 a[248:251], v6, s[16:19], s73 offen sc1
	v_mfma_f32_16x16x32_bf16 v[172:175], a[40:43], v[28:31], v[172:175]
	s_add_u32 s73, s73, s92
	v_exp_f32 v37, v37
	v_mfma_f32_16x16x32_bf16 v[188:191], a[44:47], v[28:31], v[188:191]
	buffer_load_dwordx4 v3, s[20:23], s83 offen offset:1024 lds
	v_mfma_f32_16x16x32_bf16 v[204:207], a[48:51], v[28:31], v[204:207]
	v_exp_f32_e64 v38, v38
	v_mfma_f32_16x16x32_bf16 v[220:223], a[52:55], v[28:31], v[220:223]
	v_mfma_f32_16x16x32_bf16 v[236:239], a[56:59], v[28:31], v[236:239]
	s_waitcnt lgkmcnt(0)
	v_exp_f32 v39, v39
	v_mfma_f32_16x16x32_bf16 v[252:255], a[60:63], v[28:31], v[252:255]
	v_cvt_pk_bf16_f32 v26, v36, v37
	v_cvt_pk_bf16_f32 v27, v38, v39
	v_mfma_f32_16x16x32_bf16 a[236:239], a[240:243], v[28:31], a[236:239]
	v_mfma_f32_16x16x32_bf16 v[32:35], a[160:163], v[72:75], v[56:59]
	v_exp_f32_e64 v40, v40
	v_mfma_f32_16x16x32_bf16 v[36:39], a[176:179], v[72:75], v[56:59]
	ds_read_b128 a[192:195], v8 offset:8192
	ds_read_b128 a[208:211], v8 offset:12288
	v_mfma_f32_16x16x32_bf16 v[32:35], a[164:167], v[88:91], v[32:35]
	v_exp_f32_e64 v41, v41
	v_mfma_f32_16x16x32_bf16 v[36:39], a[180:183], v[88:91], v[36:39]
	ds_read_b128 a[196:199], v9 offset:8192
	ds_read_b128 a[212:215], v9 offset:12288
	v_mfma_f32_16x16x32_bf16 v[32:35], a[168:171], v[104:107], v[32:35]
	v_exp_f32_e64 v42, v42
	v_mfma_f32_16x16x32_bf16 v[36:39], a[184:187], v[104:107], v[36:39]
	ds_read_b64_tr_b16 a[32:33], v12 offset:8192
	ds_read_b64_tr_b16 a[34:35], v12 offset:12288
	v_mfma_f32_16x16x32_bf16 v[32:35], a[172:175], v[120:123], v[32:35]
	v_exp_f32_e64 v43, v43
	v_mfma_f32_16x16x32_bf16 v[36:39], a[188:191], v[120:123], v[36:39]
	v_cvt_pk_bf16_f32 v28, v40, v41
	v_cvt_pk_bf16_f32 v29, v42, v43
	v_mfma_f32_16x16x32_bf16 v[128:131], a[0:3], v[24:27], v[128:131]
	v_exp_f32_e64 v44, v44
	v_mfma_f32_16x16x32_bf16 v[144:147], a[4:7], v[24:27], v[144:147]
	buffer_store_dwordx4 a[248:251], v6, s[16:19], s73 offen sc1
	v_mfma_f32_16x16x32_bf16 v[160:163], a[8:11], v[24:27], v[160:163]
	s_add_u32 s73, s73, s92
	v_exp_f32 v45, v45
	v_mfma_f32_16x16x32_bf16 v[176:179], a[12:15], v[24:27], v[176:179]
	buffer_load_dwordx4 v4, s[20:23], s83 offen offset:2048 lds
	v_mfma_f32_16x16x32_bf16 v[192:195], a[16:19], v[24:27], v[192:195]
	v_exp_f32_e64 v46, v46
	v_mfma_f32_16x16x32_bf16 v[208:211], a[20:23], v[24:27], v[208:211]
	v_mfma_f32_16x16x32_bf16 v[224:227], a[24:27], v[24:27], v[224:227]
	v_exp_f32_e64 v47, v47
	v_mfma_f32_16x16x32_bf16 v[240:243], a[28:31], v[24:27], v[240:243]
	v_cvt_pk_bf16_f32 v30, v44, v45
	v_cvt_pk_bf16_f32 v31, v46, v47
	v_mfma_f32_16x16x32_bf16 a[224:227], a[240:243], v[24:27], a[224:227]
	v_mfma_f32_16x16x32_bf16 v[40:43], a[160:163], v[76:79], v[60:63]
	v_exp_f32_e64 v32, v32
	v_mfma_f32_16x16x32_bf16 v[44:47], a[176:179], v[76:79], v[60:63]
	ds_read_b128 a[200:203], v10 offset:8192
	ds_read_b128 a[216:219], v10 offset:12288
	v_mfma_f32_16x16x32_bf16 v[40:43], a[164:167], v[92:95], v[40:43]
	v_exp_f32_e64 v33, v33
	v_mfma_f32_16x16x32_bf16 v[44:47], a[180:183], v[92:95], v[44:47]
	ds_read_b128 a[204:207], v11 offset:8192
	ds_read_b128 a[220:223], v11 offset:12288
	v_mfma_f32_16x16x32_bf16 v[40:43], a[168:171], v[108:111], v[40:43]
	v_exp_f32_e64 v34, v34
	v_mfma_f32_16x16x32_bf16 v[44:47], a[184:187], v[108:111], v[44:47]
	ds_read_b64_tr_b16 a[36:37], v13 offset:8192
	ds_read_b64_tr_b16 a[38:39], v13 offset:12288
	v_mfma_f32_16x16x32_bf16 v[40:43], a[172:175], v[124:127], v[40:43]
	v_exp_f32_e64 v35, v35
	v_mfma_f32_16x16x32_bf16 v[44:47], a[188:191], v[124:127], v[44:47]
	v_cvt_pk_bf16_f32 v24, v32, v33
	v_cvt_pk_bf16_f32 v25, v34, v35
	v_mfma_f32_16x16x32_bf16 v[132:135], a[0:3], v[28:31], v[132:135]
	v_exp_f32_e64 v36, v36
	v_mfma_f32_16x16x32_bf16 v[148:151], a[4:7], v[28:31], v[148:151]
	buffer_store_dwordx4 a[248:251], v6, s[16:19], s73 offen sc1
	v_mfma_f32_16x16x32_bf16 v[164:167], a[8:11], v[28:31], v[164:167]
	s_add_u32 s73, s73, s92
	v_exp_f32 v37, v37
	v_mfma_f32_16x16x32_bf16 v[180:183], a[12:15], v[28:31], v[180:183]
	buffer_load_dwordx4 v5, s[20:23], s83 offen offset:3072 lds
	v_mfma_f32_16x16x32_bf16 v[196:199], a[16:19], v[28:31], v[196:199]
	v_exp_f32_e64 v38, v38
	v_mfma_f32_16x16x32_bf16 v[212:215], a[20:23], v[28:31], v[212:215]
	v_mfma_f32_16x16x32_bf16 v[228:231], a[24:27], v[28:31], v[228:231]
	s_waitcnt lgkmcnt(2)
	v_exp_f32 v39, v39
	v_mfma_f32_16x16x32_bf16 v[244:247], a[28:31], v[28:31], v[244:247]
	v_cvt_pk_bf16_f32 v26, v36, v37
	v_cvt_pk_bf16_f32 v27, v38, v39
	v_mfma_f32_16x16x32_bf16 a[228:231], a[240:243], v[28:31], a[228:231]
	v_mfma_f32_16x16x32_bf16 v[32:35], a[192:195], v[64:67], v[48:51]
	v_exp_f32_e64 v40, v40
	v_mfma_f32_16x16x32_bf16 v[36:39], a[208:211], v[64:67], v[48:51]
	ds_read_b64_tr_b16 a[40:41], v14 offset:8192
	ds_read_b64_tr_b16 a[42:43], v14 offset:12288
	v_mfma_f32_16x16x32_bf16 v[32:35], a[196:199], v[80:83], v[32:35]
	v_exp_f32_e64 v41, v41
	v_mfma_f32_16x16x32_bf16 v[36:39], a[212:215], v[80:83], v[36:39]
	ds_read_b64_tr_b16 a[44:45], v15 offset:8192
	ds_read_b64_tr_b16 a[46:47], v15 offset:12288
	v_mfma_f32_16x16x32_bf16 v[32:35], a[200:203], v[96:99], v[32:35]
	v_exp_f32_e64 v42, v42
	v_mfma_f32_16x16x32_bf16 v[36:39], a[216:219], v[96:99], v[36:39]
	ds_read_b64_tr_b16 a[48:49], v16 offset:8192
	ds_read_b64_tr_b16 a[50:51], v16 offset:12288
	v_mfma_f32_16x16x32_bf16 v[32:35], a[204:207], v[112:115], v[32:35]
	v_exp_f32_e64 v43, v43
	v_mfma_f32_16x16x32_bf16 v[36:39], a[220:223], v[112:115], v[36:39]
	v_cvt_pk_bf16_f32 v28, v40, v41
	v_cvt_pk_bf16_f32 v29, v42, v43
	v_mfma_f32_16x16x32_bf16 v[136:139], a[0:3], v[24:27], v[136:139]
	v_exp_f32_e64 v44, v44
	v_mfma_f32_16x16x32_bf16 v[152:155], a[4:7], v[24:27], v[152:155]
	buffer_store_dwordx4 a[248:251], v6, s[16:19], s73 offen sc1
	v_mfma_f32_16x16x32_bf16 v[168:171], a[8:11], v[24:27], v[168:171]
	s_add_u32 s73, s73, s92
	v_exp_f32 v45, v45
	v_mfma_f32_16x16x32_bf16 v[184:187], a[12:15], v[24:27], v[184:187]
	v_mfma_f32_16x16x32_bf16 v[200:203], a[16:19], v[24:27], v[200:203]
	v_exp_f32_e64 v46, v46
	v_mfma_f32_16x16x32_bf16 v[216:219], a[20:23], v[24:27], v[216:219]
	v_mfma_f32_16x16x32_bf16 v[232:235], a[24:27], v[24:27], v[232:235]
	v_exp_f32_e64 v47, v47
	v_mfma_f32_16x16x32_bf16 v[248:251], a[28:31], v[24:27], v[248:251]
	v_cvt_pk_bf16_f32 v30, v44, v45
	v_cvt_pk_bf16_f32 v31, v46, v47
	v_mfma_f32_16x16x32_bf16 a[232:235], a[240:243], v[24:27], a[232:235]
	v_mfma_f32_16x16x32_bf16 v[40:43], a[192:195], v[68:71], v[52:55]
	s_add_u32 s83, s83, 32768
	v_exp_f32_e64 v32, v32
	v_mfma_f32_16x16x32_bf16 v[44:47], a[208:211], v[68:71], v[52:55]
	s_add_u32 s84, s84, s85
	s_nop 0
	ds_read_b64_tr_b16 a[52:53], v17 offset:8192
	ds_read_b64_tr_b16 a[54:55], v17 offset:12288
	v_mfma_f32_16x16x32_bf16 v[40:43], a[196:199], v[84:87], v[40:43]
	s_mul_i32 s85, s85, 3
	v_exp_f32 v33, v33
	v_mfma_f32_16x16x32_bf16 v[44:47], a[212:215], v[84:87], v[44:47]
	s_sub_u32 s74, s74, 1
	s_nop 0
	ds_read_b64_tr_b16 a[56:57], v18 offset:8192
	ds_read_b64_tr_b16 a[58:59], v18 offset:12288
	v_mfma_f32_16x16x32_bf16 v[40:43], a[200:203], v[100:103], v[40:43]
	v_exp_f32_e64 v34, v34
	v_mfma_f32_16x16x32_bf16 v[44:47], a[216:219], v[100:103], v[44:47]
	ds_read_b64_tr_b16 a[60:61], v19 offset:8192
	ds_read_b64_tr_b16 a[62:63], v19 offset:12288
	v_mfma_f32_16x16x32_bf16 v[40:43], a[204:207], v[116:119], v[40:43]
	v_exp_f32_e64 v35, v35
	v_mfma_f32_16x16x32_bf16 v[44:47], a[220:223], v[116:119], v[44:47]
	v_cvt_pk_bf16_f32 v24, v32, v33
	v_cvt_pk_bf16_f32 v25, v34, v35
	v_mfma_f32_16x16x32_bf16 v[140:143], a[0:3], v[28:31], v[140:143]
	v_exp_f32_e64 v36, v36
	v_mfma_f32_16x16x32_bf16 v[156:159], a[4:7], v[28:31], v[156:159]
	v_mfma_f32_16x16x32_bf16 v[172:175], a[8:11], v[28:31], v[172:175]
	v_exp_f32_e64 v37, v37
	v_mfma_f32_16x16x32_bf16 v[188:191], a[12:15], v[28:31], v[188:191]
	v_mfma_f32_16x16x32_bf16 v[204:207], a[16:19], v[28:31], v[204:207]
	v_exp_f32_e64 v38, v38
	v_mfma_f32_16x16x32_bf16 v[220:223], a[20:23], v[28:31], v[220:223]
	v_mfma_f32_16x16x32_bf16 v[236:239], a[24:27], v[28:31], v[236:239]
	v_exp_f32_e64 v39, v39
	v_mfma_f32_16x16x32_bf16 v[252:255], a[28:31], v[28:31], v[252:255]
	v_cvt_pk_bf16_f32 v26, v36, v37
	v_cvt_pk_bf16_f32 v27, v38, v39
	v_mfma_f32_16x16x32_bf16 a[236:239], a[240:243], v[28:31], a[236:239]
	s_cmp_lg_u32 s74, 0
	s_cbranch_scc1 L_attn
	s_waitcnt vmcnt(9) lgkmcnt(0)
	s_barrier
	s_cmp_lg_u32 s56, 0
	s_cbranch_scc1 L_noflag
	s_mov_b64 exec, 1
	s_nop 0
	v_accvgpr_write_b32 a254, s3
	buffer_store_byte a254, off, s[36:39], s2 sc1
	s_mov_b64 exec, -1
	s_nop 0
L_noflag:
	v_mfma_f32_16x16x32_bf16 v[32:35], a[192:195], v[72:75], v[56:59]
	v_exp_f32_e64 v40, v40
	v_mfma_f32_16x16x32_bf16 v[36:39], a[208:211], v[72:75], v[56:59]
	ds_read_b128 a[160:163], v8 offset:16384
	ds_read_b128 a[176:179], v8 offset:20480
	v_mfma_f32_16x16x32_bf16 v[32:35], a[196:199], v[88:91], v[32:35]
	v_exp_f32_e64 v41, v41
	v_mfma_f32_16x16x32_bf16 v[36:39], a[212:215], v[88:91], v[36:39]
	ds_read_b128 a[164:167], v9 offset:16384
	ds_read_b128 a[180:183], v9 offset:20480
	v_mfma_f32_16x16x32_bf16 v[32:35], a[200:203], v[104:107], v[32:35]
	v_exp_f32_e64 v42, v42
	v_mfma_f32_16x16x32_bf16 v[36:39], a[216:219], v[104:107], v[36:39]
	ds_read_b64_tr_b16 a[0:1], v12 offset:16384
	ds_read_b64_tr_b16 a[2:3], v12 offset:20480
	v_mfma_f32_16x16x32_bf16 v[32:35], a[204:207], v[120:123], v[32:35]
	v_exp_f32_e64 v43, v43
	v_mfma_f32_16x16x32_bf16 v[36:39], a[220:223], v[120:123], v[36:39]
	v_cvt_pk_bf16_f32 v28, v40, v41
	v_cvt_pk_bf16_f32 v29, v42, v43
	v_mfma_f32_16x16x32_bf16 v[128:131], a[32:35], v[24:27], v[128:131]
	v_exp_f32_e64 v44, v44
	v_mfma_f32_16x16x32_bf16 v[144:147], a[36:39], v[24:27], v[144:147]
	s_lshl_b32 s62, s59, 2
	s_add_u32 s62, s62, s56
	v_mov_b32 v7, 0x5d800000
	v_mfma_f32_16x16x32_bf16 v[160:163], a[40:43], v[24:27], v[160:163]
	v_exp_f32_e64 v45, v45
	v_mfma_f32_16x16x32_bf16 v[176:179], a[44:47], v[24:27], v[176:179]
	v_bfe_u32 v21, v0, 2, 3
	v_mul_u32_u24 v21, 3584, v21
	v_mfma_f32_16x16x32_bf16 v[192:195], a[48:51], v[24:27], v[192:195]
	v_exp_f32_e64 v46, v46
	v_mfma_f32_16x16x32_bf16 v[208:211], a[52:55], v[24:27], v[208:211]
	s_mul_i32 s62, s62, 28672
	v_and_b32_e64 v20, 3, v0
	v_lshl_add_u32 v21, v20, 7, v21
	v_mfma_f32_16x16x32_bf16 v[224:227], a[56:59], v[24:27], v[224:227]
	s_and_b32 s61, s71, 0xffffff80
	v_exp_f32_e64 v47, v47
	v_mfma_f32_16x16x32_bf16 v[240:243], a[60:63], v[24:27], v[240:243]
	s_add_u32 s62, s62, s61
	s_nop 0
	v_cvt_pk_bf16_f32 v30, v44, v45
	v_cvt_pk_bf16_f32 v31, v46, v47
	v_mfma_f32_16x16x32_bf16 a[224:227], a[240:243], v[24:27], a[224:227]
	buffer_load_dword a244, v21, s[24:27], s62 offen
	v_mfma_f32_16x16x32_bf16 v[40:43], a[192:195], v[76:79], v[60:63]
	v_exp_f32_e64 v32, v32
	v_mfma_f32_16x16x32_bf16 v[44:47], a[208:211], v[76:79], v[60:63]
	ds_read_b128 a[168:171], v10 offset:16384
	ds_read_b128 a[184:187], v10 offset:20480
	v_mfma_f32_16x16x32_bf16 v[40:43], a[196:199], v[92:95], v[40:43]
	v_exp_f32_e64 v33, v33
	v_mfma_f32_16x16x32_bf16 v[44:47], a[212:215], v[92:95], v[44:47]
	ds_read_b128 a[172:175], v11 offset:16384
	ds_read_b128 a[188:191], v11 offset:20480
	v_mfma_f32_16x16x32_bf16 v[40:43], a[200:203], v[108:111], v[40:43]
	v_exp_f32_e64 v34, v34
	v_mfma_f32_16x16x32_bf16 v[44:47], a[216:219], v[108:111], v[44:47]
	ds_read_b64_tr_b16 a[4:5], v13 offset:16384
	ds_read_b64_tr_b16 a[6:7], v13 offset:20480
	v_mfma_f32_16x16x32_bf16 v[40:43], a[204:207], v[124:127], v[40:43]
	v_exp_f32_e64 v35, v35
	v_mfma_f32_16x16x32_bf16 v[44:47], a[220:223], v[124:127], v[44:47]
	v_cvt_pk_bf16_f32 v24, v32, v33
	v_cvt_pk_bf16_f32 v25, v34, v35
	v_mfma_f32_16x16x32_bf16 v[132:135], a[32:35], v[28:31], v[132:135]
	v_exp_f32_e64 v36, v36
	v_mfma_f32_16x16x32_bf16 v[148:151], a[36:39], v[28:31], v[148:151]
	v_and_b32 v20, 63, v0
	v_min_u32 v20, 27, v20
	v_mfma_f32_16x16x32_bf16 v[164:167], a[40:43], v[28:31], v[164:167]
	v_exp_f32_e64 v37, v37
	v_mfma_f32_16x16x32_bf16 v[180:183], a[44:47], v[28:31], v[180:183]
	s_lshl_b32 s62, s59, 2
	s_add_u32 s62, s62, s56
	v_lshlrev_b32_e64 v20, 7, v20
	v_mfma_f32_16x16x32_bf16 v[196:199], a[48:51], v[28:31], v[196:199]
	s_mul_i32 s61, s62, 3584
	v_exp_f32_e64 v38, v38
	v_mfma_f32_16x16x32_bf16 v[212:215], a[52:55], v[28:31], v[212:215]
	s_add_u32 s61, s61, s72
	s_nop 0
	v_mfma_f32_16x16x32_bf16 v[228:231], a[56:59], v[28:31], v[228:231]
	s_waitcnt lgkmcnt(2)
	v_exp_f32 v39, v39
	v_mfma_f32_16x16x32_bf16 v[244:247], a[60:63], v[28:31], v[244:247]
	v_cvt_pk_bf16_f32 v26, v36, v37
	v_cvt_pk_bf16_f32 v27, v38, v39
	v_mfma_f32_16x16x32_bf16 a[228:231], a[240:243], v[28:31], a[228:231]
	buffer_load_dword a244, v20, s[28:31], s61 offen
	v_mfma_f32_16x16x32_bf16 v[32:35], a[160:163], v[64:67], v[48:51]
	v_exp_f32_e64 v40, v40
	v_mfma_f32_16x16x32_bf16 v[36:39], a[176:179], v[64:67], v[48:51]
	ds_read_b64_tr_b16 a[8:9], v14 offset:16384
	ds_read_b64_tr_b16 a[10:11], v14 offset:20480
	v_mfma_f32_16x16x32_bf16 v[32:35], a[164:167], v[80:83], v[32:35]
	v_exp_f32_e64 v41, v41
	v_mfma_f32_16x16x32_bf16 v[36:39], a[180:183], v[80:83], v[36:39]
	ds_read_b64_tr_b16 a[12:13], v15 offset:16384
	ds_read_b64_tr_b16 a[14:15], v15 offset:20480
	v_mfma_f32_16x16x32_bf16 v[32:35], a[168:171], v[96:99], v[32:35]
	v_exp_f32_e64 v42, v42
	v_mfma_f32_16x16x32_bf16 v[36:39], a[184:187], v[96:99], v[36:39]
	ds_read_b64_tr_b16 a[16:17], v16 offset:16384
	ds_read_b64_tr_b16 a[18:19], v16 offset:20480
	v_mfma_f32_16x16x32_bf16 v[32:35], a[172:175], v[112:115], v[32:35]
	v_exp_f32_e64 v43, v43
	v_mfma_f32_16x16x32_bf16 v[36:39], a[188:191], v[112:115], v[36:39]
	v_cvt_pk_bf16_f32 v28, v40, v41
	v_cvt_pk_bf16_f32 v29, v42, v43
	v_mfma_f32_16x16x32_bf16 v[136:139], a[32:35], v[24:27], v[136:139]
	v_exp_f32_e64 v44, v44
	v_mfma_f32_16x16x32_bf16 v[152:155], a[36:39], v[24:27], v[152:155]
	v_accvgpr_read_b32 v20, a245
	v_xor_b32_e64 v21, 32, v20
	v_mfma_f32_16x16x32_bf16 v[168:171], a[40:43], v[24:27], v[168:171]
	v_exp_f32_e64 v45, v45
	v_mfma_f32_16x16x32_bf16 v[184:187], a[44:47], v[24:27], v[184:187]
	v_xor_b32_e64 v22, 64, v20
	v_xor_b32 v23, 96, v20
	v_mfma_f32_16x16x32_bf16 v[200:203], a[48:51], v[24:27], v[200:203]
	v_exp_f32_e64 v46, v46
	v_mfma_f32_16x16x32_bf16 v[216:219], a[52:55], v[24:27], v[216:219]
	ds_read_b64_tr_b16 a[124:125], v20 offset:0
	ds_read_b64_tr_b16 a[126:127], v20 offset:2048
	v_mfma_f32_16x16x32_bf16 v[232:235], a[56:59], v[24:27], v[232:235]
	v_exp_f32_e64 v47, v47
	v_mfma_f32_16x16x32_bf16 v[248:251], a[60:63], v[24:27], v[248:251]
	v_cvt_pk_bf16_f32 v30, v44, v45
	v_cvt_pk_bf16_f32 v31, v46, v47
	v_mfma_f32_16x16x32_bf16 a[232:235], a[240:243], v[24:27], a[232:235]
	ds_read_b64_tr_b16 a[128:129], v21 offset:0
	ds_read_b64_tr_b16 a[130:131], v21 offset:2048
	v_mfma_f32_16x16x32_bf16 v[40:43], a[160:163], v[68:71], v[52:55]
	v_exp_f32_e64 v32, v32
	v_mfma_f32_16x16x32_bf16 v[44:47], a[176:179], v[68:71], v[52:55]
	ds_read_b64_tr_b16 a[20:21], v17 offset:16384
	ds_read_b64_tr_b16 a[22:23], v17 offset:20480
	v_mfma_f32_16x16x32_bf16 v[40:43], a[164:167], v[84:87], v[40:43]
	v_exp_f32_e64 v33, v33
	v_mfma_f32_16x16x32_bf16 v[44:47], a[180:183], v[84:87], v[44:47]
	ds_read_b64_tr_b16 a[24:25], v18 offset:16384
	ds_read_b64_tr_b16 a[26:27], v18 offset:20480
	v_mfma_f32_16x16x32_bf16 v[40:43], a[168:171], v[100:103], v[40:43]
	v_exp_f32_e64 v34, v34
	v_mfma_f32_16x16x32_bf16 v[44:47], a[184:187], v[100:103], v[44:47]
	ds_read_b64_tr_b16 a[28:29], v19 offset:16384
	ds_read_b64_tr_b16 a[30:31], v19 offset:20480
	v_mfma_f32_16x16x32_bf16 v[40:43], a[172:175], v[116:119], v[40:43]
	v_exp_f32_e64 v35, v35
	v_mfma_f32_16x16x32_bf16 v[44:47], a[188:191], v[116:119], v[44:47]
	v_cvt_pk_bf16_f32 v24, v32, v33
	v_cvt_pk_bf16_f32 v25, v34, v35
	v_mfma_f32_16x16x32_bf16 v[140:143], a[32:35], v[28:31], v[140:143]
	v_exp_f32_e64 v36, v36
	v_mfma_f32_16x16x32_bf16 v[156:159], a[36:39], v[28:31], v[156:159]
	ds_read_b64_tr_b16 a[132:133], v22 offset:0
	ds_read_b64_tr_b16 a[134:135], v22 offset:2048
	v_mfma_f32_16x16x32_bf16 v[172:175], a[40:43], v[28:31], v[172:175]
	v_exp_f32_e64 v37, v37
	v_mfma_f32_16x16x32_bf16 v[188:191], a[44:47], v[28:31], v[188:191]
	ds_read_b64_tr_b16 a[136:137], v23 offset:0
	ds_read_b64_tr_b16 a[138:139], v23 offset:2048
	v_mfma_f32_16x16x32_bf16 v[204:207], a[48:51], v[28:31], v[204:207]
	v_exp_f32_e64 v38, v38
	v_mfma_f32_16x16x32_bf16 v[220:223], a[52:55], v[28:31], v[220:223]
	ds_read_b64_tr_b16 a[140:141], v20 offset:16384
	ds_read_b64_tr_b16 a[142:143], v20 offset:18432
	v_mfma_f32_16x16x32_bf16 v[236:239], a[56:59], v[28:31], v[236:239]
	s_waitcnt lgkmcnt(6)
	v_exp_f32 v39, v39
	v_mfma_f32_16x16x32_bf16 v[252:255], a[60:63], v[28:31], v[252:255]
	v_cvt_pk_bf16_f32 v26, v36, v37
	v_cvt_pk_bf16_f32 v27, v38, v39
	v_mfma_f32_16x16x32_bf16 a[236:239], a[240:243], v[28:31], a[236:239]
	ds_read_b64_tr_b16 a[144:145], v21 offset:16384
	ds_read_b64_tr_b16 a[146:147], v21 offset:18432
	v_mfma_f32_16x16x32_bf16 v[32:35], a[160:163], v[72:75], v[56:59]
	v_exp_f32_e64 v40, v40
	v_mfma_f32_16x16x32_bf16 v[36:39], a[176:179], v[72:75], v[56:59]
	ds_read_b128 a[192:195], v8 offset:24576
	ds_read_b128 a[208:211], v8 offset:28672
	v_mfma_f32_16x16x32_bf16 v[32:35], a[164:167], v[88:91], v[32:35]
	v_exp_f32_e64 v41, v41
	v_mfma_f32_16x16x32_bf16 v[36:39], a[180:183], v[88:91], v[36:39]
	ds_read_b128 a[196:199], v9 offset:24576
	ds_read_b128 a[212:215], v9 offset:28672
	v_mfma_f32_16x16x32_bf16 v[32:35], a[168:171], v[104:107], v[32:35]
	v_exp_f32_e64 v42, v42
	v_mfma_f32_16x16x32_bf16 v[36:39], a[184:187], v[104:107], v[36:39]
	ds_read_b64_tr_b16 a[32:33], v12 offset:24576
	ds_read_b64_tr_b16 a[34:35], v12 offset:28672
	v_mfma_f32_16x16x32_bf16 v[32:35], a[172:175], v[120:123], v[32:35]
	v_exp_f32_e64 v43, v43
	v_mfma_f32_16x16x32_bf16 v[36:39], a[188:191], v[120:123], v[36:39]
	v_cvt_pk_bf16_f32 v28, v40, v41
	v_cvt_pk_bf16_f32 v29, v42, v43
	v_mfma_f32_16x16x32_bf16 v[128:131], a[0:3], v[24:27], v[128:131]
	v_exp_f32_e64 v44, v44
	v_mfma_f32_16x16x32_bf16 v[144:147], a[4:7], v[24:27], v[144:147]
	ds_read_b64_tr_b16 a[148:149], v22 offset:16384
	ds_read_b64_tr_b16 a[150:151], v22 offset:18432
	v_mfma_f32_16x16x32_bf16 v[160:163], a[8:11], v[24:27], v[160:163]
	v_exp_f32_e64 v45, v45
	v_mfma_f32_16x16x32_bf16 v[176:179], a[12:15], v[24:27], v[176:179]
	ds_read_b64_tr_b16 a[152:153], v23 offset:16384
	ds_read_b64_tr_b16 a[154:155], v23 offset:18432
	v_mfma_f32_16x16x32_bf16 v[192:195], a[16:19], v[24:27], v[192:195]
	v_exp_f32_e64 v46, v46
	v_mfma_f32_16x16x32_bf16 v[208:211], a[20:23], v[24:27], v[208:211]
	s_waitcnt lgkmcnt(0)
	s_nop 0
	s_add_u32 s63, s70, 196608
	s_add_u32 m0, s68, 0
	s_nop 0
	v_mfma_f32_16x16x32_bf16 v[224:227], a[24:27], v[24:27], v[224:227]
	v_exp_f32_e64 v47, v47
	v_mfma_f32_16x16x32_bf16 v[240:243], a[28:31], v[24:27], v[240:243]
	v_cvt_pk_bf16_f32 v30, v44, v45
	v_cvt_pk_bf16_f32 v31, v46, v47
	v_mfma_f32_16x16x32_bf16 a[224:227], a[240:243], v[24:27], a[224:227]
	buffer_load_dwordx4 v2, s[20:23], s63 offen offset:0 lds
	v_mfma_f32_16x16x32_bf16 v[40:43], a[160:163], v[76:79], v[60:63]
	v_exp_f32_e64 v32, v32
	v_mfma_f32_16x16x32_bf16 v[44:47], a[176:179], v[76:79], v[60:63]
	ds_read_b128 a[200:203], v10 offset:24576
	ds_read_b128 a[216:219], v10 offset:28672
	v_mfma_f32_16x16x32_bf16 v[40:43], a[164:167], v[92:95], v[40:43]
	v_exp_f32_e64 v33, v33
	v_mfma_f32_16x16x32_bf16 v[44:47], a[180:183], v[92:95], v[44:47]
	ds_read_b128 a[204:207], v11 offset:24576
	ds_read_b128 a[220:223], v11 offset:28672
	v_mfma_f32_16x16x32_bf16 v[40:43], a[168:171], v[108:111], v[40:43]
	v_exp_f32_e64 v34, v34
	v_mfma_f32_16x16x32_bf16 v[44:47], a[184:187], v[108:111], v[44:47]
	ds_read_b64_tr_b16 a[36:37], v13 offset:24576
	ds_read_b64_tr_b16 a[38:39], v13 offset:28672
	v_mfma_f32_16x16x32_bf16 v[40:43], a[172:175], v[124:127], v[40:43]
	v_exp_f32_e64 v35, v35
	v_mfma_f32_16x16x32_bf16 v[44:47], a[188:191], v[124:127], v[44:47]
	v_cvt_pk_bf16_f32 v24, v32, v33
	v_cvt_pk_bf16_f32 v25, v34, v35
	v_mfma_f32_16x16x32_bf16 v[132:135], a[0:3], v[28:31], v[132:135]
	v_exp_f32_e64 v36, v36
	v_mfma_f32_16x16x32_bf16 v[148:151], a[4:7], v[28:31], v[148:151]
	buffer_load_dwordx4 v3, s[20:23], s63 offen offset:1024 lds
	v_mfma_f32_16x16x32_bf16 v[164:167], a[8:11], v[28:31], v[164:167]
	v_exp_f32_e64 v37, v37
	v_mfma_f32_16x16x32_bf16 v[180:183], a[12:15], v[28:31], v[180:183]
	buffer_load_dwordx4 v4, s[20:23], s63 offen offset:2048 lds
	v_mfma_f32_16x16x32_bf16 v[196:199], a[16:19], v[28:31], v[196:199]
	v_exp_f32_e64 v38, v38
	v_mfma_f32_16x16x32_bf16 v[212:215], a[20:23], v[28:31], v[212:215]
	buffer_load_dwordx4 v5, s[20:23], s63 offen offset:3072 lds
	v_mfma_f32_16x16x32_bf16 v[228:231], a[24:27], v[28:31], v[228:231]
	s_waitcnt lgkmcnt(2)
	v_exp_f32 v39, v39
	v_mfma_f32_16x16x32_bf16 v[244:247], a[28:31], v[28:31], v[244:247]
	s_add_u32 s63, s70, 229376
	v_cvt_pk_bf16_f32 v26, v36, v37
	v_cvt_pk_bf16_f32 v27, v38, v39
	v_mfma_f32_16x16x32_bf16 a[228:231], a[240:243], v[28:31], a[228:231]
	s_add_u32 m0, s68, 16384
	v_mfma_f32_16x16x32_bf16 v[32:35], a[192:195], v[64:67], v[48:51]
	v_exp_f32_e64 v40, v40
	v_mfma_f32_16x16x32_bf16 v[36:39], a[208:211], v[64:67], v[48:51]
	ds_read_b64_tr_b16 a[40:41], v14 offset:24576
	ds_read_b64_tr_b16 a[42:43], v14 offset:28672
	v_mfma_f32_16x16x32_bf16 v[32:35], a[196:199], v[80:83], v[32:35]
	v_exp_f32_e64 v41, v41
	v_mfma_f32_16x16x32_bf16 v[36:39], a[212:215], v[80:83], v[36:39]
	ds_read_b64_tr_b16 a[44:45], v15 offset:24576
	ds_read_b64_tr_b16 a[46:47], v15 offset:28672
	v_mfma_f32_16x16x32_bf16 v[32:35], a[200:203], v[96:99], v[32:35]
	v_exp_f32_e64 v42, v42
	v_mfma_f32_16x16x32_bf16 v[36:39], a[216:219], v[96:99], v[36:39]
	ds_read_b64_tr_b16 a[48:49], v16 offset:24576
	ds_read_b64_tr_b16 a[50:51], v16 offset:28672
	v_mfma_f32_16x16x32_bf16 v[32:35], a[204:207], v[112:115], v[32:35]
	v_exp_f32_e64 v43, v43
	v_mfma_f32_16x16x32_bf16 v[36:39], a[220:223], v[112:115], v[36:39]
	v_cvt_pk_bf16_f32 v28, v40, v41
	v_cvt_pk_bf16_f32 v29, v42, v43
	v_mfma_f32_16x16x32_bf16 v[136:139], a[0:3], v[24:27], v[136:139]
	v_exp_f32_e64 v44, v44
	v_mfma_f32_16x16x32_bf16 v[152:155], a[4:7], v[24:27], v[152:155]
	buffer_load_dwordx4 v2, s[20:23], s63 offen offset:0 lds
	v_mfma_f32_16x16x32_bf16 v[168:171], a[8:11], v[24:27], v[168:171]
	v_exp_f32_e64 v45, v45
	v_mfma_f32_16x16x32_bf16 v[184:187], a[12:15], v[24:27], v[184:187]
	buffer_load_dwordx4 v3, s[20:23], s63 offen offset:1024 lds
	v_mfma_f32_16x16x32_bf16 v[200:203], a[16:19], v[24:27], v[200:203]
	v_exp_f32_e64 v46, v46
	v_mfma_f32_16x16x32_bf16 v[216:219], a[20:23], v[24:27], v[216:219]
	buffer_load_dwordx4 v4, s[20:23], s63 offen offset:2048 lds
	v_mfma_f32_16x16x32_bf16 v[232:235], a[24:27], v[24:27], v[232:235]
	v_exp_f32_e64 v47, v47
	v_mfma_f32_16x16x32_bf16 v[248:251], a[28:31], v[24:27], v[248:251]
	v_cvt_pk_bf16_f32 v30, v44, v45
	v_cvt_pk_bf16_f32 v31, v46, v47
	v_mfma_f32_16x16x32_bf16 a[232:235], a[240:243], v[24:27], a[232:235]
	buffer_load_dwordx4 v5, s[20:23], s63 offen offset:3072 lds
	v_mfma_f32_16x16x32_bf16 v[40:43], a[192:195], v[68:71], v[52:55]
	v_exp_f32_e64 v32, v32
	v_mfma_f32_16x16x32_bf16 v[44:47], a[208:211], v[68:71], v[52:55]
	ds_read_b64_tr_b16 a[52:53], v17 offset:24576
	ds_read_b64_tr_b16 a[54:55], v17 offset:28672
	v_mfma_f32_16x16x32_bf16 v[40:43], a[196:199], v[84:87], v[40:43]
	v_exp_f32_e64 v33, v33
	v_mfma_f32_16x16x32_bf16 v[44:47], a[212:215], v[84:87], v[44:47]
	ds_read_b64_tr_b16 a[56:57], v18 offset:24576
	ds_read_b64_tr_b16 a[58:59], v18 offset:28672
	v_mfma_f32_16x16x32_bf16 v[40:43], a[200:203], v[100:103], v[40:43]
	v_exp_f32_e64 v34, v34
	v_mfma_f32_16x16x32_bf16 v[44:47], a[216:219], v[100:103], v[44:47]
	ds_read_b64_tr_b16 a[60:61], v19 offset:24576
	ds_read_b64_tr_b16 a[62:63], v19 offset:28672
	v_mfma_f32_16x16x32_bf16 v[40:43], a[204:207], v[116:119], v[40:43]
	v_exp_f32_e64 v35, v35
	v_mfma_f32_16x16x32_bf16 v[44:47], a[220:223], v[116:119], v[44:47]
	v_cvt_pk_bf16_f32 v24, v32, v33
	v_cvt_pk_bf16_f32 v25, v34, v35
	v_mfma_f32_16x16x32_bf16 v[140:143], a[0:3], v[28:31], v[140:143]
	v_exp_f32_e64 v36, v36
	v_mfma_f32_16x16x32_bf16 v[156:159], a[4:7], v[28:31], v[156:159]
	ds_read_b64_tr_b16 a[160:161], v20 offset:32768
	ds_read_b64_tr_b16 a[162:163], v20 offset:34816
	v_mfma_f32_16x16x32_bf16 v[172:175], a[8:11], v[28:31], v[172:175]
	v_exp_f32_e64 v37, v37
	v_mfma_f32_16x16x32_bf16 v[188:191], a[12:15], v[28:31], v[188:191]
	ds_read_b64_tr_b16 a[164:165], v21 offset:32768
	ds_read_b64_tr_b16 a[166:167], v21 offset:34816
	v_mfma_f32_16x16x32_bf16 v[204:207], a[16:19], v[28:31], v[204:207]
	v_exp_f32_e64 v38, v38
	v_mfma_f32_16x16x32_bf16 v[220:223], a[20:23], v[28:31], v[220:223]
	ds_read_b64_tr_b16 a[168:169], v22 offset:32768
	ds_read_b64_tr_b16 a[170:171], v22 offset:34816
	v_mfma_f32_16x16x32_bf16 v[236:239], a[24:27], v[28:31], v[236:239]
	v_exp_f32_e64 v39, v39
	v_mfma_f32_16x16x32_bf16 v[252:255], a[28:31], v[28:31], v[252:255]
	v_cvt_pk_bf16_f32 v26, v36, v37
	v_cvt_pk_bf16_f32 v27, v38, v39
	v_mfma_f32_16x16x32_bf16 a[236:239], a[240:243], v[28:31], a[236:239]
	s_waitcnt lgkmcnt(0)
	s_barrier
	v_mfma_f32_16x16x32_bf16 v[32:35], a[192:195], v[72:75], v[56:59]
	v_exp_f32_e64 v40, v40
	v_mfma_f32_16x16x32_bf16 v[36:39], a[208:211], v[72:75], v[56:59]
	ds_read_b64_tr_b16 a[172:173], v23 offset:32768
	ds_read_b64_tr_b16 a[174:175], v23 offset:34816
	v_mfma_f32_16x16x32_bf16 v[32:35], a[196:199], v[88:91], v[32:35]
	v_exp_f32_e64 v41, v41
	v_mfma_f32_16x16x32_bf16 v[36:39], a[212:215], v[88:91], v[36:39]
	ds_read_b64_tr_b16 a[176:177], v20 offset:49152
	ds_read_b64_tr_b16 a[178:179], v20 offset:51200
	v_mfma_f32_16x16x32_bf16 v[32:35], a[200:203], v[104:107], v[32:35]
	v_exp_f32_e64 v42, v42
	v_mfma_f32_16x16x32_bf16 v[36:39], a[216:219], v[104:107], v[36:39]
	ds_read_b64_tr_b16 a[180:181], v21 offset:49152
	ds_read_b64_tr_b16 a[182:183], v21 offset:51200
	v_mfma_f32_16x16x32_bf16 v[32:35], a[204:207], v[120:123], v[32:35]
	v_exp_f32_e64 v43, v43
	v_mfma_f32_16x16x32_bf16 v[36:39], a[220:223], v[120:123], v[36:39]
	v_cvt_pk_bf16_f32 v28, v40, v41
	v_cvt_pk_bf16_f32 v29, v42, v43
	v_mfma_f32_16x16x32_bf16 v[128:131], a[32:35], v[24:27], v[128:131]
	v_exp_f32_e64 v44, v44
	v_mfma_f32_16x16x32_bf16 v[144:147], a[36:39], v[24:27], v[144:147]
	ds_read_b64_tr_b16 a[184:185], v22 offset:49152
	ds_read_b64_tr_b16 a[186:187], v22 offset:51200
	v_mfma_f32_16x16x32_bf16 v[160:163], a[40:43], v[24:27], v[160:163]
	v_exp_f32_e64 v45, v45
	v_mfma_f32_16x16x32_bf16 v[176:179], a[44:47], v[24:27], v[176:179]
	ds_read_b64_tr_b16 a[188:189], v23 offset:49152
	ds_read_b64_tr_b16 a[190:191], v23 offset:51200
	v_mfma_f32_16x16x32_bf16 v[192:195], a[48:51], v[24:27], v[192:195]
	v_exp_f32_e64 v46, v46
	v_mfma_f32_16x16x32_bf16 v[208:211], a[52:55], v[24:27], v[208:211]
	s_waitcnt lgkmcnt(0)
	s_nop 0
	s_add_u32 s63, s70, 262144
	s_add_u32 m0, s68, 32768
	v_mfma_f32_16x16x32_bf16 v[224:227], a[56:59], v[24:27], v[224:227]
	v_exp_f32_e64 v47, v47
	v_mfma_f32_16x16x32_bf16 v[240:243], a[60:63], v[24:27], v[240:243]
	v_cvt_pk_bf16_f32 v30, v44, v45
	v_cvt_pk_bf16_f32 v31, v46, v47
	v_mfma_f32_16x16x32_bf16 a[224:227], a[240:243], v[24:27], a[224:227]
	buffer_load_dwordx4 v2, s[20:23], s63 offen offset:0 lds
	v_mfma_f32_16x16x32_bf16 v[40:43], a[192:195], v[76:79], v[60:63]
	v_exp_f32_e64 v32, v32
	v_mfma_f32_16x16x32_bf16 v[44:47], a[208:211], v[76:79], v[60:63]
	buffer_load_dwordx4 v3, s[20:23], s63 offen offset:1024 lds
	v_mfma_f32_16x16x32_bf16 v[40:43], a[196:199], v[92:95], v[40:43]
	v_exp_f32_e64 v33, v33
	v_mfma_f32_16x16x32_bf16 v[44:47], a[212:215], v[92:95], v[44:47]
	buffer_load_dwordx4 v4, s[20:23], s63 offen offset:2048 lds
	v_mfma_f32_16x16x32_bf16 v[40:43], a[200:203], v[108:111], v[40:43]
	v_exp_f32_e64 v34, v34
	v_mfma_f32_16x16x32_bf16 v[44:47], a[216:219], v[108:111], v[44:47]
	buffer_load_dwordx4 v5, s[20:23], s63 offen offset:3072 lds
	v_mfma_f32_16x16x32_bf16 v[40:43], a[204:207], v[124:127], v[40:43]
	s_add_u32 s63, s70, 294912
	v_exp_f32_e64 v35, v35
	v_mfma_f32_16x16x32_bf16 v[44:47], a[220:223], v[124:127], v[44:47]
	s_add_u32 m0, s68, 49152
	v_cvt_pk_bf16_f32 v24, v32, v33
	v_cvt_pk_bf16_f32 v25, v34, v35
	v_mfma_f32_16x16x32_bf16 v[132:135], a[32:35], v[28:31], v[132:135]
	v_exp_f32_e64 v36, v36
	v_mfma_f32_16x16x32_bf16 v[148:151], a[36:39], v[28:31], v[148:151]
	buffer_load_dwordx4 v2, s[20:23], s63 offen offset:0 lds
	v_mfma_f32_16x16x32_bf16 v[164:167], a[40:43], v[28:31], v[164:167]
	v_exp_f32_e64 v37, v37
	v_mfma_f32_16x16x32_bf16 v[180:183], a[44:47], v[28:31], v[180:183]
	buffer_load_dwordx4 v3, s[20:23], s63 offen offset:1024 lds
	v_mfma_f32_16x16x32_bf16 v[196:199], a[48:51], v[28:31], v[196:199]
	v_exp_f32_e64 v38, v38
	v_mfma_f32_16x16x32_bf16 v[212:215], a[52:55], v[28:31], v[212:215]
	buffer_load_dwordx4 v4, s[20:23], s63 offen offset:2048 lds
	v_mfma_f32_16x16x32_bf16 v[228:231], a[56:59], v[28:31], v[228:231]
	v_exp_f32_e64 v39, v39
	v_mfma_f32_16x16x32_bf16 v[244:247], a[60:63], v[28:31], v[244:247]
	v_cvt_pk_bf16_f32 v26, v36, v37
	v_cvt_pk_bf16_f32 v27, v38, v39
	v_mfma_f32_16x16x32_bf16 a[228:231], a[240:243], v[28:31], a[228:231]
	buffer_load_dwordx4 v5, s[20:23], s63 offen offset:3072 lds
	s_nop 1
	s_nop 0
	v_mfma_f32_16x16x32_bf16 v[136:139], a[32:35], v[24:27], v[136:139]
	v_exp_f32_e64 v40, v40
	v_mfma_f32_16x16x32_bf16 v[152:155], a[36:39], v[24:27], v[152:155]
	v_accvgpr_read_b32 v8, a245
	v_xor_b32_e64 v9, 32, v8
	v_mfma_f32_16x16x32_bf16 v[168:171], a[40:43], v[24:27], v[168:171]
	v_exp_f32_e64 v41, v41
	v_mfma_f32_16x16x32_bf16 v[184:187], a[44:47], v[24:27], v[184:187]
	v_xor_b32_e64 v10, 64, v8
	v_xor_b32 v11, 96, v8
	v_exp_f32_e64 v42, v42
	v_mfma_f32_16x16x32_bf16 v[200:203], a[48:51], v[24:27], v[200:203]
	v_cvt_pk_bf16_f32 v28, v40, v41
	v_exp_f32_e64 v43, v43
	v_mfma_f32_16x16x32_bf16 v[216:219], a[52:55], v[24:27], v[216:219]
	v_exp_f32_e64 v44, v44
	v_mfma_f32_16x16x32_bf16 v[232:235], a[56:59], v[24:27], v[232:235]
	v_cvt_pk_bf16_f32 v29, v42, v43
	v_exp_f32_e64 v45, v45
	v_mfma_f32_16x16x32_bf16 v[248:251], a[60:63], v[24:27], v[248:251]
	v_exp_f32_e64 v46, v46
	v_mfma_f32_16x16x32_bf16 a[232:235], a[240:243], v[24:27], a[232:235]
	v_cvt_pk_bf16_f32 v30, v44, v45
	v_exp_f32 v47, v47
	s_nop 0
	v_cvt_pk_bf16_f32 v31, v46, v47
	s_nop 1
	s_nop 0
	v_mfma_f32_16x16x32_bf16 v[140:143], a[32:35], v[28:31], v[140:143]
	v_mfma_f32_16x16x32_bf16 v[156:159], a[36:39], v[28:31], v[156:159]
	v_mfma_f32_16x16x32_bf16 v[172:175], a[40:43], v[28:31], v[172:175]
	v_mfma_f32_16x16x32_bf16 v[188:191], a[44:47], v[28:31], v[188:191]
	v_mfma_f32_16x16x32_bf16 v[204:207], a[48:51], v[28:31], v[204:207]
	v_mfma_f32_16x16x32_bf16 v[220:223], a[52:55], v[28:31], v[220:223]
	v_mfma_f32_16x16x32_bf16 v[236:239], a[56:59], v[28:31], v[236:239]
	v_mfma_f32_16x16x32_bf16 v[252:255], a[60:63], v[28:31], v[252:255]
	v_mfma_f32_16x16x32_bf16 a[236:239], a[240:243], v[28:31], a[236:239]
	s_nop 4
	s_nop 0
	v_accvgpr_read_b32 v48, a224
	v_accvgpr_read_b32 v50, a228
	v_accvgpr_read_b32 v52, a232
	v_accvgpr_read_b32 v54, a236
	v_max3_f32 v49, v48, v50, v52
	v_cmp_u_f32 s[60:61], v48, v50
	v_cmp_u_f32 s[78:79], v52, v54
	v_max_f32 v49, v49, v54
	v_rcp_f32 v48, v48
	v_cmp_nle_f32 vcc, v49, v7
	v_rcp_f32 v50, v50
	v_rcp_f32 v52, v52
	v_rcp_f32_e64 v54, v54
	s_or_b64 vcc, vcc, s[60:61]
	s_or_b64 vcc, vcc, s[78:79]
	s_or_b32 s101, vcc_lo, vcc_hi
	v_pk_mul_f32 v[128:129], v[128:129], v[48:49] op_sel_hi:[1,0]
	v_pk_mul_f32 v[130:131], v[130:131], v[48:49] op_sel_hi:[1,0]
	v_pk_mul_f32 v[144:145], v[144:145], v[48:49] op_sel_hi:[1,0]
	v_pk_mul_f32 v[146:147], v[146:147], v[48:49] op_sel_hi:[1,0]
	v_pk_mul_f32 v[160:161], v[160:161], v[48:49] op_sel_hi:[1,0]
	v_pk_mul_f32 v[162:163], v[162:163], v[48:49] op_sel_hi:[1,0]
	v_pk_mul_f32 v[176:177], v[176:177], v[48:49] op_sel_hi:[1,0]
	v_pk_mul_f32 v[178:179], v[178:179], v[48:49] op_sel_hi:[1,0]
	v_pk_mul_f32 v[192:193], v[192:193], v[48:49] op_sel_hi:[1,0]
	v_pk_mul_f32 v[194:195], v[194:195], v[48:49] op_sel_hi:[1,0]
	v_pk_mul_f32 v[208:209], v[208:209], v[48:49] op_sel_hi:[1,0]
	v_pk_mul_f32 v[210:211], v[210:211], v[48:49] op_sel_hi:[1,0]
	v_pk_mul_f32 v[224:225], v[224:225], v[48:49] op_sel_hi:[1,0]
	v_pk_mul_f32 v[226:227], v[226:227], v[48:49] op_sel_hi:[1,0]
	v_pk_mul_f32 v[240:241], v[240:241], v[48:49] op_sel_hi:[1,0]
	v_pk_mul_f32 v[242:243], v[242:243], v[48:49] op_sel_hi:[1,0]
	v_cvt_pk_bf16_f32 v128, v128, v129
	v_cvt_pk_bf16_f32 v129, v130, v131
	v_cvt_pk_bf16_f32 v130, v144, v145
	v_cvt_pk_bf16_f32 v131, v146, v147
	v_cvt_pk_bf16_f32 v160, v160, v161
	v_cvt_pk_bf16_f32 v161, v162, v163
	v_cvt_pk_bf16_f32 v162, v176, v177
	v_cvt_pk_bf16_f32 v163, v178, v179
	v_cvt_pk_bf16_f32 v192, v192, v193
	v_cvt_pk_bf16_f32 v193, v194, v195
	v_cvt_pk_bf16_f32 v194, v208, v209
	v_cvt_pk_bf16_f32 v195, v210, v211
	v_cvt_pk_bf16_f32 v224, v224, v225
	v_cvt_pk_bf16_f32 v225, v226, v227
	v_cvt_pk_bf16_f32 v226, v240, v241
	v_cvt_pk_bf16_f32 v227, v242, v243
	v_pk_mul_f32 v[132:133], v[132:133], v[50:51] op_sel_hi:[1,0]
	v_pk_mul_f32 v[134:135], v[134:135], v[50:51] op_sel_hi:[1,0]
	v_pk_mul_f32 v[148:149], v[148:149], v[50:51] op_sel_hi:[1,0]
	v_pk_mul_f32 v[150:151], v[150:151], v[50:51] op_sel_hi:[1,0]
	v_pk_mul_f32 v[164:165], v[164:165], v[50:51] op_sel_hi:[1,0]
	v_pk_mul_f32 v[166:167], v[166:167], v[50:51] op_sel_hi:[1,0]
	v_pk_mul_f32 v[180:181], v[180:181], v[50:51] op_sel_hi:[1,0]
	v_pk_mul_f32 v[182:183], v[182:183], v[50:51] op_sel_hi:[1,0]
	ds_write_b128 v1, v[128:131] offset:0
	ds_write_b128 v1, v[160:163] offset:4096
	ds_write_b128 v1, v[192:195] offset:8192
	ds_write_b128 v1, v[224:227] offset:12288
	v_pk_mul_f32 v[196:197], v[196:197], v[50:51] op_sel_hi:[1,0]
	v_pk_mul_f32 v[198:199], v[198:199], v[50:51] op_sel_hi:[1,0]
	v_pk_mul_f32 v[212:213], v[212:213], v[50:51] op_sel_hi:[1,0]
	v_pk_mul_f32 v[214:215], v[214:215], v[50:51] op_sel_hi:[1,0]
	v_pk_mul_f32 v[228:229], v[228:229], v[50:51] op_sel_hi:[1,0]
	v_pk_mul_f32 v[230:231], v[230:231], v[50:51] op_sel_hi:[1,0]
	v_pk_mul_f32 v[244:245], v[244:245], v[50:51] op_sel_hi:[1,0]
	v_pk_mul_f32 v[246:247], v[246:247], v[50:51] op_sel_hi:[1,0]
	v_cvt_pk_bf16_f32 v132, v132, v133
	v_cvt_pk_bf16_f32 v133, v134, v135
	v_cvt_pk_bf16_f32 v134, v148, v149
	v_cvt_pk_bf16_f32 v135, v150, v151
	v_cvt_pk_bf16_f32 v164, v164, v165
	v_cvt_pk_bf16_f32 v165, v166, v167
	v_cvt_pk_bf16_f32 v166, v180, v181
	v_cvt_pk_bf16_f32 v167, v182, v183
	v_cvt_pk_bf16_f32 v196, v196, v197
	v_cvt_pk_bf16_f32 v197, v198, v199
	v_cvt_pk_bf16_f32 v198, v212, v213
	v_cvt_pk_bf16_f32 v199, v214, v215
	v_cvt_pk_bf16_f32 v228, v228, v229
	v_cvt_pk_bf16_f32 v229, v230, v231
	v_cvt_pk_bf16_f32 v230, v244, v245
	v_cvt_pk_bf16_f32 v231, v246, v247
	v_pk_mul_f32 v[136:137], v[136:137], v[52:53] op_sel_hi:[1,0]
	v_pk_mul_f32 v[138:139], v[138:139], v[52:53] op_sel_hi:[1,0]
	v_pk_mul_f32 v[152:153], v[152:153], v[52:53] op_sel_hi:[1,0]
	v_pk_mul_f32 v[154:155], v[154:155], v[52:53] op_sel_hi:[1,0]
	v_pk_mul_f32 v[168:169], v[168:169], v[52:53] op_sel_hi:[1,0]
	v_pk_mul_f32 v[170:171], v[170:171], v[52:53] op_sel_hi:[1,0]
	v_pk_mul_f32 v[184:185], v[184:185], v[52:53] op_sel_hi:[1,0]
	v_pk_mul_f32 v[186:187], v[186:187], v[52:53] op_sel_hi:[1,0]
	ds_write_b128 v1, v[132:135] offset:1024
	ds_write_b128 v1, v[164:167] offset:5120
	ds_write_b128 v1, v[196:199] offset:9216
	ds_write_b128 v1, v[228:231] offset:13312
	v_pk_mul_f32 v[200:201], v[200:201], v[52:53] op_sel_hi:[1,0]
	v_pk_mul_f32 v[202:203], v[202:203], v[52:53] op_sel_hi:[1,0]
	v_pk_mul_f32 v[216:217], v[216:217], v[52:53] op_sel_hi:[1,0]
	v_pk_mul_f32 v[218:219], v[218:219], v[52:53] op_sel_hi:[1,0]
	v_pk_mul_f32 v[232:233], v[232:233], v[52:53] op_sel_hi:[1,0]
	v_pk_mul_f32 v[234:235], v[234:235], v[52:53] op_sel_hi:[1,0]
	v_pk_mul_f32 v[248:249], v[248:249], v[52:53] op_sel_hi:[1,0]
	v_pk_mul_f32 v[250:251], v[250:251], v[52:53] op_sel_hi:[1,0]
	v_cvt_pk_bf16_f32 v136, v136, v137
	v_cvt_pk_bf16_f32 v137, v138, v139
	v_cvt_pk_bf16_f32 v138, v152, v153
	v_cvt_pk_bf16_f32 v139, v154, v155
	v_cvt_pk_bf16_f32 v168, v168, v169
	v_cvt_pk_bf16_f32 v169, v170, v171
	v_cvt_pk_bf16_f32 v170, v184, v185
	v_cvt_pk_bf16_f32 v171, v186, v187
	v_cvt_pk_bf16_f32 v200, v200, v201
	v_cvt_pk_bf16_f32 v201, v202, v203
	v_cvt_pk_bf16_f32 v202, v216, v217
	v_cvt_pk_bf16_f32 v203, v218, v219
	v_cvt_pk_bf16_f32 v232, v232, v233
	v_cvt_pk_bf16_f32 v233, v234, v235
	v_cvt_pk_bf16_f32 v234, v248, v249
	v_cvt_pk_bf16_f32 v235, v250, v251
	v_pk_mul_f32 v[140:141], v[140:141], v[54:55] op_sel_hi:[1,0]
	v_pk_mul_f32 v[142:143], v[142:143], v[54:55] op_sel_hi:[1,0]
	v_pk_mul_f32 v[156:157], v[156:157], v[54:55] op_sel_hi:[1,0]
	v_pk_mul_f32 v[158:159], v[158:159], v[54:55] op_sel_hi:[1,0]
	v_pk_mul_f32 v[172:173], v[172:173], v[54:55] op_sel_hi:[1,0]
	v_pk_mul_f32 v[174:175], v[174:175], v[54:55] op_sel_hi:[1,0]
	v_pk_mul_f32 v[188:189], v[188:189], v[54:55] op_sel_hi:[1,0]
	v_pk_mul_f32 v[190:191], v[190:191], v[54:55] op_sel_hi:[1,0]
	ds_write_b128 v1, v[136:139] offset:2048
	ds_write_b128 v1, v[168:171] offset:6144
	ds_write_b128 v1, v[200:203] offset:10240
	ds_write_b128 v1, v[232:235] offset:14336
	v_pk_mul_f32 v[204:205], v[204:205], v[54:55] op_sel_hi:[1,0]
	v_pk_mul_f32 v[206:207], v[206:207], v[54:55] op_sel_hi:[1,0]
	v_pk_mul_f32 v[220:221], v[220:221], v[54:55] op_sel_hi:[1,0]
	v_pk_mul_f32 v[222:223], v[222:223], v[54:55] op_sel_hi:[1,0]
	v_pk_mul_f32 v[236:237], v[236:237], v[54:55] op_sel_hi:[1,0]
	v_pk_mul_f32 v[238:239], v[238:239], v[54:55] op_sel_hi:[1,0]
	v_pk_mul_f32 v[252:253], v[252:253], v[54:55] op_sel_hi:[1,0]
	v_pk_mul_f32 v[254:255], v[254:255], v[54:55] op_sel_hi:[1,0]
	v_cvt_pk_bf16_f32 v140, v140, v141
	v_cvt_pk_bf16_f32 v141, v142, v143
	v_cvt_pk_bf16_f32 v142, v156, v157
	v_cvt_pk_bf16_f32 v143, v158, v159
	v_cvt_pk_bf16_f32 v172, v172, v173
	v_cvt_pk_bf16_f32 v173, v174, v175
	v_cvt_pk_bf16_f32 v174, v188, v189
	v_cvt_pk_bf16_f32 v175, v190, v191
	v_cvt_pk_bf16_f32 v204, v204, v205
	v_cvt_pk_bf16_f32 v205, v206, v207
	v_cvt_pk_bf16_f32 v206, v220, v221
	v_cvt_pk_bf16_f32 v207, v222, v223
	v_cvt_pk_bf16_f32 v236, v236, v237
	v_cvt_pk_bf16_f32 v237, v238, v239
	v_cvt_pk_bf16_f32 v238, v252, v253
	v_cvt_pk_bf16_f32 v239, v254, v255
	ds_write_b128 v1, v[140:143] offset:3072
	ds_write_b128 v1, v[172:175] offset:7168
	ds_write_b128 v1, v[204:207] offset:11264
	ds_write_b128 v1, v[236:239] offset:15360
	s_cmp_lg_u32 s101, 0
	s_cbranch_scc1 L_fallback
L_fb_ret:
	v_add_u32 v12, 131072, v8
	v_add_u32 v13, 131072, v9
	v_add_u32 v14, 131072, v10
	v_add_u32 v15, 131072, v11
	v_mov_b32_e64 v16, v6
	v_add_u32 v7, 65536, v6
	s_waitcnt vmcnt(19)
	s_nop 0
	ds_read_b64_tr_b16 a[0:1], v12 offset:0
	ds_read_b64_tr_b16 a[2:3], v12 offset:2048
	ds_read_b64_tr_b16 a[4:5], v13 offset:0
	ds_read_b64_tr_b16 a[6:7], v13 offset:2048
	ds_read_b64_tr_b16 a[8:9], v14 offset:0
	ds_read_b64_tr_b16 a[10:11], v14 offset:2048
	ds_read_b64_tr_b16 a[12:13], v15 offset:0
	ds_read_b64_tr_b16 a[14:15], v15 offset:2048
	s_waitcnt vmcnt(18) lgkmcnt(0)
	s_barrier
	ds_read_b128 a[32:35], v7 offset:0
	ds_read_b128 a[36:39], v7 offset:1024
	ds_read_b128 a[40:43], v7 offset:2048
	ds_read_b128 a[44:47], v7 offset:3072
	s_waitcnt lgkmcnt(0)
	s_nop 0
	v_mfma_f32_16x16x32_bf16 v[128:131], a[124:127], a[32:35], 0
	s_add_u32 s63, s70, 327680
	ds_read_b64_tr_b16 a[16:17], v12 offset:16384
	ds_read_b64_tr_b16 a[18:19], v12 offset:18432
	v_mfma_f32_16x16x32_bf16 v[132:135], a[124:127], a[36:39], 0
	s_add_u32 m0, s68, 131072
	ds_read_b64_tr_b16 a[20:21], v13 offset:16384
	ds_read_b64_tr_b16 a[22:23], v13 offset:18432
	v_mfma_f32_16x16x32_bf16 v[136:139], a[124:127], a[40:43], 0
	buffer_load_dwordx4 v2, s[20:23], s63 offen offset:0 lds
	v_mfma_f32_16x16x32_bf16 v[140:143], a[124:127], a[44:47], 0
	ds_read_b64_tr_b16 a[24:25], v14 offset:16384
	ds_read_b128 a[48:51], v7 offset:4096
	v_mfma_f32_16x16x32_bf16 v[144:147], a[128:131], a[32:35], 0
	ds_read_b64_tr_b16 a[26:27], v14 offset:18432
	ds_read_b128 a[52:55], v7 offset:5120
	v_mfma_f32_16x16x32_bf16 v[148:151], a[128:131], a[36:39], 0
	ds_read_b64_tr_b16 a[28:29], v15 offset:16384
	ds_read_b128 a[56:59], v7 offset:6144
	v_mfma_f32_16x16x32_bf16 v[152:155], a[128:131], a[40:43], 0
	buffer_load_dwordx4 v3, s[20:23], s63 offen offset:1024 lds
	v_mfma_f32_16x16x32_bf16 v[156:159], a[128:131], a[44:47], 0
	ds_read_b64_tr_b16 a[30:31], v15 offset:18432
	ds_read_b128 a[60:63], v7 offset:7168
	v_mfma_f32_16x16x32_bf16 v[160:163], a[132:135], a[32:35], 0
	v_and_b32_e64 v31, 63, v0
	v_bfe_u32 v28, v31, 1, 3
	v_mfma_f32_16x16x32_bf16 v[164:167], a[132:135], a[36:39], 0
	v_and_b32 v29, 1, v31
	v_lshrrev_b32 v30, 4, v31
	v_mfma_f32_16x16x32_bf16 v[168:171], a[132:135], a[40:43], 0
	buffer_load_dwordx4 v4, s[20:23], s63 offen offset:2048 lds
	v_mfma_f32_16x16x32_bf16 v[172:175], a[132:135], a[44:47], 0
	v_lshlrev_b32_e64 v21, 7, v28
	v_lshl_or_b32 v21, v29, 6, v21
	v_mfma_f32_16x16x32_bf16 v[176:179], a[136:139], a[32:35], 0
	v_lshl_or_b32 v21, v30, 4, v21
	v_and_b32 v1, 127, v21
	v_mfma_f32_16x16x32_bf16 v[180:183], a[136:139], a[36:39], 0
	v_add_u32 v1, s68, v1
	v_cmp_eq_u32 vcc, s57, v28
	v_mfma_f32_16x16x32_bf16 v[184:187], a[136:139], a[40:43], 0
	buffer_load_dwordx4 v5, s[20:23], s63 offen offset:3072 lds
	v_mfma_f32_16x16x32_bf16 v[188:191], a[136:139], a[44:47], 0
	s_waitcnt vmcnt(16) lgkmcnt(0)
	s_nop 0
	v_mfma_f32_16x16x32_bf16 v[128:131], a[140:143], a[48:51], v[128:131]
	s_add_u32 s63, s70, 360448
	ds_read_b64_tr_b16 a[124:125], v8 offset:0
	ds_read_b64_tr_b16 a[126:127], v8 offset:2048
	v_mfma_f32_16x16x32_bf16 v[132:135], a[140:143], a[52:55], v[132:135]
	s_add_u32 m0, s68, 147456
	ds_read_b64_tr_b16 a[128:129], v9 offset:0
	ds_read_b64_tr_b16 a[130:131], v9 offset:2048
	v_mfma_f32_16x16x32_bf16 v[136:139], a[140:143], a[56:59], v[136:139]
	buffer_load_dwordx4 v2, s[20:23], s63 offen offset:0 lds
	v_mfma_f32_16x16x32_bf16 v[140:143], a[140:143], a[60:63], v[140:143]
	ds_read_b64_tr_b16 a[132:133], v10 offset:0
	ds_read_b128 a[32:35], v7 offset:8192
	v_mfma_f32_16x16x32_bf16 v[144:147], a[144:147], a[48:51], v[144:147]
	ds_read_b64_tr_b16 a[134:135], v10 offset:2048
	ds_read_b128 a[36:39], v7 offset:9216
	v_mfma_f32_16x16x32_bf16 v[148:151], a[144:147], a[52:55], v[148:151]
	ds_read_b64_tr_b16 a[136:137], v11 offset:0
	ds_read_b128 a[40:43], v7 offset:10240
	v_mfma_f32_16x16x32_bf16 v[152:155], a[144:147], a[56:59], v[152:155]
	buffer_load_dwordx4 v3, s[20:23], s63 offen offset:1024 lds
	v_mfma_f32_16x16x32_bf16 v[156:159], a[144:147], a[60:63], v[156:159]
	ds_read_b64_tr_b16 a[138:139], v11 offset:2048
	ds_read_b128 a[44:47], v7 offset:11264
	v_mfma_f32_16x16x32_bf16 v[160:163], a[148:151], a[48:51], v[160:163]
	v_mov_b32 v29, 0x40000000
	v_cndmask_b32 v29, 0, v29, vcc
	v_mfma_f32_16x16x32_bf16 v[164:167], a[148:151], a[52:55], v[164:167]
	s_lshl_b32 s60, s57, 1
	s_nop 0
	s_lshl_b32 s94, 0x30003, s60
	v_or_b32_e64 v21, v21, v29
	v_mfma_f32_16x16x32_bf16 v[168:171], a[148:151], a[56:59], v[168:171]
	buffer_load_dwordx4 v4, s[20:23], s63 offen offset:2048 lds
	v_mfma_f32_16x16x32_bf16 v[172:175], a[148:151], a[60:63], v[172:175]
	s_mov_b32 s95, s94
	s_nop 0
	v_bfe_u32 v28, v31, 3, 1
	v_and_b32_e64 v29, 7, v31
	v_mfma_f32_16x16x32_bf16 v[176:179], a[152:155], a[48:51], v[176:179]
	v_mul_u32_u24 v22, 34816, v30
	v_lshl_add_u32 v22, v28, 10, v22
	v_mfma_f32_16x16x32_bf16 v[180:183], a[152:155], a[52:55], v[180:183]
	s_lshl_b32 s60, s57, 7
	s_add_u32 s60, s60, s69
	v_lshl_add_u32 v22, v29, 4, v22
	v_mfma_f32_16x16x32_bf16 v[184:187], a[152:155], a[56:59], v[184:187]
	buffer_load_dwordx4 v5, s[20:23], s63 offen offset:3072 lds
	v_mfma_f32_16x16x32_bf16 v[188:191], a[152:155], a[60:63], v[188:191]
	s_waitcnt vmcnt(16) lgkmcnt(0)
	s_nop 0
	v_mfma_f32_16x16x32_bf16 v[128:131], a[160:163], a[32:35], v[128:131]
	s_add_u32 s63, s70, 393216
	ds_read_b64_tr_b16 a[140:141], v8 offset:16384
	ds_read_b64_tr_b16 a[142:143], v8 offset:18432
	v_mfma_f32_16x16x32_bf16 v[132:135], a[160:163], a[36:39], v[132:135]
	s_add_u32 m0, s68, 0
	s_nop 0
	ds_read_b64_tr_b16 a[144:145], v9 offset:16384
	ds_read_b64_tr_b16 a[146:147], v9 offset:18432
	v_mfma_f32_16x16x32_bf16 v[136:139], a[160:163], a[40:43], v[136:139]
	buffer_load_dwordx4 v2, s[20:23], s63 offen offset:0 lds
	v_mfma_f32_16x16x32_bf16 v[140:143], a[160:163], a[44:47], v[140:143]
	ds_read_b64_tr_b16 a[148:149], v10 offset:16384
	ds_read_b128 a[48:51], v7 offset:12288
	v_mfma_f32_16x16x32_bf16 v[144:147], a[164:167], a[32:35], v[144:147]
	ds_read_b64_tr_b16 a[150:151], v10 offset:18432
	ds_read_b128 a[52:55], v7 offset:13312
	v_mfma_f32_16x16x32_bf16 v[148:151], a[164:167], a[36:39], v[148:151]
	ds_read_b64_tr_b16 a[152:153], v11 offset:16384
	ds_read_b128 a[56:59], v7 offset:14336
	v_mfma_f32_16x16x32_bf16 v[152:155], a[164:167], a[40:43], v[152:155]
	buffer_load_dwordx4 v3, s[20:23], s63 offen offset:1024 lds
	v_mfma_f32_16x16x32_bf16 v[156:159], a[164:167], a[44:47], v[156:159]
	ds_read_b64_tr_b16 a[154:155], v11 offset:18432
	ds_read_b128 a[60:63], v7 offset:15360
	v_mfma_f32_16x16x32_bf16 v[160:163], a[168:171], a[32:35], v[160:163]
	v_add_u32_e64 v22, s60, v22
	v_accvgpr_read_b32 v28, a247
	v_mfma_f32_16x16x32_bf16 v[164:167], a[168:171], a[36:39], v[164:167]
	s_lshl_b32 s60, s56, 7
	v_lshrrev_b32 v29, 3, v31
	v_mul_u32_u24 v29, 3584, v29
	v_mfma_f32_16x16x32_bf16 v[168:171], a[168:171], a[40:43], v[168:171]
	buffer_load_dwordx4 v4, s[20:23], s63 offen offset:2048 lds
	v_mfma_f32_16x16x32_bf16 v[172:175], a[168:171], a[44:47], v[172:175]
	s_cmp_eq_u32 s56, 3
	s_nop 0
	v_add3_u32 v17, v28, v29, s60
	s_cselect_b32 s60, 64, 0
	s_nop 0
	v_mfma_f32_16x16x32_bf16 v[176:179], a[172:175], a[32:35], v[176:179]
	v_and_b32_e64 v28, s60, v28
	v_lshl_or_b32 v17, v28, 24, v17
	v_mfma_f32_16x16x32_bf16 v[180:183], a[172:175], a[36:39], v[180:183]
	v_add_u32 v18, 27648, v17
	v_add_u32 v19, 55296, v17
	v_mfma_f32_16x16x32_bf16 v[184:187], a[172:175], a[40:43], v[184:187]
	buffer_load_dwordx4 v5, s[20:23], s63 offen offset:3072 lds
	v_mfma_f32_16x16x32_bf16 v[188:191], a[172:175], a[44:47], v[188:191]
	s_waitcnt vmcnt(16) lgkmcnt(0)
	s_nop 0
	v_mfma_f32_16x16x32_bf16 v[128:131], a[176:179], a[48:51], v[128:131]
	s_add_u32 s63, s70, 425984
	ds_read_b64_tr_b16 a[160:161], v8 offset:32768
	ds_read_b64_tr_b16 a[162:163], v8 offset:34816
	v_mfma_f32_16x16x32_bf16 v[132:135], a[176:179], a[52:55], v[132:135]
	s_add_u32 m0, s68, 16384
	ds_read_b64_tr_b16 a[164:165], v9 offset:32768
	ds_read_b64_tr_b16 a[166:167], v9 offset:34816
	v_mfma_f32_16x16x32_bf16 v[136:139], a[176:179], a[56:59], v[136:139]
	buffer_load_dwordx4 v2, s[20:23], s63 offen offset:0 lds
	v_mfma_f32_16x16x32_bf16 v[140:143], a[176:179], a[60:63], v[140:143]
	ds_read_b64_tr_b16 a[168:169], v10 offset:32768
	ds_read_b128 a[32:35], v7 offset:16384
	v_mfma_f32_16x16x32_bf16 v[144:147], a[180:183], a[48:51], v[144:147]
	ds_read_b64_tr_b16 a[170:171], v10 offset:34816
	ds_read_b128 a[36:39], v7 offset:17408
	v_mfma_f32_16x16x32_bf16 v[148:151], a[180:183], a[52:55], v[148:151]
	ds_read_b64_tr_b16 a[172:173], v11 offset:32768
	ds_read_b128 a[40:43], v7 offset:18432
	v_mfma_f32_16x16x32_bf16 v[152:155], a[180:183], a[56:59], v[152:155]
	buffer_load_dwordx4 v3, s[20:23], s63 offen offset:1024 lds
	v_mfma_f32_16x16x32_bf16 v[156:159], a[180:183], a[60:63], v[156:159]
	ds_read_b64_tr_b16 a[174:175], v11 offset:34816
	ds_read_b128 a[44:47], v7 offset:19456
	v_mfma_f32_16x16x32_bf16 v[160:163], a[184:187], a[48:51], v[160:163]
	v_add_u32 v20, 82944, v17
	v_lshlrev_b32_e64 v28, 1, v30
	v_mfma_f32_16x16x32_bf16 v[164:167], a[184:187], a[52:55], v[164:167]
	v_xor_b32 v23, v31, v28
	v_lshlrev_b32 v23, 4, v23
	v_mfma_f32_16x16x32_bf16 v[168:171], a[184:187], a[56:59], v[168:171]
	buffer_load_dwordx4 v4, s[20:23], s63 offen offset:2048 lds
	v_mfma_f32_16x16x32_bf16 v[172:175], a[184:187], a[60:63], v[172:175]
	v_add_u32 v23, 65536, v23
	v_lshrrev_b32_e64 v28, 3, v31
	v_mfma_f32_16x16x32_bf16 v[176:179], a[188:191], a[48:51], v[176:179]
	v_and_b32_e64 v29, 3, v31
	v_bfe_u32 v30, v31, 2, 1
	v_mfma_f32_16x16x32_bf16 v[180:183], a[188:191], a[52:55], v[180:183]
	v_lshlrev_b32_e64 v24, 12, v28
	v_lshl_or_b32 v24, v29, 8, v24
	v_mfma_f32_16x16x32_bf16 v[184:187], a[188:191], a[56:59], v[184:187]
	buffer_load_dwordx4 v5, s[20:23], s63 offen offset:3072 lds
	v_mfma_f32_16x16x32_bf16 v[188:191], a[188:191], a[60:63], v[188:191]
	s_waitcnt vmcnt(16) lgkmcnt(0)
	s_nop 0
	v_mfma_f32_16x16x32_bf16 v[128:131], a[0:3], a[32:35], v[128:131]
	s_add_u32 s63, s70, 458752
	ds_read_b64_tr_b16 a[176:177], v8 offset:49152
	ds_read_b64_tr_b16 a[178:179], v8 offset:51200
	v_mfma_f32_16x16x32_bf16 v[132:135], a[0:3], a[36:39], v[132:135]
	s_add_u32 m0, s68, 32768
	ds_read_b64_tr_b16 a[180:181], v9 offset:49152
	ds_read_b64_tr_b16 a[182:183], v9 offset:51200
	v_mfma_f32_16x16x32_bf16 v[136:139], a[0:3], a[40:43], v[136:139]
	buffer_load_dwordx4 v2, s[20:23], s63 offen offset:0 lds
	v_mfma_f32_16x16x32_bf16 v[140:143], a[0:3], a[44:47], v[140:143]
	ds_read_b64_tr_b16 a[184:185], v10 offset:49152
	ds_read_b128 a[48:51], v7 offset:20480
	v_mfma_f32_16x16x32_bf16 v[144:147], a[4:7], a[32:35], v[144:147]
	ds_read_b64_tr_b16 a[186:187], v10 offset:51200
	ds_read_b128 a[52:55], v7 offset:21504
	v_mfma_f32_16x16x32_bf16 v[148:151], a[4:7], a[36:39], v[148:151]
	ds_read_b64_tr_b16 a[188:189], v11 offset:49152
	ds_read_b128 a[56:59], v7 offset:22528
	v_mfma_f32_16x16x32_bf16 v[152:155], a[4:7], a[40:43], v[152:155]
	buffer_load_dwordx4 v3, s[20:23], s63 offen offset:1024 lds
	v_mfma_f32_16x16x32_bf16 v[156:159], a[4:7], a[44:47], v[156:159]
	ds_read_b64_tr_b16 a[190:191], v11 offset:51200
	ds_read_b128 a[60:63], v7 offset:23552
	v_mfma_f32_16x16x32_bf16 v[160:163], a[8:11], a[32:35], v[160:163]
	s_lshl_b32 s60, s56, 10
	s_nop 0
	v_lshl_or_b32 v24, v30, 4, v24
	v_lshl_or_b32 v24, v29, 5, v24
	v_mfma_f32_16x16x32_bf16 v[164:167], a[8:11], a[36:39], v[164:167]
	s_add_u32 s60, s60, 65536
	v_add_u32 v24, s60, v24
	s_lshl_b32 s60, s57, 5
	v_mfma_f32_16x16x32_bf16 v[168:171], a[8:11], a[40:43], v[168:171]
	buffer_load_dwordx4 v4, s[20:23], s63 offen offset:2048 lds
	v_mfma_f32_16x16x32_bf16 v[172:175], a[8:11], a[44:47], v[172:175]
	v_xor_b32 v24, s60, v24
	v_xor_b32 v25, 32, v24
	v_mfma_f32_16x16x32_bf16 v[176:179], a[12:15], a[32:35], v[176:179]
	s_mul_i32 s60, s56, 34816
	v_xor_b32_e64 v26, 64, v24
	v_xor_b32 v27, 96, v24
	v_mfma_f32_16x16x32_bf16 v[180:183], a[12:15], a[36:39], v[180:183]
	v_add_u32 v6, s60, v16
	v_lshrrev_b32 v28, 4, v31
	v_mfma_f32_16x16x32_bf16 v[184:187], a[12:15], a[40:43], v[184:187]
	buffer_load_dwordx4 v5, s[20:23], s63 offen offset:3072 lds
	v_mfma_f32_16x16x32_bf16 v[188:191], a[12:15], a[44:47], v[188:191]
	s_waitcnt vmcnt(16) lgkmcnt(0)
	s_nop 0
	v_mfma_f32_16x16x32_bf16 v[128:131], a[16:19], a[48:51], v[128:131]
	s_add_u32 s63, s70, 491520
	ds_read_b64_tr_b16 a[0:1], v12 offset:0
	ds_read_b64_tr_b16 a[2:3], v12 offset:2048
	v_mfma_f32_16x16x32_bf16 v[132:135], a[16:19], a[52:55], v[132:135]
	s_add_u32 m0, s68, 49152
	ds_read_b64_tr_b16 a[4:5], v13 offset:0
	ds_read_b64_tr_b16 a[6:7], v13 offset:2048
	v_mfma_f32_16x16x32_bf16 v[136:139], a[16:19], a[56:59], v[136:139]
	buffer_load_dwordx4 v2, s[20:23], s63 offen offset:0 lds
	v_mfma_f32_16x16x32_bf16 v[140:143], a[16:19], a[60:63], v[140:143]
	ds_read_b64_tr_b16 a[8:9], v14 offset:0
	ds_read_b128 a[32:35], v7 offset:24576
	v_mfma_f32_16x16x32_bf16 v[144:147], a[20:23], a[48:51], v[144:147]
	ds_read_b64_tr_b16 a[10:11], v14 offset:2048
	ds_read_b128 a[36:39], v7 offset:25600
	v_mfma_f32_16x16x32_bf16 v[148:151], a[20:23], a[52:55], v[148:151]
	ds_read_b64_tr_b16 a[12:13], v15 offset:0
	ds_read_b128 a[40:43], v7 offset:26624
	v_mfma_f32_16x16x32_bf16 v[152:155], a[20:23], a[56:59], v[152:155]
	buffer_load_dwordx4 v3, s[20:23], s63 offen offset:1024 lds
	v_mfma_f32_16x16x32_bf16 v[156:159], a[20:23], a[60:63], v[156:159]
	ds_read_b64_tr_b16 a[14:15], v15 offset:2048
	ds_read_b128 a[44:47], v7 offset:27648
	v_mfma_f32_16x16x32_bf16 v[160:163], a[24:27], a[48:51], v[160:163]
	v_and_b32 v29, 15, v31
	v_lshlrev_b32 v29, 4, v29
	v_mfma_f32_16x16x32_bf16 v[164:167], a[24:27], a[52:55], v[164:167]
	s_lshl_b32 s60, s56, 8
	s_nop 0
	v_lshl_or_b32 v29, v28, 12, v29
	v_add_u32_e64 v31, s60, v29
	v_mfma_f32_16x16x32_bf16 v[168:171], a[24:27], a[56:59], v[168:171]
	buffer_load_dwordx4 v4, s[20:23], s63 offen offset:2048 lds
	v_mfma_f32_16x16x32_bf16 v[172:175], a[24:27], a[60:63], v[172:175]
	v_accvgpr_read_b32 v64, a96
	v_accvgpr_read_b32 v65, a97
	v_mfma_f32_16x16x32_bf16 v[176:179], a[28:31], a[48:51], v[176:179]
	v_accvgpr_read_b32 v66, a98
	v_accvgpr_read_b32 v67, a99
	v_mfma_f32_16x16x32_bf16 v[180:183], a[28:31], a[52:55], v[180:183]
	v_accvgpr_read_b32 v68, a100
	v_accvgpr_read_b32 v69, a101
	v_mfma_f32_16x16x32_bf16 v[184:187], a[28:31], a[56:59], v[184:187]
	buffer_load_dwordx4 v5, s[20:23], s63 offen offset:3072 lds
	v_mfma_f32_16x16x32_bf16 v[188:191], a[28:31], a[60:63], v[188:191]
	s_waitcnt vmcnt(16) lgkmcnt(0)
	s_nop 0
	v_mfma_f32_16x16x32_bf16 v[128:131], a[124:127], a[32:35], v[128:131]
	s_add_u32 s63, s70, 128
	ds_read_b64_tr_b16 a[16:17], v12 offset:16384
	ds_read_b64_tr_b16 a[18:19], v12 offset:18432
	v_mfma_f32_16x16x32_bf16 v[132:135], a[124:127], a[36:39], v[132:135]
	s_add_u32 m0, s68, 131072
	ds_read_b64_tr_b16 a[20:21], v13 offset:16384
	ds_read_b64_tr_b16 a[22:23], v13 offset:18432
	v_mfma_f32_16x16x32_bf16 v[136:139], a[124:127], a[40:43], v[136:139]
	buffer_load_dwordx4 v2, s[20:23], s63 offen offset:0 lds
	v_mfma_f32_16x16x32_bf16 v[140:143], a[124:127], a[44:47], v[140:143]
	ds_read_b64_tr_b16 a[24:25], v14 offset:16384
	ds_read_b128 a[48:51], v7 offset:28672
	v_mfma_f32_16x16x32_bf16 v[144:147], a[128:131], a[32:35], v[144:147]
	ds_read_b64_tr_b16 a[26:27], v14 offset:18432
	ds_read_b128 a[52:55], v7 offset:29696
	v_mfma_f32_16x16x32_bf16 v[148:151], a[128:131], a[36:39], v[148:151]
	ds_read_b64_tr_b16 a[28:29], v15 offset:16384
	ds_read_b128 a[56:59], v7 offset:30720
	v_mfma_f32_16x16x32_bf16 v[152:155], a[128:131], a[40:43], v[152:155]
	buffer_load_dwordx4 v3, s[20:23], s63 offen offset:1024 lds
	v_mfma_f32_16x16x32_bf16 v[156:159], a[128:131], a[44:47], v[156:159]
	ds_read_b64_tr_b16 a[30:31], v15 offset:18432
	ds_read_b128 a[60:63], v7 offset:31744
	v_mfma_f32_16x16x32_bf16 v[160:163], a[132:135], a[32:35], v[160:163]
	v_accvgpr_read_b32 v70, a102
	v_accvgpr_read_b32 v71, a103
	v_mfma_f32_16x16x32_bf16 v[164:167], a[132:135], a[36:39], v[164:167]
	v_lshlrev_b32_e64 v32, 16, v64
	v_and_b32 v33, 0xffff0000, v64
	v_mfma_f32_16x16x32_bf16 v[168:171], a[132:135], a[40:43], v[168:171]
	buffer_load_dwordx4 v4, s[20:23], s63 offen offset:2048 lds
	v_mfma_f32_16x16x32_bf16 v[172:175], a[132:135], a[44:47], v[172:175]
	v_lshlrev_b32_e64 v34, 16, v65
	v_and_b32 v35, 0xffff0000, v65
	v_mfma_f32_16x16x32_bf16 v[176:179], a[136:139], a[32:35], v[176:179]
	v_lshlrev_b32_e64 v36, 16, v66
	v_and_b32 v37, 0xffff0000, v66
	v_mfma_f32_16x16x32_bf16 v[180:183], a[136:139], a[36:39], v[180:183]
	v_lshlrev_b32_e64 v38, 16, v67
	v_and_b32 v39, 0xffff0000, v67
	v_mfma_f32_16x16x32_bf16 v[184:187], a[136:139], a[40:43], v[184:187]
	buffer_load_dwordx4 v5, s[20:23], s63 offen offset:3072 lds
	v_mfma_f32_16x16x32_bf16 v[188:191], a[136:139], a[44:47], v[188:191]
	s_waitcnt vmcnt(16) lgkmcnt(0)
	s_nop 0
	v_mfma_f32_16x16x32_bf16 v[128:131], a[140:143], a[48:51], v[128:131]
	s_add_u32 s63, s70, 32896
	ds_read_b64_tr_b16 a[124:125], v8 offset:0
	ds_read_b64_tr_b16 a[126:127], v8 offset:2048
	v_mfma_f32_16x16x32_bf16 v[132:135], a[140:143], a[52:55], v[132:135]
	s_add_u32 m0, s68, 147456
	ds_read_b64_tr_b16 a[128:129], v9 offset:0
	ds_read_b64_tr_b16 a[130:131], v9 offset:2048
	v_mfma_f32_16x16x32_bf16 v[136:139], a[140:143], a[56:59], v[136:139]
	buffer_load_dwordx4 v2, s[20:23], s63 offen offset:0 lds
	v_mfma_f32_16x16x32_bf16 v[140:143], a[140:143], a[60:63], v[140:143]
	ds_read_b64_tr_b16 a[132:133], v10 offset:0
	ds_read_b128 a[32:35], v7 offset:32768
	v_mfma_f32_16x16x32_bf16 v[144:147], a[144:147], a[48:51], v[144:147]
	ds_read_b64_tr_b16 a[134:135], v10 offset:2048
	ds_read_b128 a[36:39], v7 offset:33792
	v_mfma_f32_16x16x32_bf16 v[148:151], a[144:147], a[52:55], v[148:151]
	ds_read_b64_tr_b16 a[136:137], v11 offset:0
	ds_read_b128 a[40:43], v7 offset:34816
	v_mfma_f32_16x16x32_bf16 v[152:155], a[144:147], a[56:59], v[152:155]
	buffer_load_dwordx4 v3, s[20:23], s63 offen offset:1024 lds
	v_mfma_f32_16x16x32_bf16 v[156:159], a[144:147], a[60:63], v[156:159]
	ds_read_b64_tr_b16 a[138:139], v11 offset:2048
	ds_read_b128 a[44:47], v7 offset:35840
	v_mfma_f32_16x16x32_bf16 v[160:163], a[148:151], a[48:51], v[160:163]
	v_lshlrev_b32_e64 v40, 16, v68
	v_and_b32 v41, 0xffff0000, v68
	v_mfma_f32_16x16x32_bf16 v[164:167], a[148:151], a[52:55], v[164:167]
	v_lshlrev_b32_e64 v42, 16, v69
	v_and_b32 v43, 0xffff0000, v69
	v_mfma_f32_16x16x32_bf16 v[168:171], a[148:151], a[56:59], v[168:171]
	buffer_load_dwordx4 v4, s[20:23], s63 offen offset:2048 lds
	v_mfma_f32_16x16x32_bf16 v[172:175], a[148:151], a[60:63], v[172:175]
	v_lshlrev_b32_e64 v44, 16, v70
	v_and_b32 v45, 0xffff0000, v70
	v_mfma_f32_16x16x32_bf16 v[176:179], a[152:155], a[48:51], v[176:179]
	v_lshlrev_b32_e64 v46, 16, v71
	v_and_b32 v47, 0xffff0000, v71
	v_mfma_f32_16x16x32_bf16 v[180:183], a[152:155], a[52:55], v[180:183]
	v_accvgpr_read_b32 v72, a112
	v_accvgpr_read_b32 v73, a113
	v_mfma_f32_16x16x32_bf16 v[184:187], a[152:155], a[56:59], v[184:187]
	buffer_load_dwordx4 v5, s[20:23], s63 offen offset:3072 lds
	v_mfma_f32_16x16x32_bf16 v[188:191], a[152:155], a[60:63], v[188:191]
	s_waitcnt vmcnt(16) lgkmcnt(0)
	s_nop 0
	v_mfma_f32_16x16x32_bf16 v[128:131], a[160:163], a[32:35], v[128:131]
	s_add_u32 s63, s70, 65664
	ds_read_b64_tr_b16 a[140:141], v8 offset:16384
	ds_read_b64_tr_b16 a[142:143], v8 offset:18432
	v_mfma_f32_16x16x32_bf16 v[132:135], a[160:163], a[36:39], v[132:135]
	s_add_u32 m0, s68, 0
	s_nop 0
	ds_read_b64_tr_b16 a[144:145], v9 offset:16384
	ds_read_b64_tr_b16 a[146:147], v9 offset:18432
	v_mfma_f32_16x16x32_bf16 v[136:139], a[160:163], a[40:43], v[136:139]
	buffer_load_dwordx4 v2, s[20:23], s63 offen offset:0 lds
	v_mfma_f32_16x16x32_bf16 v[140:143], a[160:163], a[44:47], v[140:143]
	ds_read_b64_tr_b16 a[148:149], v10 offset:16384
	ds_read_b128 a[48:51], v7 offset:36864
	v_mfma_f32_16x16x32_bf16 v[144:147], a[164:167], a[32:35], v[144:147]
	ds_read_b64_tr_b16 a[150:151], v10 offset:18432
	ds_read_b128 a[52:55], v7 offset:37888
	v_mfma_f32_16x16x32_bf16 v[148:151], a[164:167], a[36:39], v[148:151]
	ds_read_b64_tr_b16 a[152:153], v11 offset:16384
	ds_read_b128 a[56:59], v7 offset:38912
	v_mfma_f32_16x16x32_bf16 v[152:155], a[164:167], a[40:43], v[152:155]
	buffer_load_dwordx4 v3, s[20:23], s63 offen offset:1024 lds
	v_mfma_f32_16x16x32_bf16 v[156:159], a[164:167], a[44:47], v[156:159]
	ds_read_b64_tr_b16 a[154:155], v11 offset:18432
	ds_read_b128 a[60:63], v7 offset:39936
	v_mfma_f32_16x16x32_bf16 v[160:163], a[168:171], a[32:35], v[160:163]
	v_accvgpr_read_b32 v74, a114
	v_accvgpr_read_b32 v75, a115
	v_mfma_f32_16x16x32_bf16 v[164:167], a[168:171], a[36:39], v[164:167]
	v_accvgpr_read_b32 v76, a116
	v_accvgpr_read_b32 v77, a117
	v_mfma_f32_16x16x32_bf16 v[168:171], a[168:171], a[40:43], v[168:171]
	buffer_load_dwordx4 v4, s[20:23], s63 offen offset:2048 lds
	v_mfma_f32_16x16x32_bf16 v[172:175], a[168:171], a[44:47], v[172:175]
	v_accvgpr_read_b32 v78, a118
	v_accvgpr_read_b32 v79, a119
	v_mfma_f32_16x16x32_bf16 v[176:179], a[172:175], a[32:35], v[176:179]
	v_lshlrev_b32_e64 v48, 16, v72
	v_and_b32 v49, 0xffff0000, v72
	v_mfma_f32_16x16x32_bf16 v[180:183], a[172:175], a[36:39], v[180:183]
	v_lshlrev_b32_e64 v50, 16, v73
	v_and_b32 v51, 0xffff0000, v73
	v_mfma_f32_16x16x32_bf16 v[184:187], a[172:175], a[40:43], v[184:187]
	buffer_load_dwordx4 v5, s[20:23], s63 offen offset:3072 lds
	v_mfma_f32_16x16x32_bf16 v[188:191], a[172:175], a[44:47], v[188:191]
	s_waitcnt vmcnt(16) lgkmcnt(0)
	s_nop 0
	v_mfma_f32_16x16x32_bf16 v[128:131], a[176:179], a[48:51], v[128:131]
	s_add_u32 s63, s70, 98432
	ds_read_b64_tr_b16 a[160:161], v8 offset:32768
	ds_read_b64_tr_b16 a[162:163], v8 offset:34816
	v_mfma_f32_16x16x32_bf16 v[132:135], a[176:179], a[52:55], v[132:135]
	s_add_u32 m0, s68, 16384
	ds_read_b64_tr_b16 a[164:165], v9 offset:32768
	ds_read_b64_tr_b16 a[166:167], v9 offset:34816
	v_mfma_f32_16x16x32_bf16 v[136:139], a[176:179], a[56:59], v[136:139]
	buffer_load_dwordx4 v2, s[20:23], s63 offen offset:0 lds
	v_mfma_f32_16x16x32_bf16 v[140:143], a[176:179], a[60:63], v[140:143]
	ds_read_b64_tr_b16 a[168:169], v10 offset:32768
	ds_read_b128 a[32:35], v7 offset:40960
	v_mfma_f32_16x16x32_bf16 v[144:147], a[180:183], a[48:51], v[144:147]
	ds_read_b64_tr_b16 a[170:171], v10 offset:34816
	ds_read_b128 a[36:39], v7 offset:41984
	v_mfma_f32_16x16x32_bf16 v[148:151], a[180:183], a[52:55], v[148:151]
	ds_read_b64_tr_b16 a[172:173], v11 offset:32768
	ds_read_b128 a[40:43], v7 offset:43008
	v_mfma_f32_16x16x32_bf16 v[152:155], a[180:183], a[56:59], v[152:155]
	buffer_load_dwordx4 v3, s[20:23], s63 offen offset:1024 lds
	v_mfma_f32_16x16x32_bf16 v[156:159], a[180:183], a[60:63], v[156:159]
	ds_read_b64_tr_b16 a[174:175], v11 offset:34816
	ds_read_b128 a[44:47], v7 offset:44032
	v_mfma_f32_16x16x32_bf16 v[160:163], a[184:187], a[48:51], v[160:163]
	v_lshlrev_b32_e64 v52, 16, v74
	v_and_b32 v53, 0xffff0000, v74
	v_mfma_f32_16x16x32_bf16 v[164:167], a[184:187], a[52:55], v[164:167]
	v_lshlrev_b32_e64 v54, 16, v75
	v_and_b32 v55, 0xffff0000, v75
	v_mfma_f32_16x16x32_bf16 v[168:171], a[184:187], a[56:59], v[168:171]
	buffer_load_dwordx4 v4, s[20:23], s63 offen offset:2048 lds
	v_mfma_f32_16x16x32_bf16 v[172:175], a[184:187], a[60:63], v[172:175]
	v_lshlrev_b32_e64 v56, 16, v76
	v_and_b32 v57, 0xffff0000, v76
	v_mfma_f32_16x16x32_bf16 v[176:179], a[188:191], a[48:51], v[176:179]
	v_lshlrev_b32_e64 v58, 16, v77
	v_and_b32 v59, 0xffff0000, v77
	v_mfma_f32_16x16x32_bf16 v[180:183], a[188:191], a[52:55], v[180:183]
	v_lshlrev_b32_e64 v60, 16, v78
	v_and_b32 v61, 0xffff0000, v78
	v_mfma_f32_16x16x32_bf16 v[184:187], a[188:191], a[56:59], v[184:187]
	buffer_load_dwordx4 v5, s[20:23], s63 offen offset:3072 lds
	v_mfma_f32_16x16x32_bf16 v[188:191], a[188:191], a[60:63], v[188:191]
	s_waitcnt vmcnt(16) lgkmcnt(0)
	s_nop 0
	v_mfma_f32_16x16x32_bf16 v[128:131], a[0:3], a[32:35], v[128:131]
	s_add_u32 s63, s70, 131200
	ds_read_b64_tr_b16 a[176:177], v8 offset:49152
	ds_read_b64_tr_b16 a[178:179], v8 offset:51200
	v_mfma_f32_16x16x32_bf16 v[132:135], a[0:3], a[36:39], v[132:135]
	s_add_u32 m0, s68, 32768
	ds_read_b64_tr_b16 a[180:181], v9 offset:49152
	ds_read_b64_tr_b16 a[182:183], v9 offset:51200
	v_mfma_f32_16x16x32_bf16 v[136:139], a[0:3], a[40:43], v[136:139]
	buffer_load_dwordx4 v2, s[20:23], s63 offen offset:0 lds
	v_mfma_f32_16x16x32_bf16 v[140:143], a[0:3], a[44:47], v[140:143]
	ds_read_b64_tr_b16 a[184:185], v10 offset:49152
	ds_read_b128 a[48:51], v7 offset:45056
	v_mfma_f32_16x16x32_bf16 v[144:147], a[4:7], a[32:35], v[144:147]
	ds_read_b64_tr_b16 a[186:187], v10 offset:51200
	ds_read_b128 a[52:55], v7 offset:46080
	v_mfma_f32_16x16x32_bf16 v[148:151], a[4:7], a[36:39], v[148:151]
	ds_read_b64_tr_b16 a[188:189], v11 offset:49152
	ds_read_b128 a[56:59], v7 offset:47104
	v_mfma_f32_16x16x32_bf16 v[152:155], a[4:7], a[40:43], v[152:155]
	buffer_load_dwordx4 v3, s[20:23], s63 offen offset:1024 lds
	v_mfma_f32_16x16x32_bf16 v[156:159], a[4:7], a[44:47], v[156:159]
	ds_read_b64_tr_b16 a[190:191], v11 offset:51200
	ds_read_b128 a[60:63], v7 offset:48128
	v_mfma_f32_16x16x32_bf16 v[160:163], a[8:11], a[32:35], v[160:163]
	v_lshlrev_b32_e64 v30, 2, v0
	v_and_b32 v30, 0xff, v30
	v_mfma_f32_16x16x32_bf16 v[164:167], a[8:11], a[36:39], v[164:167]
	buffer_load_dword a254, v30, s[36:39], 0 offen sc1
	v_mfma_f32_16x16x32_bf16 v[168:171], a[8:11], a[40:43], v[168:171]
	buffer_load_dwordx4 v4, s[20:23], s63 offen offset:2048 lds
	v_mfma_f32_16x16x32_bf16 v[172:175], a[8:11], a[44:47], v[172:175]
	v_lshlrev_b32_e64 v62, 16, v79
	v_and_b32 v63, 0xffff0000, v79
	v_mfma_f32_16x16x32_bf16 v[176:179], a[12:15], a[32:35], v[176:179]
	v_bfe_u32 v97, v0, 3, 3
	v_and_b32_e64 v96, 7, v0
	v_mfma_f32_16x16x32_bf16 v[180:183], a[12:15], a[36:39], v[180:183]
	s_lshr_b32 s60, s2, 3
	v_lshlrev_b32 v96, 2, v96
	v_lshl_or_b32 v97, v97, 8, v96
	v_mfma_f32_16x16x32_bf16 v[184:187], a[12:15], a[40:43], v[184:187]
	buffer_load_dwordx4 v5, s[20:23], s63 offen offset:3072 lds
	v_mfma_f32_16x16x32_bf16 v[188:191], a[12:15], a[44:47], v[188:191]
	s_waitcnt vmcnt(17) lgkmcnt(0)
	s_nop 0
	v_mfma_f32_16x16x32_bf16 v[128:131], a[16:19], a[48:51], v[128:131]
	s_add_u32 s63, s70, 163968
	ds_read_b64_tr_b16 a[0:1], v12 offset:0
	ds_read_b64_tr_b16 a[2:3], v12 offset:2048
	v_mfma_f32_16x16x32_bf16 v[132:135], a[16:19], a[52:55], v[132:135]
	s_add_u32 m0, s68, 49152
	ds_read_b64_tr_b16 a[4:5], v13 offset:0
	ds_read_b64_tr_b16 a[6:7], v13 offset:2048
	v_mfma_f32_16x16x32_bf16 v[136:139], a[16:19], a[56:59], v[136:139]
	buffer_load_dwordx4 v2, s[20:23], s63 offen offset:0 lds
	v_mfma_f32_16x16x32_bf16 v[140:143], a[16:19], a[60:63], v[140:143]
	ds_read_b64_tr_b16 a[8:9], v14 offset:0
	ds_read_b128 a[32:35], v7 offset:49152
	v_mfma_f32_16x16x32_bf16 v[144:147], a[20:23], a[48:51], v[144:147]
	ds_read_b64_tr_b16 a[10:11], v14 offset:2048
	ds_read_b128 a[36:39], v7 offset:50176
	v_mfma_f32_16x16x32_bf16 v[148:151], a[20:23], a[52:55], v[148:151]
	ds_read_b64_tr_b16 a[12:13], v15 offset:0
	ds_read_b128 a[40:43], v7 offset:51200
	v_mfma_f32_16x16x32_bf16 v[152:155], a[20:23], a[56:59], v[152:155]
	buffer_load_dwordx4 v3, s[20:23], s63 offen offset:1024 lds
	v_mfma_f32_16x16x32_bf16 v[156:159], a[20:23], a[60:63], v[156:159]
	ds_read_b64_tr_b16 a[14:15], v15 offset:2048
	ds_read_b128 a[44:47], v7 offset:52224
	v_mfma_f32_16x16x32_bf16 v[160:163], a[24:27], a[48:51], v[160:163]
	s_lshl_b32 s60, s60, 11
	s_and_b32 s61, s2, 7
	s_lshl_b32 s61, s61, 5
	s_nop 0
	v_mfma_f32_16x16x32_bf16 v[164:167], a[24:27], a[52:55], v[164:167]
	s_add_u32 s60, s60, s61
	s_nop 0
	s_add_u32 s93, s60, 65536
	v_mfma_f32_16x16x32_bf16 v[168:171], a[24:27], a[56:59], v[168:171]
	buffer_load_dwordx4 v4, s[20:23], s63 offen offset:2048 lds
	v_mfma_f32_16x16x32_bf16 v[172:175], a[24:27], a[60:63], v[172:175]
	v_mfma_f32_16x16x32_bf16 v[176:179], a[28:31], a[48:51], v[176:179]
	v_mfma_f32_16x16x32_bf16 v[180:183], a[28:31], a[52:55], v[180:183]
	v_mfma_f32_16x16x32_bf16 v[184:187], a[28:31], a[56:59], v[184:187]
	buffer_load_dwordx4 v5, s[20:23], s63 offen offset:3072 lds
	v_mfma_f32_16x16x32_bf16 v[188:191], a[28:31], a[60:63], v[188:191]
	s_waitcnt vmcnt(17) lgkmcnt(0)
	s_nop 0
	v_mfma_f32_16x16x32_bf16 v[128:131], a[124:127], a[32:35], v[128:131]
	s_add_u32 s63, s70, 196736
	ds_read_b64_tr_b16 a[16:17], v12 offset:16384
	ds_read_b64_tr_b16 a[18:19], v12 offset:18432
	v_mfma_f32_16x16x32_bf16 v[132:135], a[124:127], a[36:39], v[132:135]
	s_add_u32 m0, s68, 131072
	ds_read_b64_tr_b16 a[20:21], v13 offset:16384
	ds_read_b64_tr_b16 a[22:23], v13 offset:18432
	v_mfma_f32_16x16x32_bf16 v[136:139], a[124:127], a[40:43], v[136:139]
	buffer_load_dwordx4 v2, s[20:23], s63 offen offset:0 lds
	v_mfma_f32_16x16x32_bf16 v[140:143], a[124:127], a[44:47], v[140:143]
	ds_read_b64_tr_b16 a[24:25], v14 offset:16384
	ds_read_b128 a[48:51], v7 offset:53248
	v_mfma_f32_16x16x32_bf16 v[144:147], a[128:131], a[32:35], v[144:147]
	ds_read_b64_tr_b16 a[26:27], v14 offset:18432
	ds_read_b128 a[52:55], v7 offset:54272
	v_mfma_f32_16x16x32_bf16 v[148:151], a[128:131], a[36:39], v[148:151]
	ds_read_b64_tr_b16 a[28:29], v15 offset:16384
	ds_read_b128 a[56:59], v7 offset:55296
	v_mfma_f32_16x16x32_bf16 v[152:155], a[128:131], a[40:43], v[152:155]
	buffer_load_dwordx4 v3, s[20:23], s63 offen offset:1024 lds
	v_mfma_f32_16x16x32_bf16 v[156:159], a[128:131], a[44:47], v[156:159]
	ds_read_b64_tr_b16 a[30:31], v15 offset:18432
	ds_read_b128 a[60:63], v7 offset:56320
	v_mfma_f32_16x16x32_bf16 v[160:163], a[132:135], a[32:35], v[160:163]
	v_mfma_f32_16x16x32_bf16 v[164:167], a[132:135], a[36:39], v[164:167]
	v_mfma_f32_16x16x32_bf16 v[168:171], a[132:135], a[40:43], v[168:171]
	buffer_load_dwordx4 v4, s[20:23], s63 offen offset:2048 lds
	v_mfma_f32_16x16x32_bf16 v[172:175], a[132:135], a[44:47], v[172:175]
	v_mfma_f32_16x16x32_bf16 v[176:179], a[136:139], a[32:35], v[176:179]
	v_mfma_f32_16x16x32_bf16 v[180:183], a[136:139], a[36:39], v[180:183]
	v_mfma_f32_16x16x32_bf16 v[184:187], a[136:139], a[40:43], v[184:187]
	buffer_load_dwordx4 v5, s[20:23], s63 offen offset:3072 lds
	v_mfma_f32_16x16x32_bf16 v[188:191], a[136:139], a[44:47], v[188:191]
	s_waitcnt vmcnt(17) lgkmcnt(0)
	s_nop 0
	v_mfma_f32_16x16x32_bf16 v[128:131], a[140:143], a[48:51], v[128:131]
	s_add_u32 s63, s70, 229504
	ds_read_b64_tr_b16 a[124:125], v8 offset:0
	ds_read_b64_tr_b16 a[126:127], v8 offset:2048
	v_mfma_f32_16x16x32_bf16 v[132:135], a[140:143], a[52:55], v[132:135]
	s_add_u32 m0, s68, 147456
	ds_read_b64_tr_b16 a[128:129], v9 offset:0
	ds_read_b64_tr_b16 a[130:131], v9 offset:2048
	v_mfma_f32_16x16x32_bf16 v[136:139], a[140:143], a[56:59], v[136:139]
	buffer_load_dwordx4 v2, s[20:23], s63 offen offset:0 lds
	v_mfma_f32_16x16x32_bf16 v[140:143], a[140:143], a[60:63], v[140:143]
	ds_read_b64_tr_b16 a[132:133], v10 offset:0
	ds_read_b128 a[32:35], v7 offset:57344
	v_mfma_f32_16x16x32_bf16 v[144:147], a[144:147], a[48:51], v[144:147]
	ds_read_b64_tr_b16 a[134:135], v10 offset:2048
	ds_read_b128 a[36:39], v7 offset:58368
	v_mfma_f32_16x16x32_bf16 v[148:151], a[144:147], a[52:55], v[148:151]
	ds_read_b64_tr_b16 a[136:137], v11 offset:0
	ds_read_b128 a[40:43], v7 offset:59392
	v_mfma_f32_16x16x32_bf16 v[152:155], a[144:147], a[56:59], v[152:155]
	buffer_load_dwordx4 v3, s[20:23], s63 offen offset:1024 lds
	v_mfma_f32_16x16x32_bf16 v[156:159], a[144:147], a[60:63], v[156:159]
	ds_read_b64_tr_b16 a[138:139], v11 offset:2048
	ds_read_b128 a[44:47], v7 offset:60416
	v_mfma_f32_16x16x32_bf16 v[160:163], a[148:151], a[48:51], v[160:163]
	v_mfma_f32_16x16x32_bf16 v[164:167], a[148:151], a[52:55], v[164:167]
	v_mfma_f32_16x16x32_bf16 v[168:171], a[148:151], a[56:59], v[168:171]
	buffer_load_dwordx4 v4, s[20:23], s63 offen offset:2048 lds
	v_mfma_f32_16x16x32_bf16 v[172:175], a[148:151], a[60:63], v[172:175]
	v_mfma_f32_16x16x32_bf16 v[176:179], a[152:155], a[48:51], v[176:179]
	v_mfma_f32_16x16x32_bf16 v[180:183], a[152:155], a[52:55], v[180:183]
	v_mfma_f32_16x16x32_bf16 v[184:187], a[152:155], a[56:59], v[184:187]
	buffer_load_dwordx4 v5, s[20:23], s63 offen offset:3072 lds
	v_mfma_f32_16x16x32_bf16 v[188:191], a[152:155], a[60:63], v[188:191]
	s_waitcnt vmcnt(17) lgkmcnt(0)
	s_nop 0
	v_mfma_f32_16x16x32_bf16 v[128:131], a[160:163], a[32:35], v[128:131]
	s_add_u32 s63, s70, 262272
	ds_read_b64_tr_b16 a[140:141], v8 offset:16384
	ds_read_b64_tr_b16 a[142:143], v8 offset:18432
	v_mfma_f32_16x16x32_bf16 v[132:135], a[160:163], a[36:39], v[132:135]
	s_add_u32 m0, s68, 0
	s_nop 0
	ds_read_b64_tr_b16 a[144:145], v9 offset:16384
	ds_read_b64_tr_b16 a[146:147], v9 offset:18432
	v_mfma_f32_16x16x32_bf16 v[136:139], a[160:163], a[40:43], v[136:139]
	buffer_load_dwordx4 v2, s[20:23], s63 offen offset:0 lds
	v_mfma_f32_16x16x32_bf16 v[140:143], a[160:163], a[44:47], v[140:143]
	ds_read_b64_tr_b16 a[148:149], v10 offset:16384
	ds_read_b128 a[48:51], v7 offset:61440
	v_mfma_f32_16x16x32_bf16 v[144:147], a[164:167], a[32:35], v[144:147]
	ds_read_b64_tr_b16 a[150:151], v10 offset:18432
	ds_read_b128 a[52:55], v7 offset:62464
	v_mfma_f32_16x16x32_bf16 v[148:151], a[164:167], a[36:39], v[148:151]
	ds_read_b64_tr_b16 a[152:153], v11 offset:16384
	ds_read_b128 a[56:59], v7 offset:63488
	v_mfma_f32_16x16x32_bf16 v[152:155], a[164:167], a[40:43], v[152:155]
	buffer_load_dwordx4 v3, s[20:23], s63 offen offset:1024 lds
	v_mfma_f32_16x16x32_bf16 v[156:159], a[164:167], a[44:47], v[156:159]
	ds_read_b64_tr_b16 a[154:155], v11 offset:18432
	ds_read_b128 a[60:63], v7 offset:64512
	v_mfma_f32_16x16x32_bf16 v[160:163], a[168:171], a[32:35], v[160:163]
	v_mfma_f32_16x16x32_bf16 v[164:167], a[168:171], a[36:39], v[164:167]
	v_mfma_f32_16x16x32_bf16 v[168:171], a[168:171], a[40:43], v[168:171]
	buffer_load_dwordx4 v4, s[20:23], s63 offen offset:2048 lds
	v_mfma_f32_16x16x32_bf16 v[172:175], a[168:171], a[44:47], v[172:175]
	v_mfma_f32_16x16x32_bf16 v[176:179], a[172:175], a[32:35], v[176:179]
	v_mfma_f32_16x16x32_bf16 v[180:183], a[172:175], a[36:39], v[180:183]
	v_mfma_f32_16x16x32_bf16 v[184:187], a[172:175], a[40:43], v[184:187]
	buffer_load_dwordx4 v5, s[20:23], s63 offen offset:3072 lds
	v_mfma_f32_16x16x32_bf16 v[188:191], a[172:175], a[44:47], v[188:191]
	s_waitcnt vmcnt(16) lgkmcnt(0)
	s_nop 0
	v_mfma_f32_16x16x32_bf16 v[128:131], a[176:179], a[48:51], v[128:131]
	s_add_u32 s63, s70, 295040
	ds_read_b64_tr_b16 a[160:161], v8 offset:32768
	ds_read_b64_tr_b16 a[162:163], v8 offset:34816
	v_mfma_f32_16x16x32_bf16 v[132:135], a[176:179], a[52:55], v[132:135]
	s_add_u32 m0, s68, 16384
	ds_read_b64_tr_b16 a[164:165], v9 offset:32768
	ds_read_b64_tr_b16 a[166:167], v9 offset:34816
	v_mfma_f32_16x16x32_bf16 v[136:139], a[176:179], a[56:59], v[136:139]
	buffer_load_dwordx4 v2, s[20:23], s63 offen offset:0 lds
	v_mfma_f32_16x16x32_bf16 v[140:143], a[176:179], a[60:63], v[140:143]
	ds_read_b64_tr_b16 a[168:169], v10 offset:32768
	ds_read_b128 a[32:35], v7 offset:0
	v_mfma_f32_16x16x32_bf16 v[144:147], a[180:183], a[48:51], v[144:147]
	ds_read_b64_tr_b16 a[170:171], v10 offset:34816
	ds_read_b128 a[36:39], v7 offset:1024
	v_mfma_f32_16x16x32_bf16 v[148:151], a[180:183], a[52:55], v[148:151]
	ds_read_b64_tr_b16 a[172:173], v11 offset:32768
	ds_read_b128 a[40:43], v7 offset:2048
	v_mfma_f32_16x16x32_bf16 v[152:155], a[180:183], a[56:59], v[152:155]
	buffer_load_dwordx4 v3, s[20:23], s63 offen offset:1024 lds
	v_mfma_f32_16x16x32_bf16 v[156:159], a[180:183], a[60:63], v[156:159]
	ds_read_b64_tr_b16 a[174:175], v11 offset:34816
	ds_read_b128 a[44:47], v7 offset:3072
	v_mfma_f32_16x16x32_bf16 v[160:163], a[184:187], a[48:51], v[160:163]
	v_mfma_f32_16x16x32_bf16 v[164:167], a[184:187], a[52:55], v[164:167]
	v_mfma_f32_16x16x32_bf16 v[168:171], a[184:187], a[56:59], v[168:171]
	buffer_load_dwordx4 v4, s[20:23], s63 offen offset:2048 lds
	v_mfma_f32_16x16x32_bf16 v[172:175], a[184:187], a[60:63], v[172:175]
	v_mfma_f32_16x16x32_bf16 v[176:179], a[188:191], a[48:51], v[176:179]
	v_mfma_f32_16x16x32_bf16 v[180:183], a[188:191], a[52:55], v[180:183]
	v_mfma_f32_16x16x32_bf16 v[184:187], a[188:191], a[56:59], v[184:187]
	buffer_load_dwordx4 v5, s[20:23], s63 offen offset:3072 lds
	v_mfma_f32_16x16x32_bf16 v[188:191], a[188:191], a[60:63], v[188:191]
	s_waitcnt lgkmcnt(0)
	s_nop 0
	v_accvgpr_read_b32 v28, a254
	v_and_b32 v28, 0x80808080, v28
	v_cmp_ne_u32 vcc, 0x80808080, v28
	s_nop 0
	s_cbranch_vccz L_flagok
	s_mov_b32 s100, 32768
L_flagsp:
	v_lshlrev_b32_e64 v28, 2, v0
	v_and_b32 v28, 0xff, v28
	buffer_load_dword a254, v28, s[36:39], 0 offen sc1
	s_waitcnt vmcnt(0)
	s_nop 0
	v_accvgpr_read_b32 v28, a254
	v_and_b32 v28, 0x80808080, v28
	v_cmp_ne_u32 vcc, 0x80808080, v28
	s_cbranch_vccz L_flagok
	s_sub_u32 s100, s100, 1
	s_cmp_lg_u32 s100, 0
	s_cbranch_scc1 L_flagsp
L_flagok:
	v_mfma_f32_16x16x32_bf16 v[192:195], a[0:3], a[32:35], 0
	ds_read_b128 a[48:51], v7 offset:4096
	ds_read_b128 a[52:55], v7 offset:5120
	v_mfma_f32_16x16x32_bf16 v[196:199], a[0:3], a[36:39], 0
	ds_read_b128 a[56:59], v7 offset:6144
	ds_read_b128 a[60:63], v7 offset:7168
	v_mfma_f32_16x16x32_bf16 v[200:203], a[0:3], a[40:43], 0
	buffer_load_dword v96, v97, s[32:35], s93 offen sc1
	v_mfma_f32_16x16x32_bf16 v[204:207], a[0:3], a[44:47], 0
	s_add_u32 s75, s66, 2048
	v_cvt_pk_bf16_f32 v128, v128, v129
	v_cvt_pk_bf16_f32 v129, v130, v131
	v_mfma_f32_16x16x32_bf16 v[208:211], a[4:7], a[32:35], 0
	v_cvt_pk_bf16_f32 v130, v144, v145
	v_cvt_pk_bf16_f32 v131, v146, v147
	v_mfma_f32_16x16x32_bf16 v[212:215], a[4:7], a[36:39], 0
	buffer_store_dwordx4 v[128:131], v21, s[32:35], s75 offen offset:0 sc1
	v_mfma_f32_16x16x32_bf16 v[216:219], a[4:7], a[40:43], 0
	v_cvt_pk_bf16_f32 v160, v160, v161
	v_cvt_pk_bf16_f32 v161, v162, v163
	v_mfma_f32_16x16x32_bf16 v[220:223], a[4:7], a[44:47], 0
	v_cvt_pk_bf16_f32 v162, v176, v177
	v_cvt_pk_bf16_f32 v163, v178, v179
	v_mfma_f32_16x16x32_bf16 v[224:227], a[8:11], a[32:35], 0
	buffer_store_dwordx4 v[160:163], v21, s[32:35], s75 offen offset:1024 sc1
	v_mfma_f32_16x16x32_bf16 v[228:231], a[8:11], a[36:39], 0
	v_cvt_pk_bf16_f32 v132, v132, v133
	v_cvt_pk_bf16_f32 v133, v134, v135
	v_mfma_f32_16x16x32_bf16 v[232:235], a[8:11], a[40:43], 0
	v_cvt_pk_bf16_f32 v134, v148, v149
	v_cvt_pk_bf16_f32 v135, v150, v151
	v_mfma_f32_16x16x32_bf16 v[236:239], a[8:11], a[44:47], 0
	buffer_store_dwordx4 v[132:135], v21, s[32:35], s75 offen offset:2048 sc1
	v_mfma_f32_16x16x32_bf16 v[240:243], a[12:15], a[32:35], 0
	v_cvt_pk_bf16_f32 v164, v164, v165
	v_cvt_pk_bf16_f32 v165, v166, v167
	v_mfma_f32_16x16x32_bf16 v[244:247], a[12:15], a[36:39], 0
	v_cvt_pk_bf16_f32 v166, v180, v181
	v_cvt_pk_bf16_f32 v167, v182, v183
	v_mfma_f32_16x16x32_bf16 v[248:251], a[12:15], a[40:43], 0
	buffer_store_dwordx4 v[164:167], v21, s[32:35], s75 offen offset:3072 sc1
	v_mfma_f32_16x16x32_bf16 v[252:255], a[12:15], a[44:47], 0
	s_waitcnt lgkmcnt(0)
	s_nop 0
	v_mfma_f32_16x16x32_bf16 v[192:195], a[16:19], a[48:51], v[192:195]
	ds_read_b128 a[32:35], v7 offset:8192
	ds_read_b128 a[36:39], v7 offset:9216
	v_mfma_f32_16x16x32_bf16 v[196:199], a[16:19], a[52:55], v[196:199]
	ds_read_b128 a[40:43], v7 offset:10240
	ds_read_b128 a[44:47], v7 offset:11264
	v_mfma_f32_16x16x32_bf16 v[200:203], a[16:19], a[56:59], v[200:203]
	s_add_u32 s75, s66, 6144
	v_cvt_pk_bf16_f32 v136, v136, v137
	v_cvt_pk_bf16_f32 v137, v138, v139
	v_mfma_f32_16x16x32_bf16 v[204:207], a[16:19], a[60:63], v[204:207]
	v_cvt_pk_bf16_f32 v138, v152, v153
	v_cvt_pk_bf16_f32 v139, v154, v155
	v_mfma_f32_16x16x32_bf16 v[208:211], a[20:23], a[48:51], v[208:211]
	buffer_store_dwordx4 v[136:139], v21, s[32:35], s75 offen offset:0 sc1
	v_mfma_f32_16x16x32_bf16 v[212:215], a[20:23], a[52:55], v[212:215]
	v_cvt_pk_bf16_f32 v168, v168, v169
	v_cvt_pk_bf16_f32 v169, v170, v171
	v_mfma_f32_16x16x32_bf16 v[216:219], a[20:23], a[56:59], v[216:219]
	v_cvt_pk_bf16_f32 v170, v184, v185
	v_cvt_pk_bf16_f32 v171, v186, v187
	v_mfma_f32_16x16x32_bf16 v[220:223], a[20:23], a[60:63], v[220:223]
	buffer_store_dwordx4 v[168:171], v21, s[32:35], s75 offen offset:1024 sc1
	v_mfma_f32_16x16x32_bf16 v[224:227], a[24:27], a[48:51], v[224:227]
	v_cvt_pk_bf16_f32 v140, v140, v141
	v_cvt_pk_bf16_f32 v141, v142, v143
	v_mfma_f32_16x16x32_bf16 v[228:231], a[24:27], a[52:55], v[228:231]
	v_cvt_pk_bf16_f32 v142, v156, v157
	v_cvt_pk_bf16_f32 v143, v158, v159
	v_mfma_f32_16x16x32_bf16 v[232:235], a[24:27], a[56:59], v[232:235]
	buffer_store_dwordx4 v[140:143], v21, s[32:35], s75 offen offset:2048 sc1
	v_mfma_f32_16x16x32_bf16 v[236:239], a[24:27], a[60:63], v[236:239]
	v_cvt_pk_bf16_f32 v172, v172, v173
	v_cvt_pk_bf16_f32 v173, v174, v175
	v_mfma_f32_16x16x32_bf16 v[240:243], a[28:31], a[48:51], v[240:243]
	v_cvt_pk_bf16_f32 v174, v188, v189
	v_cvt_pk_bf16_f32 v175, v190, v191
	v_mfma_f32_16x16x32_bf16 v[244:247], a[28:31], a[52:55], v[244:247]
	buffer_store_dwordx4 v[172:175], v21, s[32:35], s75 offen offset:3072 sc1
	v_mfma_f32_16x16x32_bf16 v[248:251], a[28:31], a[56:59], v[248:251]
	v_mfma_f32_16x16x32_bf16 v[252:255], a[28:31], a[60:63], v[252:255]
	s_waitcnt lgkmcnt(0)
	s_nop 0
	v_mfma_f32_16x16x32_bf16 v[192:195], a[124:127], a[32:35], v[192:195]
	ds_read_b128 a[48:51], v7 offset:12288
	ds_read_b128 a[52:55], v7 offset:13312
	v_mfma_f32_16x16x32_bf16 v[196:199], a[124:127], a[36:39], v[196:199]
	ds_read_b128 a[56:59], v7 offset:14336
	ds_read_b128 a[60:63], v7 offset:15360
	v_mfma_f32_16x16x32_bf16 v[200:203], a[124:127], a[40:43], v[200:203]
	v_mfma_f32_16x16x32_bf16 v[204:207], a[124:127], a[44:47], v[204:207]
	v_mfma_f32_16x16x32_bf16 v[208:211], a[128:131], a[32:35], v[208:211]
	v_mfma_f32_16x16x32_bf16 v[212:215], a[128:131], a[36:39], v[212:215]
	v_mfma_f32_16x16x32_bf16 v[216:219], a[128:131], a[40:43], v[216:219]
	v_mfma_f32_16x16x32_bf16 v[220:223], a[128:131], a[44:47], v[220:223]
	v_mfma_f32_16x16x32_bf16 v[224:227], a[132:135], a[32:35], v[224:227]
	v_mfma_f32_16x16x32_bf16 v[228:231], a[132:135], a[36:39], v[228:231]
	v_mfma_f32_16x16x32_bf16 v[232:235], a[132:135], a[40:43], v[232:235]
	v_mfma_f32_16x16x32_bf16 v[236:239], a[132:135], a[44:47], v[236:239]
	v_mfma_f32_16x16x32_bf16 v[240:243], a[136:139], a[32:35], v[240:243]
	v_mfma_f32_16x16x32_bf16 v[244:247], a[136:139], a[36:39], v[244:247]
	v_mfma_f32_16x16x32_bf16 v[248:251], a[136:139], a[40:43], v[248:251]
	v_mfma_f32_16x16x32_bf16 v[252:255], a[136:139], a[44:47], v[252:255]
	s_waitcnt lgkmcnt(0)
	s_nop 0
	v_mfma_f32_16x16x32_bf16 v[192:195], a[140:143], a[48:51], v[192:195]
	ds_read_b128 a[32:35], v7 offset:16384
	ds_read_b128 a[36:39], v7 offset:17408
	v_mfma_f32_16x16x32_bf16 v[196:199], a[140:143], a[52:55], v[196:199]
	ds_read_b128 a[40:43], v7 offset:18432
	ds_read_b128 a[44:47], v7 offset:19456
	v_mfma_f32_16x16x32_bf16 v[200:203], a[140:143], a[56:59], v[200:203]
	v_mfma_f32_16x16x32_bf16 v[204:207], a[140:143], a[60:63], v[204:207]
	v_mfma_f32_16x16x32_bf16 v[208:211], a[144:147], a[48:51], v[208:211]
	v_mfma_f32_16x16x32_bf16 v[212:215], a[144:147], a[52:55], v[212:215]
	v_mfma_f32_16x16x32_bf16 v[216:219], a[144:147], a[56:59], v[216:219]
	v_mfma_f32_16x16x32_bf16 v[220:223], a[144:147], a[60:63], v[220:223]
	v_mfma_f32_16x16x32_bf16 v[224:227], a[148:151], a[48:51], v[224:227]
	v_mfma_f32_16x16x32_bf16 v[228:231], a[148:151], a[52:55], v[228:231]
	v_mfma_f32_16x16x32_bf16 v[232:235], a[148:151], a[56:59], v[232:235]
	v_mfma_f32_16x16x32_bf16 v[236:239], a[148:151], a[60:63], v[236:239]
	v_mfma_f32_16x16x32_bf16 v[240:243], a[152:155], a[48:51], v[240:243]
	v_mfma_f32_16x16x32_bf16 v[244:247], a[152:155], a[52:55], v[244:247]
	v_mfma_f32_16x16x32_bf16 v[248:251], a[152:155], a[56:59], v[248:251]
	v_mfma_f32_16x16x32_bf16 v[252:255], a[152:155], a[60:63], v[252:255]
	s_waitcnt vmcnt(25) lgkmcnt(0)
	s_nop 0
	v_mfma_f32_16x16x32_bf16 v[192:195], a[160:163], a[32:35], v[192:195]
	s_add_u32 s63, s70, 327808
	ds_read_b64_tr_b16 a[176:177], v8 offset:49152
	ds_read_b64_tr_b16 a[178:179], v8 offset:51200
	v_mfma_f32_16x16x32_bf16 v[196:199], a[160:163], a[36:39], v[196:199]
	s_add_u32 m0, s68, 32768
	ds_read_b64_tr_b16 a[180:181], v9 offset:49152
	ds_read_b64_tr_b16 a[182:183], v9 offset:51200
	v_mfma_f32_16x16x32_bf16 v[200:203], a[160:163], a[40:43], v[200:203]
	buffer_load_dwordx4 v2, s[20:23], s63 offen offset:0 lds
	v_mfma_f32_16x16x32_bf16 v[204:207], a[160:163], a[44:47], v[204:207]
	ds_read_b64_tr_b16 a[184:185], v10 offset:49152
	ds_read_b128 a[48:51], v7 offset:20480
	v_mfma_f32_16x16x32_bf16 v[208:211], a[164:167], a[32:35], v[208:211]
	ds_read_b64_tr_b16 a[186:187], v10 offset:51200
	ds_read_b128 a[52:55], v7 offset:21504
	v_mfma_f32_16x16x32_bf16 v[212:215], a[164:167], a[36:39], v[212:215]
	ds_read_b64_tr_b16 a[188:189], v11 offset:49152
	ds_read_b128 a[56:59], v7 offset:22528
	v_mfma_f32_16x16x32_bf16 v[216:219], a[164:167], a[40:43], v[216:219]
	buffer_load_dwordx4 v3, s[20:23], s63 offen offset:1024 lds
	v_mfma_f32_16x16x32_bf16 v[220:223], a[164:167], a[44:47], v[220:223]
	ds_read_b64_tr_b16 a[190:191], v11 offset:51200
	ds_read_b128 a[60:63], v7 offset:23552
	v_mfma_f32_16x16x32_bf16 v[224:227], a[168:171], a[32:35], v[224:227]
	s_waitcnt vmcnt(10)
	s_nop 0
	v_add_f32_dpp v96, v96, v96 row_ror:8 row_mask:0xf bank_mask:0xf
	v_mov_b32_e64 v97, v96
	v_mfma_f32_16x16x32_bf16 v[228:231], a[168:171], a[36:39], v[228:231]
	v_mfma_f32_16x16x32_bf16 v[232:235], a[168:171], a[40:43], v[232:235]
	buffer_load_dwordx4 v4, s[20:23], s63 offen offset:2048 lds
	v_mfma_f32_16x16x32_bf16 v[236:239], a[168:171], a[44:47], v[236:239]
	v_permlane16_swap_b32 v96, v97
	v_add_f32 v96, v96, v97
	v_mfma_f32_16x16x32_bf16 v[240:243], a[172:175], a[32:35], v[240:243]
	v_mov_b32_e64 v97, v96
	v_mfma_f32_16x16x32_bf16 v[244:247], a[172:175], a[36:39], v[244:247]
	v_mfma_f32_16x16x32_bf16 v[248:251], a[172:175], a[40:43], v[248:251]
	buffer_load_dwordx4 v5, s[20:23], s63 offen offset:3072 lds
	v_mfma_f32_16x16x32_bf16 v[252:255], a[172:175], a[44:47], v[252:255]
	s_waitcnt lgkmcnt(0)
	s_nop 0
	v_mfma_f32_16x16x32_bf16 v[192:195], a[176:179], a[48:51], v[192:195]
	s_add_u32 s63, s70, 360576
	ds_read_b64_tr_b16 a[0:1], v12 offset:0
	ds_read_b64_tr_b16 a[2:3], v12 offset:2048
	v_mfma_f32_16x16x32_bf16 v[196:199], a[176:179], a[52:55], v[196:199]
	s_add_u32 m0, s68, 49152
	ds_read_b64_tr_b16 a[4:5], v13 offset:0
	ds_read_b64_tr_b16 a[6:7], v13 offset:2048
	v_mfma_f32_16x16x32_bf16 v[200:203], a[176:179], a[56:59], v[200:203]
	buffer_load_dwordx4 v2, s[20:23], s63 offen offset:0 lds
	v_mfma_f32_16x16x32_bf16 v[204:207], a[176:179], a[60:63], v[204:207]
	ds_read_b64_tr_b16 a[8:9], v14 offset:0
	ds_read_b128 a[32:35], v7 offset:24576
	v_mfma_f32_16x16x32_bf16 v[208:211], a[180:183], a[48:51], v[208:211]
	ds_read_b64_tr_b16 a[10:11], v14 offset:2048
	ds_read_b128 a[36:39], v7 offset:25600
	v_mfma_f32_16x16x32_bf16 v[212:215], a[180:183], a[52:55], v[212:215]
	ds_read_b64_tr_b16 a[12:13], v15 offset:0
	ds_read_b128 a[40:43], v7 offset:26624
	v_mfma_f32_16x16x32_bf16 v[216:219], a[180:183], a[56:59], v[216:219]
	buffer_load_dwordx4 v3, s[20:23], s63 offen offset:1024 lds
	v_mfma_f32_16x16x32_bf16 v[220:223], a[180:183], a[60:63], v[220:223]
	ds_read_b64_tr_b16 a[14:15], v15 offset:2048
	ds_read_b128 a[44:47], v7 offset:27648
	v_mfma_f32_16x16x32_bf16 v[224:227], a[184:187], a[48:51], v[224:227]
	v_permlane32_swap_b32 v96, v97
	v_add_f32 v96, v96, v97
	v_mfma_f32_16x16x32_bf16 v[228:231], a[184:187], a[52:55], v[228:231]
	v_and_b32 v98, 2, v0
	v_and_b32 v99, 4, v0
	v_mfma_f32_16x16x32_bf16 v[232:235], a[184:187], a[56:59], v[232:235]
	buffer_load_dwordx4 v4, s[20:23], s63 offen offset:2048 lds
	v_mfma_f32_16x16x32_bf16 v[236:239], a[184:187], a[60:63], v[236:239]
	v_lshlrev_b32_e64 v98, 1, v98
	v_lshl_or_b32 v98, v99, 2, v98
	v_mfma_f32_16x16x32_bf16 v[240:243], a[188:191], a[48:51], v[240:243]
	v_and_b32_e64 v99, 1, v0
	v_lshl_or_b32 v98, v99, 30, v98
	v_mfma_f32_16x16x32_bf16 v[244:247], a[188:191], a[52:55], v[244:247]
	v_mov_b32_dpp v97, v96 quad_perm:[1,0,3,2] row_mask:0xf bank_mask:0xf
	v_cvt_pk_bf16_f32 v96, v96, v97
	v_mfma_f32_16x16x32_bf16 v[248:251], a[188:191], a[56:59], v[248:251]
	buffer_load_dwordx4 v5, s[20:23], s63 offen offset:3072 lds
	v_mfma_f32_16x16x32_bf16 v[252:255], a[188:191], a[60:63], v[252:255]
	s_waitcnt lgkmcnt(0)
	s_nop 0
	v_mfma_f32_16x16x32_bf16 v[192:195], a[0:3], a[32:35], v[192:195]
	s_add_u32 s63, s70, 393344
	ds_read_b64_tr_b16 a[16:17], v12 offset:16384
	ds_read_b64_tr_b16 a[18:19], v12 offset:18432
	v_mfma_f32_16x16x32_bf16 v[196:199], a[0:3], a[36:39], v[196:199]
	s_add_u32 m0, s68, 131072
	ds_read_b64_tr_b16 a[20:21], v13 offset:16384
	ds_read_b64_tr_b16 a[22:23], v13 offset:18432
	v_mfma_f32_16x16x32_bf16 v[200:203], a[0:3], a[40:43], v[200:203]
	buffer_load_dwordx4 v2, s[20:23], s63 offen offset:0 lds
	v_mfma_f32_16x16x32_bf16 v[204:207], a[0:3], a[44:47], v[204:207]
	ds_read_b64_tr_b16 a[24:25], v14 offset:16384
	ds_read_b128 a[48:51], v7 offset:28672
	v_mfma_f32_16x16x32_bf16 v[208:211], a[4:7], a[32:35], v[208:211]
	ds_read_b64_tr_b16 a[26:27], v14 offset:18432
	ds_read_b128 a[52:55], v7 offset:29696
	v_mfma_f32_16x16x32_bf16 v[212:215], a[4:7], a[36:39], v[212:215]
	ds_read_b64_tr_b16 a[28:29], v15 offset:16384
	ds_read_b128 a[56:59], v7 offset:30720
	v_mfma_f32_16x16x32_bf16 v[216:219], a[4:7], a[40:43], v[216:219]
	buffer_load_dwordx4 v3, s[20:23], s63 offen offset:1024 lds
	v_mfma_f32_16x16x32_bf16 v[220:223], a[4:7], a[44:47], v[220:223]
	ds_read_b64_tr_b16 a[30:31], v15 offset:18432
	ds_read_b128 a[60:63], v7 offset:31744
	v_mfma_f32_16x16x32_bf16 v[224:227], a[8:11], a[32:35], v[224:227]
	buffer_store_dword v96, v98, s[32:35], s89 offen sc1
	v_mfma_f32_16x16x32_bf16 v[228:231], a[8:11], a[36:39], v[228:231]
	v_mfma_f32_16x16x32_bf16 v[232:235], a[8:11], a[40:43], v[232:235]
	buffer_load_dwordx4 v4, s[20:23], s63 offen offset:2048 lds
	v_mfma_f32_16x16x32_bf16 v[236:239], a[8:11], a[44:47], v[236:239]
	v_mfma_f32_16x16x32_bf16 v[240:243], a[12:15], a[32:35], v[240:243]
	v_mfma_f32_16x16x32_bf16 v[244:247], a[12:15], a[36:39], v[244:247]
	v_mfma_f32_16x16x32_bf16 v[248:251], a[12:15], a[40:43], v[248:251]
	buffer_load_dwordx4 v5, s[20:23], s63 offen offset:3072 lds
	v_mfma_f32_16x16x32_bf16 v[252:255], a[12:15], a[44:47], v[252:255]
	s_waitcnt lgkmcnt(0)
	s_nop 0
	v_mfma_f32_16x16x32_bf16 v[192:195], a[16:19], a[48:51], v[192:195]
	s_add_u32 s63, s70, 426112
	ds_read_b64_tr_b16 a[124:125], v8 offset:0
	ds_read_b64_tr_b16 a[126:127], v8 offset:2048
	v_mfma_f32_16x16x32_bf16 v[196:199], a[16:19], a[52:55], v[196:199]
	s_add_u32 m0, s68, 147456
	ds_read_b64_tr_b16 a[128:129], v9 offset:0
	ds_read_b64_tr_b16 a[130:131], v9 offset:2048
	v_mfma_f32_16x16x32_bf16 v[200:203], a[16:19], a[56:59], v[200:203]
	buffer_load_dwordx4 v2, s[20:23], s63 offen offset:0 lds
	v_mfma_f32_16x16x32_bf16 v[204:207], a[16:19], a[60:63], v[204:207]
	ds_read_b64_tr_b16 a[132:133], v10 offset:0
	ds_read_b128 a[32:35], v7 offset:32768
	v_mfma_f32_16x16x32_bf16 v[208:211], a[20:23], a[48:51], v[208:211]
	ds_read_b64_tr_b16 a[134:135], v10 offset:2048
	ds_read_b128 a[36:39], v7 offset:33792
	v_mfma_f32_16x16x32_bf16 v[212:215], a[20:23], a[52:55], v[212:215]
	ds_read_b64_tr_b16 a[136:137], v11 offset:0
	ds_read_b128 a[40:43], v7 offset:34816
	v_mfma_f32_16x16x32_bf16 v[216:219], a[20:23], a[56:59], v[216:219]
	buffer_load_dwordx4 v3, s[20:23], s63 offen offset:1024 lds
	v_mfma_f32_16x16x32_bf16 v[220:223], a[20:23], a[60:63], v[220:223]
	ds_read_b64_tr_b16 a[138:139], v11 offset:2048
	ds_read_b128 a[44:47], v7 offset:35840
	v_mfma_f32_16x16x32_bf16 v[224:227], a[24:27], a[48:51], v[224:227]
	v_mfma_f32_16x16x32_bf16 v[228:231], a[24:27], a[52:55], v[228:231]
	v_mfma_f32_16x16x32_bf16 v[232:235], a[24:27], a[56:59], v[232:235]
	buffer_load_dwordx4 v4, s[20:23], s63 offen offset:2048 lds
	v_mfma_f32_16x16x32_bf16 v[236:239], a[24:27], a[60:63], v[236:239]
	v_mfma_f32_16x16x32_bf16 v[240:243], a[28:31], a[48:51], v[240:243]
	v_mfma_f32_16x16x32_bf16 v[244:247], a[28:31], a[52:55], v[244:247]
	v_mfma_f32_16x16x32_bf16 v[248:251], a[28:31], a[56:59], v[248:251]
	buffer_load_dwordx4 v5, s[20:23], s63 offen offset:3072 lds
	v_mfma_f32_16x16x32_bf16 v[252:255], a[28:31], a[60:63], v[252:255]
	s_waitcnt lgkmcnt(0)
	s_nop 0
	v_mfma_f32_16x16x32_bf16 v[192:195], a[124:127], a[32:35], v[192:195]
	s_add_u32 s63, s70, 458880
	ds_read_b64_tr_b16 a[140:141], v8 offset:16384
	ds_read_b64_tr_b16 a[142:143], v8 offset:18432
	v_mfma_f32_16x16x32_bf16 v[196:199], a[124:127], a[36:39], v[196:199]
	s_add_u32 m0, s68, 0
	s_nop 0
	ds_read_b64_tr_b16 a[144:145], v9 offset:16384
	ds_read_b64_tr_b16 a[146:147], v9 offset:18432
	v_mfma_f32_16x16x32_bf16 v[200:203], a[124:127], a[40:43], v[200:203]
	buffer_load_dwordx4 v2, s[20:23], s63 offen offset:0 lds
	v_mfma_f32_16x16x32_bf16 v[204:207], a[124:127], a[44:47], v[204:207]
	ds_read_b64_tr_b16 a[148:149], v10 offset:16384
	ds_read_b128 a[48:51], v7 offset:36864
	v_mfma_f32_16x16x32_bf16 v[208:211], a[128:131], a[32:35], v[208:211]
	ds_read_b64_tr_b16 a[150:151], v10 offset:18432
	ds_read_b128 a[52:55], v7 offset:37888
	v_mfma_f32_16x16x32_bf16 v[212:215], a[128:131], a[36:39], v[212:215]
	ds_read_b64_tr_b16 a[152:153], v11 offset:16384
	ds_read_b128 a[56:59], v7 offset:38912
	v_mfma_f32_16x16x32_bf16 v[216:219], a[128:131], a[40:43], v[216:219]
	buffer_load_dwordx4 v3, s[20:23], s63 offen offset:1024 lds
	v_mfma_f32_16x16x32_bf16 v[220:223], a[128:131], a[44:47], v[220:223]
	ds_read_b64_tr_b16 a[154:155], v11 offset:18432
	ds_read_b128 a[60:63], v7 offset:39936
	v_mfma_f32_16x16x32_bf16 v[224:227], a[132:135], a[32:35], v[224:227]
	v_mfma_f32_16x16x32_bf16 v[228:231], a[132:135], a[36:39], v[228:231]
	v_mfma_f32_16x16x32_bf16 v[232:235], a[132:135], a[40:43], v[232:235]
	buffer_load_dwordx4 v4, s[20:23], s63 offen offset:2048 lds
	v_mfma_f32_16x16x32_bf16 v[236:239], a[132:135], a[44:47], v[236:239]
	v_mfma_f32_16x16x32_bf16 v[240:243], a[136:139], a[32:35], v[240:243]
	v_mfma_f32_16x16x32_bf16 v[244:247], a[136:139], a[36:39], v[244:247]
	v_mfma_f32_16x16x32_bf16 v[248:251], a[136:139], a[40:43], v[248:251]
	buffer_load_dwordx4 v5, s[20:23], s63 offen offset:3072 lds
	v_mfma_f32_16x16x32_bf16 v[252:255], a[136:139], a[44:47], v[252:255]
	s_waitcnt vmcnt(17) lgkmcnt(0)
	s_nop 0
	v_mfma_f32_16x16x32_bf16 v[192:195], a[140:143], a[48:51], v[192:195]
	s_add_u32 s63, s70, 491648
	ds_read_b64_tr_b16 a[160:161], v8 offset:32768
	ds_read_b64_tr_b16 a[162:163], v8 offset:34816
	v_mfma_f32_16x16x32_bf16 v[196:199], a[140:143], a[52:55], v[196:199]
	s_add_u32 m0, s68, 16384
	ds_read_b64_tr_b16 a[164:165], v9 offset:32768
	ds_read_b64_tr_b16 a[166:167], v9 offset:34816
	v_mfma_f32_16x16x32_bf16 v[200:203], a[140:143], a[56:59], v[200:203]
	buffer_load_dwordx4 v2, s[20:23], s63 offen offset:0 lds
	v_mfma_f32_16x16x32_bf16 v[204:207], a[140:143], a[60:63], v[204:207]
	ds_read_b64_tr_b16 a[168:169], v10 offset:32768
	ds_read_b128 a[32:35], v7 offset:40960
	v_mfma_f32_16x16x32_bf16 v[208:211], a[144:147], a[48:51], v[208:211]
	ds_read_b64_tr_b16 a[170:171], v10 offset:34816
	ds_read_b128 a[36:39], v7 offset:41984
	v_mfma_f32_16x16x32_bf16 v[212:215], a[144:147], a[52:55], v[212:215]
	ds_read_b64_tr_b16 a[172:173], v11 offset:32768
	ds_read_b64_tr_b16 a[174:175], v11 offset:34816
	v_mfma_f32_16x16x32_bf16 v[216:219], a[144:147], a[56:59], v[216:219]
	buffer_load_dwordx4 v3, s[20:23], s63 offen offset:1024 lds
	v_mfma_f32_16x16x32_bf16 v[220:223], a[144:147], a[60:63], v[220:223]
	v_mfma_f32_16x16x32_bf16 v[224:227], a[148:151], a[48:51], v[224:227]
	v_mfma_f32_16x16x32_bf16 v[228:231], a[148:151], a[52:55], v[228:231]
	v_mfma_f32_16x16x32_bf16 v[232:235], a[148:151], a[56:59], v[232:235]
	buffer_load_dwordx4 v4, s[20:23], s63 offen offset:2048 lds
	v_mfma_f32_16x16x32_bf16 v[236:239], a[148:151], a[60:63], v[236:239]
	v_mfma_f32_16x16x32_bf16 v[240:243], a[152:155], a[48:51], v[240:243]
	v_mfma_f32_16x16x32_bf16 v[244:247], a[152:155], a[52:55], v[244:247]
	v_mfma_f32_16x16x32_bf16 v[248:251], a[152:155], a[56:59], v[248:251]
	buffer_load_dwordx4 v5, s[20:23], s63 offen offset:3072 lds
	v_mfma_f32_16x16x32_bf16 v[252:255], a[152:155], a[60:63], v[252:255]
	s_waitcnt vmcnt(17) lgkmcnt(0)
	s_nop 0
	v_mfma_f32_16x16x32_bf16 v[192:195], a[160:163], a[32:35], v[192:195]
	ds_read_b64_tr_b16 a[176:177], v8 offset:49152
	ds_read_b64_tr_b16 a[178:179], v8 offset:51200
	v_mfma_f32_16x16x32_bf16 v[196:199], a[160:163], a[36:39], v[196:199]
	s_add_u32 s77, s67, 2048
	ds_read_b64_tr_b16 a[180:181], v9 offset:49152
	ds_read_b64_tr_b16 a[182:183], v9 offset:51200
	v_mfma_f32_16x16x32_bf16 v[208:211], a[164:167], a[32:35], v[208:211]
	s_xor_b32 s76, s77, 262144
	v_mfma_f32_16x16x32_bf16 v[212:215], a[164:167], a[36:39], v[212:215]
	ds_read_b64_tr_b16 a[184:185], v10 offset:49152
	ds_read_b64_tr_b16 a[186:187], v10 offset:51200
	v_mfma_f32_16x16x32_bf16 v[224:227], a[168:171], a[32:35], v[224:227]
	ds_read_b64_tr_b16 a[188:189], v11 offset:49152
	ds_read_b64_tr_b16 a[190:191], v11 offset:51200
	v_mfma_f32_16x16x32_bf16 v[228:231], a[168:171], a[36:39], v[228:231]
	ds_read_b128 a[48:51], v7 offset:45056
	ds_read_b128 a[52:55], v7 offset:46080
	v_mfma_f32_16x16x32_bf16 v[240:243], a[172:175], a[32:35], v[240:243]
	buffer_load_dwordx4 v[68:71], v22, s[32:35], s76 offen sc1
	v_mfma_f32_16x16x32_bf16 v[244:247], a[172:175], a[36:39], v[244:247]
	s_waitcnt lgkmcnt(0)
	s_nop 0
	s_xor_b32 s76, s77, 524288
	v_mfma_f32_16x16x32_bf16 v[192:195], a[176:179], a[48:51], v[192:195]
	s_waitcnt vmcnt(13)
	s_nop 0
	ds_read_b64_tr_b16 a[0:1], v12 offset:0
	ds_read_b64_tr_b16 a[2:3], v12 offset:2048
	v_mfma_f32_16x16x32_bf16 v[196:199], a[176:179], a[52:55], v[196:199]
	ds_read_b64_tr_b16 a[4:5], v13 offset:0
	ds_read_b64_tr_b16 a[6:7], v13 offset:2048
	v_mfma_f32_16x16x32_bf16 v[208:211], a[180:183], a[48:51], v[208:211]
	buffer_load_dwordx4 v[72:75], v22, s[32:35], s76 offen sc1
	v_mfma_f32_16x16x32_bf16 v[212:215], a[180:183], a[52:55], v[212:215]
	s_xor_b32 s76, s77, 786432
	ds_read_b64_tr_b16 a[8:9], v14 offset:0
	ds_read_b64_tr_b16 a[10:11], v14 offset:2048
	v_mfma_f32_16x16x32_bf16 v[224:227], a[184:187], a[48:51], v[224:227]
	ds_read_b64_tr_b16 a[12:13], v15 offset:0
	ds_read_b64_tr_b16 a[14:15], v15 offset:2048
	v_mfma_f32_16x16x32_bf16 v[228:231], a[184:187], a[52:55], v[228:231]
	ds_read_b128 a[32:35], v7 offset:49152
	ds_read_b128 a[36:39], v7 offset:50176
	v_mfma_f32_16x16x32_bf16 v[240:243], a[188:191], a[48:51], v[240:243]
	buffer_load_dwordx4 v[76:79], v22, s[32:35], s76 offen sc1
	v_mfma_f32_16x16x32_bf16 v[244:247], a[188:191], a[52:55], v[244:247]
	s_waitcnt lgkmcnt(0)
	s_nop 0
	s_xor_b32 s76, s77, 1048576
	v_mfma_f32_16x16x32_bf16 v[192:195], a[0:3], a[32:35], v[192:195]
	s_waitcnt vmcnt(11)
	s_nop 0
	ds_read_b64_tr_b16 a[16:17], v12 offset:16384
	ds_read_b64_tr_b16 a[18:19], v12 offset:18432
	v_mfma_f32_16x16x32_bf16 v[196:199], a[0:3], a[36:39], v[196:199]
	ds_read_b64_tr_b16 a[20:21], v13 offset:16384
	ds_read_b64_tr_b16 a[22:23], v13 offset:18432
	v_mfma_f32_16x16x32_bf16 v[208:211], a[4:7], a[32:35], v[208:211]
	buffer_load_dwordx4 v[80:83], v22, s[32:35], s76 offen sc1
	v_mfma_f32_16x16x32_bf16 v[212:215], a[4:7], a[36:39], v[212:215]
	s_xor_b32 s76, s77, 1310720
	ds_read_b64_tr_b16 a[24:25], v14 offset:16384
	ds_read_b64_tr_b16 a[26:27], v14 offset:18432
	v_mfma_f32_16x16x32_bf16 v[224:227], a[8:11], a[32:35], v[224:227]
	ds_read_b64_tr_b16 a[28:29], v15 offset:16384
	ds_read_b64_tr_b16 a[30:31], v15 offset:18432
	v_mfma_f32_16x16x32_bf16 v[228:231], a[8:11], a[36:39], v[228:231]
	ds_read_b128 a[48:51], v7 offset:53248
	ds_read_b128 a[52:55], v7 offset:54272
	v_mfma_f32_16x16x32_bf16 v[240:243], a[12:15], a[32:35], v[240:243]
	buffer_load_dwordx4 v[84:87], v22, s[32:35], s76 offen sc1
	v_mfma_f32_16x16x32_bf16 v[244:247], a[12:15], a[36:39], v[244:247]
	s_waitcnt lgkmcnt(0)
	s_nop 0
	s_xor_b32 s76, s77, 1572864
	v_mfma_f32_16x16x32_bf16 v[192:195], a[16:19], a[48:51], v[192:195]
	s_waitcnt vmcnt(9)
	s_nop 0
	ds_read_b64_tr_b16 a[124:125], v8 offset:0
	ds_read_b64_tr_b16 a[126:127], v8 offset:2048
	v_mfma_f32_16x16x32_bf16 v[196:199], a[16:19], a[52:55], v[196:199]
	ds_read_b64_tr_b16 a[128:129], v9 offset:0
	ds_read_b64_tr_b16 a[130:131], v9 offset:2048
	v_mfma_f32_16x16x32_bf16 v[208:211], a[20:23], a[48:51], v[208:211]
	buffer_load_dwordx4 v[88:91], v22, s[32:35], s76 offen sc1
	v_mfma_f32_16x16x32_bf16 v[212:215], a[20:23], a[52:55], v[212:215]
	s_xor_b32 s76, s77, 1835008
	ds_read_b64_tr_b16 a[132:133], v10 offset:0
	ds_read_b64_tr_b16 a[134:135], v10 offset:2048
	v_mfma_f32_16x16x32_bf16 v[224:227], a[24:27], a[48:51], v[224:227]
	ds_read_b64_tr_b16 a[136:137], v11 offset:0
	ds_read_b64_tr_b16 a[138:139], v11 offset:2048
	v_mfma_f32_16x16x32_bf16 v[228:231], a[24:27], a[52:55], v[228:231]
	ds_read_b128 a[32:35], v7 offset:57344
	ds_read_b128 a[36:39], v7 offset:58368
	v_mfma_f32_16x16x32_bf16 v[240:243], a[28:31], a[48:51], v[240:243]
	buffer_load_dwordx4 v[92:95], v22, s[32:35], s76 offen sc1
	v_mfma_f32_16x16x32_bf16 v[244:247], a[28:31], a[52:55], v[244:247]
	s_waitcnt lgkmcnt(0)
	s_nop 0
	v_mfma_f32_16x16x32_bf16 v[192:195], a[124:127], a[32:35], v[192:195]
	s_waitcnt vmcnt(7)
	s_nop 0
	ds_read_b64_tr_b16 a[140:141], v8 offset:16384
	ds_read_b64_tr_b16 a[142:143], v8 offset:18432
	v_mfma_f32_16x16x32_bf16 v[196:199], a[124:127], a[36:39], v[196:199]
	ds_read_b64_tr_b16 a[144:145], v9 offset:16384
	ds_read_b64_tr_b16 a[146:147], v9 offset:18432
	v_mfma_f32_16x16x32_bf16 v[208:211], a[128:131], a[32:35], v[208:211]
	v_mfma_f32_16x16x32_bf16 v[212:215], a[128:131], a[36:39], v[212:215]
	ds_read_b64_tr_b16 a[148:149], v10 offset:16384
	ds_read_b64_tr_b16 a[150:151], v10 offset:18432
	v_mfma_f32_16x16x32_bf16 v[224:227], a[132:135], a[32:35], v[224:227]
	ds_read_b64_tr_b16 a[152:153], v11 offset:16384
	ds_read_b64_tr_b16 a[154:155], v11 offset:18432
	v_mfma_f32_16x16x32_bf16 v[228:231], a[132:135], a[36:39], v[228:231]
	ds_read_b128 a[48:51], v7 offset:61440
	ds_read_b128 a[52:55], v7 offset:62464
	v_mfma_f32_16x16x32_bf16 v[240:243], a[136:139], a[32:35], v[240:243]
	v_mfma_f32_16x16x32_bf16 v[244:247], a[136:139], a[36:39], v[244:247]
	s_waitcnt lgkmcnt(0)
	s_nop 0
	v_mfma_f32_16x16x32_bf16 v[192:195], a[140:143], a[48:51], v[192:195]
	ds_read_b128 a[40:43], v7 offset:43008
	ds_read_b128 a[44:47], v7 offset:44032
	v_mfma_f32_16x16x32_bf16 v[196:199], a[140:143], a[52:55], v[196:199]
	v_mfma_f32_16x16x32_bf16 v[208:211], a[144:147], a[48:51], v[208:211]
	v_mfma_f32_16x16x32_bf16 v[212:215], a[144:147], a[52:55], v[212:215]
	v_mfma_f32_16x16x32_bf16 v[224:227], a[148:151], a[48:51], v[224:227]
	v_mfma_f32_16x16x32_bf16 v[228:231], a[148:151], a[52:55], v[228:231]
	v_mfma_f32_16x16x32_bf16 v[240:243], a[152:155], a[48:51], v[240:243]
	v_mfma_f32_16x16x32_bf16 v[244:247], a[152:155], a[52:55], v[244:247]
	s_waitcnt lgkmcnt(0)
	s_nop 0
	v_mfma_f32_16x16x32_bf16 v[200:203], a[160:163], a[40:43], v[200:203]
	ds_read_b128 a[56:59], v7 offset:47104
	ds_read_b128 a[60:63], v7 offset:48128
	v_mfma_f32_16x16x32_bf16 v[204:207], a[160:163], a[44:47], v[204:207]
	s_mov_b64 exec, s[94:95]
	s_nop 0
	ds_write_b128 v1, v[128:131] offset:0
	ds_write_b128 v1, v[160:163] offset:128
	s_mov_b64 exec, -1
	s_nop 0
	v_mfma_f32_16x16x32_bf16 v[216:219], a[164:167], a[40:43], v[216:219]
	s_mov_b64 exec, s[94:95]
	s_nop 0
	ds_write_b128 v1, v[132:135] offset:256
	ds_write_b128 v1, v[164:167] offset:384
	s_mov_b64 exec, -1
	s_nop 0
	v_mfma_f32_16x16x32_bf16 v[220:223], a[164:167], a[44:47], v[220:223]
	s_add_u32 s75, s66, 10240
	v_cvt_pk_bf16_f32 v192, v192, v193
	v_cvt_pk_bf16_f32 v193, v194, v195
	v_mfma_f32_16x16x32_bf16 v[232:235], a[168:171], a[40:43], v[232:235]
	v_cvt_pk_bf16_f32 v194, v208, v209
	v_cvt_pk_bf16_f32 v195, v210, v211
	v_mfma_f32_16x16x32_bf16 v[236:239], a[168:171], a[44:47], v[236:239]
	buffer_store_dwordx4 v[192:195], v21, s[32:35], s75 offen offset:0 sc1
	v_mfma_f32_16x16x32_bf16 v[248:251], a[172:175], a[40:43], v[248:251]
	v_cvt_pk_bf16_f32 v224, v224, v225
	v_cvt_pk_bf16_f32 v225, v226, v227
	v_mfma_f32_16x16x32_bf16 v[252:255], a[172:175], a[44:47], v[252:255]
	s_waitcnt lgkmcnt(4)
	s_nop 0
	v_cvt_pk_bf16_f32 v226, v240, v241
	v_cvt_pk_bf16_f32 v227, v242, v243
	v_mfma_f32_16x16x32_bf16 v[200:203], a[176:179], a[56:59], v[200:203]
	ds_read_b128 a[40:43], v7 offset:51200
	ds_read_b128 a[44:47], v7 offset:52224
	v_mfma_f32_16x16x32_bf16 v[204:207], a[176:179], a[60:63], v[204:207]
	buffer_store_dwordx4 v[224:227], v21, s[32:35], s75 offen offset:1024 sc1
	v_mfma_f32_16x16x32_bf16 v[216:219], a[180:183], a[56:59], v[216:219]
	v_cvt_pk_bf16_f32 v196, v196, v197
	v_cvt_pk_bf16_f32 v197, v198, v199
	v_mfma_f32_16x16x32_bf16 v[220:223], a[180:183], a[60:63], v[220:223]
	v_cvt_pk_bf16_f32 v198, v212, v213
	v_cvt_pk_bf16_f32 v199, v214, v215
	v_mfma_f32_16x16x32_bf16 v[232:235], a[184:187], a[56:59], v[232:235]
	buffer_store_dwordx4 v[196:199], v21, s[32:35], s75 offen offset:2048 sc1
	v_mfma_f32_16x16x32_bf16 v[236:239], a[184:187], a[60:63], v[236:239]
	v_cvt_pk_bf16_f32 v228, v228, v229
	v_cvt_pk_bf16_f32 v229, v230, v231
	v_mfma_f32_16x16x32_bf16 v[248:251], a[188:191], a[56:59], v[248:251]
	v_cvt_pk_bf16_f32 v230, v244, v245
	v_cvt_pk_bf16_f32 v231, v246, v247
	v_mfma_f32_16x16x32_bf16 v[252:255], a[188:191], a[60:63], v[252:255]
	s_waitcnt lgkmcnt(0)
	s_nop 0
	v_mfma_f32_16x16x32_bf16 v[200:203], a[0:3], a[40:43], v[200:203]
	ds_read_b128 a[56:59], v7 offset:55296
	ds_read_b128 a[60:63], v7 offset:56320
	v_mfma_f32_16x16x32_bf16 v[204:207], a[0:3], a[44:47], v[204:207]
	buffer_store_dwordx4 v[228:231], v21, s[32:35], s75 offen offset:3072 sc1
	v_mfma_f32_16x16x32_bf16 v[216:219], a[4:7], a[40:43], v[216:219]
	s_mov_b64 exec, s[94:95]
	s_nop 0
	ds_write_b128 v1, v[136:139] offset:512
	ds_write_b128 v1, v[168:171] offset:640
	s_mov_b64 exec, -1
	s_nop 0
	v_mfma_f32_16x16x32_bf16 v[220:223], a[4:7], a[44:47], v[220:223]
	s_mov_b64 exec, s[94:95]
	s_nop 0
	ds_write_b128 v1, v[140:143] offset:768
	ds_write_b128 v1, v[172:175] offset:896
	s_mov_b64 exec, -1
	s_nop 0
	v_mfma_f32_16x16x32_bf16 v[232:235], a[8:11], a[40:43], v[232:235]
	s_mov_b64 exec, s[94:95]
	s_nop 0
	ds_write_b128 v1, v[192:195] offset:1024
	ds_write_b128 v1, v[224:227] offset:1152
	s_mov_b64 exec, -1
	s_nop 0
	v_mfma_f32_16x16x32_bf16 v[236:239], a[8:11], a[44:47], v[236:239]
	s_mov_b64 exec, s[94:95]
	s_nop 0
	ds_write_b128 v1, v[196:199] offset:1280
	ds_write_b128 v1, v[228:231] offset:1408
	s_mov_b64 exec, -1
	s_nop 0
	v_mfma_f32_16x16x32_bf16 v[248:251], a[12:15], a[40:43], v[248:251]
	s_add_u32 s63, s71, 0
	s_nop 0
	s_add_u32 m0, s68, 32768
	v_mfma_f32_16x16x32_bf16 v[252:255], a[12:15], a[44:47], v[252:255]
	s_waitcnt lgkmcnt(8)
	s_nop 0
	v_mfma_f32_16x16x32_bf16 v[200:203], a[16:19], a[56:59], v[200:203]
	ds_read_b128 a[40:43], v7 offset:59392
	ds_read_b128 a[44:47], v7 offset:60416
	v_mfma_f32_16x16x32_bf16 v[204:207], a[16:19], a[60:63], v[204:207]
	buffer_load_dwordx4 v17, s[24:27], s63 offen offset:0 lds
	v_mfma_f32_16x16x32_bf16 v[216:219], a[20:23], a[56:59], v[216:219]
	v_mfma_f32_16x16x32_bf16 v[220:223], a[20:23], a[60:63], v[220:223]
	v_mfma_f32_16x16x32_bf16 v[232:235], a[24:27], a[56:59], v[232:235]
	buffer_load_dwordx4 v18, s[24:27], s63 offen offset:1024 lds
	v_mfma_f32_16x16x32_bf16 v[236:239], a[24:27], a[60:63], v[236:239]
	v_mfma_f32_16x16x32_bf16 v[248:251], a[28:31], a[56:59], v[248:251]
	v_mfma_f32_16x16x32_bf16 v[252:255], a[28:31], a[60:63], v[252:255]
	s_waitcnt lgkmcnt(0)
	s_nop 0
	v_mfma_f32_16x16x32_bf16 v[200:203], a[124:127], a[40:43], v[200:203]
	ds_read_b128 a[56:59], v7 offset:63488
	ds_read_b128 a[60:63], v7 offset:64512
	v_mfma_f32_16x16x32_bf16 v[204:207], a[124:127], a[44:47], v[204:207]
	buffer_load_dwordx4 v19, s[24:27], s63 offen offset:2048 lds
	v_mfma_f32_16x16x32_bf16 v[216:219], a[128:131], a[40:43], v[216:219]
	v_mfma_f32_16x16x32_bf16 v[220:223], a[128:131], a[44:47], v[220:223]
	v_mfma_f32_16x16x32_bf16 v[232:235], a[132:135], a[40:43], v[232:235]
	buffer_load_dwordx4 v20, s[24:27], s63 offen offset:3072 lds
	v_mfma_f32_16x16x32_bf16 v[236:239], a[132:135], a[44:47], v[236:239]
	v_mfma_f32_16x16x32_bf16 v[248:251], a[136:139], a[40:43], v[248:251]
	v_mfma_f32_16x16x32_bf16 v[252:255], a[136:139], a[44:47], v[252:255]
	s_waitcnt lgkmcnt(0)
	s_nop 0
	s_add_u32 s63, s71, 114688
	s_add_u32 m0, s68, 49152
	v_mfma_f32_16x16x32_bf16 v[200:203], a[140:143], a[56:59], v[200:203]
	buffer_load_dwordx4 v17, s[24:27], s63 offen offset:0 lds
	v_mfma_f32_16x16x32_bf16 v[204:207], a[140:143], a[60:63], v[204:207]
	v_mfma_f32_16x16x32_bf16 v[216:219], a[144:147], a[56:59], v[216:219]
	v_mfma_f32_16x16x32_bf16 v[220:223], a[144:147], a[60:63], v[220:223]
	buffer_load_dwordx4 v18, s[24:27], s63 offen offset:1024 lds
	v_mfma_f32_16x16x32_bf16 v[232:235], a[148:151], a[56:59], v[232:235]
	v_mfma_f32_16x16x32_bf16 v[236:239], a[148:151], a[60:63], v[236:239]
	v_mfma_f32_16x16x32_bf16 v[248:251], a[152:155], a[56:59], v[248:251]
	buffer_load_dwordx4 v19, s[24:27], s63 offen offset:2048 lds
	v_mfma_f32_16x16x32_bf16 v[252:255], a[152:155], a[60:63], v[252:255]
	buffer_load_dwordx4 v20, s[24:27], s63 offen offset:3072 lds
	s_nop 3
	s_nop 0
	s_add_u32 s75, s66, 14336
	v_cvt_pk_bf16_f32 v200, v200, v201
	v_cvt_pk_bf16_f32 v201, v202, v203
	v_cvt_pk_bf16_f32 v202, v216, v217
	v_cvt_pk_bf16_f32 v203, v218, v219
	buffer_store_dwordx4 v[200:203], v21, s[32:35], s75 offen offset:0 sc1
	v_cvt_pk_bf16_f32 v232, v232, v233
	v_cvt_pk_bf16_f32 v233, v234, v235
	v_cvt_pk_bf16_f32 v234, v248, v249
	v_cvt_pk_bf16_f32 v235, v250, v251
	buffer_store_dwordx4 v[232:235], v21, s[32:35], s75 offen offset:1024 sc1
	v_cvt_pk_bf16_f32 v204, v204, v205
	v_cvt_pk_bf16_f32 v205, v206, v207
	v_cvt_pk_bf16_f32 v206, v220, v221
	v_cvt_pk_bf16_f32 v207, v222, v223
	buffer_store_dwordx4 v[204:207], v21, s[32:35], s75 offen offset:2048 sc1
	v_cvt_pk_bf16_f32 v236, v236, v237
	v_cvt_pk_bf16_f32 v237, v238, v239
	v_cvt_pk_bf16_f32 v238, v252, v253
	v_cvt_pk_bf16_f32 v239, v254, v255
	buffer_store_dwordx4 v[236:239], v21, s[32:35], s75 offen offset:3072 sc1
	s_mov_b64 exec, s[94:95]
	s_nop 0
	ds_write_b128 v1, v[200:203] offset:1536
	ds_write_b128 v1, v[232:235] offset:1664
	s_mov_b64 exec, -1
	s_mov_b64 exec, s[94:95]
	ds_write_b128 v1, v[204:207] offset:1792
	ds_write_b128 v1, v[236:239] offset:1920
	s_mov_b64 exec, -1
	s_waitcnt lgkmcnt(0)
	s_barrier
	s_nop 0
	ds_read_b128 v[64:67], v31
	ds_read_b128 v[96:99], v31 offset:1024
	s_waitcnt lgkmcnt(0)
	s_barrier
	v_bfe_u32 v28, v0, 3, 3
	v_and_b32 v29, 3, v0
	v_lshlrev_b32 v29, 4, v29
	v_lshl_or_b32 v29, v28, 6, v29
	buffer_load_dwordx4 a[64:67], v29, s[32:35], s88 offen offset:0 sc1
	buffer_load_dwordx4 a[68:71], v29, s[32:35], s88 offen offset:512 sc1
	buffer_load_dwordx4 a[72:75], v29, s[32:35], s88 offen offset:1024 sc1
	buffer_load_dwordx4 a[76:79], v29, s[32:35], s88 offen offset:1536 sc1
	buffer_load_dwordx4 a[80:83], v29, s[32:35], s88 offen offset:2048 sc1
	buffer_load_dwordx4 a[84:87], v29, s[32:35], s88 offen offset:2560 sc1
	buffer_load_dwordx4 a[88:91], v29, s[32:35], s88 offen offset:3072 sc1
	buffer_load_dwordx4 a[92:95], v29, s[32:35], s88 offen offset:3584 sc1
	s_waitcnt vmcnt(20)
	s_cmp_lt_u32 s56, 2
	s_cselect_b64 exec, -1, 0
	s_nop 0
	s_add_u32 s77, s67, 10240
	s_xor_b32 s76, s77, 262144
	buffer_load_dwordx4 v[100:103], v22, s[32:35], s76 offen sc1
	s_xor_b32 s76, s77, 524288
	buffer_load_dwordx4 v[104:107], v22, s[32:35], s76 offen sc1
	s_xor_b32 s76, s77, 786432
	buffer_load_dwordx4 v[108:111], v22, s[32:35], s76 offen sc1
	s_xor_b32 s76, s77, 1048576
	buffer_load_dwordx4 v[112:115], v22, s[32:35], s76 offen sc1
	s_xor_b32 s76, s77, 1310720
	buffer_load_dwordx4 v[116:119], v22, s[32:35], s76 offen sc1
	s_xor_b32 s76, s77, 1572864
	buffer_load_dwordx4 v[120:123], v22, s[32:35], s76 offen sc1
	s_xor_b32 s76, s77, 1835008
	buffer_load_dwordx4 v[124:127], v22, s[32:35], s76 offen sc1
	s_waitcnt vmcnt(15)
	s_cmp_lt_u32 s56, 2
	s_cselect_b64 exec, 0, -1
	s_nop 0
	s_add_u32 s77, s67, 10240
	s_xor_b32 s76, s77, 262144
	buffer_load_dwordx4 v[100:103], v22, s[32:35], s76 offen sc1
	s_xor_b32 s76, s77, 524288
	buffer_load_dwordx4 v[104:107], v22, s[32:35], s76 offen sc1
	s_xor_b32 s76, s77, 786432
	buffer_load_dwordx4 v[108:111], v22, s[32:35], s76 offen sc1
	s_xor_b32 s76, s77, 1048576
	buffer_load_dwordx4 v[112:115], v22, s[32:35], s76 offen sc1
	s_xor_b32 s76, s77, 1310720
	buffer_load_dwordx4 v[116:119], v22, s[32:35], s76 offen sc1
	s_xor_b32 s76, s77, 1572864
	buffer_load_dwordx4 v[120:123], v22, s[32:35], s76 offen sc1
	s_xor_b32 s76, s77, 1835008
	buffer_load_dwordx4 v[124:127], v22, s[32:35], s76 offen sc1
	s_mov_b64 exec, -1
	s_waitcnt vmcnt(14)
	v_accvgpr_read_b32 v146, a64
	v_accvgpr_read_b32 v147, a65
	v_accvgpr_read_b32 v148, a66
	v_accvgpr_read_b32 v149, a67
	v_accvgpr_read_b32 v150, a68
	v_accvgpr_read_b32 v151, a69
	v_accvgpr_read_b32 v152, a70
	v_accvgpr_read_b32 v153, a71
	v_max3_u32 v144, v146, v147, v146
	v_max3_u32 v144, v148, v149, v144
	v_max3_u32 v144, v150, v151, v144
	v_max3_u32 v144, v152, v153, v144
	v_accvgpr_read_b32 v146, a72
	v_accvgpr_read_b32 v147, a73
	v_accvgpr_read_b32 v148, a74
	v_accvgpr_read_b32 v149, a75
	v_accvgpr_read_b32 v150, a76
	v_accvgpr_read_b32 v151, a77
	v_accvgpr_read_b32 v152, a78
	v_accvgpr_read_b32 v153, a79
	v_max3_u32 v144, v146, v147, v144
	v_max3_u32 v144, v148, v149, v144
	v_max3_u32 v144, v150, v151, v144
	v_max3_u32 v144, v152, v153, v144
	v_accvgpr_read_b32 v146, a80
	v_accvgpr_read_b32 v147, a81
	v_accvgpr_read_b32 v148, a82
	v_accvgpr_read_b32 v149, a83
	v_accvgpr_read_b32 v150, a84
	v_accvgpr_read_b32 v151, a85
	v_accvgpr_read_b32 v152, a86
	v_accvgpr_read_b32 v153, a87
	v_max3_u32 v144, v146, v147, v144
	v_max3_u32 v144, v148, v149, v144
	v_max3_u32 v144, v150, v151, v144
	v_max3_u32 v144, v152, v153, v144
	v_accvgpr_read_b32 v146, a88
	v_accvgpr_read_b32 v147, a89
	v_accvgpr_read_b32 v148, a90
	v_accvgpr_read_b32 v149, a91
	v_accvgpr_read_b32 v150, a92
	v_accvgpr_read_b32 v151, a93
	v_accvgpr_read_b32 v152, a94
	v_accvgpr_read_b32 v153, a95
	v_max3_u32 v144, v146, v147, v144
	v_max3_u32 v144, v148, v149, v144
	v_max3_u32 v144, v150, v151, v144
	v_max3_u32 v144, v152, v153, v144
	v_cmp_eq_u32 vcc, -1, v144
	s_cbranch_vccz L_m2ok
	s_mov_b32 s100, 32768
L_m2re:
	buffer_load_dwordx4 a[64:67], v29, s[32:35], s88 offen offset:0 sc1
	buffer_load_dwordx4 a[68:71], v29, s[32:35], s88 offen offset:512 sc1
	buffer_load_dwordx4 a[72:75], v29, s[32:35], s88 offen offset:1024 sc1
	buffer_load_dwordx4 a[76:79], v29, s[32:35], s88 offen offset:1536 sc1
	buffer_load_dwordx4 a[80:83], v29, s[32:35], s88 offen offset:2048 sc1
	buffer_load_dwordx4 a[84:87], v29, s[32:35], s88 offen offset:2560 sc1
	buffer_load_dwordx4 a[88:91], v29, s[32:35], s88 offen offset:3072 sc1
	buffer_load_dwordx4 a[92:95], v29, s[32:35], s88 offen offset:3584 sc1
	s_waitcnt vmcnt(0)
	s_nop 0
	v_accvgpr_read_b32 v146, a64
	v_accvgpr_read_b32 v147, a65
	v_accvgpr_read_b32 v148, a66
	v_accvgpr_read_b32 v149, a67
	v_accvgpr_read_b32 v150, a68
	v_accvgpr_read_b32 v151, a69
	v_accvgpr_read_b32 v152, a70
	v_accvgpr_read_b32 v153, a71
	v_max3_u32 v144, v146, v147, v146
	v_max3_u32 v144, v148, v149, v144
	v_max3_u32 v144, v150, v151, v144
	v_max3_u32 v144, v152, v153, v144
	v_accvgpr_read_b32 v146, a72
	v_accvgpr_read_b32 v147, a73
	v_accvgpr_read_b32 v148, a74
	v_accvgpr_read_b32 v149, a75
	v_accvgpr_read_b32 v150, a76
	v_accvgpr_read_b32 v151, a77
	v_accvgpr_read_b32 v152, a78
	v_accvgpr_read_b32 v153, a79
	v_max3_u32 v144, v146, v147, v144
	v_max3_u32 v144, v148, v149, v144
	v_max3_u32 v144, v150, v151, v144
	v_max3_u32 v144, v152, v153, v144
	v_accvgpr_read_b32 v146, a80
	v_accvgpr_read_b32 v147, a81
	v_accvgpr_read_b32 v148, a82
	v_accvgpr_read_b32 v149, a83
	v_accvgpr_read_b32 v150, a84
	v_accvgpr_read_b32 v151, a85
	v_accvgpr_read_b32 v152, a86
	v_accvgpr_read_b32 v153, a87
	v_max3_u32 v144, v146, v147, v144
	v_max3_u32 v144, v148, v149, v144
	v_max3_u32 v144, v150, v151, v144
	v_max3_u32 v144, v152, v153, v144
	v_accvgpr_read_b32 v146, a88
	v_accvgpr_read_b32 v147, a89
	v_accvgpr_read_b32 v148, a90
	v_accvgpr_read_b32 v149, a91
	v_accvgpr_read_b32 v150, a92
	v_accvgpr_read_b32 v151, a93
	v_accvgpr_read_b32 v152, a94
	v_accvgpr_read_b32 v153, a95
	v_max3_u32 v144, v146, v147, v144
	v_max3_u32 v144, v148, v149, v144
	v_max3_u32 v144, v150, v151, v144
	v_max3_u32 v144, v152, v153, v144
	v_cmp_eq_u32_e64 vcc, -1, v144
	s_cbranch_vccz L_m2ok
	s_sub_u32 s100, s100, 1
	s_cmp_lg_u32 s100, 0
	s_cbranch_scc1 L_m2re
L_m2ok:
	v_accvgpr_read_b32 v144, a64
	v_accvgpr_read_b32 v145, a65
	v_accvgpr_read_b32 v146, a66
	v_accvgpr_read_b32 v147, a67
	v_lshlrev_b32_e64 v160, 16, v144
	v_and_b32 v161, 0xffff0000, v144
	v_lshlrev_b32_e64 v162, 16, v145
	v_and_b32 v163, 0xffff0000, v145
	v_lshlrev_b32_e64 v164, 16, v146
	v_and_b32 v165, 0xffff0000, v146
	v_lshlrev_b32_e64 v166, 16, v147
	v_and_b32 v167, 0xffff0000, v147
	v_accvgpr_read_b32 v144, a80
	v_accvgpr_read_b32 v145, a81
	v_accvgpr_read_b32 v146, a82
	v_accvgpr_read_b32 v147, a83
	v_lshlrev_b32_e64 v168, 16, v144
	v_and_b32 v169, 0xffff0000, v144
	v_lshlrev_b32_e64 v170, 16, v145
	v_and_b32 v171, 0xffff0000, v145
	v_lshlrev_b32_e64 v172, 16, v146
	v_and_b32 v173, 0xffff0000, v146
	v_lshlrev_b32_e64 v174, 16, v147
	v_and_b32 v175, 0xffff0000, v147
	s_add_u32 s63, s71, 458752
	s_add_u32 m0, s68, 131072
	s_nop 0
	s_nop 0
	buffer_load_dwordx4 v17, s[24:27], s63 offen offset:0 lds
	buffer_load_dwordx4 v18, s[24:27], s63 offen offset:1024 lds
	buffer_load_dwordx4 v19, s[24:27], s63 offen offset:2048 lds
	buffer_load_dwordx4 v20, s[24:27], s63 offen offset:3072 lds
	s_add_u32 s63, s71, 573440
	s_add_u32 m0, s68, 147456
	s_nop 0
	s_nop 0
	buffer_load_dwordx4 v17, s[24:27], s63 offen offset:0 lds
	buffer_load_dwordx4 v18, s[24:27], s63 offen offset:1024 lds
	buffer_load_dwordx4 v19, s[24:27], s63 offen offset:2048 lds
	buffer_load_dwordx4 v20, s[24:27], s63 offen offset:3072 lds
	v_lshlrev_b32_e64 v128, 16, v64
	v_and_b32 v129, 0xffff0000, v64
	v_lshlrev_b32_e64 v130, 16, v65
	v_and_b32 v131, 0xffff0000, v65
	v_lshlrev_b32_e64 v132, 16, v66
	v_and_b32 v133, 0xffff0000, v66
	v_lshlrev_b32_e64 v134, 16, v67
	v_and_b32 v135, 0xffff0000, v67
	v_max3_u32 v144, v68, v69, v69
	v_max3_u32 v144, v70, v71, v144
	v_dot2c_f32_bf16 v128, s90, v68
	v_dot2c_f32_bf16 v129, s91, v68
	v_dot2c_f32_bf16 v130, s90, v69
	v_dot2c_f32_bf16 v131, s91, v69
	v_dot2c_f32_bf16 v132, s90, v70
	v_dot2c_f32_bf16 v133, s91, v70
	v_dot2c_f32_bf16 v134, s90, v71
	v_dot2c_f32_bf16 v135, s91, v71
	v_max3_u32 v144, v72, v73, v144
	v_max3_u32 v144, v74, v75, v144
	v_dot2c_f32_bf16 v128, s90, v72
	v_dot2c_f32_bf16 v129, s91, v72
	v_dot2c_f32_bf16 v130, s90, v73
	v_dot2c_f32_bf16 v131, s91, v73
	v_dot2c_f32_bf16 v132, s90, v74
	v_dot2c_f32_bf16 v133, s91, v74
	v_dot2c_f32_bf16 v134, s90, v75
	v_dot2c_f32_bf16 v135, s91, v75
	v_max3_u32 v144, v76, v77, v144
	v_max3_u32 v144, v78, v79, v144
	v_dot2c_f32_bf16 v128, s90, v76
	v_dot2c_f32_bf16 v129, s91, v76
	v_dot2c_f32_bf16 v130, s90, v77
	v_dot2c_f32_bf16 v131, s91, v77
	v_dot2c_f32_bf16 v132, s90, v78
	v_dot2c_f32_bf16 v133, s91, v78
	v_dot2c_f32_bf16 v134, s90, v79
	v_dot2c_f32_bf16 v135, s91, v79
	v_max3_u32 v144, v80, v81, v144
	v_max3_u32 v144, v82, v83, v144
	v_dot2c_f32_bf16 v128, s90, v80
	v_dot2c_f32_bf16 v129, s91, v80
	v_dot2c_f32_bf16 v130, s90, v81
	v_dot2c_f32_bf16 v131, s91, v81
	v_dot2c_f32_bf16 v132, s90, v82
	v_dot2c_f32_bf16 v133, s91, v82
	v_dot2c_f32_bf16 v134, s90, v83
	v_dot2c_f32_bf16 v135, s91, v83
	v_max3_u32 v144, v84, v85, v144
	v_max3_u32 v144, v86, v87, v144
	v_dot2c_f32_bf16 v128, s90, v84
	v_dot2c_f32_bf16 v129, s91, v84
	v_dot2c_f32_bf16 v130, s90, v85
	v_dot2c_f32_bf16 v131, s91, v85
	v_dot2c_f32_bf16 v132, s90, v86
	v_dot2c_f32_bf16 v133, s91, v86
	v_dot2c_f32_bf16 v134, s90, v87
	v_dot2c_f32_bf16 v135, s91, v87
	v_max3_u32 v144, v88, v89, v144
	v_max3_u32 v144, v90, v91, v144
	v_dot2c_f32_bf16 v128, s90, v88
	v_dot2c_f32_bf16 v129, s91, v88
	v_dot2c_f32_bf16 v130, s90, v89
	v_dot2c_f32_bf16 v131, s91, v89
	v_dot2c_f32_bf16 v132, s90, v90
	v_dot2c_f32_bf16 v133, s91, v90
	v_dot2c_f32_bf16 v134, s90, v91
	v_dot2c_f32_bf16 v135, s91, v91
	v_max3_u32 v144, v92, v93, v144
	v_max3_u32 v144, v94, v95, v144
	v_dot2c_f32_bf16 v128, s90, v92
	v_dot2c_f32_bf16 v129, s91, v92
	v_dot2c_f32_bf16 v130, s90, v93
	v_dot2c_f32_bf16 v131, s91, v93
	v_dot2c_f32_bf16 v132, s90, v94
	v_dot2c_f32_bf16 v133, s91, v94
	v_dot2c_f32_bf16 v134, s90, v95
	v_dot2c_f32_bf16 v135, s91, v95
	v_cmp_eq_u32 vcc, -1, v144
	s_cbranch_vccz L_gok_1
	s_mov_b32 s100, 32768
	s_add_u32 s77, s67, 2048
L_gre_2:
	v_max3_u32 v144, v68, v69, v70
	v_max_u32 v144, v144, v71
	v_cmp_eq_u32_e64 vcc, -1, v144
	s_cbranch_vccz L_gsk_4
	s_xor_b32 s76, s77, 262144
	buffer_load_dwordx4 v[68:71], v22, s[32:35], s76 offen sc1
L_gsk_4:
	v_max3_u32 v144, v72, v73, v74
	v_max_u32 v144, v144, v75
	v_cmp_eq_u32_e64 vcc, -1, v144
	s_cbranch_vccz L_gsk_5
	s_xor_b32 s76, s77, 524288
	buffer_load_dwordx4 v[72:75], v22, s[32:35], s76 offen sc1
L_gsk_5:
	v_max3_u32 v144, v76, v77, v78
	v_max_u32 v144, v144, v79
	v_cmp_eq_u32_e64 vcc, -1, v144
	s_cbranch_vccz L_gsk_6
	s_xor_b32 s76, s77, 786432
	buffer_load_dwordx4 v[76:79], v22, s[32:35], s76 offen sc1
L_gsk_6:
	v_max3_u32 v144, v80, v81, v82
	v_max_u32 v144, v144, v83
	v_cmp_eq_u32_e64 vcc, -1, v144
	s_cbranch_vccz L_gsk_7
	s_xor_b32 s76, s77, 1048576
	buffer_load_dwordx4 v[80:83], v22, s[32:35], s76 offen sc1
L_gsk_7:
	v_max3_u32 v144, v84, v85, v86
	v_max_u32 v144, v144, v87
	v_cmp_eq_u32_e64 vcc, -1, v144
	s_cbranch_vccz L_gsk_8
	s_xor_b32 s76, s77, 1310720
	buffer_load_dwordx4 v[84:87], v22, s[32:35], s76 offen sc1
L_gsk_8:
	v_max3_u32 v144, v88, v89, v90
	v_max_u32 v144, v144, v91
	v_cmp_eq_u32_e64 vcc, -1, v144
	s_cbranch_vccz L_gsk_9
	s_xor_b32 s76, s77, 1572864
	buffer_load_dwordx4 v[88:91], v22, s[32:35], s76 offen sc1
L_gsk_9:
	v_max3_u32 v144, v92, v93, v94
	v_max_u32 v144, v144, v95
	v_cmp_eq_u32_e64 vcc, -1, v144
	s_cbranch_vccz L_gsk_10
	s_xor_b32 s76, s77, 1835008
	buffer_load_dwordx4 v[92:95], v22, s[32:35], s76 offen sc1
L_gsk_10:
	s_waitcnt vmcnt(0)
	s_nop 0
	v_max3_u32 v144, v68, v69, v70
	v_max3_u32 v145, v71, v72, v73
	v_max3_u32 v144, v144, v74, v75
	v_max3_u32 v145, v145, v76, v77
	v_max3_u32 v144, v144, v78, v79
	v_max3_u32 v145, v145, v80, v81
	v_max3_u32 v144, v144, v82, v83
	v_max3_u32 v145, v145, v84, v85
	v_max3_u32 v144, v144, v86, v87
	v_max3_u32 v145, v145, v88, v89
	v_max3_u32 v144, v144, v90, v91
	v_max3_u32 v145, v145, v92, v93
	v_max3_u32 v144, v144, v94, v95
	v_max_u32 v144, v144, v145
	v_cmp_eq_u32 vcc, -1, v144
	s_cbranch_vccz L_grd_3
	s_sub_u32 s100, s100, 1
	s_cmp_lg_u32 s100, 0
	s_cbranch_scc1 L_gre_2
L_grd_3:
	v_lshlrev_b32_e64 v128, 16, v64
	v_and_b32 v129, 0xffff0000, v64
	v_lshlrev_b32_e64 v130, 16, v65
	v_and_b32 v131, 0xffff0000, v65
	v_lshlrev_b32_e64 v132, 16, v66
	v_and_b32 v133, 0xffff0000, v66
	v_lshlrev_b32_e64 v134, 16, v67
	v_and_b32 v135, 0xffff0000, v67
	v_dot2c_f32_bf16 v128, s90, v68
	v_dot2c_f32_bf16 v129, s91, v68
	v_dot2c_f32_bf16 v130, s90, v69
	v_dot2c_f32_bf16 v131, s91, v69
	v_dot2c_f32_bf16 v132, s90, v70
	v_dot2c_f32_bf16 v133, s91, v70
	v_dot2c_f32_bf16 v134, s90, v71
	v_dot2c_f32_bf16 v135, s91, v71
	v_dot2c_f32_bf16 v128, s90, v72
	v_dot2c_f32_bf16 v129, s91, v72
	v_dot2c_f32_bf16 v130, s90, v73
	v_dot2c_f32_bf16 v131, s91, v73
	v_dot2c_f32_bf16 v132, s90, v74
	v_dot2c_f32_bf16 v133, s91, v74
	v_dot2c_f32_bf16 v134, s90, v75
	v_dot2c_f32_bf16 v135, s91, v75
	v_dot2c_f32_bf16 v128, s90, v76
	v_dot2c_f32_bf16 v129, s91, v76
	v_dot2c_f32_bf16 v130, s90, v77
	v_dot2c_f32_bf16 v131, s91, v77
	v_dot2c_f32_bf16 v132, s90, v78
	v_dot2c_f32_bf16 v133, s91, v78
	v_dot2c_f32_bf16 v134, s90, v79
	v_dot2c_f32_bf16 v135, s91, v79
	v_dot2c_f32_bf16 v128, s90, v80
	v_dot2c_f32_bf16 v129, s91, v80
	v_dot2c_f32_bf16 v130, s90, v81
	v_dot2c_f32_bf16 v131, s91, v81
	v_dot2c_f32_bf16 v132, s90, v82
	v_dot2c_f32_bf16 v133, s91, v82
	v_dot2c_f32_bf16 v134, s90, v83
	v_dot2c_f32_bf16 v135, s91, v83
	v_dot2c_f32_bf16 v128, s90, v84
	v_dot2c_f32_bf16 v129, s91, v84
	v_dot2c_f32_bf16 v130, s90, v85
	v_dot2c_f32_bf16 v131, s91, v85
	v_dot2c_f32_bf16 v132, s90, v86
	v_dot2c_f32_bf16 v133, s91, v86
	v_dot2c_f32_bf16 v134, s90, v87
	v_dot2c_f32_bf16 v135, s91, v87
	v_dot2c_f32_bf16 v128, s90, v88
	v_dot2c_f32_bf16 v129, s91, v88
	v_dot2c_f32_bf16 v130, s90, v89
	v_dot2c_f32_bf16 v131, s91, v89
	v_dot2c_f32_bf16 v132, s90, v90
	v_dot2c_f32_bf16 v133, s91, v90
	v_dot2c_f32_bf16 v134, s90, v91
	v_dot2c_f32_bf16 v135, s91, v91
	v_dot2c_f32_bf16 v128, s90, v92
	v_dot2c_f32_bf16 v129, s91, v92
	v_dot2c_f32_bf16 v130, s90, v93
	v_dot2c_f32_bf16 v131, s91, v93
	v_dot2c_f32_bf16 v132, s90, v94
	v_dot2c_f32_bf16 v133, s91, v94
	v_dot2c_f32_bf16 v134, s90, v95
	v_dot2c_f32_bf16 v135, s91, v95
L_gok_1:
	s_nop 1
	s_nop 0
	v_pk_fma_f32 v[32:33], v[128:129], v[160:161], v[32:33]
	v_pk_fma_f32 v[34:35], v[130:131], v[162:163], v[34:35]
	v_pk_fma_f32 v[36:37], v[132:133], v[164:165], v[36:37]
	v_pk_fma_f32 v[38:39], v[134:135], v[166:167], v[38:39]
	v_pk_add_f32 v[224:225], v[32:33], v[34:35]
	v_pk_mul_f32 v[226:227], v[32:33], v[32:33]
	v_pk_fma_f32 v[226:227], v[34:35], v[34:35], v[226:227]
	v_pk_add_f32 v[224:225], v[224:225], v[36:37]
	v_pk_fma_f32 v[226:227], v[36:37], v[36:37], v[226:227]
	v_pk_add_f32 v[224:225], v[224:225], v[38:39]
	v_pk_fma_f32 v[226:227], v[38:39], v[38:39], v[226:227]
	v_accvgpr_read_b32 v144, a72
	v_accvgpr_read_b32 v145, a73
	v_accvgpr_read_b32 v146, a74
	v_accvgpr_read_b32 v147, a75
	v_lshlrev_b32_e64 v192, 16, v144
	v_and_b32 v193, 0xffff0000, v144
	v_lshlrev_b32_e64 v194, 16, v145
	v_and_b32 v195, 0xffff0000, v145
	v_lshlrev_b32_e64 v196, 16, v146
	v_and_b32 v197, 0xffff0000, v146
	v_lshlrev_b32_e64 v198, 16, v147
	v_and_b32 v199, 0xffff0000, v147
	v_add_f32 v192, 1.0, v192
	v_add_f32 v193, 1.0, v193
	v_add_f32 v194, 1.0, v194
	v_add_f32 v195, 1.0, v195
	v_add_f32 v196, 1.0, v196
	v_add_f32 v197, 1.0, v197
	v_add_f32 v198, 1.0, v198
	v_add_f32 v199, 1.0, v199
	v_cvt_pk_bf16_f32 v144, v192, v193
	v_cvt_pk_bf16_f32 v145, v194, v195
	v_cvt_pk_bf16_f32 v146, v196, v197
	v_cvt_pk_bf16_f32 v147, v198, v199
	v_lshlrev_b32_e64 v192, 16, v144
	v_and_b32 v193, 0xffff0000, v144
	v_lshlrev_b32_e64 v194, 16, v145
	v_and_b32 v195, 0xffff0000, v145
	v_lshlrev_b32_e64 v196, 16, v146
	v_and_b32 v197, 0xffff0000, v146
	v_lshlrev_b32_e64 v198, 16, v147
	v_and_b32 v199, 0xffff0000, v147
	v_accvgpr_read_b32 v144, a68
	v_accvgpr_read_b32 v145, a69
	v_accvgpr_read_b32 v146, a70
	v_accvgpr_read_b32 v147, a71
	v_lshlrev_b32_e64 v208, 16, v144
	v_and_b32 v209, 0xffff0000, v144
	v_lshlrev_b32_e64 v210, 16, v145
	v_and_b32 v211, 0xffff0000, v145
	v_lshlrev_b32_e64 v212, 16, v146
	v_and_b32 v213, 0xffff0000, v146
	v_lshlrev_b32_e64 v214, 16, v147
	v_and_b32 v215, 0xffff0000, v147
	v_accvgpr_read_b32 v144, a88
	v_accvgpr_read_b32 v145, a89
	v_accvgpr_read_b32 v146, a90
	v_accvgpr_read_b32 v147, a91
	v_lshlrev_b32_e64 v200, 16, v144
	v_and_b32 v201, 0xffff0000, v144
	v_lshlrev_b32_e64 v202, 16, v145
	v_and_b32 v203, 0xffff0000, v145
	v_lshlrev_b32_e64 v204, 16, v146
	v_and_b32 v205, 0xffff0000, v146
	v_lshlrev_b32_e64 v206, 16, v147
	v_and_b32 v207, 0xffff0000, v147
	v_add_f32 v200, 1.0, v200
	v_add_f32 v201, 1.0, v201
	v_add_f32 v202, 1.0, v202
	v_add_f32 v203, 1.0, v203
	v_add_f32 v204, 1.0, v204
	v_add_f32 v205, 1.0, v205
	v_add_f32 v206, 1.0, v206
	v_add_f32 v207, 1.0, v207
	v_cvt_pk_bf16_f32 v144, v200, v201
	v_cvt_pk_bf16_f32 v145, v202, v203
	v_cvt_pk_bf16_f32 v146, v204, v205
	v_cvt_pk_bf16_f32 v147, v206, v207
	v_lshlrev_b32_e64 v200, 16, v144
	v_and_b32 v201, 0xffff0000, v144
	v_lshlrev_b32_e64 v202, 16, v145
	v_and_b32 v203, 0xffff0000, v145
	v_lshlrev_b32_e64 v204, 16, v146
	v_and_b32 v205, 0xffff0000, v146
	v_lshlrev_b32_e64 v206, 16, v147
	v_and_b32 v207, 0xffff0000, v147
	v_accvgpr_read_b32 v144, a84
	v_accvgpr_read_b32 v145, a85
	v_accvgpr_read_b32 v146, a86
	v_accvgpr_read_b32 v147, a87
	v_lshlrev_b32_e64 v216, 16, v144
	v_and_b32 v217, 0xffff0000, v144
	v_lshlrev_b32_e64 v218, 16, v145
	v_and_b32 v219, 0xffff0000, v145
	v_lshlrev_b32_e64 v220, 16, v146
	v_and_b32 v221, 0xffff0000, v146
	v_lshlrev_b32_e64 v222, 16, v147
	v_and_b32 v223, 0xffff0000, v147
	v_lshlrev_b32_e64 v136, 16, v96
	v_and_b32 v137, 0xffff0000, v96
	v_lshlrev_b32_e64 v138, 16, v97
	v_and_b32 v139, 0xffff0000, v97
	v_lshlrev_b32_e64 v140, 16, v98
	v_and_b32 v141, 0xffff0000, v98
	v_lshlrev_b32_e64 v142, 16, v99
	v_and_b32 v143, 0xffff0000, v99
	s_waitcnt vmcnt(14)
	s_nop 0
	v_max3_u32 v144, v100, v101, v101
	v_max3_u32 v144, v102, v103, v144
	v_dot2c_f32_bf16 v136, s90, v100
	v_dot2c_f32_bf16 v137, s91, v100
	v_dot2c_f32_bf16 v138, s90, v101
	v_dot2c_f32_bf16 v139, s91, v101
	v_dot2c_f32_bf16 v140, s90, v102
	v_dot2c_f32_bf16 v141, s91, v102
	v_dot2c_f32_bf16 v142, s90, v103
	v_dot2c_f32_bf16 v143, s91, v103
	s_waitcnt vmcnt(13)
	s_nop 0
	v_max3_u32 v144, v104, v105, v144
	v_max3_u32 v144, v106, v107, v144
	v_dot2c_f32_bf16 v136, s90, v104
	v_dot2c_f32_bf16 v137, s91, v104
	v_dot2c_f32_bf16 v138, s90, v105
	v_dot2c_f32_bf16 v139, s91, v105
	v_dot2c_f32_bf16 v140, s90, v106
	v_dot2c_f32_bf16 v141, s91, v106
	v_dot2c_f32_bf16 v142, s90, v107
	v_dot2c_f32_bf16 v143, s91, v107
	s_waitcnt vmcnt(12)
	s_nop 0
	v_max3_u32 v144, v108, v109, v144
	v_max3_u32 v144, v110, v111, v144
	v_dot2c_f32_bf16 v136, s90, v108
	v_dot2c_f32_bf16 v137, s91, v108
	v_dot2c_f32_bf16 v138, s90, v109
	v_dot2c_f32_bf16 v139, s91, v109
	v_dot2c_f32_bf16 v140, s90, v110
	v_dot2c_f32_bf16 v141, s91, v110
	v_dot2c_f32_bf16 v142, s90, v111
	v_dot2c_f32_bf16 v143, s91, v111
	s_waitcnt vmcnt(11)
	s_nop 0
	v_max3_u32 v144, v112, v113, v144
	v_max3_u32 v144, v114, v115, v144
	v_dot2c_f32_bf16 v136, s90, v112
	v_dot2c_f32_bf16 v137, s91, v112
	v_dot2c_f32_bf16 v138, s90, v113
	v_dot2c_f32_bf16 v139, s91, v113
	v_dot2c_f32_bf16 v140, s90, v114
	v_dot2c_f32_bf16 v141, s91, v114
	v_dot2c_f32_bf16 v142, s90, v115
	v_dot2c_f32_bf16 v143, s91, v115
	s_waitcnt vmcnt(10)
	s_nop 0
	v_max3_u32 v144, v116, v117, v144
	v_max3_u32 v144, v118, v119, v144
	v_dot2c_f32_bf16 v136, s90, v116
	v_dot2c_f32_bf16 v137, s91, v116
	v_dot2c_f32_bf16 v138, s90, v117
	v_dot2c_f32_bf16 v139, s91, v117
	v_dot2c_f32_bf16 v140, s90, v118
	v_dot2c_f32_bf16 v141, s91, v118
	v_dot2c_f32_bf16 v142, s90, v119
	v_dot2c_f32_bf16 v143, s91, v119
	s_waitcnt vmcnt(9)
	s_nop 0
	v_max3_u32 v144, v120, v121, v144
	v_max3_u32 v144, v122, v123, v144
	v_dot2c_f32_bf16 v136, s90, v120
	v_dot2c_f32_bf16 v137, s91, v120
	v_dot2c_f32_bf16 v138, s90, v121
	v_dot2c_f32_bf16 v139, s91, v121
	v_dot2c_f32_bf16 v140, s90, v122
	v_dot2c_f32_bf16 v141, s91, v122
	v_dot2c_f32_bf16 v142, s90, v123
	v_dot2c_f32_bf16 v143, s91, v123
	s_waitcnt vmcnt(8)
	s_nop 0
	v_max3_u32 v144, v124, v125, v144
	v_max3_u32 v144, v126, v127, v144
	v_dot2c_f32_bf16 v136, s90, v124
	v_dot2c_f32_bf16 v137, s91, v124
	v_dot2c_f32_bf16 v138, s90, v125
	v_dot2c_f32_bf16 v139, s91, v125
	v_dot2c_f32_bf16 v140, s90, v126
	v_dot2c_f32_bf16 v141, s91, v126
	v_dot2c_f32_bf16 v142, s90, v127
	v_dot2c_f32_bf16 v143, s91, v127
	v_cmp_eq_u32 vcc, -1, v144
	s_cbranch_vccz L_gok_11
	s_mov_b32 s100, 32768
	s_add_u32 s77, s67, 10240
L_gre_12:
	v_max3_u32 v144, v100, v101, v102
	v_max_u32 v144, v144, v103
	v_cmp_eq_u32_e64 vcc, -1, v144
	s_cbranch_vccz L_gsk_14
	s_xor_b32 s76, s77, 262144
	buffer_load_dwordx4 v[100:103], v22, s[32:35], s76 offen sc1
L_gsk_14:
	v_max3_u32 v144, v104, v105, v106
	v_max_u32 v144, v144, v107
	v_cmp_eq_u32_e64 vcc, -1, v144
	s_cbranch_vccz L_gsk_15
	s_xor_b32 s76, s77, 524288
	buffer_load_dwordx4 v[104:107], v22, s[32:35], s76 offen sc1
L_gsk_15:
	v_max3_u32 v144, v108, v109, v110
	v_max_u32 v144, v144, v111
	v_cmp_eq_u32_e64 vcc, -1, v144
	s_cbranch_vccz L_gsk_16
	s_xor_b32 s76, s77, 786432
	buffer_load_dwordx4 v[108:111], v22, s[32:35], s76 offen sc1
L_gsk_16:
	v_max3_u32 v144, v112, v113, v114
	v_max_u32 v144, v144, v115
	v_cmp_eq_u32_e64 vcc, -1, v144
	s_cbranch_vccz L_gsk_17
	s_xor_b32 s76, s77, 1048576
	buffer_load_dwordx4 v[112:115], v22, s[32:35], s76 offen sc1
L_gsk_17:
	v_max3_u32 v144, v116, v117, v118
	v_max_u32 v144, v144, v119
	v_cmp_eq_u32_e64 vcc, -1, v144
	s_cbranch_vccz L_gsk_18
	s_xor_b32 s76, s77, 1310720
	buffer_load_dwordx4 v[116:119], v22, s[32:35], s76 offen sc1
L_gsk_18:
	v_max3_u32 v144, v120, v121, v122
	v_max_u32 v144, v144, v123
	v_cmp_eq_u32_e64 vcc, -1, v144
	s_cbranch_vccz L_gsk_19
	s_xor_b32 s76, s77, 1572864
	buffer_load_dwordx4 v[120:123], v22, s[32:35], s76 offen sc1
L_gsk_19:
	v_max3_u32 v144, v124, v125, v126
	v_max_u32 v144, v144, v127
	v_cmp_eq_u32_e64 vcc, -1, v144
	s_cbranch_vccz L_gsk_20
	s_xor_b32 s76, s77, 1835008
	buffer_load_dwordx4 v[124:127], v22, s[32:35], s76 offen sc1
L_gsk_20:
	s_waitcnt vmcnt(0)
	s_nop 0
	v_max3_u32 v144, v100, v101, v102
	v_max3_u32 v145, v103, v104, v105
	v_max3_u32 v144, v144, v106, v107
	v_max3_u32 v145, v145, v108, v109
	v_max3_u32 v144, v144, v110, v111
	v_max3_u32 v145, v145, v112, v113
	v_max3_u32 v144, v144, v114, v115
	v_max3_u32 v145, v145, v116, v117
	v_max3_u32 v144, v144, v118, v119
	v_max3_u32 v145, v145, v120, v121
	v_max3_u32 v144, v144, v122, v123
	v_max3_u32 v145, v145, v124, v125
	v_max3_u32 v144, v144, v126, v127
	v_max_u32 v144, v144, v145
	v_cmp_eq_u32 vcc, -1, v144
	s_cbranch_vccz L_grd_13
	s_sub_u32 s100, s100, 1
	s_cmp_lg_u32 s100, 0
	s_cbranch_scc1 L_gre_12
L_grd_13:
	v_lshlrev_b32_e64 v136, 16, v96
	v_and_b32 v137, 0xffff0000, v96
	v_lshlrev_b32_e64 v138, 16, v97
	v_and_b32 v139, 0xffff0000, v97
	v_lshlrev_b32_e64 v140, 16, v98
	v_and_b32 v141, 0xffff0000, v98
	v_lshlrev_b32_e64 v142, 16, v99
	v_and_b32 v143, 0xffff0000, v99
	v_dot2c_f32_bf16 v136, s90, v100
	v_dot2c_f32_bf16 v137, s91, v100
	v_dot2c_f32_bf16 v138, s90, v101
	v_dot2c_f32_bf16 v139, s91, v101
	v_dot2c_f32_bf16 v140, s90, v102
	v_dot2c_f32_bf16 v141, s91, v102
	v_dot2c_f32_bf16 v142, s90, v103
	v_dot2c_f32_bf16 v143, s91, v103
	v_dot2c_f32_bf16 v136, s90, v104
	v_dot2c_f32_bf16 v137, s91, v104
	v_dot2c_f32_bf16 v138, s90, v105
	v_dot2c_f32_bf16 v139, s91, v105
	v_dot2c_f32_bf16 v140, s90, v106
	v_dot2c_f32_bf16 v141, s91, v106
	v_dot2c_f32_bf16 v142, s90, v107
	v_dot2c_f32_bf16 v143, s91, v107
	v_dot2c_f32_bf16 v136, s90, v108
	v_dot2c_f32_bf16 v137, s91, v108
	v_dot2c_f32_bf16 v138, s90, v109
	v_dot2c_f32_bf16 v139, s91, v109
	v_dot2c_f32_bf16 v140, s90, v110
	v_dot2c_f32_bf16 v141, s91, v110
	v_dot2c_f32_bf16 v142, s90, v111
	v_dot2c_f32_bf16 v143, s91, v111
	v_dot2c_f32_bf16 v136, s90, v112
	v_dot2c_f32_bf16 v137, s91, v112
	v_dot2c_f32_bf16 v138, s90, v113
	v_dot2c_f32_bf16 v139, s91, v113
	v_dot2c_f32_bf16 v140, s90, v114
	v_dot2c_f32_bf16 v141, s91, v114
	v_dot2c_f32_bf16 v142, s90, v115
	v_dot2c_f32_bf16 v143, s91, v115
	v_dot2c_f32_bf16 v136, s90, v116
	v_dot2c_f32_bf16 v137, s91, v116
	v_dot2c_f32_bf16 v138, s90, v117
	v_dot2c_f32_bf16 v139, s91, v117
	v_dot2c_f32_bf16 v140, s90, v118
	v_dot2c_f32_bf16 v141, s91, v118
	v_dot2c_f32_bf16 v142, s90, v119
	v_dot2c_f32_bf16 v143, s91, v119
	v_dot2c_f32_bf16 v136, s90, v120
	v_dot2c_f32_bf16 v137, s91, v120
	v_dot2c_f32_bf16 v138, s90, v121
	v_dot2c_f32_bf16 v139, s91, v121
	v_dot2c_f32_bf16 v140, s90, v122
	v_dot2c_f32_bf16 v141, s91, v122
	v_dot2c_f32_bf16 v142, s90, v123
	v_dot2c_f32_bf16 v143, s91, v123
	v_dot2c_f32_bf16 v136, s90, v124
	v_dot2c_f32_bf16 v137, s91, v124
	v_dot2c_f32_bf16 v138, s90, v125
	v_dot2c_f32_bf16 v139, s91, v125
	v_dot2c_f32_bf16 v140, s90, v126
	v_dot2c_f32_bf16 v141, s91, v126
	v_dot2c_f32_bf16 v142, s90, v127
	v_dot2c_f32_bf16 v143, s91, v127
L_gok_11:
	s_nop 1
	s_nop 0
	v_pk_fma_f32 v[40:41], v[136:137], v[168:169], v[40:41]
	v_pk_fma_f32 v[42:43], v[138:139], v[170:171], v[42:43]
	v_pk_fma_f32 v[44:45], v[140:141], v[172:173], v[44:45]
	v_pk_fma_f32 v[46:47], v[142:143], v[174:175], v[46:47]
	v_pk_add_f32 v[224:225], v[224:225], v[40:41]
	v_pk_fma_f32 v[226:227], v[40:41], v[40:41], v[226:227]
	v_pk_add_f32 v[224:225], v[224:225], v[42:43]
	v_pk_fma_f32 v[226:227], v[42:43], v[42:43], v[226:227]
	v_pk_add_f32 v[224:225], v[224:225], v[44:45]
	v_pk_fma_f32 v[226:227], v[44:45], v[44:45], v[226:227]
	v_pk_add_f32 v[224:225], v[224:225], v[46:47]
	v_pk_fma_f32 v[226:227], v[46:47], v[46:47], v[226:227]
	v_add_f32 v224, v224, v225
	v_add_f32_e64 v225, v226, v227
	s_nop 0
	v_add_f32_dpp v224, v224, v224 quad_perm:[1,0,3,2] row_mask:0xf bank_mask:0xf
	v_add_f32_dpp v225, v225, v225 quad_perm:[1,0,3,2] row_mask:0xf bank_mask:0xf
	s_nop 0
	s_nop 0
	v_add_f32_dpp v224, v224, v224 quad_perm:[2,3,0,1] row_mask:0xf bank_mask:0xf
	v_add_f32_dpp v225, v225, v225 quad_perm:[2,3,0,1] row_mask:0xf bank_mask:0xf
	s_nop 0
	s_nop 0
	v_add_f32_dpp v224, v224, v224 row_ror:8 row_mask:0xf bank_mask:0xf
	v_add_f32_dpp v225, v225, v225 row_ror:8 row_mask:0xf bank_mask:0xf
	v_mov_b32 v226, v224
	v_mov_b32 v227, v225
	s_nop 0
	v_permlane16_swap_b32 v224, v226
	v_permlane16_swap_b32 v225, v227
	v_add_f32 v224, v224, v226
	v_add_f32 v225, v225, v227
	v_mov_b32 v226, v224
	v_mov_b32 v227, v225
	s_nop 0
	v_permlane32_swap_b32 v224, v226
	v_permlane32_swap_b32 v225, v227
	v_add_f32 v224, v224, v226
	v_add_f32 v225, v225, v227
	v_mul_f32 v226, 0x3b000000, v224
	v_mul_f32 v225, 0x3b000000, v225
	v_fma_f32 v224, -v226, v226, v225
	v_max_f32_e64 v224, 0, v224
	v_add_f32 v224, 0x3727c5ac, v224
	v_rsq_f32 v224, v224
	s_nop 0
	v_mul_f32 v225, -v226, v224
	v_pk_fma_f32 v[128:129], v[32:33], v[224:225], v[224:225] op_sel:[0,0,1] op_sel_hi:[1,0,1]
	v_pk_fma_f32 v[130:131], v[34:35], v[224:225], v[224:225] op_sel:[0,0,1] op_sel_hi:[1,0,1]
	v_pk_fma_f32 v[132:133], v[36:37], v[224:225], v[224:225] op_sel:[0,0,1] op_sel_hi:[1,0,1]
	v_pk_fma_f32 v[134:135], v[38:39], v[224:225], v[224:225] op_sel:[0,0,1] op_sel_hi:[1,0,1]
	v_pk_fma_f32 v[136:137], v[40:41], v[224:225], v[224:225] op_sel:[0,0,1] op_sel_hi:[1,0,1]
	v_pk_fma_f32 v[138:139], v[42:43], v[224:225], v[224:225] op_sel:[0,0,1] op_sel_hi:[1,0,1]
	v_pk_fma_f32 v[140:141], v[44:45], v[224:225], v[224:225] op_sel:[0,0,1] op_sel_hi:[1,0,1]
	v_pk_fma_f32 v[142:143], v[46:47], v[224:225], v[224:225] op_sel:[0,0,1] op_sel_hi:[1,0,1]
	v_pk_fma_f32 v[128:129], v[128:129], v[192:193], v[208:209]
	v_pk_fma_f32 v[130:131], v[130:131], v[194:195], v[210:211]
	v_pk_fma_f32 v[132:133], v[132:133], v[196:197], v[212:213]
	v_pk_fma_f32 v[134:135], v[134:135], v[198:199], v[214:215]
	v_pk_fma_f32 v[136:137], v[136:137], v[200:201], v[216:217]
	v_pk_fma_f32 v[138:139], v[138:139], v[202:203], v[218:219]
	v_pk_fma_f32 v[140:141], v[140:141], v[204:205], v[220:221]
	v_pk_fma_f32 v[142:143], v[142:143], v[206:207], v[222:223]
	v_pk_add_f32 v[144:145], v[128:129], v[130:131]
	v_pk_mul_f32 v[146:147], v[128:129], v[128:129]
	v_pk_fma_f32 v[146:147], v[130:131], v[130:131], v[146:147]
	v_pk_add_f32 v[144:145], v[144:145], v[132:133]
	v_pk_fma_f32 v[146:147], v[132:133], v[132:133], v[146:147]
	v_pk_add_f32 v[144:145], v[144:145], v[134:135]
	v_pk_fma_f32 v[146:147], v[134:135], v[134:135], v[146:147]
	v_pk_add_f32 v[144:145], v[144:145], v[136:137]
	v_pk_fma_f32 v[146:147], v[136:137], v[136:137], v[146:147]
	v_pk_add_f32 v[144:145], v[144:145], v[138:139]
	v_pk_fma_f32 v[146:147], v[138:139], v[138:139], v[146:147]
	v_pk_add_f32 v[144:145], v[144:145], v[140:141]
	v_pk_fma_f32 v[146:147], v[140:141], v[140:141], v[146:147]
	v_pk_add_f32 v[144:145], v[144:145], v[142:143]
	v_pk_fma_f32 v[146:147], v[142:143], v[142:143], v[146:147]
	v_add_f32 v144, v144, v145
	v_add_f32_e64 v145, v146, v147
	s_nop 0
	v_add_f32_dpp v144, v144, v144 quad_perm:[1,0,3,2] row_mask:0xf bank_mask:0xf
	v_add_f32_dpp v145, v145, v145 quad_perm:[1,0,3,2] row_mask:0xf bank_mask:0xf
	s_nop 0
	s_nop 0
	v_add_f32_dpp v144, v144, v144 quad_perm:[2,3,0,1] row_mask:0xf bank_mask:0xf
	v_add_f32_dpp v145, v145, v145 quad_perm:[2,3,0,1] row_mask:0xf bank_mask:0xf
	s_nop 0
	s_nop 0
	v_add_f32_dpp v144, v144, v144 row_ror:8 row_mask:0xf bank_mask:0xf
	v_add_f32_dpp v145, v145, v145 row_ror:8 row_mask:0xf bank_mask:0xf
	v_mov_b32 v146, v144
	v_mov_b32 v147, v145
	s_nop 0
	v_permlane16_swap_b32 v144, v146
	v_permlane16_swap_b32 v145, v147
	v_add_f32 v144, v144, v146
	v_add_f32 v145, v145, v147
	v_mov_b32 v146, v144
	v_mov_b32 v147, v145
	s_nop 0
	v_permlane32_swap_b32 v144, v146
	v_permlane32_swap_b32 v145, v147
	v_add_f32 v144, v144, v146
	v_add_f32 v145, v145, v147
	v_mul_f32 v146, 0x3b000000, v144
	v_mul_f32 v145, 0x3b000000, v145
	v_fma_f32 v144, -v146, v146, v145
	v_max_f32_e64 v144, 0, v144
	v_add_f32 v144, 0x3727c5ac, v144
	v_rsq_f32 v144, v144
	s_nop 0
	v_mul_f32 v145, -v146, v144
	v_pk_fma_f32 v[128:129], v[128:129], v[144:145], v[144:145] op_sel:[0,0,1] op_sel_hi:[1,0,1]
	v_pk_fma_f32 v[130:131], v[130:131], v[144:145], v[144:145] op_sel:[0,0,1] op_sel_hi:[1,0,1]
	v_pk_fma_f32 v[132:133], v[132:133], v[144:145], v[144:145] op_sel:[0,0,1] op_sel_hi:[1,0,1]
	v_pk_fma_f32 v[134:135], v[134:135], v[144:145], v[144:145] op_sel:[0,0,1] op_sel_hi:[1,0,1]
	v_pk_fma_f32 v[136:137], v[136:137], v[144:145], v[144:145] op_sel:[0,0,1] op_sel_hi:[1,0,1]
	v_pk_fma_f32 v[138:139], v[138:139], v[144:145], v[144:145] op_sel:[0,0,1] op_sel_hi:[1,0,1]
	v_pk_fma_f32 v[140:141], v[140:141], v[144:145], v[144:145] op_sel:[0,0,1] op_sel_hi:[1,0,1]
	v_pk_fma_f32 v[142:143], v[142:143], v[144:145], v[144:145] op_sel:[0,0,1] op_sel_hi:[1,0,1]
	s_add_u32 s60, s66, 0
	s_nop 0
	v_cvt_pk_bf16_f32 v176, v128, v129
	v_cvt_pk_bf16_f32 v177, v130, v131
	v_cvt_pk_bf16_f32 v178, v132, v133
	v_cvt_pk_bf16_f32 v179, v134, v135
	buffer_store_dwordx4 v[176:179], v16, s[32:35], s60 offen offset:0 sc1
	v_cvt_pk_bf16_f32 v180, v136, v137
	v_cvt_pk_bf16_f32 v181, v138, v139
	v_cvt_pk_bf16_f32 v182, v140, v141
	v_cvt_pk_bf16_f32 v183, v142, v143
	buffer_store_dwordx4 v[180:183], v16, s[32:35], s60 offen offset:1024 sc1
	ds_write_b128 v24, v[176:179] offset:0
	ds_write_b128 v24, v[180:183] offset:32768
	v_xor_b32 v64, 128, v24
	v_xor_b32 v65, 128, v25
	v_xor_b32 v66, 128, v26
	v_xor_b32 v67, 128, v27
	s_add_u32 s63, s71, 917504
	s_add_u32 m0, s68, 0
	s_nop 0
	buffer_load_dwordx4 v17, s[24:27], s63 offen offset:0 lds
	buffer_load_dwordx4 v18, s[24:27], s63 offen offset:1024 lds
	buffer_load_dwordx4 v19, s[24:27], s63 offen offset:2048 lds
	buffer_load_dwordx4 v20, s[24:27], s63 offen offset:3072 lds
	s_add_u32 s63, s71, 1032192
	s_add_u32 m0, s68, 16384
	s_nop 0
	s_nop 0
	buffer_load_dwordx4 v17, s[24:27], s63 offen offset:0 lds
	buffer_load_dwordx4 v18, s[24:27], s63 offen offset:1024 lds
	buffer_load_dwordx4 v19, s[24:27], s63 offen offset:2048 lds
	buffer_load_dwordx4 v20, s[24:27], s63 offen offset:3072 lds
	s_waitcnt vmcnt(8)
	s_add_u32 s77, s67, 0
	s_xor_b32 s76, s77, 262144
	buffer_load_dwordx4 v[68:71], v6, s[32:35], s76 offen sc1
	s_xor_b32 s76, s77, 524288
	buffer_load_dwordx4 v[72:75], v6, s[32:35], s76 offen sc1
	s_xor_b32 s76, s77, 786432
	buffer_load_dwordx4 v[76:79], v6, s[32:35], s76 offen sc1
	s_xor_b32 s76, s77, 1048576
	buffer_load_dwordx4 v[80:83], v6, s[32:35], s76 offen sc1
	s_xor_b32 s76, s77, 1310720
	buffer_load_dwordx4 v[84:87], v6, s[32:35], s76 offen sc1
	s_xor_b32 s76, s77, 1572864
	buffer_load_dwordx4 v[88:91], v6, s[32:35], s76 offen sc1
	s_xor_b32 s76, s77, 1835008
	buffer_load_dwordx4 v[92:95], v6, s[32:35], s76 offen sc1
	ds_read_b64_tr_b16 a[160:161], v8 offset:32768
	ds_read_b64_tr_b16 a[162:163], v8 offset:34816
	ds_read_b64_tr_b16 a[164:165], v9 offset:32768
	ds_read_b64_tr_b16 a[166:167], v9 offset:34816
	ds_read_b64_tr_b16 a[168:169], v10 offset:32768
	ds_read_b64_tr_b16 a[170:171], v10 offset:34816
	ds_read_b64_tr_b16 a[172:173], v11 offset:32768
	ds_read_b64_tr_b16 a[174:175], v11 offset:34816
	s_waitcnt vmcnt(6)
	s_nop 0
	v_max3_u32 v144, v68, v69, v69
	v_max3_u32 v144, v70, v71, v144
	ds_write_b128 v25, v[68:71] offset:0
	s_waitcnt vmcnt(5)
	s_nop 0
	v_max3_u32 v144, v72, v73, v144
	v_max3_u32 v144, v74, v75, v144
	ds_write_b128 v26, v[72:75] offset:0
	s_waitcnt vmcnt(4)
	s_nop 0
	v_max3_u32 v144, v76, v77, v144
	v_max3_u32 v144, v78, v79, v144
	ds_write_b128 v27, v[76:79] offset:0
	s_waitcnt vmcnt(3)
	s_nop 0
	v_max3_u32 v144, v80, v81, v144
	v_max3_u32 v144, v82, v83, v144
	ds_write_b128 v64, v[80:83] offset:0
	s_waitcnt vmcnt(2)
	s_nop 0
	v_max3_u32 v144, v84, v85, v144
	v_max3_u32 v144, v86, v87, v144
	ds_write_b128 v65, v[84:87] offset:0
	s_waitcnt vmcnt(1)
	s_nop 0
	v_max3_u32 v144, v88, v89, v144
	v_max3_u32 v144, v90, v91, v144
	ds_write_b128 v66, v[88:91] offset:0
	s_waitcnt vmcnt(0)
	s_nop 0
	v_max3_u32 v144, v92, v93, v144
	v_max3_u32 v144, v94, v95, v144
	ds_write_b128 v67, v[92:95] offset:0
	v_cmp_eq_u32 vcc, -1, v144
	s_cbranch_vccz L_gok_21
	s_mov_b32 s100, 32768
	s_add_u32 s77, s67, 0
	s_nop 0
L_gre_22:
	v_max3_u32 v144, v68, v69, v70
	v_max_u32 v144, v144, v71
	v_cmp_eq_u32_e64 vcc, -1, v144
	s_cbranch_vccz L_gsk_24
	s_xor_b32 s76, s77, 262144
	buffer_load_dwordx4 v[68:71], v6, s[32:35], s76 offen sc1
L_gsk_24:
	v_max3_u32 v144, v72, v73, v74
	v_max_u32 v144, v144, v75
	v_cmp_eq_u32_e64 vcc, -1, v144
	s_cbranch_vccz L_gsk_25
	s_xor_b32 s76, s77, 524288
	buffer_load_dwordx4 v[72:75], v6, s[32:35], s76 offen sc1
L_gsk_25:
	v_max3_u32 v144, v76, v77, v78
	v_max_u32 v144, v144, v79
	v_cmp_eq_u32_e64 vcc, -1, v144
	s_cbranch_vccz L_gsk_26
	s_xor_b32 s76, s77, 786432
	buffer_load_dwordx4 v[76:79], v6, s[32:35], s76 offen sc1
L_gsk_26:
	v_max3_u32 v144, v80, v81, v82
	v_max_u32 v144, v144, v83
	v_cmp_eq_u32_e64 vcc, -1, v144
	s_cbranch_vccz L_gsk_27
	s_xor_b32 s76, s77, 1048576
	buffer_load_dwordx4 v[80:83], v6, s[32:35], s76 offen sc1
L_gsk_27:
	v_max3_u32 v144, v84, v85, v86
	v_max_u32 v144, v144, v87
	v_cmp_eq_u32_e64 vcc, -1, v144
	s_cbranch_vccz L_gsk_28
	s_xor_b32 s76, s77, 1310720
	buffer_load_dwordx4 v[84:87], v6, s[32:35], s76 offen sc1
L_gsk_28:
	v_max3_u32 v144, v88, v89, v90
	v_max_u32 v144, v144, v91
	v_cmp_eq_u32_e64 vcc, -1, v144
	s_cbranch_vccz L_gsk_29
	s_xor_b32 s76, s77, 1572864
	buffer_load_dwordx4 v[88:91], v6, s[32:35], s76 offen sc1
L_gsk_29:
	v_max3_u32 v144, v92, v93, v94
	v_max_u32 v144, v144, v95
	v_cmp_eq_u32_e64 vcc, -1, v144
	s_cbranch_vccz L_gsk_30
	s_xor_b32 s76, s77, 1835008
	buffer_load_dwordx4 v[92:95], v6, s[32:35], s76 offen sc1
L_gsk_30:
	s_waitcnt vmcnt(0)
	s_nop 0
	v_max3_u32 v144, v68, v69, v70
	v_max3_u32 v145, v71, v72, v73
	v_max3_u32 v144, v144, v74, v75
	v_max3_u32 v145, v145, v76, v77
	v_max3_u32 v144, v144, v78, v79
	v_max3_u32 v145, v145, v80, v81
	v_max3_u32 v144, v144, v82, v83
	v_max3_u32 v145, v145, v84, v85
	v_max3_u32 v144, v144, v86, v87
	v_max3_u32 v145, v145, v88, v89
	v_max3_u32 v144, v144, v90, v91
	v_max3_u32 v145, v145, v92, v93
	v_max3_u32 v144, v144, v94, v95
	v_max_u32 v144, v144, v145
	v_cmp_eq_u32 vcc, -1, v144
	s_cbranch_vccz L_grd_23
	s_sub_u32 s100, s100, 1
	s_cmp_lg_u32 s100, 0
	s_cbranch_scc1 L_gre_22
L_grd_23:
	ds_write_b128 v25, v[68:71] offset:0
	ds_write_b128 v26, v[72:75] offset:0
	ds_write_b128 v27, v[76:79] offset:0
	ds_write_b128 v64, v[80:83] offset:0
	ds_write_b128 v65, v[84:87] offset:0
	ds_write_b128 v66, v[88:91] offset:0
	ds_write_b128 v67, v[92:95] offset:0
L_gok_21:
	s_add_u32 s77, s67, 1024
	s_xor_b32 s76, s77, 262144
	buffer_load_dwordx4 v[100:103], v6, s[32:35], s76 offen sc1
	s_xor_b32 s76, s77, 524288
	buffer_load_dwordx4 v[104:107], v6, s[32:35], s76 offen sc1
	s_xor_b32 s76, s77, 786432
	buffer_load_dwordx4 v[108:111], v6, s[32:35], s76 offen sc1
	s_xor_b32 s76, s77, 1048576
	buffer_load_dwordx4 v[112:115], v6, s[32:35], s76 offen sc1
	s_xor_b32 s76, s77, 1310720
	buffer_load_dwordx4 v[116:119], v6, s[32:35], s76 offen sc1
	s_xor_b32 s76, s77, 1572864
	buffer_load_dwordx4 v[120:123], v6, s[32:35], s76 offen sc1
	s_xor_b32 s76, s77, 1835008
	buffer_load_dwordx4 v[124:127], v6, s[32:35], s76 offen sc1
	s_waitcnt lgkmcnt(0)
	s_barrier
	ds_read_b128 a[32:35], v23 offset:0
	ds_read_b128 a[36:39], v23 offset:1024
	ds_read_b128 a[40:43], v23 offset:2048
	ds_read_b128 a[44:47], v23 offset:3072
	s_waitcnt lgkmcnt(0)
	s_nop 0
	v_mfma_f32_16x16x32_bf16 v[128:131], a[160:163], a[32:35], v[48:51]
	s_add_u32 s63, s71, 1376256
	ds_read_b64_tr_b16 a[176:177], v8 offset:49152
	ds_read_b64_tr_b16 a[178:179], v8 offset:51200
	v_mfma_f32_16x16x32_bf16 v[132:135], a[160:163], a[36:39], v[48:51]
	s_add_u32 m0, s68, 32768
	ds_read_b64_tr_b16 a[180:181], v9 offset:49152
	ds_read_b64_tr_b16 a[182:183], v9 offset:51200
	v_mfma_f32_16x16x32_bf16 v[136:139], a[160:163], a[40:43], v[48:51]
	buffer_load_dwordx4 v17, s[24:27], s63 offen offset:0 lds
	v_mfma_f32_16x16x32_bf16 v[140:143], a[160:163], a[44:47], v[48:51]
	ds_read_b64_tr_b16 a[184:185], v10 offset:49152
	ds_read_b128 a[48:51], v23 offset:4096
	v_mfma_f32_16x16x32_bf16 v[144:147], a[164:167], a[32:35], v[52:55]
	ds_read_b64_tr_b16 a[186:187], v10 offset:51200
	ds_read_b128 a[52:55], v23 offset:5120
	v_mfma_f32_16x16x32_bf16 v[148:151], a[164:167], a[36:39], v[52:55]
	ds_read_b64_tr_b16 a[188:189], v11 offset:49152
	ds_read_b128 a[56:59], v23 offset:6144
	v_mfma_f32_16x16x32_bf16 v[152:155], a[164:167], a[40:43], v[52:55]
	buffer_load_dwordx4 v18, s[24:27], s63 offen offset:1024 lds
	v_mfma_f32_16x16x32_bf16 v[156:159], a[164:167], a[44:47], v[52:55]
	ds_read_b64_tr_b16 a[190:191], v11 offset:51200
	ds_read_b128 a[60:63], v23 offset:7168
	v_mfma_f32_16x16x32_bf16 v[160:163], a[168:171], a[32:35], v[56:59]
	v_mfma_f32_16x16x32_bf16 v[164:167], a[168:171], a[36:39], v[56:59]
	v_mfma_f32_16x16x32_bf16 v[168:171], a[168:171], a[40:43], v[56:59]
	buffer_load_dwordx4 v19, s[24:27], s63 offen offset:2048 lds
	v_mfma_f32_16x16x32_bf16 v[172:175], a[168:171], a[44:47], v[56:59]
	v_mfma_f32_16x16x32_bf16 v[176:179], a[172:175], a[32:35], v[60:63]
	v_mfma_f32_16x16x32_bf16 v[180:183], a[172:175], a[36:39], v[60:63]
	v_mfma_f32_16x16x32_bf16 v[184:187], a[172:175], a[40:43], v[60:63]
	buffer_load_dwordx4 v20, s[24:27], s63 offen offset:3072 lds
	v_mfma_f32_16x16x32_bf16 v[188:191], a[172:175], a[44:47], v[60:63]
	s_waitcnt lgkmcnt(0)
	s_nop 0
	v_mfma_f32_16x16x32_bf16 v[128:131], a[176:179], a[48:51], v[128:131]
	s_add_u32 s63, s71, 1490944
	ds_read_b64_tr_b16 a[0:1], v12 offset:0
	ds_read_b64_tr_b16 a[2:3], v12 offset:2048
	v_mfma_f32_16x16x32_bf16 v[132:135], a[176:179], a[52:55], v[132:135]
	s_add_u32 m0, s68, 49152
	ds_read_b64_tr_b16 a[4:5], v13 offset:0
	ds_read_b64_tr_b16 a[6:7], v13 offset:2048
	v_mfma_f32_16x16x32_bf16 v[136:139], a[176:179], a[56:59], v[136:139]
	buffer_load_dwordx4 v17, s[24:27], s63 offen offset:0 lds
	v_mfma_f32_16x16x32_bf16 v[140:143], a[176:179], a[60:63], v[140:143]
	ds_read_b64_tr_b16 a[8:9], v14 offset:0
	ds_read_b128 a[32:35], v23 offset:8192
	v_mfma_f32_16x16x32_bf16 v[144:147], a[180:183], a[48:51], v[144:147]
	ds_read_b64_tr_b16 a[10:11], v14 offset:2048
	ds_read_b128 a[36:39], v23 offset:9216
	v_mfma_f32_16x16x32_bf16 v[148:151], a[180:183], a[52:55], v[148:151]
	ds_read_b64_tr_b16 a[12:13], v15 offset:0
	ds_read_b128 a[40:43], v23 offset:10240
	v_mfma_f32_16x16x32_bf16 v[152:155], a[180:183], a[56:59], v[152:155]
	buffer_load_dwordx4 v18, s[24:27], s63 offen offset:1024 lds
	v_mfma_f32_16x16x32_bf16 v[156:159], a[180:183], a[60:63], v[156:159]
	ds_read_b64_tr_b16 a[14:15], v15 offset:2048
	ds_read_b128 a[44:47], v23 offset:11264
	v_mfma_f32_16x16x32_bf16 v[160:163], a[184:187], a[48:51], v[160:163]
	v_mfma_f32_16x16x32_bf16 v[164:167], a[184:187], a[52:55], v[164:167]
	v_mfma_f32_16x16x32_bf16 v[168:171], a[184:187], a[56:59], v[168:171]
	buffer_load_dwordx4 v19, s[24:27], s63 offen offset:2048 lds
	v_mfma_f32_16x16x32_bf16 v[172:175], a[184:187], a[60:63], v[172:175]
	v_mfma_f32_16x16x32_bf16 v[176:179], a[188:191], a[48:51], v[176:179]
	v_mfma_f32_16x16x32_bf16 v[180:183], a[188:191], a[52:55], v[180:183]
	v_mfma_f32_16x16x32_bf16 v[184:187], a[188:191], a[56:59], v[184:187]
	buffer_load_dwordx4 v20, s[24:27], s63 offen offset:3072 lds
	v_mfma_f32_16x16x32_bf16 v[188:191], a[188:191], a[60:63], v[188:191]
	s_waitcnt lgkmcnt(0)
	s_nop 0
	v_mfma_f32_16x16x32_bf16 v[128:131], a[0:3], a[32:35], v[128:131]
	s_add_u32 s63, s71, 229376
	ds_read_b64_tr_b16 a[16:17], v12 offset:16384
	ds_read_b64_tr_b16 a[18:19], v12 offset:18432
	v_mfma_f32_16x16x32_bf16 v[132:135], a[0:3], a[36:39], v[132:135]
	s_add_u32 m0, s68, 131072
	ds_read_b64_tr_b16 a[20:21], v13 offset:16384
	ds_read_b64_tr_b16 a[22:23], v13 offset:18432
	v_mfma_f32_16x16x32_bf16 v[136:139], a[0:3], a[40:43], v[136:139]
	buffer_load_dwordx4 v17, s[24:27], s63 offen offset:0 lds
	v_mfma_f32_16x16x32_bf16 v[140:143], a[0:3], a[44:47], v[140:143]
	ds_read_b64_tr_b16 a[24:25], v14 offset:16384
	ds_read_b128 a[48:51], v23 offset:12288
	v_mfma_f32_16x16x32_bf16 v[144:147], a[4:7], a[32:35], v[144:147]
	ds_read_b64_tr_b16 a[26:27], v14 offset:18432
	ds_read_b128 a[52:55], v23 offset:13312
	v_mfma_f32_16x16x32_bf16 v[148:151], a[4:7], a[36:39], v[148:151]
	ds_read_b64_tr_b16 a[28:29], v15 offset:16384
	ds_read_b128 a[56:59], v23 offset:14336
	v_mfma_f32_16x16x32_bf16 v[152:155], a[4:7], a[40:43], v[152:155]
	buffer_load_dwordx4 v18, s[24:27], s63 offen offset:1024 lds
	v_mfma_f32_16x16x32_bf16 v[156:159], a[4:7], a[44:47], v[156:159]
	ds_read_b64_tr_b16 a[30:31], v15 offset:18432
	ds_read_b128 a[60:63], v23 offset:15360
	v_mfma_f32_16x16x32_bf16 v[160:163], a[8:11], a[32:35], v[160:163]
	v_mfma_f32_16x16x32_bf16 v[164:167], a[8:11], a[36:39], v[164:167]
	v_mfma_f32_16x16x32_bf16 v[168:171], a[8:11], a[40:43], v[168:171]
	buffer_load_dwordx4 v19, s[24:27], s63 offen offset:2048 lds
	v_mfma_f32_16x16x32_bf16 v[172:175], a[8:11], a[44:47], v[172:175]
	v_mfma_f32_16x16x32_bf16 v[176:179], a[12:15], a[32:35], v[176:179]
	v_mfma_f32_16x16x32_bf16 v[180:183], a[12:15], a[36:39], v[180:183]
	v_mfma_f32_16x16x32_bf16 v[184:187], a[12:15], a[40:43], v[184:187]
	buffer_load_dwordx4 v20, s[24:27], s63 offen offset:3072 lds
	v_mfma_f32_16x16x32_bf16 v[188:191], a[12:15], a[44:47], v[188:191]
	s_waitcnt lgkmcnt(0)
	s_nop 0
	v_mfma_f32_16x16x32_bf16 v[128:131], a[16:19], a[48:51], v[128:131]
	s_add_u32 s63, s71, 344064
	ds_read_b64_tr_b16 a[124:125], v8 offset:0
	ds_read_b64_tr_b16 a[126:127], v8 offset:2048
	v_mfma_f32_16x16x32_bf16 v[132:135], a[16:19], a[52:55], v[132:135]
	s_add_u32 m0, s68, 147456
	ds_read_b64_tr_b16 a[128:129], v9 offset:0
	ds_read_b64_tr_b16 a[130:131], v9 offset:2048
	v_mfma_f32_16x16x32_bf16 v[136:139], a[16:19], a[56:59], v[136:139]
	buffer_load_dwordx4 v17, s[24:27], s63 offen offset:0 lds
	v_mfma_f32_16x16x32_bf16 v[140:143], a[16:19], a[60:63], v[140:143]
	ds_read_b64_tr_b16 a[132:133], v10 offset:0
	ds_read_b128 a[32:35], v23 offset:16384
	v_mfma_f32_16x16x32_bf16 v[144:147], a[20:23], a[48:51], v[144:147]
	ds_read_b64_tr_b16 a[134:135], v10 offset:2048
	ds_read_b128 a[36:39], v23 offset:17408
	v_mfma_f32_16x16x32_bf16 v[148:151], a[20:23], a[52:55], v[148:151]
	ds_read_b64_tr_b16 a[136:137], v11 offset:0
	ds_read_b128 a[40:43], v23 offset:18432
	v_mfma_f32_16x16x32_bf16 v[152:155], a[20:23], a[56:59], v[152:155]
	buffer_load_dwordx4 v18, s[24:27], s63 offen offset:1024 lds
	v_mfma_f32_16x16x32_bf16 v[156:159], a[20:23], a[60:63], v[156:159]
	ds_read_b64_tr_b16 a[138:139], v11 offset:2048
	ds_read_b128 a[44:47], v23 offset:19456
	v_mfma_f32_16x16x32_bf16 v[160:163], a[24:27], a[48:51], v[160:163]
	s_waitcnt vmcnt(14)
	s_nop 0
	v_max3_u32 v28, v100, v101, v102
	v_max3_u32 v29, v103, v104, v105
	v_mfma_f32_16x16x32_bf16 v[164:167], a[24:27], a[52:55], v[164:167]
	v_max3_u32 v28, v28, v106, v107
	v_max3_u32 v29, v29, v108, v109
	v_mfma_f32_16x16x32_bf16 v[168:171], a[24:27], a[56:59], v[168:171]
	buffer_load_dwordx4 v19, s[24:27], s63 offen offset:2048 lds
	v_mfma_f32_16x16x32_bf16 v[172:175], a[24:27], a[60:63], v[172:175]
	v_max3_u32 v28, v28, v110, v111
	v_max3_u32 v29, v29, v112, v113
	v_mfma_f32_16x16x32_bf16 v[176:179], a[28:31], a[48:51], v[176:179]
	v_max3_u32 v28, v28, v114, v115
	v_max3_u32 v29, v29, v116, v117
	v_mfma_f32_16x16x32_bf16 v[180:183], a[28:31], a[52:55], v[180:183]
	v_max3_u32 v28, v28, v118, v119
	v_max3_u32 v29, v29, v120, v121
	v_mfma_f32_16x16x32_bf16 v[184:187], a[28:31], a[56:59], v[184:187]
	buffer_load_dwordx4 v20, s[24:27], s63 offen offset:3072 lds
	v_mfma_f32_16x16x32_bf16 v[188:191], a[28:31], a[60:63], v[188:191]
	s_waitcnt lgkmcnt(0)
	s_nop 0
	v_mfma_f32_16x16x32_bf16 v[128:131], a[124:127], a[32:35], v[128:131]
	s_add_u32 s63, s71, 688128
	ds_read_b64_tr_b16 a[140:141], v8 offset:16384
	ds_read_b64_tr_b16 a[142:143], v8 offset:18432
	v_mfma_f32_16x16x32_bf16 v[132:135], a[124:127], a[36:39], v[132:135]
	s_add_u32 m0, s68, 0
	s_nop 0
	ds_read_b64_tr_b16 a[144:145], v9 offset:16384
	ds_read_b64_tr_b16 a[146:147], v9 offset:18432
	v_mfma_f32_16x16x32_bf16 v[136:139], a[124:127], a[40:43], v[136:139]
	buffer_load_dwordx4 v17, s[24:27], s63 offen offset:0 lds
	v_mfma_f32_16x16x32_bf16 v[140:143], a[124:127], a[44:47], v[140:143]
	ds_read_b64_tr_b16 a[148:149], v10 offset:16384
	ds_read_b128 a[48:51], v23 offset:20480
	v_mfma_f32_16x16x32_bf16 v[144:147], a[128:131], a[32:35], v[144:147]
	ds_read_b64_tr_b16 a[150:151], v10 offset:18432
	ds_read_b128 a[52:55], v23 offset:21504
	v_mfma_f32_16x16x32_bf16 v[148:151], a[128:131], a[36:39], v[148:151]
	ds_read_b64_tr_b16 a[152:153], v11 offset:16384
	ds_read_b128 a[56:59], v23 offset:22528
	v_mfma_f32_16x16x32_bf16 v[152:155], a[128:131], a[40:43], v[152:155]
	buffer_load_dwordx4 v18, s[24:27], s63 offen offset:1024 lds
	v_mfma_f32_16x16x32_bf16 v[156:159], a[128:131], a[44:47], v[156:159]
	ds_read_b64_tr_b16 a[154:155], v11 offset:18432
	ds_read_b128 a[60:63], v23 offset:23552
	v_mfma_f32_16x16x32_bf16 v[160:163], a[132:135], a[32:35], v[160:163]
	v_max3_u32 v28, v28, v122, v123
	v_max3_u32 v29, v29, v124, v125
	v_mfma_f32_16x16x32_bf16 v[164:167], a[132:135], a[36:39], v[164:167]
	v_max3_u32 v28, v28, v126, v127
	v_max_u32_e64 v28, v28, v29
	v_mfma_f32_16x16x32_bf16 v[168:171], a[132:135], a[40:43], v[168:171]
	buffer_load_dwordx4 v19, s[24:27], s63 offen offset:2048 lds
	v_mfma_f32_16x16x32_bf16 v[172:175], a[132:135], a[44:47], v[172:175]
	v_cmp_eq_u32_e64 vcc, -1, v28
	v_mfma_f32_16x16x32_bf16 v[176:179], a[136:139], a[32:35], v[176:179]
	v_mfma_f32_16x16x32_bf16 v[180:183], a[136:139], a[36:39], v[180:183]
	v_mfma_f32_16x16x32_bf16 v[184:187], a[136:139], a[40:43], v[184:187]
	buffer_load_dwordx4 v20, s[24:27], s63 offen offset:3072 lds
	v_mfma_f32_16x16x32_bf16 v[188:191], a[136:139], a[44:47], v[188:191]
	s_waitcnt vmcnt(16) lgkmcnt(0)
	s_cbranch_vccz L_gok_31
	s_mov_b32 s100, 32768
	s_add_u32 s77, s67, 1024
L_gre_32:
	v_max3_u32 v28, v100, v101, v102
	v_max_u32 v28, v28, v103
	v_cmp_eq_u32_e64 vcc, -1, v28
	s_cbranch_vccz L_gsk_34
	s_xor_b32 s76, s77, 262144
	buffer_load_dwordx4 v[100:103], v6, s[32:35], s76 offen sc1
L_gsk_34:
	v_max3_u32 v28, v104, v105, v106
	v_max_u32 v28, v28, v107
	v_cmp_eq_u32_e64 vcc, -1, v28
	s_cbranch_vccz L_gsk_35
	s_xor_b32 s76, s77, 524288
	buffer_load_dwordx4 v[104:107], v6, s[32:35], s76 offen sc1
L_gsk_35:
	v_max3_u32 v28, v108, v109, v110
	v_max_u32 v28, v28, v111
	v_cmp_eq_u32_e64 vcc, -1, v28
	s_cbranch_vccz L_gsk_36
	s_xor_b32 s76, s77, 786432
	buffer_load_dwordx4 v[108:111], v6, s[32:35], s76 offen sc1
L_gsk_36:
	v_max3_u32 v28, v112, v113, v114
	v_max_u32 v28, v28, v115
	v_cmp_eq_u32_e64 vcc, -1, v28
	s_cbranch_vccz L_gsk_37
	s_xor_b32 s76, s77, 1048576
	buffer_load_dwordx4 v[112:115], v6, s[32:35], s76 offen sc1
L_gsk_37:
	v_max3_u32 v28, v116, v117, v118
	v_max_u32 v28, v28, v119
	v_cmp_eq_u32_e64 vcc, -1, v28
	s_cbranch_vccz L_gsk_38
	s_xor_b32 s76, s77, 1310720
	buffer_load_dwordx4 v[116:119], v6, s[32:35], s76 offen sc1
L_gsk_38:
	v_max3_u32 v28, v120, v121, v122
	v_max_u32 v28, v28, v123
	v_cmp_eq_u32_e64 vcc, -1, v28
	s_cbranch_vccz L_gsk_39
	s_xor_b32 s76, s77, 1572864
	buffer_load_dwordx4 v[120:123], v6, s[32:35], s76 offen sc1
L_gsk_39:
	v_max3_u32 v28, v124, v125, v126
	v_max_u32 v28, v28, v127
	v_cmp_eq_u32_e64 vcc, -1, v28
	s_cbranch_vccz L_gsk_40
	s_xor_b32 s76, s77, 1835008
	buffer_load_dwordx4 v[124:127], v6, s[32:35], s76 offen sc1
L_gsk_40:
	s_waitcnt vmcnt(0)
	s_nop 0
	v_max3_u32 v28, v100, v101, v102
	v_max3_u32 v29, v103, v104, v105
	v_max3_u32 v28, v28, v106, v107
	v_max3_u32 v29, v29, v108, v109
	v_max3_u32 v28, v28, v110, v111
	v_max3_u32 v29, v29, v112, v113
	v_max3_u32 v28, v28, v114, v115
	v_max3_u32 v29, v29, v116, v117
	v_max3_u32 v28, v28, v118, v119
	v_max3_u32 v29, v29, v120, v121
	v_max3_u32 v28, v28, v122, v123
	v_max3_u32 v29, v29, v124, v125
	v_max3_u32 v28, v28, v126, v127
	v_max_u32 v28, v28, v29
	v_cmp_eq_u32 vcc, -1, v28
	s_cbranch_vccz L_grd_33
	s_sub_u32 s100, s100, 1
	s_cmp_lg_u32 s100, 0
	s_cbranch_scc1 L_gre_32
L_grd_33:
L_gok_31:
	v_mfma_f32_16x16x32_bf16 v[128:131], a[140:143], a[48:51], v[128:131]
	s_add_u32 s63, s71, 802816
	ds_read_b64_tr_b16 a[160:161], v8 offset:32768
	ds_read_b64_tr_b16 a[162:163], v8 offset:34816
	v_mfma_f32_16x16x32_bf16 v[132:135], a[140:143], a[52:55], v[132:135]
	s_add_u32 m0, s68, 16384
	ds_read_b64_tr_b16 a[164:165], v9 offset:32768
	ds_read_b64_tr_b16 a[166:167], v9 offset:34816
	v_mfma_f32_16x16x32_bf16 v[136:139], a[140:143], a[56:59], v[136:139]
	buffer_load_dwordx4 v17, s[24:27], s63 offen offset:0 lds
	v_mfma_f32_16x16x32_bf16 v[140:143], a[140:143], a[60:63], v[140:143]
	ds_read_b64_tr_b16 a[168:169], v10 offset:32768
	ds_read_b128 a[32:35], v23 offset:24576
	v_mfma_f32_16x16x32_bf16 v[144:147], a[144:147], a[48:51], v[144:147]
	ds_read_b64_tr_b16 a[170:171], v10 offset:34816
	ds_read_b128 a[36:39], v23 offset:25600
	v_mfma_f32_16x16x32_bf16 v[148:151], a[144:147], a[52:55], v[148:151]
	ds_read_b64_tr_b16 a[172:173], v11 offset:32768
	ds_read_b128 a[40:43], v23 offset:26624
	v_mfma_f32_16x16x32_bf16 v[152:155], a[144:147], a[56:59], v[152:155]
	buffer_load_dwordx4 v18, s[24:27], s63 offen offset:1024 lds
	v_mfma_f32_16x16x32_bf16 v[156:159], a[144:147], a[60:63], v[156:159]
	ds_read_b64_tr_b16 a[174:175], v11 offset:34816
	ds_read_b128 a[44:47], v23 offset:27648
	v_mfma_f32_16x16x32_bf16 v[160:163], a[148:151], a[48:51], v[160:163]
	ds_write_b128 v25, v[100:103] offset:32768
	ds_write_b128 v26, v[104:107] offset:32768
	v_mfma_f32_16x16x32_bf16 v[164:167], a[148:151], a[52:55], v[164:167]
	ds_write_b128 v27, v[108:111] offset:32768
	ds_write_b128 v64, v[112:115] offset:32768
	v_mfma_f32_16x16x32_bf16 v[168:171], a[148:151], a[56:59], v[168:171]
	buffer_load_dwordx4 v19, s[24:27], s63 offen offset:2048 lds
	v_mfma_f32_16x16x32_bf16 v[172:175], a[148:151], a[60:63], v[172:175]
	ds_write_b128 v65, v[116:119] offset:32768
	ds_write_b128 v66, v[120:123] offset:32768
	v_mfma_f32_16x16x32_bf16 v[176:179], a[152:155], a[48:51], v[176:179]
	ds_write_b128 v67, v[124:127] offset:32768
	v_mfma_f32_16x16x32_bf16 v[180:183], a[152:155], a[52:55], v[180:183]
	v_mfma_f32_16x16x32_bf16 v[184:187], a[152:155], a[56:59], v[184:187]
	buffer_load_dwordx4 v20, s[24:27], s63 offen offset:3072 lds
	v_mfma_f32_16x16x32_bf16 v[188:191], a[152:155], a[60:63], v[188:191]
	s_waitcnt vmcnt(16) lgkmcnt(7)
	s_nop 0
	v_mfma_f32_16x16x32_bf16 v[128:131], a[160:163], a[32:35], v[128:131]
	s_add_u32 s63, s71, 1146880
	ds_read_b64_tr_b16 a[176:177], v8 offset:49152
	ds_read_b64_tr_b16 a[178:179], v8 offset:51200
	v_mfma_f32_16x16x32_bf16 v[132:135], a[160:163], a[36:39], v[132:135]
	s_add_u32 m0, s68, 32768
	ds_read_b64_tr_b16 a[180:181], v9 offset:49152
	ds_read_b64_tr_b16 a[182:183], v9 offset:51200
	v_mfma_f32_16x16x32_bf16 v[136:139], a[160:163], a[40:43], v[136:139]
	buffer_load_dwordx4 v17, s[24:27], s63 offen offset:0 lds
	v_mfma_f32_16x16x32_bf16 v[140:143], a[160:163], a[44:47], v[140:143]
	ds_read_b64_tr_b16 a[184:185], v10 offset:49152
	ds_read_b128 a[48:51], v23 offset:28672
	v_mfma_f32_16x16x32_bf16 v[144:147], a[164:167], a[32:35], v[144:147]
	ds_read_b64_tr_b16 a[186:187], v10 offset:51200
	ds_read_b128 a[52:55], v23 offset:29696
	v_mfma_f32_16x16x32_bf16 v[148:151], a[164:167], a[36:39], v[148:151]
	ds_read_b64_tr_b16 a[188:189], v11 offset:49152
	ds_read_b128 a[56:59], v23 offset:30720
	v_mfma_f32_16x16x32_bf16 v[152:155], a[164:167], a[40:43], v[152:155]
	buffer_load_dwordx4 v18, s[24:27], s63 offen offset:1024 lds
	v_mfma_f32_16x16x32_bf16 v[156:159], a[164:167], a[44:47], v[156:159]
	ds_read_b64_tr_b16 a[190:191], v11 offset:51200
	ds_read_b128 a[60:63], v23 offset:31744
	v_mfma_f32_16x16x32_bf16 v[160:163], a[168:171], a[32:35], v[160:163]
	v_mfma_f32_16x16x32_bf16 v[164:167], a[168:171], a[36:39], v[164:167]
	v_mfma_f32_16x16x32_bf16 v[168:171], a[168:171], a[40:43], v[168:171]
	buffer_load_dwordx4 v19, s[24:27], s63 offen offset:2048 lds
	v_mfma_f32_16x16x32_bf16 v[172:175], a[168:171], a[44:47], v[172:175]
	v_mfma_f32_16x16x32_bf16 v[176:179], a[172:175], a[32:35], v[176:179]
	v_mfma_f32_16x16x32_bf16 v[180:183], a[172:175], a[36:39], v[180:183]
	v_mfma_f32_16x16x32_bf16 v[184:187], a[172:175], a[40:43], v[184:187]
	buffer_load_dwordx4 v20, s[24:27], s63 offen offset:3072 lds
	v_mfma_f32_16x16x32_bf16 v[188:191], a[172:175], a[44:47], v[188:191]
	s_waitcnt vmcnt(16) lgkmcnt(0)
	s_barrier
	v_mfma_f32_16x16x32_bf16 v[128:131], a[176:179], a[48:51], v[128:131]
	s_add_u32 s63, s71, 1261568
	ds_read_b64_tr_b16 a[0:1], v12 offset:0
	ds_read_b64_tr_b16 a[2:3], v12 offset:2048
	v_mfma_f32_16x16x32_bf16 v[132:135], a[176:179], a[52:55], v[132:135]
	s_add_u32 m0, s68, 49152
	ds_read_b64_tr_b16 a[4:5], v13 offset:0
	ds_read_b64_tr_b16 a[6:7], v13 offset:2048
	v_mfma_f32_16x16x32_bf16 v[136:139], a[176:179], a[56:59], v[136:139]
	buffer_load_dwordx4 v17, s[24:27], s63 offen offset:0 lds
	v_mfma_f32_16x16x32_bf16 v[140:143], a[176:179], a[60:63], v[140:143]
	ds_read_b64_tr_b16 a[8:9], v14 offset:0
	ds_read_b128 a[32:35], v23 offset:32768
	v_mfma_f32_16x16x32_bf16 v[144:147], a[180:183], a[48:51], v[144:147]
	ds_read_b64_tr_b16 a[10:11], v14 offset:2048
	ds_read_b128 a[36:39], v23 offset:33792
	v_mfma_f32_16x16x32_bf16 v[148:151], a[180:183], a[52:55], v[148:151]
	ds_read_b64_tr_b16 a[12:13], v15 offset:0
	ds_read_b128 a[40:43], v23 offset:34816
	v_mfma_f32_16x16x32_bf16 v[152:155], a[180:183], a[56:59], v[152:155]
	buffer_load_dwordx4 v18, s[24:27], s63 offen offset:1024 lds
	v_mfma_f32_16x16x32_bf16 v[156:159], a[180:183], a[60:63], v[156:159]
	ds_read_b64_tr_b16 a[14:15], v15 offset:2048
	ds_read_b128 a[44:47], v23 offset:35840
	v_mfma_f32_16x16x32_bf16 v[160:163], a[184:187], a[48:51], v[160:163]
	v_mfma_f32_16x16x32_bf16 v[164:167], a[184:187], a[52:55], v[164:167]
	v_mfma_f32_16x16x32_bf16 v[168:171], a[184:187], a[56:59], v[168:171]
	buffer_load_dwordx4 v19, s[24:27], s63 offen offset:2048 lds
	v_mfma_f32_16x16x32_bf16 v[172:175], a[184:187], a[60:63], v[172:175]
	v_mfma_f32_16x16x32_bf16 v[176:179], a[188:191], a[48:51], v[176:179]
	v_mfma_f32_16x16x32_bf16 v[180:183], a[188:191], a[52:55], v[180:183]
	v_mfma_f32_16x16x32_bf16 v[184:187], a[188:191], a[56:59], v[184:187]
	buffer_load_dwordx4 v20, s[24:27], s63 offen offset:3072 lds
	v_mfma_f32_16x16x32_bf16 v[188:191], a[188:191], a[60:63], v[188:191]
	s_waitcnt vmcnt(16) lgkmcnt(0)
	s_nop 0
	v_mfma_f32_16x16x32_bf16 v[128:131], a[0:3], a[32:35], v[128:131]
	s_add_u32 s63, s71, 1605632
	ds_read_b64_tr_b16 a[16:17], v12 offset:16384
	ds_read_b64_tr_b16 a[18:19], v12 offset:18432
	v_mfma_f32_16x16x32_bf16 v[132:135], a[0:3], a[36:39], v[132:135]
	s_add_u32 m0, s68, 131072
	ds_read_b64_tr_b16 a[20:21], v13 offset:16384
	ds_read_b64_tr_b16 a[22:23], v13 offset:18432
	v_mfma_f32_16x16x32_bf16 v[136:139], a[0:3], a[40:43], v[136:139]
	buffer_load_dwordx4 v17, s[24:27], s63 offen offset:0 lds
	v_mfma_f32_16x16x32_bf16 v[140:143], a[0:3], a[44:47], v[140:143]
	ds_read_b64_tr_b16 a[24:25], v14 offset:16384
	ds_read_b128 a[48:51], v23 offset:36864
	v_mfma_f32_16x16x32_bf16 v[144:147], a[4:7], a[32:35], v[144:147]
	ds_read_b64_tr_b16 a[26:27], v14 offset:18432
	ds_read_b128 a[52:55], v23 offset:37888
	v_mfma_f32_16x16x32_bf16 v[148:151], a[4:7], a[36:39], v[148:151]
	ds_read_b64_tr_b16 a[28:29], v15 offset:16384
	ds_read_b128 a[56:59], v23 offset:38912
	v_mfma_f32_16x16x32_bf16 v[152:155], a[4:7], a[40:43], v[152:155]
	buffer_load_dwordx4 v18, s[24:27], s63 offen offset:1024 lds
	v_mfma_f32_16x16x32_bf16 v[156:159], a[4:7], a[44:47], v[156:159]
	ds_read_b64_tr_b16 a[30:31], v15 offset:18432
	ds_read_b128 a[60:63], v23 offset:39936
	v_mfma_f32_16x16x32_bf16 v[160:163], a[8:11], a[32:35], v[160:163]
	s_mov_b32 s80, 0xbdd2d3e8
	s_mov_b32 s81, 0xc0135761
	s_lshl_b32 s60, s56, 13
	s_nop 0
	v_mfma_f32_16x16x32_bf16 v[164:167], a[8:11], a[36:39], v[164:167]
	v_add_u32_e64 v28, s60, v7
	s_lshr_b32 s60, s56, 1
	s_lshl_b32 s60, s60, 30
	v_mfma_f32_16x16x32_bf16 v[168:171], a[8:11], a[40:43], v[168:171]
	buffer_load_dwordx4 v19, s[24:27], s63 offen offset:2048 lds
	v_mfma_f32_16x16x32_bf16 v[172:175], a[8:11], a[44:47], v[172:175]
	v_or_b32_e64 v29, s60, v22
	v_mfma_f32_16x16x32_bf16 v[176:179], a[12:15], a[32:35], v[176:179]
	v_mfma_f32_16x16x32_bf16 v[180:183], a[12:15], a[36:39], v[180:183]
	v_mfma_f32_16x16x32_bf16 v[184:187], a[12:15], a[40:43], v[184:187]
	buffer_load_dwordx4 v20, s[24:27], s63 offen offset:3072 lds
	v_mfma_f32_16x16x32_bf16 v[188:191], a[12:15], a[44:47], v[188:191]
	s_waitcnt vmcnt(16) lgkmcnt(0)
	s_nop 0
	v_mfma_f32_16x16x32_bf16 v[128:131], a[16:19], a[48:51], v[128:131]
	s_add_u32 s63, s71, 1720320
	ds_read_b64_tr_b16 a[124:125], v8 offset:0
	ds_read_b64_tr_b16 a[126:127], v8 offset:2048
	v_mfma_f32_16x16x32_bf16 v[132:135], a[16:19], a[52:55], v[132:135]
	s_add_u32 m0, s68, 147456
	ds_read_b64_tr_b16 a[128:129], v9 offset:0
	ds_read_b64_tr_b16 a[130:131], v9 offset:2048
	v_mfma_f32_16x16x32_bf16 v[136:139], a[16:19], a[56:59], v[136:139]
	buffer_load_dwordx4 v17, s[24:27], s63 offen offset:0 lds
	v_mfma_f32_16x16x32_bf16 v[140:143], a[16:19], a[60:63], v[140:143]
	ds_read_b64_tr_b16 a[132:133], v10 offset:0
	ds_read_b128 a[32:35], v23 offset:40960
	v_mfma_f32_16x16x32_bf16 v[144:147], a[20:23], a[48:51], v[144:147]
	ds_read_b64_tr_b16 a[134:135], v10 offset:2048
	ds_read_b128 a[36:39], v23 offset:41984
	v_mfma_f32_16x16x32_bf16 v[148:151], a[20:23], a[52:55], v[148:151]
	ds_read_b64_tr_b16 a[136:137], v11 offset:0
	ds_read_b128 a[40:43], v23 offset:43008
	v_mfma_f32_16x16x32_bf16 v[152:155], a[20:23], a[56:59], v[152:155]
	buffer_load_dwordx4 v18, s[24:27], s63 offen offset:1024 lds
	v_mfma_f32_16x16x32_bf16 v[156:159], a[20:23], a[60:63], v[156:159]
	ds_read_b64_tr_b16 a[138:139], v11 offset:2048
	ds_read_b128 a[44:47], v23 offset:44032
	v_mfma_f32_16x16x32_bf16 v[160:163], a[24:27], a[48:51], v[160:163]
	v_mfma_f32_16x16x32_bf16 v[164:167], a[24:27], a[52:55], v[164:167]
	v_mfma_f32_16x16x32_bf16 v[168:171], a[24:27], a[56:59], v[168:171]
	buffer_load_dwordx4 v19, s[24:27], s63 offen offset:2048 lds
	v_mfma_f32_16x16x32_bf16 v[172:175], a[24:27], a[60:63], v[172:175]
	v_mfma_f32_16x16x32_bf16 v[176:179], a[28:31], a[48:51], v[176:179]
	v_mfma_f32_16x16x32_bf16 v[180:183], a[28:31], a[52:55], v[180:183]
	v_mfma_f32_16x16x32_bf16 v[184:187], a[28:31], a[56:59], v[184:187]
	buffer_load_dwordx4 v20, s[24:27], s63 offen offset:3072 lds
	v_mfma_f32_16x16x32_bf16 v[188:191], a[28:31], a[60:63], v[188:191]
	s_waitcnt vmcnt(16) lgkmcnt(0)
	s_nop 0
	v_mfma_f32_16x16x32_bf16 v[128:131], a[124:127], a[32:35], v[128:131]
	s_add_u32 s63, s72, 0
	s_nop 0
	ds_read_b64_tr_b16 a[140:141], v8 offset:16384
	ds_read_b64_tr_b16 a[142:143], v8 offset:18432
	v_mfma_f32_16x16x32_bf16 v[132:135], a[124:127], a[36:39], v[132:135]
	s_add_u32 m0, s68, 0
	s_nop 0
	ds_read_b64_tr_b16 a[144:145], v9 offset:16384
	ds_read_b64_tr_b16 a[146:147], v9 offset:18432
	v_mfma_f32_16x16x32_bf16 v[136:139], a[124:127], a[40:43], v[136:139]
	buffer_load_dwordx4 v2, s[28:31], s63 offen offset:0 lds
	v_mfma_f32_16x16x32_bf16 v[140:143], a[124:127], a[44:47], v[140:143]
	ds_read_b64_tr_b16 a[148:149], v10 offset:16384
	ds_read_b128 a[48:51], v23 offset:45056
	v_mfma_f32_16x16x32_bf16 v[144:147], a[128:131], a[32:35], v[144:147]
	ds_read_b64_tr_b16 a[150:151], v10 offset:18432
	ds_read_b128 a[52:55], v23 offset:46080
	v_mfma_f32_16x16x32_bf16 v[148:151], a[128:131], a[36:39], v[148:151]
	ds_read_b64_tr_b16 a[152:153], v11 offset:16384
	ds_read_b128 a[56:59], v23 offset:47104
	v_mfma_f32_16x16x32_bf16 v[152:155], a[128:131], a[40:43], v[152:155]
	buffer_load_dwordx4 v3, s[28:31], s63 offen offset:1024 lds
	v_mfma_f32_16x16x32_bf16 v[156:159], a[128:131], a[44:47], v[156:159]
	ds_read_b64_tr_b16 a[154:155], v11 offset:18432
	ds_read_b128 a[60:63], v23 offset:48128
	v_mfma_f32_16x16x32_bf16 v[160:163], a[132:135], a[32:35], v[160:163]
	v_mfma_f32_16x16x32_bf16 v[164:167], a[132:135], a[36:39], v[164:167]
	v_mfma_f32_16x16x32_bf16 v[168:171], a[132:135], a[40:43], v[168:171]
	buffer_load_dwordx4 v4, s[28:31], s63 offen offset:2048 lds
	v_mfma_f32_16x16x32_bf16 v[172:175], a[132:135], a[44:47], v[172:175]
	v_mfma_f32_16x16x32_bf16 v[176:179], a[136:139], a[32:35], v[176:179]
	v_mfma_f32_16x16x32_bf16 v[180:183], a[136:139], a[36:39], v[180:183]
	v_mfma_f32_16x16x32_bf16 v[184:187], a[136:139], a[40:43], v[184:187]
	buffer_load_dwordx4 v5, s[28:31], s63 offen offset:3072 lds
	v_mfma_f32_16x16x32_bf16 v[188:191], a[136:139], a[44:47], v[188:191]
	s_waitcnt vmcnt(16) lgkmcnt(0)
	s_nop 0
	v_mfma_f32_16x16x32_bf16 v[128:131], a[140:143], a[48:51], v[128:131]
	s_add_u32 s63, s72, 32768
	ds_read_b64_tr_b16 a[160:161], v8 offset:32768
	ds_read_b64_tr_b16 a[162:163], v8 offset:34816
	v_mfma_f32_16x16x32_bf16 v[132:135], a[140:143], a[52:55], v[132:135]
	s_add_u32 m0, s68, 16384
	ds_read_b64_tr_b16 a[164:165], v9 offset:32768
	ds_read_b64_tr_b16 a[166:167], v9 offset:34816
	v_mfma_f32_16x16x32_bf16 v[136:139], a[140:143], a[56:59], v[136:139]
	buffer_load_dwordx4 v2, s[28:31], s63 offen offset:0 lds
	v_mfma_f32_16x16x32_bf16 v[140:143], a[140:143], a[60:63], v[140:143]
	ds_read_b64_tr_b16 a[168:169], v10 offset:32768
	ds_read_b128 a[32:35], v23 offset:49152
	v_mfma_f32_16x16x32_bf16 v[144:147], a[144:147], a[48:51], v[144:147]
	ds_read_b64_tr_b16 a[170:171], v10 offset:34816
	ds_read_b128 a[36:39], v23 offset:50176
	v_mfma_f32_16x16x32_bf16 v[148:151], a[144:147], a[52:55], v[148:151]
	ds_read_b64_tr_b16 a[172:173], v11 offset:32768
	ds_read_b128 a[40:43], v23 offset:51200
	v_mfma_f32_16x16x32_bf16 v[152:155], a[144:147], a[56:59], v[152:155]
	buffer_load_dwordx4 v3, s[28:31], s63 offen offset:1024 lds
	v_mfma_f32_16x16x32_bf16 v[156:159], a[144:147], a[60:63], v[156:159]
	ds_read_b64_tr_b16 a[174:175], v11 offset:34816
	ds_read_b128 a[44:47], v23 offset:52224
	v_mfma_f32_16x16x32_bf16 v[160:163], a[148:151], a[48:51], v[160:163]
	v_mfma_f32_16x16x32_bf16 v[164:167], a[148:151], a[52:55], v[164:167]
	v_mfma_f32_16x16x32_bf16 v[168:171], a[148:151], a[56:59], v[168:171]
	buffer_load_dwordx4 v4, s[28:31], s63 offen offset:2048 lds
	v_mfma_f32_16x16x32_bf16 v[172:175], a[148:151], a[60:63], v[172:175]
	v_mfma_f32_16x16x32_bf16 v[176:179], a[152:155], a[48:51], v[176:179]
	v_mfma_f32_16x16x32_bf16 v[180:183], a[152:155], a[52:55], v[180:183]
	v_mfma_f32_16x16x32_bf16 v[184:187], a[152:155], a[56:59], v[184:187]
	buffer_load_dwordx4 v5, s[28:31], s63 offen offset:3072 lds
	v_mfma_f32_16x16x32_bf16 v[188:191], a[152:155], a[60:63], v[188:191]
	s_waitcnt vmcnt(16) lgkmcnt(0)
	s_nop 0
	v_mfma_f32_16x16x32_bf16 v[128:131], a[160:163], a[32:35], v[128:131]
	s_add_u32 s63, s72, 65536
	ds_read_b64_tr_b16 a[176:177], v8 offset:49152
	ds_read_b64_tr_b16 a[178:179], v8 offset:51200
	v_mfma_f32_16x16x32_bf16 v[132:135], a[160:163], a[36:39], v[132:135]
	s_add_u32 m0, s68, 32768
	ds_read_b64_tr_b16 a[180:181], v9 offset:49152
	ds_read_b64_tr_b16 a[182:183], v9 offset:51200
	v_mfma_f32_16x16x32_bf16 v[136:139], a[160:163], a[40:43], v[136:139]
	buffer_load_dwordx4 v2, s[28:31], s63 offen offset:0 lds
	v_mfma_f32_16x16x32_bf16 v[140:143], a[160:163], a[44:47], v[140:143]
	ds_read_b64_tr_b16 a[184:185], v10 offset:49152
	ds_read_b128 a[48:51], v23 offset:53248
	v_mfma_f32_16x16x32_bf16 v[144:147], a[164:167], a[32:35], v[144:147]
	ds_read_b64_tr_b16 a[186:187], v10 offset:51200
	ds_read_b128 a[52:55], v23 offset:54272
	v_mfma_f32_16x16x32_bf16 v[148:151], a[164:167], a[36:39], v[148:151]
	ds_read_b64_tr_b16 a[188:189], v11 offset:49152
	ds_read_b128 a[56:59], v23 offset:55296
	v_mfma_f32_16x16x32_bf16 v[152:155], a[164:167], a[40:43], v[152:155]
	buffer_load_dwordx4 v3, s[28:31], s63 offen offset:1024 lds
	v_mfma_f32_16x16x32_bf16 v[156:159], a[164:167], a[44:47], v[156:159]
	ds_read_b64_tr_b16 a[190:191], v11 offset:51200
	ds_read_b128 a[60:63], v23 offset:56320
	v_mfma_f32_16x16x32_bf16 v[160:163], a[168:171], a[32:35], v[160:163]
	v_mfma_f32_16x16x32_bf16 v[164:167], a[168:171], a[36:39], v[164:167]
	v_mfma_f32_16x16x32_bf16 v[168:171], a[168:171], a[40:43], v[168:171]
	buffer_load_dwordx4 v4, s[28:31], s63 offen offset:2048 lds
	v_mfma_f32_16x16x32_bf16 v[172:175], a[168:171], a[44:47], v[172:175]
	v_mfma_f32_16x16x32_bf16 v[176:179], a[172:175], a[32:35], v[176:179]
	v_mfma_f32_16x16x32_bf16 v[180:183], a[172:175], a[36:39], v[180:183]
	v_mfma_f32_16x16x32_bf16 v[184:187], a[172:175], a[40:43], v[184:187]
	buffer_load_dwordx4 v5, s[28:31], s63 offen offset:3072 lds
	v_mfma_f32_16x16x32_bf16 v[188:191], a[172:175], a[44:47], v[188:191]
	s_waitcnt vmcnt(16) lgkmcnt(0)
	s_nop 0
	v_mfma_f32_16x16x32_bf16 v[128:131], a[176:179], a[48:51], v[128:131]
	s_add_u32 s63, s72, 98304
	ds_read_b64_tr_b16 a[0:1], v12 offset:0
	ds_read_b64_tr_b16 a[2:3], v12 offset:2048
	v_mfma_f32_16x16x32_bf16 v[132:135], a[176:179], a[52:55], v[132:135]
	s_add_u32 m0, s68, 49152
	ds_read_b64_tr_b16 a[4:5], v13 offset:0
	ds_read_b64_tr_b16 a[6:7], v13 offset:2048
	v_mfma_f32_16x16x32_bf16 v[136:139], a[176:179], a[56:59], v[136:139]
	buffer_load_dwordx4 v2, s[28:31], s63 offen offset:0 lds
	v_mfma_f32_16x16x32_bf16 v[140:143], a[176:179], a[60:63], v[140:143]
	ds_read_b64_tr_b16 a[8:9], v14 offset:0
	ds_read_b128 a[32:35], v23 offset:57344
	v_mfma_f32_16x16x32_bf16 v[144:147], a[180:183], a[48:51], v[144:147]
	ds_read_b64_tr_b16 a[10:11], v14 offset:2048
	ds_read_b128 a[36:39], v23 offset:58368
	v_mfma_f32_16x16x32_bf16 v[148:151], a[180:183], a[52:55], v[148:151]
	ds_read_b64_tr_b16 a[12:13], v15 offset:0
	ds_read_b128 a[40:43], v23 offset:59392
	v_mfma_f32_16x16x32_bf16 v[152:155], a[180:183], a[56:59], v[152:155]
	buffer_load_dwordx4 v3, s[28:31], s63 offen offset:1024 lds
	v_mfma_f32_16x16x32_bf16 v[156:159], a[180:183], a[60:63], v[156:159]
	ds_read_b64_tr_b16 a[14:15], v15 offset:2048
	ds_read_b128 a[44:47], v23 offset:60416
	v_mfma_f32_16x16x32_bf16 v[160:163], a[184:187], a[48:51], v[160:163]
	v_mfma_f32_16x16x32_bf16 v[164:167], a[184:187], a[52:55], v[164:167]
	v_mfma_f32_16x16x32_bf16 v[168:171], a[184:187], a[56:59], v[168:171]
	buffer_load_dwordx4 v4, s[28:31], s63 offen offset:2048 lds
	v_mfma_f32_16x16x32_bf16 v[172:175], a[184:187], a[60:63], v[172:175]
	v_mfma_f32_16x16x32_bf16 v[176:179], a[188:191], a[48:51], v[176:179]
	v_mfma_f32_16x16x32_bf16 v[180:183], a[188:191], a[52:55], v[180:183]
	v_mfma_f32_16x16x32_bf16 v[184:187], a[188:191], a[56:59], v[184:187]
	buffer_load_dwordx4 v5, s[28:31], s63 offen offset:3072 lds
	v_mfma_f32_16x16x32_bf16 v[188:191], a[188:191], a[60:63], v[188:191]
	s_waitcnt vmcnt(16) lgkmcnt(0)
	s_nop 0
	v_mfma_f32_16x16x32_bf16 v[128:131], a[0:3], a[32:35], v[128:131]
	s_add_u32 s63, s72, 131072
	ds_read_b64_tr_b16 a[16:17], v12 offset:16384
	ds_read_b64_tr_b16 a[18:19], v12 offset:18432
	v_mfma_f32_16x16x32_bf16 v[132:135], a[0:3], a[36:39], v[132:135]
	s_add_u32 m0, s68, 131072
	ds_read_b64_tr_b16 a[20:21], v13 offset:16384
	ds_read_b64_tr_b16 a[22:23], v13 offset:18432
	v_mfma_f32_16x16x32_bf16 v[136:139], a[0:3], a[40:43], v[136:139]
	buffer_load_dwordx4 v2, s[28:31], s63 offen offset:0 lds
	v_mfma_f32_16x16x32_bf16 v[140:143], a[0:3], a[44:47], v[140:143]
	ds_read_b64_tr_b16 a[24:25], v14 offset:16384
	ds_read_b128 a[48:51], v23 offset:61440
	v_mfma_f32_16x16x32_bf16 v[144:147], a[4:7], a[32:35], v[144:147]
	ds_read_b64_tr_b16 a[26:27], v14 offset:18432
	ds_read_b128 a[52:55], v23 offset:62464
	v_mfma_f32_16x16x32_bf16 v[148:151], a[4:7], a[36:39], v[148:151]
	ds_read_b64_tr_b16 a[28:29], v15 offset:16384
	ds_read_b128 a[56:59], v23 offset:63488
	v_mfma_f32_16x16x32_bf16 v[152:155], a[4:7], a[40:43], v[152:155]
	buffer_load_dwordx4 v3, s[28:31], s63 offen offset:1024 lds
	v_mfma_f32_16x16x32_bf16 v[156:159], a[4:7], a[44:47], v[156:159]
	ds_read_b64_tr_b16 a[30:31], v15 offset:18432
	ds_read_b128 a[60:63], v23 offset:64512
	v_mfma_f32_16x16x32_bf16 v[160:163], a[8:11], a[32:35], v[160:163]
	v_mfma_f32_16x16x32_bf16 v[164:167], a[8:11], a[36:39], v[164:167]
	v_mfma_f32_16x16x32_bf16 v[168:171], a[8:11], a[40:43], v[168:171]
	buffer_load_dwordx4 v4, s[28:31], s63 offen offset:2048 lds
	v_mfma_f32_16x16x32_bf16 v[172:175], a[8:11], a[44:47], v[172:175]
	v_mfma_f32_16x16x32_bf16 v[176:179], a[12:15], a[32:35], v[176:179]
	v_mfma_f32_16x16x32_bf16 v[180:183], a[12:15], a[36:39], v[180:183]
	v_mfma_f32_16x16x32_bf16 v[184:187], a[12:15], a[40:43], v[184:187]
	buffer_load_dwordx4 v5, s[28:31], s63 offen offset:3072 lds
	v_mfma_f32_16x16x32_bf16 v[188:191], a[12:15], a[44:47], v[188:191]
	s_waitcnt vmcnt(16) lgkmcnt(0)
	s_nop 0
	v_mfma_f32_16x16x32_bf16 v[128:131], a[16:19], a[48:51], v[128:131]
	s_add_u32 s63, s72, 163840
	v_mfma_f32_16x16x32_bf16 v[132:135], a[16:19], a[52:55], v[132:135]
	s_add_u32 m0, s68, 147456
	v_mfma_f32_16x16x32_bf16 v[136:139], a[16:19], a[56:59], v[136:139]
	buffer_load_dwordx4 v2, s[28:31], s63 offen offset:0 lds
	v_mfma_f32_16x16x32_bf16 v[140:143], a[16:19], a[60:63], v[140:143]
	s_waitcnt vmcnt(13)
	s_nop 0
	ds_read_b64_tr_b16 a[124:125], v8 offset:0
	ds_read_b64_tr_b16 a[126:127], v8 offset:2048
	v_mfma_f32_16x16x32_bf16 v[144:147], a[20:23], a[48:51], v[144:147]
	ds_read_b64_tr_b16 a[128:129], v9 offset:0
	ds_read_b64_tr_b16 a[130:131], v9 offset:2048
	v_mfma_f32_16x16x32_bf16 v[148:151], a[20:23], a[52:55], v[148:151]
	ds_read_b64_tr_b16 a[132:133], v10 offset:0
	ds_read_b64_tr_b16 a[134:135], v10 offset:2048
	v_mfma_f32_16x16x32_bf16 v[152:155], a[20:23], a[56:59], v[152:155]
	buffer_load_dwordx4 v3, s[28:31], s63 offen offset:1024 lds
	v_mfma_f32_16x16x32_bf16 v[156:159], a[20:23], a[60:63], v[156:159]
	ds_read_b64_tr_b16 a[136:137], v11 offset:0
	ds_read_b64_tr_b16 a[138:139], v11 offset:2048
	v_mfma_f32_16x16x32_bf16 v[160:163], a[24:27], a[48:51], v[160:163]
	ds_read_b64_tr_b16 a[140:141], v8 offset:16384
	ds_read_b64_tr_b16 a[142:143], v8 offset:18432
	v_mfma_f32_16x16x32_bf16 v[164:167], a[24:27], a[52:55], v[164:167]
	ds_read_b64_tr_b16 a[144:145], v9 offset:16384
	ds_read_b64_tr_b16 a[146:147], v9 offset:18432
	v_mfma_f32_16x16x32_bf16 v[168:171], a[24:27], a[56:59], v[168:171]
	buffer_load_dwordx4 v4, s[28:31], s63 offen offset:2048 lds
	v_mfma_f32_16x16x32_bf16 v[172:175], a[24:27], a[60:63], v[172:175]
	ds_read_b64_tr_b16 a[148:149], v10 offset:16384
	ds_read_b64_tr_b16 a[150:151], v10 offset:18432
	v_mfma_f32_16x16x32_bf16 v[176:179], a[28:31], a[48:51], v[176:179]
	ds_read_b64_tr_b16 a[152:153], v11 offset:16384
	ds_read_b64_tr_b16 a[154:155], v11 offset:18432
	v_mfma_f32_16x16x32_bf16 v[180:183], a[28:31], a[52:55], v[180:183]
	v_mfma_f32_16x16x32_bf16 v[184:187], a[28:31], a[56:59], v[184:187]
	buffer_load_dwordx4 v5, s[28:31], s63 offen offset:3072 lds
	v_mfma_f32_16x16x32_bf16 v[188:191], a[28:31], a[60:63], v[188:191]
	s_nop 2
	s_nop 0
	v_pk_mul_f32 v[192:193], v[128:129], v[128:129]
	v_pk_mul_f32 v[194:195], v[130:131], v[130:131]
	v_pk_mul_f32 v[196:197], v[144:145], v[144:145]
	v_pk_mul_f32 v[198:199], v[146:147], v[146:147]
	v_pk_fma_f32 v[192:193], v[192:193], s[80:81], s[80:81] op_sel:[0,0,1] op_sel_hi:[1,0,1]
	v_pk_fma_f32 v[194:195], v[194:195], s[80:81], s[80:81] op_sel:[0,0,1] op_sel_hi:[1,0,1]
	v_pk_fma_f32 v[196:197], v[196:197], s[80:81], s[80:81] op_sel:[0,0,1] op_sel_hi:[1,0,1]
	v_pk_fma_f32 v[198:199], v[198:199], s[80:81], s[80:81] op_sel:[0,0,1] op_sel_hi:[1,0,1]
	v_pk_mul_f32 v[192:193], v[192:193], v[128:129]
	v_pk_mul_f32 v[194:195], v[194:195], v[130:131]
	v_pk_mul_f32 v[196:197], v[196:197], v[144:145]
	v_pk_mul_f32 v[198:199], v[198:199], v[146:147]
	v_exp_f32 v192, v192
	v_exp_f32 v193, v193
	v_exp_f32 v194, v194
	v_exp_f32 v195, v195
	v_exp_f32 v196, v196
	v_exp_f32 v197, v197
	v_exp_f32 v198, v198
	v_exp_f32_e64 v199, v199
	s_waitcnt lgkmcnt(0)
	s_add_u32 s63, s72, 196608
	s_add_u32 m0, s68, 0
	s_nop 0
	buffer_load_dwordx4 v2, s[28:31], s63 offen offset:0 lds
	v_pk_add_f32 v[192:193], v[192:193], 1.0 op_sel_hi:[1,0]
	v_pk_add_f32 v[194:195], v[194:195], 1.0 op_sel_hi:[1,0]
	v_pk_add_f32 v[196:197], v[196:197], 1.0 op_sel_hi:[1,0]
	v_pk_add_f32 v[198:199], v[198:199], 1.0 op_sel_hi:[1,0]
	v_rcp_f32 v192, v192
	v_rcp_f32 v193, v193
	v_rcp_f32 v194, v194
	v_rcp_f32 v195, v195
	v_rcp_f32 v196, v196
	v_rcp_f32 v197, v197
	v_rcp_f32 v198, v198
	v_rcp_f32 v199, v199
	buffer_load_dwordx4 v3, s[28:31], s63 offen offset:1024 lds
	v_pk_mul_f32 v[128:129], v[192:193], v[128:129]
	v_pk_mul_f32 v[130:131], v[194:195], v[130:131]
	v_pk_mul_f32 v[144:145], v[196:197], v[144:145]
	v_pk_mul_f32 v[146:147], v[198:199], v[146:147]
	v_cvt_pk_bf16_f32 v128, v128, v129
	v_cvt_pk_bf16_f32 v129, v130, v131
	v_cvt_pk_bf16_f32 v130, v144, v145
	v_cvt_pk_bf16_f32 v131, v146, v147
	s_barrier
	s_nop 0
	ds_write_b128 v28, v[128:131] offset:0
	v_pk_mul_f32 v[200:201], v[160:161], v[160:161]
	v_pk_mul_f32 v[202:203], v[162:163], v[162:163]
	v_pk_mul_f32 v[204:205], v[176:177], v[176:177]
	v_pk_mul_f32 v[206:207], v[178:179], v[178:179]
	v_pk_fma_f32 v[200:201], v[200:201], s[80:81], s[80:81] op_sel:[0,0,1] op_sel_hi:[1,0,1]
	v_pk_fma_f32 v[202:203], v[202:203], s[80:81], s[80:81] op_sel:[0,0,1] op_sel_hi:[1,0,1]
	v_pk_fma_f32 v[204:205], v[204:205], s[80:81], s[80:81] op_sel:[0,0,1] op_sel_hi:[1,0,1]
	v_pk_fma_f32 v[206:207], v[206:207], s[80:81], s[80:81] op_sel:[0,0,1] op_sel_hi:[1,0,1]
	v_pk_mul_f32 v[200:201], v[200:201], v[160:161]
	v_pk_mul_f32 v[202:203], v[202:203], v[162:163]
	v_pk_mul_f32 v[204:205], v[204:205], v[176:177]
	v_pk_mul_f32 v[206:207], v[206:207], v[178:179]
	v_exp_f32 v200, v200
	v_exp_f32 v201, v201
	v_exp_f32 v202, v202
	v_exp_f32 v203, v203
	v_exp_f32 v204, v204
	v_exp_f32 v205, v205
	v_exp_f32 v206, v206
	v_exp_f32 v207, v207
	buffer_load_dwordx4 v4, s[28:31], s63 offen offset:2048 lds
	v_pk_add_f32 v[200:201], v[200:201], 1.0 op_sel_hi:[1,0]
	v_pk_add_f32 v[202:203], v[202:203], 1.0 op_sel_hi:[1,0]
	v_pk_add_f32 v[204:205], v[204:205], 1.0 op_sel_hi:[1,0]
	v_pk_add_f32 v[206:207], v[206:207], 1.0 op_sel_hi:[1,0]
	v_rcp_f32 v200, v200
	v_rcp_f32 v201, v201
	v_rcp_f32 v202, v202
	v_rcp_f32 v203, v203
	v_rcp_f32 v204, v204
	v_rcp_f32 v205, v205
	v_rcp_f32 v206, v206
	v_rcp_f32 v207, v207
	buffer_load_dwordx4 v5, s[28:31], s63 offen offset:3072 lds
	v_pk_mul_f32 v[160:161], v[200:201], v[160:161]
	v_pk_mul_f32 v[162:163], v[202:203], v[162:163]
	v_pk_mul_f32 v[176:177], v[204:205], v[176:177]
	v_pk_mul_f32 v[178:179], v[206:207], v[178:179]
	v_cvt_pk_bf16_f32 v160, v160, v161
	v_cvt_pk_bf16_f32 v161, v162, v163
	v_cvt_pk_bf16_f32 v162, v176, v177
	v_cvt_pk_bf16_f32 v163, v178, v179
	ds_write_b128 v28, v[160:163] offset:4096
	v_pk_mul_f32 v[192:193], v[132:133], v[132:133]
	v_pk_mul_f32 v[194:195], v[134:135], v[134:135]
	v_pk_mul_f32 v[196:197], v[148:149], v[148:149]
	v_pk_mul_f32 v[198:199], v[150:151], v[150:151]
	v_pk_fma_f32 v[192:193], v[192:193], s[80:81], s[80:81] op_sel:[0,0,1] op_sel_hi:[1,0,1]
	v_pk_fma_f32 v[194:195], v[194:195], s[80:81], s[80:81] op_sel:[0,0,1] op_sel_hi:[1,0,1]
	v_pk_fma_f32 v[196:197], v[196:197], s[80:81], s[80:81] op_sel:[0,0,1] op_sel_hi:[1,0,1]
	v_pk_fma_f32 v[198:199], v[198:199], s[80:81], s[80:81] op_sel:[0,0,1] op_sel_hi:[1,0,1]
	v_pk_mul_f32 v[192:193], v[192:193], v[132:133]
	v_pk_mul_f32 v[194:195], v[194:195], v[134:135]
	v_pk_mul_f32 v[196:197], v[196:197], v[148:149]
	v_pk_mul_f32 v[198:199], v[198:199], v[150:151]
	v_exp_f32 v192, v192
	v_exp_f32 v193, v193
	v_exp_f32 v194, v194
	v_exp_f32 v195, v195
	v_exp_f32 v196, v196
	v_exp_f32 v197, v197
	v_exp_f32 v198, v198
	v_exp_f32 v199, v199
	s_add_u32 s63, s72, 128
	s_add_u32 m0, s68, 16384
	s_nop 0
	s_nop 0
	buffer_load_dwordx4 v2, s[28:31], s63 offen offset:0 lds
	v_pk_add_f32 v[192:193], v[192:193], 1.0 op_sel_hi:[1,0]
	v_pk_add_f32 v[194:195], v[194:195], 1.0 op_sel_hi:[1,0]
	v_pk_add_f32 v[196:197], v[196:197], 1.0 op_sel_hi:[1,0]
	v_pk_add_f32 v[198:199], v[198:199], 1.0 op_sel_hi:[1,0]
	v_rcp_f32 v192, v192
	v_rcp_f32 v193, v193
	v_rcp_f32 v194, v194
	v_rcp_f32 v195, v195
	v_rcp_f32 v196, v196
	v_rcp_f32 v197, v197
	v_rcp_f32 v198, v198
	v_rcp_f32 v199, v199
	buffer_load_dwordx4 v3, s[28:31], s63 offen offset:1024 lds
	v_pk_mul_f32 v[132:133], v[192:193], v[132:133]
	v_pk_mul_f32 v[134:135], v[194:195], v[134:135]
	v_pk_mul_f32 v[148:149], v[196:197], v[148:149]
	v_pk_mul_f32 v[150:151], v[198:199], v[150:151]
	v_cvt_pk_bf16_f32 v132, v132, v133
	v_cvt_pk_bf16_f32 v133, v134, v135
	v_cvt_pk_bf16_f32 v134, v148, v149
	v_cvt_pk_bf16_f32 v135, v150, v151
	ds_write_b128 v28, v[132:135] offset:1024
	v_pk_mul_f32 v[200:201], v[164:165], v[164:165]
	v_pk_mul_f32 v[202:203], v[166:167], v[166:167]
	v_pk_mul_f32 v[204:205], v[180:181], v[180:181]
	v_pk_mul_f32 v[206:207], v[182:183], v[182:183]
	v_pk_fma_f32 v[200:201], v[200:201], s[80:81], s[80:81] op_sel:[0,0,1] op_sel_hi:[1,0,1]
	v_pk_fma_f32 v[202:203], v[202:203], s[80:81], s[80:81] op_sel:[0,0,1] op_sel_hi:[1,0,1]
	v_pk_fma_f32 v[204:205], v[204:205], s[80:81], s[80:81] op_sel:[0,0,1] op_sel_hi:[1,0,1]
	v_pk_fma_f32 v[206:207], v[206:207], s[80:81], s[80:81] op_sel:[0,0,1] op_sel_hi:[1,0,1]
	v_pk_mul_f32 v[200:201], v[200:201], v[164:165]
	v_pk_mul_f32 v[202:203], v[202:203], v[166:167]
	v_pk_mul_f32 v[204:205], v[204:205], v[180:181]
	v_pk_mul_f32 v[206:207], v[206:207], v[182:183]
	v_exp_f32 v200, v200
	v_exp_f32 v201, v201
	v_exp_f32 v202, v202
	v_exp_f32 v203, v203
	v_exp_f32 v204, v204
	v_exp_f32 v205, v205
	v_exp_f32 v206, v206
	v_exp_f32 v207, v207
	buffer_load_dwordx4 v4, s[28:31], s63 offen offset:2048 lds
	v_pk_add_f32 v[200:201], v[200:201], 1.0 op_sel_hi:[1,0]
	v_pk_add_f32 v[202:203], v[202:203], 1.0 op_sel_hi:[1,0]
	v_pk_add_f32 v[204:205], v[204:205], 1.0 op_sel_hi:[1,0]
	v_pk_add_f32 v[206:207], v[206:207], 1.0 op_sel_hi:[1,0]
	v_rcp_f32 v200, v200
	v_rcp_f32 v201, v201
	v_rcp_f32 v202, v202
	v_rcp_f32 v203, v203
	v_rcp_f32 v204, v204
	v_rcp_f32 v205, v205
	v_rcp_f32 v206, v206
	v_rcp_f32 v207, v207
	buffer_load_dwordx4 v5, s[28:31], s63 offen offset:3072 lds
	v_pk_mul_f32 v[164:165], v[200:201], v[164:165]
	v_pk_mul_f32 v[166:167], v[202:203], v[166:167]
	v_pk_mul_f32 v[180:181], v[204:205], v[180:181]
	v_pk_mul_f32 v[182:183], v[206:207], v[182:183]
	v_cvt_pk_bf16_f32 v164, v164, v165
	v_cvt_pk_bf16_f32 v165, v166, v167
	v_cvt_pk_bf16_f32 v166, v180, v181
	v_cvt_pk_bf16_f32 v167, v182, v183
	ds_write_b128 v28, v[164:167] offset:5120
	s_waitcnt lgkmcnt(0)
	s_barrier
	ds_read_b128 a[32:35], v7 offset:0
	ds_read_b128 a[36:39], v7 offset:1024
	s_waitcnt lgkmcnt(0)
	s_nop 0
	v_mfma_f32_16x16x32_bf16 v[128:131], a[124:127], a[32:35], 0
	ds_read_b128 a[48:51], v7 offset:4096
	ds_read_b128 a[52:55], v7 offset:5120
	v_mfma_f32_16x16x32_bf16 v[132:135], a[124:127], a[36:39], 0
	v_mfma_f32_16x16x32_bf16 v[144:147], a[128:131], a[32:35], 0
	v_mfma_f32_16x16x32_bf16 v[148:151], a[128:131], a[36:39], 0
	v_mfma_f32_16x16x32_bf16 v[160:163], a[132:135], a[32:35], 0
	v_mfma_f32_16x16x32_bf16 v[164:167], a[132:135], a[36:39], 0
	v_mfma_f32_16x16x32_bf16 v[176:179], a[136:139], a[32:35], 0
	v_mfma_f32_16x16x32_bf16 v[180:183], a[136:139], a[36:39], 0
	s_waitcnt lgkmcnt(0)
	s_nop 0
	v_mfma_f32_16x16x32_bf16 v[128:131], a[140:143], a[48:51], v[128:131]
	s_waitcnt vmcnt(20)
	s_nop 0
	ds_read_b64_tr_b16 a[160:161], v8 offset:32768
	ds_read_b64_tr_b16 a[162:163], v8 offset:34816
	v_mfma_f32_16x16x32_bf16 v[132:135], a[140:143], a[52:55], v[132:135]
	ds_read_b64_tr_b16 a[164:165], v9 offset:32768
	ds_read_b64_tr_b16 a[166:167], v9 offset:34816
	v_mfma_f32_16x16x32_bf16 v[144:147], a[144:147], a[48:51], v[144:147]
	v_mfma_f32_16x16x32_bf16 v[148:151], a[144:147], a[52:55], v[148:151]
	ds_read_b64_tr_b16 a[168:169], v10 offset:32768
	ds_read_b64_tr_b16 a[170:171], v10 offset:34816
	v_mfma_f32_16x16x32_bf16 v[160:163], a[148:151], a[48:51], v[160:163]
	ds_read_b64_tr_b16 a[172:173], v11 offset:32768
	ds_read_b64_tr_b16 a[174:175], v11 offset:34816
	v_mfma_f32_16x16x32_bf16 v[164:167], a[148:151], a[52:55], v[164:167]
	ds_read_b128 a[32:35], v7 offset:8192
	ds_read_b128 a[36:39], v7 offset:9216
	v_mfma_f32_16x16x32_bf16 v[176:179], a[152:155], a[48:51], v[176:179]
	v_mfma_f32_16x16x32_bf16 v[180:183], a[152:155], a[52:55], v[180:183]
	s_waitcnt lgkmcnt(0)
	s_nop 0
	v_mfma_f32_16x16x32_bf16 v[128:131], a[160:163], a[32:35], v[128:131]
	s_add_u32 s63, s72, 32896
	s_waitcnt vmcnt(16)
	s_nop 0
	ds_read_b64_tr_b16 a[176:177], v8 offset:49152
	ds_read_b64_tr_b16 a[178:179], v8 offset:51200
	v_mfma_f32_16x16x32_bf16 v[132:135], a[160:163], a[36:39], v[132:135]
	s_add_u32 m0, s68, 32768
	ds_read_b64_tr_b16 a[180:181], v9 offset:49152
	ds_read_b64_tr_b16 a[182:183], v9 offset:51200
	v_mfma_f32_16x16x32_bf16 v[144:147], a[164:167], a[32:35], v[144:147]
	buffer_load_dwordx4 v2, s[28:31], s63 offen offset:0 lds
	v_mfma_f32_16x16x32_bf16 v[148:151], a[164:167], a[36:39], v[148:151]
	ds_read_b64_tr_b16 a[184:185], v10 offset:49152
	ds_read_b64_tr_b16 a[186:187], v10 offset:51200
	v_mfma_f32_16x16x32_bf16 v[160:163], a[168:171], a[32:35], v[160:163]
	ds_read_b64_tr_b16 a[188:189], v11 offset:49152
	ds_read_b64_tr_b16 a[190:191], v11 offset:51200
	v_mfma_f32_16x16x32_bf16 v[164:167], a[168:171], a[36:39], v[164:167]
	ds_read_b128 a[48:51], v7 offset:12288
	ds_read_b128 a[52:55], v7 offset:13312
	v_mfma_f32_16x16x32_bf16 v[176:179], a[172:175], a[32:35], v[176:179]
	buffer_load_dwordx4 v3, s[28:31], s63 offen offset:1024 lds
	v_mfma_f32_16x16x32_bf16 v[180:183], a[172:175], a[36:39], v[180:183]
	s_waitcnt lgkmcnt(0)
	s_nop 0
	v_mfma_f32_16x16x32_bf16 v[128:131], a[176:179], a[48:51], v[128:131]
	s_waitcnt vmcnt(14)
	s_nop 0
	ds_read_b64_tr_b16 a[0:1], v12 offset:0
	ds_read_b64_tr_b16 a[2:3], v12 offset:2048
	v_mfma_f32_16x16x32_bf16 v[132:135], a[176:179], a[52:55], v[132:135]
	ds_read_b64_tr_b16 a[4:5], v13 offset:0
	ds_read_b64_tr_b16 a[6:7], v13 offset:2048
	v_mfma_f32_16x16x32_bf16 v[144:147], a[180:183], a[48:51], v[144:147]
	buffer_load_dwordx4 v4, s[28:31], s63 offen offset:2048 lds
	v_mfma_f32_16x16x32_bf16 v[148:151], a[180:183], a[52:55], v[148:151]
	ds_read_b64_tr_b16 a[8:9], v14 offset:0
	ds_read_b64_tr_b16 a[10:11], v14 offset:2048
	v_mfma_f32_16x16x32_bf16 v[160:163], a[184:187], a[48:51], v[160:163]
	ds_read_b64_tr_b16 a[12:13], v15 offset:0
	ds_read_b64_tr_b16 a[14:15], v15 offset:2048
	v_mfma_f32_16x16x32_bf16 v[164:167], a[184:187], a[52:55], v[164:167]
	ds_read_b128 a[32:35], v7 offset:16384
	ds_read_b128 a[36:39], v7 offset:17408
	v_mfma_f32_16x16x32_bf16 v[176:179], a[188:191], a[48:51], v[176:179]
	buffer_load_dwordx4 v5, s[28:31], s63 offen offset:3072 lds
	v_mfma_f32_16x16x32_bf16 v[180:183], a[188:191], a[52:55], v[180:183]
	s_waitcnt lgkmcnt(0)
	s_nop 0
	v_mfma_f32_16x16x32_bf16 v[128:131], a[0:3], a[32:35], v[128:131]
	s_add_u32 s63, s72, 65664
	s_waitcnt vmcnt(12)
	s_nop 0
	ds_read_b64_tr_b16 a[16:17], v12 offset:16384
	ds_read_b64_tr_b16 a[18:19], v12 offset:18432
	v_mfma_f32_16x16x32_bf16 v[132:135], a[0:3], a[36:39], v[132:135]
	s_add_u32 m0, s68, 49152
	ds_read_b64_tr_b16 a[20:21], v13 offset:16384
	ds_read_b64_tr_b16 a[22:23], v13 offset:18432
	v_mfma_f32_16x16x32_bf16 v[144:147], a[4:7], a[32:35], v[144:147]
	buffer_load_dwordx4 v2, s[28:31], s63 offen offset:0 lds
	v_mfma_f32_16x16x32_bf16 v[148:151], a[4:7], a[36:39], v[148:151]
	ds_read_b64_tr_b16 a[24:25], v14 offset:16384
	ds_read_b64_tr_b16 a[26:27], v14 offset:18432
	v_mfma_f32_16x16x32_bf16 v[160:163], a[8:11], a[32:35], v[160:163]
	ds_read_b64_tr_b16 a[28:29], v15 offset:16384
	ds_read_b64_tr_b16 a[30:31], v15 offset:18432
	v_mfma_f32_16x16x32_bf16 v[164:167], a[8:11], a[36:39], v[164:167]
	ds_read_b128 a[48:51], v7 offset:20480
	ds_read_b128 a[52:55], v7 offset:21504
	v_mfma_f32_16x16x32_bf16 v[176:179], a[12:15], a[32:35], v[176:179]
	buffer_load_dwordx4 v3, s[28:31], s63 offen offset:1024 lds
	v_mfma_f32_16x16x32_bf16 v[180:183], a[12:15], a[36:39], v[180:183]
	s_waitcnt lgkmcnt(0)
	s_nop 0
	v_mfma_f32_16x16x32_bf16 v[128:131], a[16:19], a[48:51], v[128:131]
	s_waitcnt vmcnt(10)
	s_nop 0
	ds_read_b64_tr_b16 a[192:193], v8 offset:0
	ds_read_b64_tr_b16 a[194:195], v8 offset:2048
	v_mfma_f32_16x16x32_bf16 v[132:135], a[16:19], a[52:55], v[132:135]
	ds_read_b64_tr_b16 a[196:197], v9 offset:0
	ds_read_b64_tr_b16 a[198:199], v9 offset:2048
	v_mfma_f32_16x16x32_bf16 v[144:147], a[20:23], a[48:51], v[144:147]
	buffer_load_dwordx4 v4, s[28:31], s63 offen offset:2048 lds
	v_mfma_f32_16x16x32_bf16 v[148:151], a[20:23], a[52:55], v[148:151]
	ds_read_b64_tr_b16 a[200:201], v10 offset:0
	ds_read_b64_tr_b16 a[202:203], v10 offset:2048
	v_mfma_f32_16x16x32_bf16 v[160:163], a[24:27], a[48:51], v[160:163]
	ds_read_b64_tr_b16 a[204:205], v11 offset:0
	ds_read_b64_tr_b16 a[206:207], v11 offset:2048
	v_mfma_f32_16x16x32_bf16 v[164:167], a[24:27], a[52:55], v[164:167]
	ds_read_b128 a[32:35], v7 offset:24576
	ds_read_b128 a[36:39], v7 offset:25600
	v_mfma_f32_16x16x32_bf16 v[176:179], a[28:31], a[48:51], v[176:179]
	buffer_load_dwordx4 v5, s[28:31], s63 offen offset:3072 lds
	v_mfma_f32_16x16x32_bf16 v[180:183], a[28:31], a[52:55], v[180:183]
	s_waitcnt lgkmcnt(0)
	s_nop 0
	v_mfma_f32_16x16x32_bf16 v[128:131], a[192:195], a[32:35], v[128:131]
	s_add_u32 s63, s72, 98432
	v_mfma_f32_16x16x32_bf16 v[132:135], a[192:195], a[36:39], v[132:135]
	s_add_u32 m0, s68, 131072
	v_mfma_f32_16x16x32_bf16 v[144:147], a[196:199], a[32:35], v[144:147]
	buffer_load_dwordx4 v2, s[28:31], s63 offen offset:0 lds
	v_mfma_f32_16x16x32_bf16 v[148:151], a[196:199], a[36:39], v[148:151]
	v_mfma_f32_16x16x32_bf16 v[160:163], a[200:203], a[32:35], v[160:163]
	v_mfma_f32_16x16x32_bf16 v[164:167], a[200:203], a[36:39], v[164:167]
	v_mfma_f32_16x16x32_bf16 v[176:179], a[204:207], a[32:35], v[176:179]
	buffer_load_dwordx4 v3, s[28:31], s63 offen offset:1024 lds
	v_mfma_f32_16x16x32_bf16 v[180:183], a[204:207], a[36:39], v[180:183]
	s_nop 3
	s_nop 0
	v_pk_mul_f32 v[192:193], v[136:137], v[136:137]
	v_pk_mul_f32 v[194:195], v[138:139], v[138:139]
	v_pk_mul_f32 v[196:197], v[152:153], v[152:153]
	v_pk_mul_f32 v[198:199], v[154:155], v[154:155]
	v_pk_fma_f32 v[192:193], v[192:193], s[80:81], s[80:81] op_sel:[0,0,1] op_sel_hi:[1,0,1]
	v_pk_fma_f32 v[194:195], v[194:195], s[80:81], s[80:81] op_sel:[0,0,1] op_sel_hi:[1,0,1]
	v_pk_fma_f32 v[196:197], v[196:197], s[80:81], s[80:81] op_sel:[0,0,1] op_sel_hi:[1,0,1]
	v_pk_fma_f32 v[198:199], v[198:199], s[80:81], s[80:81] op_sel:[0,0,1] op_sel_hi:[1,0,1]
	v_pk_mul_f32 v[192:193], v[192:193], v[136:137]
	v_pk_mul_f32 v[194:195], v[194:195], v[138:139]
	v_pk_mul_f32 v[196:197], v[196:197], v[152:153]
	v_pk_mul_f32 v[198:199], v[198:199], v[154:155]
	v_exp_f32 v192, v192
	v_exp_f32 v193, v193
	v_exp_f32 v194, v194
	v_exp_f32 v195, v195
	v_exp_f32 v196, v196
	v_exp_f32 v197, v197
	v_exp_f32 v198, v198
	v_exp_f32 v199, v199
	s_add_u32 s75, s66, 18432
	v_cvt_pk_bf16_f32 v128, v128, v129
	v_cvt_pk_bf16_f32 v129, v130, v131
	v_cvt_pk_bf16_f32 v130, v144, v145
	v_cvt_pk_bf16_f32 v131, v146, v147
	buffer_store_dwordx4 v[128:131], v21, s[32:35], s75 offen offset:0 sc1
	v_pk_add_f32 v[192:193], v[192:193], 1.0 op_sel_hi:[1,0]
	v_pk_add_f32 v[194:195], v[194:195], 1.0 op_sel_hi:[1,0]
	v_pk_add_f32 v[196:197], v[196:197], 1.0 op_sel_hi:[1,0]
	v_pk_add_f32 v[198:199], v[198:199], 1.0 op_sel_hi:[1,0]
	v_rcp_f32 v192, v192
	v_rcp_f32 v193, v193
	v_rcp_f32 v194, v194
	v_rcp_f32 v195, v195
	v_rcp_f32 v196, v196
	v_rcp_f32 v197, v197
	v_rcp_f32 v198, v198
	v_rcp_f32 v199, v199
	buffer_load_dwordx4 v4, s[28:31], s63 offen offset:2048 lds
	v_pk_mul_f32 v[136:137], v[192:193], v[136:137]
	v_pk_mul_f32 v[138:139], v[194:195], v[138:139]
	v_pk_mul_f32 v[152:153], v[196:197], v[152:153]
	v_pk_mul_f32 v[154:155], v[198:199], v[154:155]
	v_cvt_pk_bf16_f32 v136, v136, v137
	v_cvt_pk_bf16_f32 v137, v138, v139
	v_cvt_pk_bf16_f32 v138, v152, v153
	v_cvt_pk_bf16_f32 v139, v154, v155
	ds_write_b128 v28, v[136:139] offset:2048
	v_pk_mul_f32 v[200:201], v[168:169], v[168:169]
	v_pk_mul_f32 v[202:203], v[170:171], v[170:171]
	v_pk_mul_f32 v[204:205], v[184:185], v[184:185]
	v_pk_mul_f32 v[206:207], v[186:187], v[186:187]
	v_pk_fma_f32 v[200:201], v[200:201], s[80:81], s[80:81] op_sel:[0,0,1] op_sel_hi:[1,0,1]
	v_pk_fma_f32 v[202:203], v[202:203], s[80:81], s[80:81] op_sel:[0,0,1] op_sel_hi:[1,0,1]
	v_pk_fma_f32 v[204:205], v[204:205], s[80:81], s[80:81] op_sel:[0,0,1] op_sel_hi:[1,0,1]
	v_pk_fma_f32 v[206:207], v[206:207], s[80:81], s[80:81] op_sel:[0,0,1] op_sel_hi:[1,0,1]
	v_pk_mul_f32 v[200:201], v[200:201], v[168:169]
	v_pk_mul_f32 v[202:203], v[202:203], v[170:171]
	v_pk_mul_f32 v[204:205], v[204:205], v[184:185]
	v_pk_mul_f32 v[206:207], v[206:207], v[186:187]
	v_exp_f32 v200, v200
	v_exp_f32 v201, v201
	v_exp_f32 v202, v202
	v_exp_f32 v203, v203
	v_exp_f32 v204, v204
	v_exp_f32 v205, v205
	v_exp_f32 v206, v206
	v_exp_f32 v207, v207
	v_cvt_pk_bf16_f32 v160, v160, v161
	v_cvt_pk_bf16_f32 v161, v162, v163
	v_cvt_pk_bf16_f32 v162, v176, v177
	v_cvt_pk_bf16_f32 v163, v178, v179
	buffer_store_dwordx4 v[160:163], v21, s[32:35], s75 offen offset:1024 sc1
	v_pk_add_f32 v[200:201], v[200:201], 1.0 op_sel_hi:[1,0]
	v_pk_add_f32 v[202:203], v[202:203], 1.0 op_sel_hi:[1,0]
	v_pk_add_f32 v[204:205], v[204:205], 1.0 op_sel_hi:[1,0]
	v_pk_add_f32 v[206:207], v[206:207], 1.0 op_sel_hi:[1,0]
	v_rcp_f32 v200, v200
	v_rcp_f32 v201, v201
	v_rcp_f32 v202, v202
	v_rcp_f32 v203, v203
	v_rcp_f32 v204, v204
	v_rcp_f32 v205, v205
	v_rcp_f32 v206, v206
	v_rcp_f32 v207, v207
	buffer_load_dwordx4 v5, s[28:31], s63 offen offset:3072 lds
	v_pk_mul_f32 v[168:169], v[200:201], v[168:169]
	v_pk_mul_f32 v[170:171], v[202:203], v[170:171]
	v_pk_mul_f32 v[184:185], v[204:205], v[184:185]
	v_pk_mul_f32 v[186:187], v[206:207], v[186:187]
	v_cvt_pk_bf16_f32 v168, v168, v169
	v_cvt_pk_bf16_f32 v169, v170, v171
	v_cvt_pk_bf16_f32 v170, v184, v185
	v_cvt_pk_bf16_f32 v171, v186, v187
	ds_write_b128 v28, v[168:171] offset:6144
	v_pk_mul_f32 v[192:193], v[140:141], v[140:141]
	v_pk_mul_f32 v[194:195], v[142:143], v[142:143]
	v_pk_mul_f32 v[196:197], v[156:157], v[156:157]
	v_pk_mul_f32 v[198:199], v[158:159], v[158:159]
	v_pk_fma_f32 v[192:193], v[192:193], s[80:81], s[80:81] op_sel:[0,0,1] op_sel_hi:[1,0,1]
	v_pk_fma_f32 v[194:195], v[194:195], s[80:81], s[80:81] op_sel:[0,0,1] op_sel_hi:[1,0,1]
	v_pk_fma_f32 v[196:197], v[196:197], s[80:81], s[80:81] op_sel:[0,0,1] op_sel_hi:[1,0,1]
	v_pk_fma_f32 v[198:199], v[198:199], s[80:81], s[80:81] op_sel:[0,0,1] op_sel_hi:[1,0,1]
	v_pk_mul_f32 v[192:193], v[192:193], v[140:141]
	v_pk_mul_f32 v[194:195], v[194:195], v[142:143]
	v_pk_mul_f32 v[196:197], v[196:197], v[156:157]
	v_pk_mul_f32 v[198:199], v[198:199], v[158:159]
	v_exp_f32 v192, v192
	v_exp_f32 v193, v193
	v_exp_f32 v194, v194
	v_exp_f32 v195, v195
	v_exp_f32 v196, v196
	v_exp_f32 v197, v197
	v_exp_f32 v198, v198
	v_exp_f32 v199, v199
	v_cvt_pk_bf16_f32 v132, v132, v133
	v_cvt_pk_bf16_f32 v133, v134, v135
	v_cvt_pk_bf16_f32 v134, v148, v149
	v_cvt_pk_bf16_f32 v135, v150, v151
	buffer_store_dwordx4 v[132:135], v21, s[32:35], s75 offen offset:2048 sc1
	v_cvt_pk_bf16_f32 v164, v164, v165
	v_pk_add_f32 v[192:193], v[192:193], 1.0 op_sel_hi:[1,0]
	v_pk_add_f32 v[194:195], v[194:195], 1.0 op_sel_hi:[1,0]
	v_pk_add_f32 v[196:197], v[196:197], 1.0 op_sel_hi:[1,0]
	v_pk_add_f32 v[198:199], v[198:199], 1.0 op_sel_hi:[1,0]
	v_rcp_f32 v192, v192
	v_rcp_f32 v193, v193
	v_rcp_f32 v194, v194
	v_rcp_f32 v195, v195
	v_rcp_f32 v196, v196
	v_rcp_f32 v197, v197
	v_rcp_f32 v198, v198
	v_rcp_f32 v199, v199
	s_add_u32 s63, s72, 131200
	s_add_u32 m0, s68, 147456
	s_nop 0
	s_nop 0
	buffer_load_dwordx4 v2, s[28:31], s63 offen offset:0 lds
	v_pk_mul_f32 v[140:141], v[192:193], v[140:141]
	v_pk_mul_f32 v[142:143], v[194:195], v[142:143]
	v_pk_mul_f32 v[156:157], v[196:197], v[156:157]
	v_pk_mul_f32 v[158:159], v[198:199], v[158:159]
	v_cvt_pk_bf16_f32 v140, v140, v141
	v_cvt_pk_bf16_f32 v141, v142, v143
	v_cvt_pk_bf16_f32 v142, v156, v157
	v_cvt_pk_bf16_f32 v143, v158, v159
	ds_write_b128 v28, v[140:143] offset:3072
	v_pk_mul_f32 v[200:201], v[172:173], v[172:173]
	v_pk_mul_f32 v[202:203], v[174:175], v[174:175]
	v_pk_mul_f32 v[204:205], v[188:189], v[188:189]
	v_pk_mul_f32 v[206:207], v[190:191], v[190:191]
	v_pk_fma_f32 v[200:201], v[200:201], s[80:81], s[80:81] op_sel:[0,0,1] op_sel_hi:[1,0,1]
	v_pk_fma_f32 v[202:203], v[202:203], s[80:81], s[80:81] op_sel:[0,0,1] op_sel_hi:[1,0,1]
	v_pk_fma_f32 v[204:205], v[204:205], s[80:81], s[80:81] op_sel:[0,0,1] op_sel_hi:[1,0,1]
	v_pk_fma_f32 v[206:207], v[206:207], s[80:81], s[80:81] op_sel:[0,0,1] op_sel_hi:[1,0,1]
	v_pk_mul_f32 v[200:201], v[200:201], v[172:173]
	v_pk_mul_f32 v[202:203], v[202:203], v[174:175]
	v_pk_mul_f32 v[204:205], v[204:205], v[188:189]
	v_pk_mul_f32 v[206:207], v[206:207], v[190:191]
	v_exp_f32 v200, v200
	v_exp_f32 v201, v201
	v_exp_f32 v202, v202
	v_exp_f32 v203, v203
	v_exp_f32 v204, v204
	v_exp_f32 v205, v205
	v_exp_f32 v206, v206
	v_exp_f32 v207, v207
	v_cvt_pk_bf16_f32 v165, v166, v167
	v_cvt_pk_bf16_f32 v166, v180, v181
	v_cvt_pk_bf16_f32 v167, v182, v183
	buffer_store_dwordx4 v[164:167], v21, s[32:35], s75 offen offset:3072 sc1
	v_pk_add_f32 v[200:201], v[200:201], 1.0 op_sel_hi:[1,0]
	v_pk_add_f32 v[202:203], v[202:203], 1.0 op_sel_hi:[1,0]
	v_pk_add_f32 v[204:205], v[204:205], 1.0 op_sel_hi:[1,0]
	v_pk_add_f32 v[206:207], v[206:207], 1.0 op_sel_hi:[1,0]
	v_rcp_f32 v200, v200
	v_rcp_f32 v201, v201
	v_rcp_f32 v202, v202
	v_rcp_f32 v203, v203
	v_rcp_f32 v204, v204
	v_rcp_f32 v205, v205
	v_rcp_f32 v206, v206
	v_rcp_f32 v207, v207
	buffer_load_dwordx4 v3, s[28:31], s63 offen offset:1024 lds
	v_pk_mul_f32 v[172:173], v[200:201], v[172:173]
	v_pk_mul_f32 v[174:175], v[202:203], v[174:175]
	v_pk_mul_f32 v[188:189], v[204:205], v[188:189]
	v_pk_mul_f32 v[190:191], v[206:207], v[190:191]
	v_cvt_pk_bf16_f32 v172, v172, v173
	v_cvt_pk_bf16_f32 v173, v174, v175
	v_cvt_pk_bf16_f32 v174, v188, v189
	v_cvt_pk_bf16_f32 v175, v190, v191
	ds_write_b128 v28, v[172:175] offset:7168
	s_waitcnt lgkmcnt(0)
	s_barrier
	ds_read_b128 a[40:43], v7 offset:2048
	ds_read_b128 a[44:47], v7 offset:3072
	s_waitcnt lgkmcnt(0)
	s_nop 0
	v_mfma_f32_16x16x32_bf16 v[136:139], a[124:127], a[40:43], 0
	ds_read_b128 a[56:59], v7 offset:6144
	ds_read_b128 a[60:63], v7 offset:7168
	v_mfma_f32_16x16x32_bf16 v[140:143], a[124:127], a[44:47], 0
	v_mfma_f32_16x16x32_bf16 v[152:155], a[128:131], a[40:43], 0
	buffer_load_dwordx4 v4, s[28:31], s63 offen offset:2048 lds
	v_mfma_f32_16x16x32_bf16 v[156:159], a[128:131], a[44:47], 0
	v_mfma_f32_16x16x32_bf16 v[168:171], a[132:135], a[40:43], 0
	v_mfma_f32_16x16x32_bf16 v[172:175], a[132:135], a[44:47], 0
	v_mfma_f32_16x16x32_bf16 v[184:187], a[136:139], a[40:43], 0
	buffer_load_dwordx4 v5, s[28:31], s63 offen offset:3072 lds
	v_mfma_f32_16x16x32_bf16 v[188:191], a[136:139], a[44:47], 0
	s_waitcnt lgkmcnt(0)
	s_nop 0
	v_mfma_f32_16x16x32_bf16 v[136:139], a[140:143], a[56:59], v[136:139]
	s_add_u32 s63, s72, 163968
	ds_read_b128 a[40:43], v7 offset:10240
	ds_read_b128 a[44:47], v7 offset:11264
	v_mfma_f32_16x16x32_bf16 v[140:143], a[140:143], a[60:63], v[140:143]
	s_add_u32 m0, s68, 0
	s_nop 0
	v_mfma_f32_16x16x32_bf16 v[152:155], a[144:147], a[56:59], v[152:155]
	buffer_load_dwordx4 v2, s[28:31], s63 offen offset:0 lds
	v_mfma_f32_16x16x32_bf16 v[156:159], a[144:147], a[60:63], v[156:159]
	v_mfma_f32_16x16x32_bf16 v[168:171], a[148:151], a[56:59], v[168:171]
	v_mfma_f32_16x16x32_bf16 v[172:175], a[148:151], a[60:63], v[172:175]
	v_mfma_f32_16x16x32_bf16 v[184:187], a[152:155], a[56:59], v[184:187]
	buffer_load_dwordx4 v3, s[28:31], s63 offen offset:1024 lds
	v_mfma_f32_16x16x32_bf16 v[188:191], a[152:155], a[60:63], v[188:191]
	s_waitcnt lgkmcnt(0)
	s_nop 0
	v_mfma_f32_16x16x32_bf16 v[136:139], a[160:163], a[40:43], v[136:139]
	ds_read_b128 a[56:59], v7 offset:14336
	ds_read_b128 a[60:63], v7 offset:15360
	v_mfma_f32_16x16x32_bf16 v[140:143], a[160:163], a[44:47], v[140:143]
	v_mfma_f32_16x16x32_bf16 v[152:155], a[164:167], a[40:43], v[152:155]
	buffer_load_dwordx4 v4, s[28:31], s63 offen offset:2048 lds
	v_mfma_f32_16x16x32_bf16 v[156:159], a[164:167], a[44:47], v[156:159]
	v_mfma_f32_16x16x32_bf16 v[168:171], a[168:171], a[40:43], v[168:171]
	v_mfma_f32_16x16x32_bf16 v[172:175], a[168:171], a[44:47], v[172:175]
	v_mfma_f32_16x16x32_bf16 v[184:187], a[172:175], a[40:43], v[184:187]
	buffer_load_dwordx4 v5, s[28:31], s63 offen offset:3072 lds
	v_mfma_f32_16x16x32_bf16 v[188:191], a[172:175], a[44:47], v[188:191]
	s_waitcnt lgkmcnt(0)
	s_nop 0
	v_mfma_f32_16x16x32_bf16 v[136:139], a[176:179], a[56:59], v[136:139]
	ds_read_b128 a[40:43], v7 offset:18432
	ds_read_b128 a[44:47], v7 offset:19456
	v_mfma_f32_16x16x32_bf16 v[140:143], a[176:179], a[60:63], v[140:143]
	v_mfma_f32_16x16x32_bf16 v[152:155], a[180:183], a[56:59], v[152:155]
	v_mfma_f32_16x16x32_bf16 v[156:159], a[180:183], a[60:63], v[156:159]
	v_mfma_f32_16x16x32_bf16 v[168:171], a[184:187], a[56:59], v[168:171]
	v_mfma_f32_16x16x32_bf16 v[172:175], a[184:187], a[60:63], v[172:175]
	v_mfma_f32_16x16x32_bf16 v[184:187], a[188:191], a[56:59], v[184:187]
	v_mfma_f32_16x16x32_bf16 v[188:191], a[188:191], a[60:63], v[188:191]
	s_waitcnt lgkmcnt(0)
	s_nop 0
	v_mfma_f32_16x16x32_bf16 v[136:139], a[0:3], a[40:43], v[136:139]
	ds_read_b128 a[56:59], v7 offset:22528
	ds_read_b128 a[60:63], v7 offset:23552
	v_mfma_f32_16x16x32_bf16 v[140:143], a[0:3], a[44:47], v[140:143]
	v_mfma_f32_16x16x32_bf16 v[152:155], a[4:7], a[40:43], v[152:155]
	v_mfma_f32_16x16x32_bf16 v[156:159], a[4:7], a[44:47], v[156:159]
	v_mfma_f32_16x16x32_bf16 v[168:171], a[8:11], a[40:43], v[168:171]
	v_mfma_f32_16x16x32_bf16 v[172:175], a[8:11], a[44:47], v[172:175]
	v_mfma_f32_16x16x32_bf16 v[184:187], a[12:15], a[40:43], v[184:187]
	v_mfma_f32_16x16x32_bf16 v[188:191], a[12:15], a[44:47], v[188:191]
	s_waitcnt lgkmcnt(0)
	s_nop 0
	v_mfma_f32_16x16x32_bf16 v[136:139], a[16:19], a[56:59], v[136:139]
	ds_read_b128 a[40:43], v7 offset:26624
	ds_read_b128 a[44:47], v7 offset:27648
	v_mfma_f32_16x16x32_bf16 v[140:143], a[16:19], a[60:63], v[140:143]
	v_mfma_f32_16x16x32_bf16 v[152:155], a[20:23], a[56:59], v[152:155]
	v_mfma_f32_16x16x32_bf16 v[156:159], a[20:23], a[60:63], v[156:159]
	v_mfma_f32_16x16x32_bf16 v[168:171], a[24:27], a[56:59], v[168:171]
	v_mfma_f32_16x16x32_bf16 v[172:175], a[24:27], a[60:63], v[172:175]
	v_mfma_f32_16x16x32_bf16 v[184:187], a[28:31], a[56:59], v[184:187]
	v_mfma_f32_16x16x32_bf16 v[188:191], a[28:31], a[60:63], v[188:191]
	s_waitcnt lgkmcnt(0)
	s_nop 0
	v_mfma_f32_16x16x32_bf16 v[136:139], a[192:195], a[40:43], v[136:139]
	s_waitcnt vmcnt(24)
	s_nop 0
	ds_read_b64_tr_b16 a[124:125], v8 offset:16384
	ds_read_b64_tr_b16 a[126:127], v8 offset:18432
	v_mfma_f32_16x16x32_bf16 v[140:143], a[192:195], a[44:47], v[140:143]
	ds_read_b64_tr_b16 a[128:129], v9 offset:16384
	ds_read_b64_tr_b16 a[130:131], v9 offset:18432
	v_mfma_f32_16x16x32_bf16 v[152:155], a[196:199], a[40:43], v[152:155]
	v_mfma_f32_16x16x32_bf16 v[156:159], a[196:199], a[44:47], v[156:159]
	ds_read_b64_tr_b16 a[132:133], v10 offset:16384
	ds_read_b64_tr_b16 a[134:135], v10 offset:18432
	v_mfma_f32_16x16x32_bf16 v[168:171], a[200:203], a[40:43], v[168:171]
	ds_read_b64_tr_b16 a[136:137], v11 offset:16384
	ds_read_b64_tr_b16 a[138:139], v11 offset:18432
	v_mfma_f32_16x16x32_bf16 v[172:175], a[200:203], a[44:47], v[172:175]
	ds_read_b128 a[48:51], v7 offset:0
	ds_read_b128 a[52:55], v7 offset:1024
	v_mfma_f32_16x16x32_bf16 v[184:187], a[204:207], a[40:43], v[184:187]
	v_mfma_f32_16x16x32_bf16 v[188:191], a[204:207], a[44:47], v[188:191]
	s_waitcnt lgkmcnt(0)
	s_nop 0
	v_mfma_f32_16x16x32_bf16 v[192:195], a[124:127], a[48:51], 0
	s_add_u32 s63, s72, 196736
	s_waitcnt vmcnt(20)
	s_nop 0
	ds_read_b64_tr_b16 a[140:141], v8 offset:32768
	ds_read_b64_tr_b16 a[142:143], v8 offset:34816
	v_mfma_f32_16x16x32_bf16 v[196:199], a[124:127], a[52:55], 0
	s_add_u32 m0, s68, 16384
	ds_read_b64_tr_b16 a[144:145], v9 offset:32768
	ds_read_b64_tr_b16 a[146:147], v9 offset:34816
	v_mfma_f32_16x16x32_bf16 v[208:211], a[128:131], a[48:51], 0
	buffer_load_dwordx4 v2, s[28:31], s63 offen offset:0 lds
	v_mfma_f32_16x16x32_bf16 v[212:215], a[128:131], a[52:55], 0
	ds_read_b64_tr_b16 a[148:149], v10 offset:32768
	ds_read_b64_tr_b16 a[150:151], v10 offset:34816
	v_mfma_f32_16x16x32_bf16 v[224:227], a[132:135], a[48:51], 0
	s_add_u32 s75, s66, 22528
	ds_read_b64_tr_b16 a[152:153], v11 offset:32768
	ds_read_b64_tr_b16 a[154:155], v11 offset:34816
	v_mfma_f32_16x16x32_bf16 v[228:231], a[132:135], a[52:55], 0
	ds_read_b128 a[32:35], v7 offset:4096
	ds_read_b128 a[36:39], v7 offset:5120
	v_mfma_f32_16x16x32_bf16 v[240:243], a[136:139], a[48:51], 0
	buffer_load_dwordx4 v3, s[28:31], s63 offen offset:1024 lds
	v_mfma_f32_16x16x32_bf16 v[244:247], a[136:139], a[52:55], 0
	s_waitcnt lgkmcnt(0)
	s_nop 0
	v_cvt_pk_bf16_f32 v136, v136, v137
	v_cvt_pk_bf16_f32 v137, v138, v139
	v_mfma_f32_16x16x32_bf16 v[192:195], a[140:143], a[32:35], v[192:195]
	s_waitcnt vmcnt(18)
	s_nop 0
	ds_read_b64_tr_b16 a[160:161], v8 offset:49152
	ds_read_b64_tr_b16 a[162:163], v8 offset:51200
	v_mfma_f32_16x16x32_bf16 v[196:199], a[140:143], a[36:39], v[196:199]
	ds_read_b64_tr_b16 a[164:165], v9 offset:49152
	ds_read_b64_tr_b16 a[166:167], v9 offset:51200
	v_mfma_f32_16x16x32_bf16 v[208:211], a[144:147], a[32:35], v[208:211]
	buffer_load_dwordx4 v4, s[28:31], s63 offen offset:2048 lds
	v_mfma_f32_16x16x32_bf16 v[212:215], a[144:147], a[36:39], v[212:215]
	ds_read_b64_tr_b16 a[168:169], v10 offset:49152
	ds_read_b64_tr_b16 a[170:171], v10 offset:51200
	v_mfma_f32_16x16x32_bf16 v[224:227], a[148:151], a[32:35], v[224:227]
	ds_read_b64_tr_b16 a[172:173], v11 offset:49152
	ds_read_b64_tr_b16 a[174:175], v11 offset:51200
	v_mfma_f32_16x16x32_bf16 v[228:231], a[148:151], a[36:39], v[228:231]
	ds_read_b128 a[48:51], v7 offset:8192
	ds_read_b128 a[52:55], v7 offset:9216
	v_mfma_f32_16x16x32_bf16 v[240:243], a[152:155], a[32:35], v[240:243]
	buffer_load_dwordx4 v5, s[28:31], s63 offen offset:3072 lds
	v_mfma_f32_16x16x32_bf16 v[244:247], a[152:155], a[36:39], v[244:247]
	s_waitcnt lgkmcnt(0)
	s_nop 0
	v_cvt_pk_bf16_f32 v138, v152, v153
	v_cvt_pk_bf16_f32 v139, v154, v155
	v_mfma_f32_16x16x32_bf16 v[192:195], a[160:163], a[48:51], v[192:195]
	s_waitcnt vmcnt(14)
	s_nop 0
	ds_read_b64_tr_b16 a[176:177], v12 offset:0
	ds_read_b64_tr_b16 a[178:179], v12 offset:2048
	v_mfma_f32_16x16x32_bf16 v[196:199], a[160:163], a[52:55], v[196:199]
	ds_read_b64_tr_b16 a[180:181], v13 offset:0
	ds_read_b64_tr_b16 a[182:183], v13 offset:2048
	v_mfma_f32_16x16x32_bf16 v[208:211], a[164:167], a[48:51], v[208:211]
	buffer_store_dwordx4 v[136:139], v21, s[32:35], s75 offen offset:0 sc1
	v_mfma_f32_16x16x32_bf16 v[212:215], a[164:167], a[52:55], v[212:215]
	ds_read_b64_tr_b16 a[184:185], v14 offset:0
	ds_read_b64_tr_b16 a[186:187], v14 offset:2048
	v_mfma_f32_16x16x32_bf16 v[224:227], a[168:171], a[48:51], v[224:227]
	ds_read_b64_tr_b16 a[188:189], v15 offset:0
	ds_read_b64_tr_b16 a[190:191], v15 offset:2048
	v_mfma_f32_16x16x32_bf16 v[228:231], a[168:171], a[52:55], v[228:231]
	ds_read_b128 a[32:35], v7 offset:12288
	ds_read_b128 a[36:39], v7 offset:13312
	v_mfma_f32_16x16x32_bf16 v[240:243], a[172:175], a[48:51], v[240:243]
	v_cvt_pk_bf16_f32 v168, v168, v169
	v_cvt_pk_bf16_f32 v169, v170, v171
	v_mfma_f32_16x16x32_bf16 v[244:247], a[172:175], a[52:55], v[244:247]
	s_waitcnt lgkmcnt(0)
	s_nop 0
	v_cvt_pk_bf16_f32 v170, v184, v185
	v_cvt_pk_bf16_f32 v171, v186, v187
	v_mfma_f32_16x16x32_bf16 v[192:195], a[176:179], a[32:35], v[192:195]
	s_waitcnt vmcnt(9)
	s_nop 0
	ds_read_b64_tr_b16 a[0:1], v12 offset:16384
	ds_read_b64_tr_b16 a[2:3], v12 offset:18432
	v_mfma_f32_16x16x32_bf16 v[196:199], a[176:179], a[36:39], v[196:199]
	ds_read_b64_tr_b16 a[4:5], v13 offset:16384
	ds_read_b64_tr_b16 a[6:7], v13 offset:18432
	v_mfma_f32_16x16x32_bf16 v[208:211], a[180:183], a[32:35], v[208:211]
	buffer_store_dwordx4 v[168:171], v21, s[32:35], s75 offen offset:1024 sc1
	v_mfma_f32_16x16x32_bf16 v[212:215], a[180:183], a[36:39], v[212:215]
	ds_read_b64_tr_b16 a[8:9], v14 offset:16384
	ds_read_b64_tr_b16 a[10:11], v14 offset:18432
	v_mfma_f32_16x16x32_bf16 v[224:227], a[184:187], a[32:35], v[224:227]
	ds_read_b64_tr_b16 a[12:13], v15 offset:16384
	ds_read_b64_tr_b16 a[14:15], v15 offset:18432
	v_mfma_f32_16x16x32_bf16 v[228:231], a[184:187], a[36:39], v[228:231]
	ds_read_b128 a[48:51], v7 offset:16384
	ds_read_b128 a[52:55], v7 offset:17408
	v_mfma_f32_16x16x32_bf16 v[240:243], a[188:191], a[32:35], v[240:243]
	v_cvt_pk_bf16_f32 v140, v140, v141
	v_cvt_pk_bf16_f32 v141, v142, v143
	v_mfma_f32_16x16x32_bf16 v[244:247], a[188:191], a[36:39], v[244:247]
	s_waitcnt lgkmcnt(0)
	s_nop 0
	v_cvt_pk_bf16_f32 v142, v156, v157
	v_cvt_pk_bf16_f32 v143, v158, v159
	v_mfma_f32_16x16x32_bf16 v[192:195], a[0:3], a[48:51], v[192:195]
	s_waitcnt vmcnt(6)
	s_nop 0
	ds_read_b64_tr_b16 a[16:17], v8 offset:0
	ds_read_b64_tr_b16 a[18:19], v8 offset:2048
	v_mfma_f32_16x16x32_bf16 v[196:199], a[0:3], a[52:55], v[196:199]
	ds_read_b64_tr_b16 a[20:21], v9 offset:0
	ds_read_b64_tr_b16 a[22:23], v9 offset:2048
	v_mfma_f32_16x16x32_bf16 v[208:211], a[4:7], a[48:51], v[208:211]
	buffer_store_dwordx4 v[140:143], v21, s[32:35], s75 offen offset:2048 sc1
	v_mfma_f32_16x16x32_bf16 v[212:215], a[4:7], a[52:55], v[212:215]
	ds_read_b64_tr_b16 a[24:25], v10 offset:0
	ds_read_b64_tr_b16 a[26:27], v10 offset:2048
	v_mfma_f32_16x16x32_bf16 v[224:227], a[8:11], a[48:51], v[224:227]
	ds_read_b64_tr_b16 a[28:29], v11 offset:0
	ds_read_b64_tr_b16 a[30:31], v11 offset:2048
	v_mfma_f32_16x16x32_bf16 v[228:231], a[8:11], a[52:55], v[228:231]
	ds_read_b128 a[32:35], v7 offset:20480
	ds_read_b128 a[36:39], v7 offset:21504
	v_mfma_f32_16x16x32_bf16 v[240:243], a[12:15], a[48:51], v[240:243]
	v_cvt_pk_bf16_f32 v172, v172, v173
	v_cvt_pk_bf16_f32 v173, v174, v175
	v_mfma_f32_16x16x32_bf16 v[244:247], a[12:15], a[52:55], v[244:247]
	s_waitcnt lgkmcnt(0)
	s_nop 0
	v_cvt_pk_bf16_f32 v174, v188, v189
	v_cvt_pk_bf16_f32 v175, v190, v191
	v_mfma_f32_16x16x32_bf16 v[192:195], a[16:19], a[32:35], v[192:195]
	s_waitcnt vmcnt(3)
	s_nop 0
	ds_read_b64_tr_b16 a[192:193], v8 offset:16384
	ds_read_b64_tr_b16 a[194:195], v8 offset:18432
	v_mfma_f32_16x16x32_bf16 v[196:199], a[16:19], a[36:39], v[196:199]
	ds_read_b64_tr_b16 a[196:197], v9 offset:16384
	ds_read_b64_tr_b16 a[198:199], v9 offset:18432
	v_mfma_f32_16x16x32_bf16 v[208:211], a[20:23], a[32:35], v[208:211]
	buffer_store_dwordx4 v[172:175], v21, s[32:35], s75 offen offset:3072 sc1
	v_mfma_f32_16x16x32_bf16 v[212:215], a[20:23], a[36:39], v[212:215]
	ds_read_b64_tr_b16 a[200:201], v10 offset:16384
	ds_read_b64_tr_b16 a[202:203], v10 offset:18432
	v_mfma_f32_16x16x32_bf16 v[224:227], a[24:27], a[32:35], v[224:227]
	ds_read_b64_tr_b16 a[204:205], v11 offset:16384
	ds_read_b64_tr_b16 a[206:207], v11 offset:18432
	v_mfma_f32_16x16x32_bf16 v[228:231], a[24:27], a[36:39], v[228:231]
	ds_read_b128 a[48:51], v7 offset:24576
	ds_read_b128 a[52:55], v7 offset:25600
	v_mfma_f32_16x16x32_bf16 v[240:243], a[28:31], a[32:35], v[240:243]
	v_mfma_f32_16x16x32_bf16 v[244:247], a[28:31], a[36:39], v[244:247]
	s_waitcnt lgkmcnt(0)
	s_nop 0
	v_mfma_f32_16x16x32_bf16 v[192:195], a[192:195], a[48:51], v[192:195]
	ds_read_b128 a[56:59], v7 offset:2048
	ds_read_b128 a[60:63], v7 offset:3072
	v_mfma_f32_16x16x32_bf16 v[196:199], a[192:195], a[52:55], v[196:199]
	v_mfma_f32_16x16x32_bf16 v[208:211], a[196:199], a[48:51], v[208:211]
	v_mfma_f32_16x16x32_bf16 v[212:215], a[196:199], a[52:55], v[212:215]
	v_mfma_f32_16x16x32_bf16 v[224:227], a[200:203], a[48:51], v[224:227]
	v_mfma_f32_16x16x32_bf16 v[228:231], a[200:203], a[52:55], v[228:231]
	v_mfma_f32_16x16x32_bf16 v[240:243], a[204:207], a[48:51], v[240:243]
	v_mfma_f32_16x16x32_bf16 v[244:247], a[204:207], a[52:55], v[244:247]
	s_waitcnt lgkmcnt(0)
	s_nop 0
	v_mfma_f32_16x16x32_bf16 v[200:203], a[124:127], a[56:59], 0
	ds_read_b128 a[40:43], v7 offset:6144
	ds_read_b128 a[44:47], v7 offset:7168
	v_mfma_f32_16x16x32_bf16 v[204:207], a[124:127], a[60:63], 0
	v_mfma_f32_16x16x32_bf16 v[216:219], a[128:131], a[56:59], 0
	v_mfma_f32_16x16x32_bf16 v[220:223], a[128:131], a[60:63], 0
	s_add_u32 s75, s66, 26624
	v_cvt_pk_bf16_f32 v192, v192, v193
	v_cvt_pk_bf16_f32 v193, v194, v195
	v_mfma_f32_16x16x32_bf16 v[232:235], a[132:135], a[56:59], 0
	v_cvt_pk_bf16_f32 v194, v208, v209
	v_cvt_pk_bf16_f32 v195, v210, v211
	v_mfma_f32_16x16x32_bf16 v[236:239], a[132:135], a[60:63], 0
	buffer_store_dwordx4 v[192:195], v21, s[32:35], s75 offen offset:0 sc1
	v_mfma_f32_16x16x32_bf16 v[248:251], a[136:139], a[56:59], 0
	v_cvt_pk_bf16_f32 v224, v224, v225
	v_cvt_pk_bf16_f32 v225, v226, v227
	v_mfma_f32_16x16x32_bf16 v[252:255], a[136:139], a[60:63], 0
	s_waitcnt lgkmcnt(0)
	s_nop 0
	v_cvt_pk_bf16_f32 v226, v240, v241
	v_cvt_pk_bf16_f32 v227, v242, v243
	v_mfma_f32_16x16x32_bf16 v[200:203], a[140:143], a[40:43], v[200:203]
	ds_read_b128 a[56:59], v7 offset:10240
	ds_read_b128 a[60:63], v7 offset:11264
	v_mfma_f32_16x16x32_bf16 v[204:207], a[140:143], a[44:47], v[204:207]
	buffer_store_dwordx4 v[224:227], v21, s[32:35], s75 offen offset:1024 sc1
	v_mfma_f32_16x16x32_bf16 v[216:219], a[144:147], a[40:43], v[216:219]
	v_cvt_pk_bf16_f32 v196, v196, v197
	v_cvt_pk_bf16_f32 v197, v198, v199
	v_mfma_f32_16x16x32_bf16 v[220:223], a[144:147], a[44:47], v[220:223]
	v_cvt_pk_bf16_f32 v198, v212, v213
	v_cvt_pk_bf16_f32 v199, v214, v215
	v_mfma_f32_16x16x32_bf16 v[232:235], a[148:151], a[40:43], v[232:235]
	buffer_store_dwordx4 v[196:199], v21, s[32:35], s75 offen offset:2048 sc1
	v_mfma_f32_16x16x32_bf16 v[236:239], a[148:151], a[44:47], v[236:239]
	v_cvt_pk_bf16_f32 v228, v228, v229
	v_cvt_pk_bf16_f32 v229, v230, v231
	v_mfma_f32_16x16x32_bf16 v[248:251], a[152:155], a[40:43], v[248:251]
	v_cvt_pk_bf16_f32 v230, v244, v245
	v_cvt_pk_bf16_f32 v231, v246, v247
	v_mfma_f32_16x16x32_bf16 v[252:255], a[152:155], a[44:47], v[252:255]
	s_waitcnt lgkmcnt(0)
	s_nop 0
	v_mfma_f32_16x16x32_bf16 v[200:203], a[160:163], a[56:59], v[200:203]
	ds_read_b128 a[40:43], v7 offset:14336
	ds_read_b128 a[44:47], v7 offset:15360
	v_mfma_f32_16x16x32_bf16 v[204:207], a[160:163], a[60:63], v[204:207]
	buffer_store_dwordx4 v[228:231], v21, s[32:35], s75 offen offset:3072 sc1
	v_mfma_f32_16x16x32_bf16 v[216:219], a[164:167], a[56:59], v[216:219]
	s_mov_b64 exec, s[94:95]
	s_nop 0
	ds_write_b128 v1, v[128:131] offset:0
	ds_write_b128 v1, v[160:163] offset:128
	s_mov_b64 exec, -1
	s_nop 0
	v_mfma_f32_16x16x32_bf16 v[220:223], a[164:167], a[60:63], v[220:223]
	s_mov_b64 exec, s[94:95]
	s_nop 0
	ds_write_b128 v1, v[132:135] offset:256
	ds_write_b128 v1, v[164:167] offset:384
	s_mov_b64 exec, -1
	s_nop 0
	v_mfma_f32_16x16x32_bf16 v[232:235], a[168:171], a[56:59], v[232:235]
	s_mov_b64 exec, s[94:95]
	s_nop 0
	ds_write_b128 v1, v[136:139] offset:512
	ds_write_b128 v1, v[168:171] offset:640
	s_mov_b64 exec, -1
	s_nop 0
	v_mfma_f32_16x16x32_bf16 v[236:239], a[168:171], a[60:63], v[236:239]
	s_mov_b64 exec, s[94:95]
	s_nop 0
	ds_write_b128 v1, v[140:143] offset:768
	ds_write_b128 v1, v[172:175] offset:896
	s_mov_b64 exec, -1
	s_nop 0
	v_mfma_f32_16x16x32_bf16 v[248:251], a[172:175], a[56:59], v[248:251]
	s_mov_b64 exec, s[94:95]
	s_nop 0
	ds_write_b128 v1, v[192:195] offset:1024
	ds_write_b128 v1, v[224:227] offset:1152
	s_mov_b64 exec, -1
	s_nop 0
	v_mfma_f32_16x16x32_bf16 v[252:255], a[172:175], a[60:63], v[252:255]
	s_waitcnt lgkmcnt(10)
	s_nop 0
	v_mfma_f32_16x16x32_bf16 v[200:203], a[176:179], a[40:43], v[200:203]
	ds_read_b128 a[56:59], v7 offset:18432
	ds_read_b128 a[60:63], v7 offset:19456
	v_mfma_f32_16x16x32_bf16 v[204:207], a[176:179], a[44:47], v[204:207]
	s_mov_b64 exec, s[94:95]
	s_nop 0
	ds_write_b128 v1, v[196:199] offset:1280
	ds_write_b128 v1, v[228:231] offset:1408
	s_mov_b64 exec, -1
	s_nop 0
	v_mfma_f32_16x16x32_bf16 v[216:219], a[180:183], a[40:43], v[216:219]
	s_add_u32 s77, s67, 18432
	s_xor_b32 s76, s77, 262144
	v_mfma_f32_16x16x32_bf16 v[220:223], a[180:183], a[44:47], v[220:223]
	buffer_load_dwordx4 v[68:71], v29, s[32:35], s76 offen sc1
	v_mfma_f32_16x16x32_bf16 v[232:235], a[184:187], a[40:43], v[232:235]
	s_xor_b32 s76, s77, 524288
	v_mfma_f32_16x16x32_bf16 v[236:239], a[184:187], a[44:47], v[236:239]
	buffer_load_dwordx4 v[72:75], v29, s[32:35], s76 offen sc1
	v_mfma_f32_16x16x32_bf16 v[248:251], a[188:191], a[40:43], v[248:251]
	s_xor_b32 s76, s77, 786432
	v_mfma_f32_16x16x32_bf16 v[252:255], a[188:191], a[44:47], v[252:255]
	s_waitcnt lgkmcnt(2)
	s_nop 0
	v_mfma_f32_16x16x32_bf16 v[200:203], a[0:3], a[56:59], v[200:203]
	ds_read_b128 a[40:43], v7 offset:22528
	ds_read_b128 a[44:47], v7 offset:23552
	v_mfma_f32_16x16x32_bf16 v[204:207], a[0:3], a[60:63], v[204:207]
	buffer_load_dwordx4 v[76:79], v29, s[32:35], s76 offen sc1
	v_mfma_f32_16x16x32_bf16 v[216:219], a[4:7], a[56:59], v[216:219]
	s_xor_b32 s76, s77, 1048576
	v_mfma_f32_16x16x32_bf16 v[220:223], a[4:7], a[60:63], v[220:223]
	buffer_load_dwordx4 v[80:83], v29, s[32:35], s76 offen sc1
	v_mfma_f32_16x16x32_bf16 v[232:235], a[8:11], a[56:59], v[232:235]
	s_xor_b32 s76, s77, 1310720
	v_mfma_f32_16x16x32_bf16 v[236:239], a[8:11], a[60:63], v[236:239]
	buffer_load_dwordx4 v[84:87], v29, s[32:35], s76 offen sc1
	v_mfma_f32_16x16x32_bf16 v[248:251], a[12:15], a[56:59], v[248:251]
	s_xor_b32 s76, s77, 1572864
	v_mfma_f32_16x16x32_bf16 v[252:255], a[12:15], a[60:63], v[252:255]
	s_waitcnt lgkmcnt(0)
	s_nop 0
	v_mfma_f32_16x16x32_bf16 v[200:203], a[16:19], a[40:43], v[200:203]
	ds_read_b128 a[56:59], v7 offset:26624
	ds_read_b128 a[60:63], v7 offset:27648
	v_mfma_f32_16x16x32_bf16 v[204:207], a[16:19], a[44:47], v[204:207]
	buffer_load_dwordx4 v[88:91], v29, s[32:35], s76 offen sc1
	v_mfma_f32_16x16x32_bf16 v[216:219], a[20:23], a[40:43], v[216:219]
	s_xor_b32 s76, s77, 1835008
	v_mfma_f32_16x16x32_bf16 v[220:223], a[20:23], a[44:47], v[220:223]
	buffer_load_dwordx4 v[92:95], v29, s[32:35], s76 offen sc1
	v_mfma_f32_16x16x32_bf16 v[232:235], a[24:27], a[40:43], v[232:235]
	v_mfma_f32_16x16x32_bf16 v[236:239], a[24:27], a[44:47], v[236:239]
	v_mfma_f32_16x16x32_bf16 v[248:251], a[28:31], a[40:43], v[248:251]
	v_mfma_f32_16x16x32_bf16 v[252:255], a[28:31], a[44:47], v[252:255]
	s_waitcnt lgkmcnt(0)
	s_nop 0
	v_mfma_f32_16x16x32_bf16 v[200:203], a[192:195], a[56:59], v[200:203]
	v_mfma_f32_16x16x32_bf16 v[204:207], a[192:195], a[60:63], v[204:207]
	v_mfma_f32_16x16x32_bf16 v[216:219], a[196:199], a[56:59], v[216:219]
	v_mfma_f32_16x16x32_bf16 v[220:223], a[196:199], a[60:63], v[220:223]
	v_mfma_f32_16x16x32_bf16 v[232:235], a[200:203], a[56:59], v[232:235]
	v_mfma_f32_16x16x32_bf16 v[236:239], a[200:203], a[60:63], v[236:239]
	v_mfma_f32_16x16x32_bf16 v[248:251], a[204:207], a[56:59], v[248:251]
	v_mfma_f32_16x16x32_bf16 v[252:255], a[204:207], a[60:63], v[252:255]
	s_nop 3
	s_nop 0
	s_add_u32 s75, s66, 30720
	v_cvt_pk_bf16_f32 v200, v200, v201
	v_cvt_pk_bf16_f32 v201, v202, v203
	v_cvt_pk_bf16_f32 v202, v216, v217
	v_cvt_pk_bf16_f32 v203, v218, v219
	buffer_store_dwordx4 v[200:203], v21, s[32:35], s75 offen offset:0 sc1
	v_cvt_pk_bf16_f32 v232, v232, v233
	v_cvt_pk_bf16_f32 v233, v234, v235
	v_cvt_pk_bf16_f32 v234, v248, v249
	v_cvt_pk_bf16_f32 v235, v250, v251
	buffer_store_dwordx4 v[232:235], v21, s[32:35], s75 offen offset:1024 sc1
	v_cvt_pk_bf16_f32 v204, v204, v205
	v_cvt_pk_bf16_f32 v205, v206, v207
	v_cvt_pk_bf16_f32 v206, v220, v221
	v_cvt_pk_bf16_f32 v207, v222, v223
	buffer_store_dwordx4 v[204:207], v21, s[32:35], s75 offen offset:2048 sc1
	v_cvt_pk_bf16_f32 v236, v236, v237
	v_cvt_pk_bf16_f32 v237, v238, v239
	v_cvt_pk_bf16_f32 v238, v252, v253
	v_cvt_pk_bf16_f32 v239, v254, v255
	buffer_store_dwordx4 v[236:239], v21, s[32:35], s75 offen offset:3072 sc1
	s_mov_b64 exec, s[94:95]
	s_nop 0
	ds_write_b128 v1, v[200:203] offset:1536
	ds_write_b128 v1, v[232:235] offset:1664
	s_mov_b64 exec, -1
	s_mov_b64 exec, s[94:95]
	ds_write_b128 v1, v[204:207] offset:1792
	ds_write_b128 v1, v[236:239] offset:1920
	s_mov_b64 exec, -1
	s_cmp_lt_u32 s56, 2
	s_cselect_b64 exec, 0, -1
	s_nop 0
	s_add_u32 s77, s67, 18432
	s_xor_b32 s76, s77, 262144
	buffer_load_dwordx4 v[68:71], v22, s[32:35], s76 offen sc1
	s_xor_b32 s76, s77, 524288
	buffer_load_dwordx4 v[72:75], v22, s[32:35], s76 offen sc1
	s_xor_b32 s76, s77, 786432
	buffer_load_dwordx4 v[76:79], v22, s[32:35], s76 offen sc1
	s_xor_b32 s76, s77, 1048576
	buffer_load_dwordx4 v[80:83], v22, s[32:35], s76 offen sc1
	s_xor_b32 s76, s77, 1310720
	buffer_load_dwordx4 v[84:87], v22, s[32:35], s76 offen sc1
	s_xor_b32 s76, s77, 1572864
	buffer_load_dwordx4 v[88:91], v22, s[32:35], s76 offen sc1
	s_xor_b32 s76, s77, 1835008
	buffer_load_dwordx4 v[92:95], v22, s[32:35], s76 offen sc1
	s_mov_b64 exec, -1
	s_waitcnt lgkmcnt(0)
	s_barrier
	s_nop 0
	ds_read_b128 v[64:67], v31
	ds_read_b128 v[96:99], v31 offset:1024
	s_waitcnt vmcnt(18)
	s_cmp_lt_u32 s56, 2
	s_cselect_b64 exec, -1, 0
	s_nop 0
	s_add_u32 s77, s67, 26624
	s_xor_b32 s76, s77, 262144
	buffer_load_dwordx4 v[100:103], v22, s[32:35], s76 offen sc1
	s_xor_b32 s76, s77, 524288
	buffer_load_dwordx4 v[104:107], v22, s[32:35], s76 offen sc1
	s_xor_b32 s76, s77, 786432
	buffer_load_dwordx4 v[108:111], v22, s[32:35], s76 offen sc1
	s_xor_b32 s76, s77, 1048576
	buffer_load_dwordx4 v[112:115], v22, s[32:35], s76 offen sc1
	s_xor_b32 s76, s77, 1310720
	buffer_load_dwordx4 v[116:119], v22, s[32:35], s76 offen sc1
	s_xor_b32 s76, s77, 1572864
	buffer_load_dwordx4 v[120:123], v22, s[32:35], s76 offen sc1
	s_xor_b32 s76, s77, 1835008
	buffer_load_dwordx4 v[124:127], v22, s[32:35], s76 offen sc1
	s_waitcnt vmcnt(14)
	s_cmp_lt_u32 s56, 2
	s_cselect_b64 exec, 0, -1
	s_nop 0
	s_add_u32 s77, s67, 26624
	s_xor_b32 s76, s77, 262144
	buffer_load_dwordx4 v[100:103], v22, s[32:35], s76 offen sc1
	s_xor_b32 s76, s77, 524288
	buffer_load_dwordx4 v[104:107], v22, s[32:35], s76 offen sc1
	s_xor_b32 s76, s77, 786432
	buffer_load_dwordx4 v[108:111], v22, s[32:35], s76 offen sc1
	s_xor_b32 s76, s77, 1048576
	buffer_load_dwordx4 v[112:115], v22, s[32:35], s76 offen sc1
	s_xor_b32 s76, s77, 1310720
	buffer_load_dwordx4 v[116:119], v22, s[32:35], s76 offen sc1
	s_xor_b32 s76, s77, 1572864
	buffer_load_dwordx4 v[120:123], v22, s[32:35], s76 offen sc1
	s_xor_b32 s76, s77, 1835008
	buffer_load_dwordx4 v[124:127], v22, s[32:35], s76 offen sc1
	s_mov_b64 exec, -1
	s_waitcnt lgkmcnt(0)
	v_accvgpr_read_b32 v144, a76
	v_accvgpr_read_b32 v145, a77
	v_accvgpr_read_b32 v146, a78
	v_accvgpr_read_b32 v147, a79
	v_lshlrev_b32_e64 v160, 16, v144
	v_and_b32 v161, 0xffff0000, v144
	v_lshlrev_b32_e64 v162, 16, v145
	v_and_b32 v163, 0xffff0000, v145
	v_lshlrev_b32_e64 v164, 16, v146
	v_and_b32 v165, 0xffff0000, v146
	v_lshlrev_b32_e64 v166, 16, v147
	v_and_b32 v167, 0xffff0000, v147
	v_accvgpr_read_b32 v144, a92
	v_accvgpr_read_b32 v145, a93
	v_accvgpr_read_b32 v146, a94
	v_accvgpr_read_b32 v147, a95
	v_lshlrev_b32_e64 v168, 16, v144
	v_and_b32 v169, 0xffff0000, v144
	v_lshlrev_b32_e64 v170, 16, v145
	v_and_b32 v171, 0xffff0000, v145
	v_lshlrev_b32_e64 v172, 16, v146
	v_and_b32 v173, 0xffff0000, v146
	v_lshlrev_b32_e64 v174, 16, v147
	v_and_b32 v175, 0xffff0000, v147
	v_accvgpr_read_b32 v144, a104
	v_accvgpr_read_b32 v145, a105
	v_accvgpr_read_b32 v146, a106
	v_accvgpr_read_b32 v147, a107
	v_accvgpr_read_b32 v148, a108
	v_accvgpr_read_b32 v149, a109
	v_accvgpr_read_b32 v150, a110
	v_accvgpr_read_b32 v151, a111
	v_lshlrev_b32_e64 v176, 16, v144
	v_and_b32 v177, 0xffff0000, v144
	v_lshlrev_b32_e64 v178, 16, v145
	v_and_b32 v179, 0xffff0000, v145
	v_lshlrev_b32_e64 v180, 16, v146
	v_and_b32 v181, 0xffff0000, v146
	v_lshlrev_b32_e64 v182, 16, v147
	v_and_b32 v183, 0xffff0000, v147
	v_lshlrev_b32_e64 v184, 16, v148
	v_and_b32 v185, 0xffff0000, v148
	v_lshlrev_b32_e64 v186, 16, v149
	v_and_b32 v187, 0xffff0000, v149
	v_lshlrev_b32_e64 v188, 16, v150
	v_and_b32 v189, 0xffff0000, v150
	v_lshlrev_b32_e64 v190, 16, v151
	v_and_b32 v191, 0xffff0000, v151
	v_pk_fma_f32 v[32:33], v[176:177], v[160:161], v[32:33]
	v_pk_fma_f32 v[34:35], v[178:179], v[162:163], v[34:35]
	v_pk_fma_f32 v[36:37], v[180:181], v[164:165], v[36:37]
	v_pk_fma_f32 v[38:39], v[182:183], v[166:167], v[38:39]
	v_pk_fma_f32 v[40:41], v[184:185], v[168:169], v[40:41]
	v_pk_fma_f32 v[42:43], v[186:187], v[170:171], v[42:43]
	v_pk_fma_f32 v[44:45], v[188:189], v[172:173], v[44:45]
	v_pk_fma_f32 v[46:47], v[190:191], v[174:175], v[46:47]
	v_accvgpr_read_b32 v28, a120
	v_lshlrev_b32_e64 v128, 16, v64
	v_and_b32 v129, 0xffff0000, v64
	v_lshlrev_b32_e64 v130, 16, v65
	v_and_b32 v131, 0xffff0000, v65
	v_lshlrev_b32_e64 v132, 16, v66
	v_and_b32 v133, 0xffff0000, v66
	v_lshlrev_b32_e64 v134, 16, v67
	v_and_b32 v135, 0xffff0000, v67
	s_waitcnt vmcnt(20)
	s_nop 0
	v_max3_u32 v144, v68, v69, v69
	v_max3_u32 v144, v70, v71, v144
	v_dot2c_f32_bf16 v128, s90, v68
	v_dot2c_f32_bf16 v129, s91, v68
	v_dot2c_f32_bf16 v130, s90, v69
	v_dot2c_f32_bf16 v131, s91, v69
	v_dot2c_f32_bf16 v132, s90, v70
	v_dot2c_f32_bf16 v133, s91, v70
	v_dot2c_f32_bf16 v134, s90, v71
	v_dot2c_f32_bf16 v135, s91, v71
	s_waitcnt vmcnt(19)
	s_nop 0
	v_max3_u32 v144, v72, v73, v144
	v_max3_u32 v144, v74, v75, v144
	v_dot2c_f32_bf16 v128, s90, v72
	v_dot2c_f32_bf16 v129, s91, v72
	v_dot2c_f32_bf16 v130, s90, v73
	v_dot2c_f32_bf16 v131, s91, v73
	v_dot2c_f32_bf16 v132, s90, v74
	v_dot2c_f32_bf16 v133, s91, v74
	v_dot2c_f32_bf16 v134, s90, v75
	v_dot2c_f32_bf16 v135, s91, v75
	s_waitcnt vmcnt(18)
	s_nop 0
	v_max3_u32 v144, v76, v77, v144
	v_max3_u32 v144, v78, v79, v144
	v_dot2c_f32_bf16 v128, s90, v76
	v_dot2c_f32_bf16 v129, s91, v76
	v_dot2c_f32_bf16 v130, s90, v77
	v_dot2c_f32_bf16 v131, s91, v77
	v_dot2c_f32_bf16 v132, s90, v78
	v_dot2c_f32_bf16 v133, s91, v78
	v_dot2c_f32_bf16 v134, s90, v79
	v_dot2c_f32_bf16 v135, s91, v79
	s_waitcnt vmcnt(17)
	s_nop 0
	v_max3_u32 v144, v80, v81, v144
	v_max3_u32 v144, v82, v83, v144
	v_dot2c_f32_bf16 v128, s90, v80
	v_dot2c_f32_bf16 v129, s91, v80
	v_dot2c_f32_bf16 v130, s90, v81
	v_dot2c_f32_bf16 v131, s91, v81
	v_dot2c_f32_bf16 v132, s90, v82
	v_dot2c_f32_bf16 v133, s91, v82
	v_dot2c_f32_bf16 v134, s90, v83
	v_dot2c_f32_bf16 v135, s91, v83
	s_waitcnt vmcnt(16)
	s_nop 0
	v_max3_u32 v144, v84, v85, v144
	v_max3_u32 v144, v86, v87, v144
	v_dot2c_f32_bf16 v128, s90, v84
	v_dot2c_f32_bf16 v129, s91, v84
	v_dot2c_f32_bf16 v130, s90, v85
	v_dot2c_f32_bf16 v131, s91, v85
	v_dot2c_f32_bf16 v132, s90, v86
	v_dot2c_f32_bf16 v133, s91, v86
	v_dot2c_f32_bf16 v134, s90, v87
	v_dot2c_f32_bf16 v135, s91, v87
	s_waitcnt vmcnt(15)
	s_nop 0
	v_max3_u32 v144, v88, v89, v144
	v_max3_u32 v144, v90, v91, v144
	v_dot2c_f32_bf16 v128, s90, v88
	v_dot2c_f32_bf16 v129, s91, v88
	v_dot2c_f32_bf16 v130, s90, v89
	v_dot2c_f32_bf16 v131, s91, v89
	v_dot2c_f32_bf16 v132, s90, v90
	v_dot2c_f32_bf16 v133, s91, v90
	v_dot2c_f32_bf16 v134, s90, v91
	v_dot2c_f32_bf16 v135, s91, v91
	s_waitcnt vmcnt(14)
	s_nop 0
	v_max3_u32 v144, v92, v93, v144
	v_max3_u32 v144, v94, v95, v144
	v_dot2c_f32_bf16 v128, s90, v92
	v_dot2c_f32_bf16 v129, s91, v92
	v_dot2c_f32_bf16 v130, s90, v93
	v_dot2c_f32_bf16 v131, s91, v93
	v_dot2c_f32_bf16 v132, s90, v94
	v_dot2c_f32_bf16 v133, s91, v94
	v_dot2c_f32_bf16 v134, s90, v95
	v_dot2c_f32_bf16 v135, s91, v95
	v_cmp_eq_u32 vcc, -1, v144
	s_cbranch_vccz L_gok_41
	s_mov_b32 s100, 32768
	s_add_u32 s77, s67, 18432
L_gre_42:
	v_max3_u32 v144, v68, v69, v70
	v_max_u32 v144, v144, v71
	v_cmp_eq_u32_e64 vcc, -1, v144
	s_cbranch_vccz L_gsk_44
	s_xor_b32 s76, s77, 262144
	buffer_load_dwordx4 v[68:71], v22, s[32:35], s76 offen sc1
L_gsk_44:
	v_max3_u32 v144, v72, v73, v74
	v_max_u32 v144, v144, v75
	v_cmp_eq_u32_e64 vcc, -1, v144
	s_cbranch_vccz L_gsk_45
	s_xor_b32 s76, s77, 524288
	buffer_load_dwordx4 v[72:75], v22, s[32:35], s76 offen sc1
L_gsk_45:
	v_max3_u32 v144, v76, v77, v78
	v_max_u32 v144, v144, v79
	v_cmp_eq_u32_e64 vcc, -1, v144
	s_cbranch_vccz L_gsk_46
	s_xor_b32 s76, s77, 786432
	buffer_load_dwordx4 v[76:79], v22, s[32:35], s76 offen sc1
L_gsk_46:
	v_max3_u32 v144, v80, v81, v82
	v_max_u32 v144, v144, v83
	v_cmp_eq_u32_e64 vcc, -1, v144
	s_cbranch_vccz L_gsk_47
	s_xor_b32 s76, s77, 1048576
	buffer_load_dwordx4 v[80:83], v22, s[32:35], s76 offen sc1
L_gsk_47:
	v_max3_u32 v144, v84, v85, v86
	v_max_u32 v144, v144, v87
	v_cmp_eq_u32_e64 vcc, -1, v144
	s_cbranch_vccz L_gsk_48
	s_xor_b32 s76, s77, 1310720
	buffer_load_dwordx4 v[84:87], v22, s[32:35], s76 offen sc1
L_gsk_48:
	v_max3_u32 v144, v88, v89, v90
	v_max_u32 v144, v144, v91
	v_cmp_eq_u32_e64 vcc, -1, v144
	s_cbranch_vccz L_gsk_49
	s_xor_b32 s76, s77, 1572864
	buffer_load_dwordx4 v[88:91], v22, s[32:35], s76 offen sc1
L_gsk_49:
	v_max3_u32 v144, v92, v93, v94
	v_max_u32 v144, v144, v95
	v_cmp_eq_u32_e64 vcc, -1, v144
	s_cbranch_vccz L_gsk_50
	s_xor_b32 s76, s77, 1835008
	buffer_load_dwordx4 v[92:95], v22, s[32:35], s76 offen sc1
L_gsk_50:
	s_waitcnt vmcnt(0)
	s_nop 0
	v_max3_u32 v144, v68, v69, v70
	v_max3_u32 v145, v71, v72, v73
	v_max3_u32 v144, v144, v74, v75
	v_max3_u32 v145, v145, v76, v77
	v_max3_u32 v144, v144, v78, v79
	v_max3_u32 v145, v145, v80, v81
	v_max3_u32 v144, v144, v82, v83
	v_max3_u32 v145, v145, v84, v85
	v_max3_u32 v144, v144, v86, v87
	v_max3_u32 v145, v145, v88, v89
	v_max3_u32 v144, v144, v90, v91
	v_max3_u32 v145, v145, v92, v93
	v_max3_u32 v144, v144, v94, v95
	v_max_u32 v144, v144, v145
	v_cmp_eq_u32 vcc, -1, v144
	s_cbranch_vccz L_grd_43
	s_sub_u32 s100, s100, 1
	s_cmp_lg_u32 s100, 0
	s_cbranch_scc1 L_gre_42
L_grd_43:
	v_lshlrev_b32_e64 v128, 16, v64
	v_and_b32 v129, 0xffff0000, v64
	v_lshlrev_b32_e64 v130, 16, v65
	v_and_b32 v131, 0xffff0000, v65
	v_lshlrev_b32_e64 v132, 16, v66
	v_and_b32 v133, 0xffff0000, v66
	v_lshlrev_b32_e64 v134, 16, v67
	v_and_b32 v135, 0xffff0000, v67
	v_dot2c_f32_bf16 v128, s90, v68
	v_dot2c_f32_bf16 v129, s91, v68
	v_dot2c_f32_bf16 v130, s90, v69
	v_dot2c_f32_bf16 v131, s91, v69
	v_dot2c_f32_bf16 v132, s90, v70
	v_dot2c_f32_bf16 v133, s91, v70
	v_dot2c_f32_bf16 v134, s90, v71
	v_dot2c_f32_bf16 v135, s91, v71
	v_dot2c_f32_bf16 v128, s90, v72
	v_dot2c_f32_bf16 v129, s91, v72
	v_dot2c_f32_bf16 v130, s90, v73
	v_dot2c_f32_bf16 v131, s91, v73
	v_dot2c_f32_bf16 v132, s90, v74
	v_dot2c_f32_bf16 v133, s91, v74
	v_dot2c_f32_bf16 v134, s90, v75
	v_dot2c_f32_bf16 v135, s91, v75
	v_dot2c_f32_bf16 v128, s90, v76
	v_dot2c_f32_bf16 v129, s91, v76
	v_dot2c_f32_bf16 v130, s90, v77
	v_dot2c_f32_bf16 v131, s91, v77
	v_dot2c_f32_bf16 v132, s90, v78
	v_dot2c_f32_bf16 v133, s91, v78
	v_dot2c_f32_bf16 v134, s90, v79
	v_dot2c_f32_bf16 v135, s91, v79
	v_dot2c_f32_bf16 v128, s90, v80
	v_dot2c_f32_bf16 v129, s91, v80
	v_dot2c_f32_bf16 v130, s90, v81
	v_dot2c_f32_bf16 v131, s91, v81
	v_dot2c_f32_bf16 v132, s90, v82
	v_dot2c_f32_bf16 v133, s91, v82
	v_dot2c_f32_bf16 v134, s90, v83
	v_dot2c_f32_bf16 v135, s91, v83
	v_dot2c_f32_bf16 v128, s90, v84
	v_dot2c_f32_bf16 v129, s91, v84
	v_dot2c_f32_bf16 v130, s90, v85
	v_dot2c_f32_bf16 v131, s91, v85
	v_dot2c_f32_bf16 v132, s90, v86
	v_dot2c_f32_bf16 v133, s91, v86
	v_dot2c_f32_bf16 v134, s90, v87
	v_dot2c_f32_bf16 v135, s91, v87
	v_dot2c_f32_bf16 v128, s90, v88
	v_dot2c_f32_bf16 v129, s91, v88
	v_dot2c_f32_bf16 v130, s90, v89
	v_dot2c_f32_bf16 v131, s91, v89
	v_dot2c_f32_bf16 v132, s90, v90
	v_dot2c_f32_bf16 v133, s91, v90
	v_dot2c_f32_bf16 v134, s90, v91
	v_dot2c_f32_bf16 v135, s91, v91
	v_dot2c_f32_bf16 v128, s90, v92
	v_dot2c_f32_bf16 v129, s91, v92
	v_dot2c_f32_bf16 v130, s90, v93
	v_dot2c_f32_bf16 v131, s91, v93
	v_dot2c_f32_bf16 v132, s90, v94
	v_dot2c_f32_bf16 v133, s91, v94
	v_dot2c_f32_bf16 v134, s90, v95
	v_dot2c_f32_bf16 v135, s91, v95
L_gok_41:
	s_nop 1
	s_nop 0
	v_pk_fma_f32 v[128:129], v[128:129], v[160:161], v[32:33]
	v_pk_fma_f32 v[130:131], v[130:131], v[162:163], v[34:35]
	v_pk_fma_f32 v[132:133], v[132:133], v[164:165], v[36:37]
	v_pk_fma_f32 v[134:135], v[134:135], v[166:167], v[38:39]
	v_cvt_pk_bf16_f32 v128, v128, v129
	v_cvt_pk_bf16_f32 v129, v130, v131
	v_cvt_pk_bf16_f32 v130, v132, v133
	v_cvt_pk_bf16_f32 v131, v134, v135
	buffer_store_dwordx2 v[128:129], v28, s[40:43], s86 offen offset:0
	buffer_store_dwordx2 v[130:131], v28, s[40:43], s86 offen offset:32
	v_lshlrev_b32_e64 v136, 16, v96
	v_and_b32 v137, 0xffff0000, v96
	v_lshlrev_b32_e64 v138, 16, v97
	v_and_b32 v139, 0xffff0000, v97
	v_lshlrev_b32_e64 v140, 16, v98
	v_and_b32 v141, 0xffff0000, v98
	v_lshlrev_b32_e64 v142, 16, v99
	v_and_b32 v143, 0xffff0000, v99
	s_waitcnt vmcnt(8)
	s_nop 0
	v_max3_u32 v144, v100, v101, v101
	v_max3_u32 v144, v102, v103, v144
	v_dot2c_f32_bf16 v136, s90, v100
	v_dot2c_f32_bf16 v137, s91, v100
	v_dot2c_f32_bf16 v138, s90, v101
	v_dot2c_f32_bf16 v139, s91, v101
	v_dot2c_f32_bf16 v140, s90, v102
	v_dot2c_f32_bf16 v141, s91, v102
	v_dot2c_f32_bf16 v142, s90, v103
	v_dot2c_f32_bf16 v143, s91, v103
	s_waitcnt vmcnt(7)
	s_nop 0
	v_max3_u32 v144, v104, v105, v144
	v_max3_u32 v144, v106, v107, v144
	v_dot2c_f32_bf16 v136, s90, v104
	v_dot2c_f32_bf16 v137, s91, v104
	v_dot2c_f32_bf16 v138, s90, v105
	v_dot2c_f32_bf16 v139, s91, v105
	v_dot2c_f32_bf16 v140, s90, v106
	v_dot2c_f32_bf16 v141, s91, v106
	v_dot2c_f32_bf16 v142, s90, v107
	v_dot2c_f32_bf16 v143, s91, v107
	s_waitcnt vmcnt(6)
	s_nop 0
	v_max3_u32 v144, v108, v109, v144
	v_max3_u32 v144, v110, v111, v144
	v_dot2c_f32_bf16 v136, s90, v108
	v_dot2c_f32_bf16 v137, s91, v108
	v_dot2c_f32_bf16 v138, s90, v109
	v_dot2c_f32_bf16 v139, s91, v109
	v_dot2c_f32_bf16 v140, s90, v110
	v_dot2c_f32_bf16 v141, s91, v110
	v_dot2c_f32_bf16 v142, s90, v111
	v_dot2c_f32_bf16 v143, s91, v111
	s_waitcnt vmcnt(5)
	s_nop 0
	v_max3_u32 v144, v112, v113, v144
	v_max3_u32 v144, v114, v115, v144
	v_dot2c_f32_bf16 v136, s90, v112
	v_dot2c_f32_bf16 v137, s91, v112
	v_dot2c_f32_bf16 v138, s90, v113
	v_dot2c_f32_bf16 v139, s91, v113
	v_dot2c_f32_bf16 v140, s90, v114
	v_dot2c_f32_bf16 v141, s91, v114
	v_dot2c_f32_bf16 v142, s90, v115
	v_dot2c_f32_bf16 v143, s91, v115
	s_waitcnt vmcnt(4)
	s_nop 0
	v_max3_u32 v144, v116, v117, v144
	v_max3_u32 v144, v118, v119, v144
	v_dot2c_f32_bf16 v136, s90, v116
	v_dot2c_f32_bf16 v137, s91, v116
	v_dot2c_f32_bf16 v138, s90, v117
	v_dot2c_f32_bf16 v139, s91, v117
	v_dot2c_f32_bf16 v140, s90, v118
	v_dot2c_f32_bf16 v141, s91, v118
	v_dot2c_f32_bf16 v142, s90, v119
	v_dot2c_f32_bf16 v143, s91, v119
	s_waitcnt vmcnt(3)
	s_nop 0
	v_max3_u32 v144, v120, v121, v144
	v_max3_u32 v144, v122, v123, v144
	v_dot2c_f32_bf16 v136, s90, v120
	v_dot2c_f32_bf16 v137, s91, v120
	v_dot2c_f32_bf16 v138, s90, v121
	v_dot2c_f32_bf16 v139, s91, v121
	v_dot2c_f32_bf16 v140, s90, v122
	v_dot2c_f32_bf16 v141, s91, v122
	v_dot2c_f32_bf16 v142, s90, v123
	v_dot2c_f32_bf16 v143, s91, v123
	s_waitcnt vmcnt(2)
	s_nop 0
	v_max3_u32 v144, v124, v125, v144
	v_max3_u32 v144, v126, v127, v144
	v_dot2c_f32_bf16 v136, s90, v124
	v_dot2c_f32_bf16 v137, s91, v124
	v_dot2c_f32_bf16 v138, s90, v125
	v_dot2c_f32_bf16 v139, s91, v125
	v_dot2c_f32_bf16 v140, s90, v126
	v_dot2c_f32_bf16 v141, s91, v126
	v_dot2c_f32_bf16 v142, s90, v127
	v_dot2c_f32_bf16 v143, s91, v127
	v_cmp_eq_u32 vcc, -1, v144
	s_cbranch_vccz L_gok_51
	s_mov_b32 s100, 32768
	s_add_u32 s77, s67, 26624
L_gre_52:
	v_max3_u32 v144, v100, v101, v102
	v_max_u32 v144, v144, v103
	v_cmp_eq_u32_e64 vcc, -1, v144
	s_cbranch_vccz L_gsk_54
	s_xor_b32 s76, s77, 262144
	buffer_load_dwordx4 v[100:103], v22, s[32:35], s76 offen sc1
L_gsk_54:
	v_max3_u32 v144, v104, v105, v106
	v_max_u32 v144, v144, v107
	v_cmp_eq_u32_e64 vcc, -1, v144
	s_cbranch_vccz L_gsk_55
	s_xor_b32 s76, s77, 524288
	buffer_load_dwordx4 v[104:107], v22, s[32:35], s76 offen sc1
L_gsk_55:
	v_max3_u32 v144, v108, v109, v110
	v_max_u32 v144, v144, v111
	v_cmp_eq_u32_e64 vcc, -1, v144
	s_cbranch_vccz L_gsk_56
	s_xor_b32 s76, s77, 786432
	buffer_load_dwordx4 v[108:111], v22, s[32:35], s76 offen sc1
L_gsk_56:
	v_max3_u32 v144, v112, v113, v114
	v_max_u32 v144, v144, v115
	v_cmp_eq_u32_e64 vcc, -1, v144
	s_cbranch_vccz L_gsk_57
	s_xor_b32 s76, s77, 1048576
	buffer_load_dwordx4 v[112:115], v22, s[32:35], s76 offen sc1
L_gsk_57:
	v_max3_u32 v144, v116, v117, v118
	v_max_u32 v144, v144, v119
	v_cmp_eq_u32_e64 vcc, -1, v144
	s_cbranch_vccz L_gsk_58
	s_xor_b32 s76, s77, 1310720
	buffer_load_dwordx4 v[116:119], v22, s[32:35], s76 offen sc1
L_gsk_58:
	v_max3_u32 v144, v120, v121, v122
	v_max_u32 v144, v144, v123
	v_cmp_eq_u32_e64 vcc, -1, v144
	s_cbranch_vccz L_gsk_59
	s_xor_b32 s76, s77, 1572864
	buffer_load_dwordx4 v[120:123], v22, s[32:35], s76 offen sc1
L_gsk_59:
	v_max3_u32 v144, v124, v125, v126
	v_max_u32 v144, v144, v127
	v_cmp_eq_u32_e64 vcc, -1, v144
	s_cbranch_vccz L_gsk_60
	s_xor_b32 s76, s77, 1835008
	buffer_load_dwordx4 v[124:127], v22, s[32:35], s76 offen sc1
L_gsk_60:
	s_waitcnt vmcnt(0)
	s_nop 0
	v_max3_u32 v144, v100, v101, v102
	v_max3_u32 v145, v103, v104, v105
	v_max3_u32 v144, v144, v106, v107
	v_max3_u32 v145, v145, v108, v109
	v_max3_u32 v144, v144, v110, v111
	v_max3_u32 v145, v145, v112, v113
	v_max3_u32 v144, v144, v114, v115
	v_max3_u32 v145, v145, v116, v117
	v_max3_u32 v144, v144, v118, v119
	v_max3_u32 v145, v145, v120, v121
	v_max3_u32 v144, v144, v122, v123
	v_max3_u32 v145, v145, v124, v125
	v_max3_u32 v144, v144, v126, v127
	v_max_u32 v144, v144, v145
	v_cmp_eq_u32 vcc, -1, v144
	s_cbranch_vccz L_grd_53
	s_sub_u32 s100, s100, 1
	s_cmp_lg_u32 s100, 0
	s_cbranch_scc1 L_gre_52
L_grd_53:
	v_lshlrev_b32_e64 v136, 16, v96
	v_and_b32 v137, 0xffff0000, v96
	v_lshlrev_b32_e64 v138, 16, v97
	v_and_b32 v139, 0xffff0000, v97
	v_lshlrev_b32_e64 v140, 16, v98
	v_and_b32 v141, 0xffff0000, v98
	v_lshlrev_b32_e64 v142, 16, v99
	v_and_b32 v143, 0xffff0000, v99
	v_dot2c_f32_bf16 v136, s90, v100
	v_dot2c_f32_bf16 v137, s91, v100
	v_dot2c_f32_bf16 v138, s90, v101
	v_dot2c_f32_bf16 v139, s91, v101
	v_dot2c_f32_bf16 v140, s90, v102
	v_dot2c_f32_bf16 v141, s91, v102
	v_dot2c_f32_bf16 v142, s90, v103
	v_dot2c_f32_bf16 v143, s91, v103
	v_dot2c_f32_bf16 v136, s90, v104
	v_dot2c_f32_bf16 v137, s91, v104
	v_dot2c_f32_bf16 v138, s90, v105
	v_dot2c_f32_bf16 v139, s91, v105
	v_dot2c_f32_bf16 v140, s90, v106
	v_dot2c_f32_bf16 v141, s91, v106
	v_dot2c_f32_bf16 v142, s90, v107
	v_dot2c_f32_bf16 v143, s91, v107
	v_dot2c_f32_bf16 v136, s90, v108
	v_dot2c_f32_bf16 v137, s91, v108
	v_dot2c_f32_bf16 v138, s90, v109
	v_dot2c_f32_bf16 v139, s91, v109
	v_dot2c_f32_bf16 v140, s90, v110
	v_dot2c_f32_bf16 v141, s91, v110
	v_dot2c_f32_bf16 v142, s90, v111
	v_dot2c_f32_bf16 v143, s91, v111
	v_dot2c_f32_bf16 v136, s90, v112
	v_dot2c_f32_bf16 v137, s91, v112
	v_dot2c_f32_bf16 v138, s90, v113
	v_dot2c_f32_bf16 v139, s91, v113
	v_dot2c_f32_bf16 v140, s90, v114
	v_dot2c_f32_bf16 v141, s91, v114
	v_dot2c_f32_bf16 v142, s90, v115
	v_dot2c_f32_bf16 v143, s91, v115
	v_dot2c_f32_bf16 v136, s90, v116
	v_dot2c_f32_bf16 v137, s91, v116
	v_dot2c_f32_bf16 v138, s90, v117
	v_dot2c_f32_bf16 v139, s91, v117
	v_dot2c_f32_bf16 v140, s90, v118
	v_dot2c_f32_bf16 v141, s91, v118
	v_dot2c_f32_bf16 v142, s90, v119
	v_dot2c_f32_bf16 v143, s91, v119
	v_dot2c_f32_bf16 v136, s90, v120
	v_dot2c_f32_bf16 v137, s91, v120
	v_dot2c_f32_bf16 v138, s90, v121
	v_dot2c_f32_bf16 v139, s91, v121
	v_dot2c_f32_bf16 v140, s90, v122
	v_dot2c_f32_bf16 v141, s91, v122
	v_dot2c_f32_bf16 v142, s90, v123
	v_dot2c_f32_bf16 v143, s91, v123
	v_dot2c_f32_bf16 v136, s90, v124
	v_dot2c_f32_bf16 v137, s91, v124
	v_dot2c_f32_bf16 v138, s90, v125
	v_dot2c_f32_bf16 v139, s91, v125
	v_dot2c_f32_bf16 v140, s90, v126
	v_dot2c_f32_bf16 v141, s91, v126
	v_dot2c_f32_bf16 v142, s90, v127
	v_dot2c_f32_bf16 v143, s91, v127
L_gok_51:
	s_nop 1
	s_nop 0
	v_pk_fma_f32 v[136:137], v[136:137], v[168:169], v[40:41]
	v_pk_fma_f32 v[138:139], v[138:139], v[170:171], v[42:43]
	v_pk_fma_f32 v[140:141], v[140:141], v[172:173], v[44:45]
	v_pk_fma_f32 v[142:143], v[142:143], v[174:175], v[46:47]
	v_cvt_pk_bf16_f32 v136, v136, v137
	v_cvt_pk_bf16_f32 v137, v138, v139
	v_cvt_pk_bf16_f32 v138, v140, v141
	v_cvt_pk_bf16_f32 v139, v142, v143
	buffer_store_dwordx2 v[136:137], v28, s[40:43], s86 offen offset:128
	buffer_store_dwordx2 v[138:139], v28, s[40:43], s86 offen offset:160
L_exit:
	s_endpgm
L_fallback:
	s_waitcnt vmcnt(0) lgkmcnt(0)
	v_and_b32 v32, 63, v0
	v_and_b32 v33, 15, v32
	v_lshrrev_b32 v34, 4, v32
	v_lshlrev_b32 v33, 8, v33
	v_lshl_or_b32 v33, v34, 6, v33
	v_and_b32 v36, 15, v32
	v_add_u32 v37, 0, v34
	v_lshlrev_b32 v37, 1, v37
	v_xor_b32 v37, v37, v36
	v_lshlrev_b32_e64 v37, 4, v37
	v_lshl_or_b32 v20, v34, 8, v37
	v_add_u32 v37, 4, v34
	v_lshlrev_b32 v37, 1, v37
	v_xor_b32 v37, v37, v36
	v_lshlrev_b32 v37, 4, v37
	v_lshl_or_b32 v21, v34, 8, v37
	s_lshl_b32 s62, s57, 19
	s_nop 0
	s_add_u32 s62, s62, 393216
	s_mov_b32 s60, s62
	s_mov_b32 s74, 32
	v_mov_b32 v48, 0xff800000
	v_mov_b32 v52, 0xff800000
	v_mov_b32 v56, 0xff800000
	v_mov_b32 v60, 0xff800000
L_fb1:
	buffer_load_dwordx4 a[192:195], v33, s[8:11], s60 offen offset:0
	buffer_load_dwordx4 a[196:199], v33, s[8:11], s60 offen offset:16
	buffer_load_dwordx4 a[200:203], v33, s[8:11], s60 offen offset:32
	buffer_load_dwordx4 a[204:207], v33, s[8:11], s60 offen offset:48
	s_waitcnt vmcnt(0)
	s_nop 0
	v_mfma_f32_16x16x32_bf16 v[36:39], a[192:195], v[64:67], 0
	v_mfma_f32_16x16x32_bf16 v[36:39], a[196:199], v[80:83], v[36:39]
	v_mfma_f32_16x16x32_bf16 v[36:39], a[200:203], v[96:99], v[36:39]
	v_mfma_f32_16x16x32_bf16 v[36:39], a[204:207], v[112:115], v[36:39]
	s_nop 9
	s_nop 0
	v_max3_f32 v48, v48, v36, v37
	v_max3_f32 v48, v48, v38, v39
	s_nop 3
	s_nop 0
	v_mfma_f32_16x16x32_bf16 v[36:39], a[192:195], v[68:71], 0
	v_mfma_f32_16x16x32_bf16 v[36:39], a[196:199], v[84:87], v[36:39]
	v_mfma_f32_16x16x32_bf16 v[36:39], a[200:203], v[100:103], v[36:39]
	v_mfma_f32_16x16x32_bf16 v[36:39], a[204:207], v[116:119], v[36:39]
	s_nop 9
	s_nop 0
	v_max3_f32 v52, v52, v36, v37
	v_max3_f32 v52, v52, v38, v39
	s_nop 3
	s_nop 0
	v_mfma_f32_16x16x32_bf16 v[36:39], a[192:195], v[72:75], 0
	v_mfma_f32_16x16x32_bf16 v[36:39], a[196:199], v[88:91], v[36:39]
	v_mfma_f32_16x16x32_bf16 v[36:39], a[200:203], v[104:107], v[36:39]
	v_mfma_f32_16x16x32_bf16 v[36:39], a[204:207], v[120:123], v[36:39]
	s_nop 9
	s_nop 0
	v_max3_f32 v56, v56, v36, v37
	v_max3_f32 v56, v56, v38, v39
	s_nop 3
	s_nop 0
	v_mfma_f32_16x16x32_bf16 v[36:39], a[192:195], v[76:79], 0
	v_mfma_f32_16x16x32_bf16 v[36:39], a[196:199], v[92:95], v[36:39]
	v_mfma_f32_16x16x32_bf16 v[36:39], a[200:203], v[108:111], v[36:39]
	v_mfma_f32_16x16x32_bf16 v[36:39], a[204:207], v[124:127], v[36:39]
	s_nop 9
	s_nop 0
	v_max3_f32 v60, v60, v36, v37
	v_max3_f32 v60, v60, v38, v39
	s_nop 3
	s_nop 0
	s_add_u32 s60, s60, 4096
	s_sub_u32 s74, s74, 1
	s_cmp_lg_u32 s74, 0
	s_cbranch_scc1 L_fb1
	v_mov_b32 v49, v48
	s_nop 1
	v_permlane16_swap_b32 v48, v49
	v_max_f32 v48, v48, v49
	v_mov_b32 v49, v48
	s_nop 1
	v_permlane32_swap_b32 v48, v49
	v_max_f32 v48, v48, v49
	v_mul_f32 v48, -1.0, v48
	v_mov_b32 v49, v48
	v_mov_b32 v50, v48
	v_mov_b32 v51, v48
	v_mov_b32 v53, v52
	s_nop 1
	v_permlane16_swap_b32 v52, v53
	v_max_f32 v52, v52, v53
	v_mov_b32 v53, v52
	s_nop 1
	v_permlane32_swap_b32 v52, v53
	v_max_f32 v52, v52, v53
	v_mul_f32 v52, -1.0, v52
	v_mov_b32 v53, v52
	v_mov_b32 v54, v52
	v_mov_b32 v55, v52
	v_mov_b32 v57, v56
	s_nop 1
	v_permlane16_swap_b32 v56, v57
	v_max_f32 v56, v56, v57
	v_mov_b32 v57, v56
	s_nop 1
	v_permlane32_swap_b32 v56, v57
	v_max_f32 v56, v56, v57
	v_mul_f32 v56, -1.0, v56
	v_mov_b32 v57, v56
	v_mov_b32 v58, v56
	v_mov_b32 v59, v56
	v_mov_b32 v61, v60
	s_nop 1
	v_permlane16_swap_b32 v60, v61
	v_max_f32 v60, v60, v61
	v_mov_b32 v61, v60
	s_nop 1
	v_permlane32_swap_b32 v60, v61
	v_max_f32 v60, v60, v61
	v_mul_f32 v60, -1.0, v60
	v_mov_b32 v61, v60
	v_mov_b32 v62, v60
	v_mov_b32 v63, v60
	v_mov_b32 v128, 0
	v_mov_b32 v129, 0
	v_mov_b32 v130, 0
	v_mov_b32 v131, 0
	v_mov_b32 v132, 0
	v_mov_b32 v133, 0
	v_mov_b32 v134, 0
	v_mov_b32 v135, 0
	v_mov_b32 v136, 0
	v_mov_b32 v137, 0
	v_mov_b32 v138, 0
	v_mov_b32 v139, 0
	v_mov_b32 v140, 0
	v_mov_b32 v141, 0
	v_mov_b32 v142, 0
	v_mov_b32 v143, 0
	v_mov_b32 v144, 0
	v_mov_b32 v145, 0
	v_mov_b32 v146, 0
	v_mov_b32 v147, 0
	v_mov_b32 v148, 0
	v_mov_b32 v149, 0
	v_mov_b32 v150, 0
	v_mov_b32 v151, 0
	v_mov_b32 v152, 0
	v_mov_b32 v153, 0
	v_mov_b32 v154, 0
	v_mov_b32 v155, 0
	v_mov_b32 v156, 0
	v_mov_b32 v157, 0
	v_mov_b32 v158, 0
	v_mov_b32 v159, 0
	v_mov_b32 v160, 0
	v_mov_b32 v161, 0
	v_mov_b32 v162, 0
	v_mov_b32 v163, 0
	v_mov_b32 v164, 0
	v_mov_b32 v165, 0
	v_mov_b32 v166, 0
	v_mov_b32 v167, 0
	v_mov_b32 v168, 0
	v_mov_b32 v169, 0
	v_mov_b32 v170, 0
	v_mov_b32 v171, 0
	v_mov_b32 v172, 0
	v_mov_b32 v173, 0
	v_mov_b32 v174, 0
	v_mov_b32 v175, 0
	v_mov_b32 v176, 0
	v_mov_b32 v177, 0
	v_mov_b32 v178, 0
	v_mov_b32 v179, 0
	v_mov_b32 v180, 0
	v_mov_b32 v181, 0
	v_mov_b32 v182, 0
	v_mov_b32 v183, 0
	v_mov_b32 v184, 0
	v_mov_b32 v185, 0
	v_mov_b32 v186, 0
	v_mov_b32 v187, 0
	v_mov_b32 v188, 0
	v_mov_b32 v189, 0
	v_mov_b32 v190, 0
	v_mov_b32 v191, 0
	v_mov_b32 v192, 0
	v_mov_b32 v193, 0
	v_mov_b32 v194, 0
	v_mov_b32 v195, 0
	v_mov_b32 v196, 0
	v_mov_b32 v197, 0
	v_mov_b32 v198, 0
	v_mov_b32 v199, 0
	v_mov_b32 v200, 0
	v_mov_b32 v201, 0
	v_mov_b32 v202, 0
	v_mov_b32 v203, 0
	v_mov_b32 v204, 0
	v_mov_b32 v205, 0
	v_mov_b32 v206, 0
	v_mov_b32 v207, 0
	v_mov_b32 v208, 0
	v_mov_b32 v209, 0
	v_mov_b32 v210, 0
	v_mov_b32 v211, 0
	v_mov_b32 v212, 0
	v_mov_b32 v213, 0
	v_mov_b32 v214, 0
	v_mov_b32 v215, 0
	v_mov_b32 v216, 0
	v_mov_b32 v217, 0
	v_mov_b32 v218, 0
	v_mov_b32 v219, 0
	v_mov_b32 v220, 0
	v_mov_b32 v221, 0
	v_mov_b32 v222, 0
	v_mov_b32 v223, 0
	v_mov_b32 v224, 0
	v_mov_b32 v225, 0
	v_mov_b32 v226, 0
	v_mov_b32 v227, 0
	v_mov_b32 v228, 0
	v_mov_b32 v229, 0
	v_mov_b32 v230, 0
	v_mov_b32 v231, 0
	v_mov_b32 v232, 0
	v_mov_b32 v233, 0
	v_mov_b32 v234, 0
	v_mov_b32 v235, 0
	v_mov_b32 v236, 0
	v_mov_b32 v237, 0
	v_mov_b32 v238, 0
	v_mov_b32 v239, 0
	v_mov_b32 v240, 0
	v_mov_b32 v241, 0
	v_mov_b32 v242, 0
	v_mov_b32 v243, 0
	v_mov_b32 v244, 0
	v_mov_b32 v245, 0
	v_mov_b32 v246, 0
	v_mov_b32 v247, 0
	v_mov_b32 v248, 0
	v_mov_b32 v249, 0
	v_mov_b32 v250, 0
	v_mov_b32 v251, 0
	v_mov_b32 v252, 0
	v_mov_b32 v253, 0
	v_mov_b32 v254, 0
	v_mov_b32_e64 v255, 0
	v_accvgpr_write_b32 a224, 0
	v_accvgpr_write_b32 a225, 0
	v_accvgpr_write_b32 a226, 0
	v_accvgpr_write_b32 a227, 0
	v_accvgpr_write_b32 a228, 0
	v_accvgpr_write_b32 a229, 0
	v_accvgpr_write_b32 a230, 0
	v_accvgpr_write_b32 a231, 0
	v_accvgpr_write_b32 a232, 0
	v_accvgpr_write_b32 a233, 0
	v_accvgpr_write_b32 a234, 0
	v_accvgpr_write_b32 a235, 0
	v_accvgpr_write_b32 a236, 0
	v_accvgpr_write_b32 a237, 0
	v_accvgpr_write_b32 a238, 0
	v_accvgpr_write_b32 a239, 0
	s_lshl_b32 s61, s56, 14
	s_nop 0
	s_add_u32 s61, s61, 65536
	s_sub_u32 s60, s61, 98304
	v_add_u32 v12, s60, v12
	v_add_u32 v13, s60, v13
	v_add_u32 v14, s60, v14
	v_add_u32 v15, s60, v15
	v_add_u32 v16, s60, v16
	v_add_u32 v17, s60, v17
	v_add_u32 v18, s60, v18
	v_add_u32 v19, s60, v19
	s_mov_b32 s60, s62
	s_mov_b32 s74, 16
L_fb2:
	s_add_u32 m0, s61, 0
	s_add_u32 s63, s60, 0
	buffer_load_dwordx4 v20, s[12:15], s63 offen lds
	buffer_load_dwordx4 v21, s[12:15], s63 offen offset:1024 lds
	s_add_u32 m0, s61, 2048
	s_add_u32 s63, s60, 2048
	buffer_load_dwordx4 v20, s[12:15], s63 offen lds
	buffer_load_dwordx4 v21, s[12:15], s63 offen offset:1024 lds
	s_add_u32 m0, s61, 4096
	s_add_u32 s63, s60, 4096
	buffer_load_dwordx4 v20, s[12:15], s63 offen lds
	buffer_load_dwordx4 v21, s[12:15], s63 offen offset:1024 lds
	s_add_u32 m0, s61, 6144
	s_add_u32 s63, s60, 6144
	buffer_load_dwordx4 v20, s[12:15], s63 offen lds
	buffer_load_dwordx4 v21, s[12:15], s63 offen offset:1024 lds
	s_add_u32 s63, s60, 4096
	buffer_load_dwordx4 a[192:195], v33, s[8:11], s60 offen offset:0
	buffer_load_dwordx4 a[208:211], v33, s[8:11], s63 offen offset:0
	buffer_load_dwordx4 a[196:199], v33, s[8:11], s60 offen offset:16
	buffer_load_dwordx4 a[212:215], v33, s[8:11], s63 offen offset:16
	buffer_load_dwordx4 a[200:203], v33, s[8:11], s60 offen offset:32
	buffer_load_dwordx4 a[216:219], v33, s[8:11], s63 offen offset:32
	buffer_load_dwordx4 a[204:207], v33, s[8:11], s60 offen offset:48
	buffer_load_dwordx4 a[220:223], v33, s[8:11], s63 offen offset:48
	s_waitcnt vmcnt(0)
	s_nop 0
	ds_read_b64_tr_b16 a[32:33], v12 offset:0
	ds_read_b64_tr_b16 a[34:35], v12 offset:4096
	ds_read_b64_tr_b16 a[36:37], v13 offset:0
	ds_read_b64_tr_b16 a[38:39], v13 offset:4096
	ds_read_b64_tr_b16 a[40:41], v14 offset:0
	ds_read_b64_tr_b16 a[42:43], v14 offset:4096
	ds_read_b64_tr_b16 a[44:45], v15 offset:0
	ds_read_b64_tr_b16 a[46:47], v15 offset:4096
	ds_read_b64_tr_b16 a[48:49], v16 offset:0
	ds_read_b64_tr_b16 a[50:51], v16 offset:4096
	ds_read_b64_tr_b16 a[52:53], v17 offset:0
	ds_read_b64_tr_b16 a[54:55], v17 offset:4096
	ds_read_b64_tr_b16 a[56:57], v18 offset:0
	ds_read_b64_tr_b16 a[58:59], v18 offset:4096
	ds_read_b64_tr_b16 a[60:61], v19 offset:0
	ds_read_b64_tr_b16 a[62:63], v19 offset:4096
	s_waitcnt lgkmcnt(0)
	s_nop 0
	v_mfma_f32_16x16x32_bf16 v[40:43], a[192:195], v[64:67], v[48:51]
	v_mfma_f32_16x16x32_bf16 v[44:47], a[208:211], v[64:67], v[48:51]
	v_mfma_f32_16x16x32_bf16 v[40:43], a[196:199], v[80:83], v[40:43]
	v_mfma_f32_16x16x32_bf16 v[44:47], a[212:215], v[80:83], v[44:47]
	v_mfma_f32_16x16x32_bf16 v[40:43], a[200:203], v[96:99], v[40:43]
	v_mfma_f32_16x16x32_bf16 v[44:47], a[216:219], v[96:99], v[44:47]
	v_mfma_f32_16x16x32_bf16 v[40:43], a[204:207], v[112:115], v[40:43]
	v_mfma_f32_16x16x32_bf16 v[44:47], a[220:223], v[112:115], v[44:47]
	s_nop 9
	v_exp_f32 v40, v40
	v_exp_f32 v41, v41
	v_exp_f32 v42, v42
	v_exp_f32 v43, v43
	v_exp_f32 v44, v44
	v_exp_f32 v45, v45
	v_exp_f32 v46, v46
	v_exp_f32 v47, v47
	s_nop 0
	v_cvt_pk_bf16_f32 v24, v40, v41
	v_cvt_pk_bf16_f32 v25, v42, v43
	v_cvt_pk_bf16_f32 v26, v44, v45
	v_cvt_pk_bf16_f32 v27, v46, v47
	s_nop 1
	s_nop 0
	v_mfma_f32_16x16x32_bf16 v[128:131], a[32:35], v[24:27], v[128:131]
	v_mfma_f32_16x16x32_bf16 v[144:147], a[36:39], v[24:27], v[144:147]
	v_mfma_f32_16x16x32_bf16 v[160:163], a[40:43], v[24:27], v[160:163]
	v_mfma_f32_16x16x32_bf16 v[176:179], a[44:47], v[24:27], v[176:179]
	v_mfma_f32_16x16x32_bf16 v[192:195], a[48:51], v[24:27], v[192:195]
	v_mfma_f32_16x16x32_bf16 v[208:211], a[52:55], v[24:27], v[208:211]
	v_mfma_f32_16x16x32_bf16 v[224:227], a[56:59], v[24:27], v[224:227]
	v_mfma_f32_16x16x32_bf16 v[240:243], a[60:63], v[24:27], v[240:243]
	v_mfma_f32_16x16x32_bf16 a[224:227], a[240:243], v[24:27], a[224:227]
	v_mfma_f32_16x16x32_bf16 v[40:43], a[192:195], v[68:71], v[52:55]
	v_mfma_f32_16x16x32_bf16 v[44:47], a[208:211], v[68:71], v[52:55]
	v_mfma_f32_16x16x32_bf16 v[40:43], a[196:199], v[84:87], v[40:43]
	v_mfma_f32_16x16x32_bf16 v[44:47], a[212:215], v[84:87], v[44:47]
	v_mfma_f32_16x16x32_bf16 v[40:43], a[200:203], v[100:103], v[40:43]
	v_mfma_f32_16x16x32_bf16 v[44:47], a[216:219], v[100:103], v[44:47]
	v_mfma_f32_16x16x32_bf16 v[40:43], a[204:207], v[116:119], v[40:43]
	v_mfma_f32_16x16x32_bf16 v[44:47], a[220:223], v[116:119], v[44:47]
	s_nop 9
	v_exp_f32 v40, v40
	v_exp_f32 v41, v41
	v_exp_f32 v42, v42
	v_exp_f32 v43, v43
	v_exp_f32 v44, v44
	v_exp_f32 v45, v45
	v_exp_f32 v46, v46
	v_exp_f32 v47, v47
	s_nop 0
	v_cvt_pk_bf16_f32 v24, v40, v41
	v_cvt_pk_bf16_f32 v25, v42, v43
	v_cvt_pk_bf16_f32 v26, v44, v45
	v_cvt_pk_bf16_f32 v27, v46, v47
	s_nop 1
	s_nop 0
	v_mfma_f32_16x16x32_bf16 v[132:135], a[32:35], v[24:27], v[132:135]
	v_mfma_f32_16x16x32_bf16 v[148:151], a[36:39], v[24:27], v[148:151]
	v_mfma_f32_16x16x32_bf16 v[164:167], a[40:43], v[24:27], v[164:167]
	v_mfma_f32_16x16x32_bf16 v[180:183], a[44:47], v[24:27], v[180:183]
	v_mfma_f32_16x16x32_bf16 v[196:199], a[48:51], v[24:27], v[196:199]
	v_mfma_f32_16x16x32_bf16 v[212:215], a[52:55], v[24:27], v[212:215]
	v_mfma_f32_16x16x32_bf16 v[228:231], a[56:59], v[24:27], v[228:231]
	v_mfma_f32_16x16x32_bf16 v[244:247], a[60:63], v[24:27], v[244:247]
	v_mfma_f32_16x16x32_bf16 a[228:231], a[240:243], v[24:27], a[228:231]
	v_mfma_f32_16x16x32_bf16 v[40:43], a[192:195], v[72:75], v[56:59]
	v_mfma_f32_16x16x32_bf16 v[44:47], a[208:211], v[72:75], v[56:59]
	v_mfma_f32_16x16x32_bf16 v[40:43], a[196:199], v[88:91], v[40:43]
	v_mfma_f32_16x16x32_bf16 v[44:47], a[212:215], v[88:91], v[44:47]
	v_mfma_f32_16x16x32_bf16 v[40:43], a[200:203], v[104:107], v[40:43]
	v_mfma_f32_16x16x32_bf16 v[44:47], a[216:219], v[104:107], v[44:47]
	v_mfma_f32_16x16x32_bf16 v[40:43], a[204:207], v[120:123], v[40:43]
	v_mfma_f32_16x16x32_bf16 v[44:47], a[220:223], v[120:123], v[44:47]
	s_nop 9
	v_exp_f32 v40, v40
	v_exp_f32 v41, v41
	v_exp_f32 v42, v42
	v_exp_f32 v43, v43
	v_exp_f32 v44, v44
	v_exp_f32 v45, v45
	v_exp_f32 v46, v46
	v_exp_f32 v47, v47
	s_nop 0
	v_cvt_pk_bf16_f32 v24, v40, v41
	v_cvt_pk_bf16_f32 v25, v42, v43
	v_cvt_pk_bf16_f32 v26, v44, v45
	v_cvt_pk_bf16_f32 v27, v46, v47
	s_nop 1
	s_nop 0
	v_mfma_f32_16x16x32_bf16 v[136:139], a[32:35], v[24:27], v[136:139]
	v_mfma_f32_16x16x32_bf16 v[152:155], a[36:39], v[24:27], v[152:155]
	v_mfma_f32_16x16x32_bf16 v[168:171], a[40:43], v[24:27], v[168:171]
	v_mfma_f32_16x16x32_bf16 v[184:187], a[44:47], v[24:27], v[184:187]
	v_mfma_f32_16x16x32_bf16 v[200:203], a[48:51], v[24:27], v[200:203]
	v_mfma_f32_16x16x32_bf16 v[216:219], a[52:55], v[24:27], v[216:219]
	v_mfma_f32_16x16x32_bf16 v[232:235], a[56:59], v[24:27], v[232:235]
	v_mfma_f32_16x16x32_bf16 v[248:251], a[60:63], v[24:27], v[248:251]
	v_mfma_f32_16x16x32_bf16 a[232:235], a[240:243], v[24:27], a[232:235]
	v_mfma_f32_16x16x32_bf16 v[40:43], a[192:195], v[76:79], v[60:63]
	v_mfma_f32_16x16x32_bf16 v[44:47], a[208:211], v[76:79], v[60:63]
	v_mfma_f32_16x16x32_bf16 v[40:43], a[196:199], v[92:95], v[40:43]
	v_mfma_f32_16x16x32_bf16 v[44:47], a[212:215], v[92:95], v[44:47]
	v_mfma_f32_16x16x32_bf16 v[40:43], a[200:203], v[108:111], v[40:43]
	v_mfma_f32_16x16x32_bf16 v[44:47], a[216:219], v[108:111], v[44:47]
	v_mfma_f32_16x16x32_bf16 v[40:43], a[204:207], v[124:127], v[40:43]
	v_mfma_f32_16x16x32_bf16 v[44:47], a[220:223], v[124:127], v[44:47]
	s_nop 9
	v_exp_f32 v40, v40
	v_exp_f32 v41, v41
	v_exp_f32 v42, v42
	v_exp_f32 v43, v43
	v_exp_f32 v44, v44
	v_exp_f32 v45, v45
	v_exp_f32 v46, v46
	v_exp_f32 v47, v47
	s_nop 0
	v_cvt_pk_bf16_f32 v24, v40, v41
	v_cvt_pk_bf16_f32 v25, v42, v43
	v_cvt_pk_bf16_f32 v26, v44, v45
	v_cvt_pk_bf16_f32 v27, v46, v47
	s_nop 1
	s_nop 0
	v_mfma_f32_16x16x32_bf16 v[140:143], a[32:35], v[24:27], v[140:143]
	v_mfma_f32_16x16x32_bf16 v[156:159], a[36:39], v[24:27], v[156:159]
	v_mfma_f32_16x16x32_bf16 v[172:175], a[40:43], v[24:27], v[172:175]
	v_mfma_f32_16x16x32_bf16 v[188:191], a[44:47], v[24:27], v[188:191]
	v_mfma_f32_16x16x32_bf16 v[204:207], a[48:51], v[24:27], v[204:207]
	v_mfma_f32_16x16x32_bf16 v[220:223], a[52:55], v[24:27], v[220:223]
	v_mfma_f32_16x16x32_bf16 v[236:239], a[56:59], v[24:27], v[236:239]
	v_mfma_f32_16x16x32_bf16 v[252:255], a[60:63], v[24:27], v[252:255]
	v_mfma_f32_16x16x32_bf16 a[236:239], a[240:243], v[24:27], a[236:239]
	s_add_u32 s60, s60, 8192
	s_sub_u32 s74, s74, 1
	s_cmp_lg_u32 s74, 0
	s_cbranch_scc1 L_fb2
	s_nop 9
	v_accvgpr_read_b32 v48, a224
	v_accvgpr_read_b32 v50, a228
	v_accvgpr_read_b32 v52, a232
	v_accvgpr_read_b32 v54, a236
	v_max3_f32 v49, v48, v50, v52
	v_cmp_u_f32 s[60:61], v48, v50
	v_cmp_u_f32 s[78:79], v52, v54
	v_max_f32 v49, v49, v54
	v_rcp_f32 v48, v48
	v_cmp_nle_f32 vcc, v49, v7
	v_rcp_f32 v50, v50
	v_rcp_f32 v52, v52
	v_rcp_f32_e64 v54, v54
	s_or_b64 vcc, vcc, s[60:61]
	s_or_b64 vcc, vcc, s[78:79]
	s_or_b32 s101, vcc_lo, vcc_hi
	v_pk_mul_f32 v[128:129], v[128:129], v[48:49] op_sel_hi:[1,0]
	v_pk_mul_f32 v[130:131], v[130:131], v[48:49] op_sel_hi:[1,0]
	v_pk_mul_f32 v[144:145], v[144:145], v[48:49] op_sel_hi:[1,0]
	v_pk_mul_f32 v[146:147], v[146:147], v[48:49] op_sel_hi:[1,0]
	v_pk_mul_f32 v[160:161], v[160:161], v[48:49] op_sel_hi:[1,0]
	v_pk_mul_f32 v[162:163], v[162:163], v[48:49] op_sel_hi:[1,0]
	v_pk_mul_f32 v[176:177], v[176:177], v[48:49] op_sel_hi:[1,0]
	v_pk_mul_f32 v[178:179], v[178:179], v[48:49] op_sel_hi:[1,0]
	v_pk_mul_f32 v[192:193], v[192:193], v[48:49] op_sel_hi:[1,0]
	v_pk_mul_f32 v[194:195], v[194:195], v[48:49] op_sel_hi:[1,0]
	v_pk_mul_f32 v[208:209], v[208:209], v[48:49] op_sel_hi:[1,0]
	v_pk_mul_f32 v[210:211], v[210:211], v[48:49] op_sel_hi:[1,0]
	v_pk_mul_f32 v[224:225], v[224:225], v[48:49] op_sel_hi:[1,0]
	v_pk_mul_f32 v[226:227], v[226:227], v[48:49] op_sel_hi:[1,0]
	v_pk_mul_f32 v[240:241], v[240:241], v[48:49] op_sel_hi:[1,0]
	v_pk_mul_f32 v[242:243], v[242:243], v[48:49] op_sel_hi:[1,0]
	v_cvt_pk_bf16_f32 v128, v128, v129
	v_cvt_pk_bf16_f32 v129, v130, v131
	v_cvt_pk_bf16_f32 v130, v144, v145
	v_cvt_pk_bf16_f32 v131, v146, v147
	v_cvt_pk_bf16_f32 v160, v160, v161
	v_cvt_pk_bf16_f32 v161, v162, v163
	v_cvt_pk_bf16_f32 v162, v176, v177
	v_cvt_pk_bf16_f32 v163, v178, v179
	v_cvt_pk_bf16_f32 v192, v192, v193
	v_cvt_pk_bf16_f32 v193, v194, v195
	v_cvt_pk_bf16_f32 v194, v208, v209
	v_cvt_pk_bf16_f32 v195, v210, v211
	v_cvt_pk_bf16_f32 v224, v224, v225
	v_cvt_pk_bf16_f32 v225, v226, v227
	v_cvt_pk_bf16_f32 v226, v240, v241
	v_cvt_pk_bf16_f32 v227, v242, v243
	v_pk_mul_f32 v[132:133], v[132:133], v[50:51] op_sel_hi:[1,0]
	v_pk_mul_f32 v[134:135], v[134:135], v[50:51] op_sel_hi:[1,0]
	v_pk_mul_f32 v[148:149], v[148:149], v[50:51] op_sel_hi:[1,0]
	v_pk_mul_f32 v[150:151], v[150:151], v[50:51] op_sel_hi:[1,0]
	v_pk_mul_f32 v[164:165], v[164:165], v[50:51] op_sel_hi:[1,0]
	v_pk_mul_f32 v[166:167], v[166:167], v[50:51] op_sel_hi:[1,0]
	v_pk_mul_f32 v[180:181], v[180:181], v[50:51] op_sel_hi:[1,0]
	v_pk_mul_f32 v[182:183], v[182:183], v[50:51] op_sel_hi:[1,0]
	ds_write_b128 v1, v[128:131] offset:0
	ds_write_b128 v1, v[160:163] offset:4096
	ds_write_b128 v1, v[192:195] offset:8192
	ds_write_b128 v1, v[224:227] offset:12288
	v_pk_mul_f32 v[196:197], v[196:197], v[50:51] op_sel_hi:[1,0]
	v_pk_mul_f32 v[198:199], v[198:199], v[50:51] op_sel_hi:[1,0]
	v_pk_mul_f32 v[212:213], v[212:213], v[50:51] op_sel_hi:[1,0]
	v_pk_mul_f32 v[214:215], v[214:215], v[50:51] op_sel_hi:[1,0]
	v_pk_mul_f32 v[228:229], v[228:229], v[50:51] op_sel_hi:[1,0]
	v_pk_mul_f32 v[230:231], v[230:231], v[50:51] op_sel_hi:[1,0]
	v_pk_mul_f32 v[244:245], v[244:245], v[50:51] op_sel_hi:[1,0]
	v_pk_mul_f32 v[246:247], v[246:247], v[50:51] op_sel_hi:[1,0]
	v_cvt_pk_bf16_f32 v132, v132, v133
	v_cvt_pk_bf16_f32 v133, v134, v135
	v_cvt_pk_bf16_f32 v134, v148, v149
	v_cvt_pk_bf16_f32 v135, v150, v151
	v_cvt_pk_bf16_f32 v164, v164, v165
	v_cvt_pk_bf16_f32 v165, v166, v167
	v_cvt_pk_bf16_f32 v166, v180, v181
	v_cvt_pk_bf16_f32 v167, v182, v183
	v_cvt_pk_bf16_f32 v196, v196, v197
	v_cvt_pk_bf16_f32 v197, v198, v199
	v_cvt_pk_bf16_f32 v198, v212, v213
	v_cvt_pk_bf16_f32 v199, v214, v215
	v_cvt_pk_bf16_f32 v228, v228, v229
	v_cvt_pk_bf16_f32 v229, v230, v231
	v_cvt_pk_bf16_f32 v230, v244, v245
	v_cvt_pk_bf16_f32 v231, v246, v247
	v_pk_mul_f32 v[136:137], v[136:137], v[52:53] op_sel_hi:[1,0]
	v_pk_mul_f32 v[138:139], v[138:139], v[52:53] op_sel_hi:[1,0]
	v_pk_mul_f32 v[152:153], v[152:153], v[52:53] op_sel_hi:[1,0]
	v_pk_mul_f32 v[154:155], v[154:155], v[52:53] op_sel_hi:[1,0]
	v_pk_mul_f32 v[168:169], v[168:169], v[52:53] op_sel_hi:[1,0]
	v_pk_mul_f32 v[170:171], v[170:171], v[52:53] op_sel_hi:[1,0]
	v_pk_mul_f32 v[184:185], v[184:185], v[52:53] op_sel_hi:[1,0]
	v_pk_mul_f32 v[186:187], v[186:187], v[52:53] op_sel_hi:[1,0]
	ds_write_b128 v1, v[132:135] offset:1024
	ds_write_b128 v1, v[164:167] offset:5120
	ds_write_b128 v1, v[196:199] offset:9216
	ds_write_b128 v1, v[228:231] offset:13312
	v_pk_mul_f32 v[200:201], v[200:201], v[52:53] op_sel_hi:[1,0]
	v_pk_mul_f32 v[202:203], v[202:203], v[52:53] op_sel_hi:[1,0]
	v_pk_mul_f32 v[216:217], v[216:217], v[52:53] op_sel_hi:[1,0]
	v_pk_mul_f32 v[218:219], v[218:219], v[52:53] op_sel_hi:[1,0]
	v_pk_mul_f32 v[232:233], v[232:233], v[52:53] op_sel_hi:[1,0]
	v_pk_mul_f32 v[234:235], v[234:235], v[52:53] op_sel_hi:[1,0]
	v_pk_mul_f32 v[248:249], v[248:249], v[52:53] op_sel_hi:[1,0]
	v_pk_mul_f32 v[250:251], v[250:251], v[52:53] op_sel_hi:[1,0]
	v_cvt_pk_bf16_f32 v136, v136, v137
	v_cvt_pk_bf16_f32 v137, v138, v139
	v_cvt_pk_bf16_f32 v138, v152, v153
	v_cvt_pk_bf16_f32 v139, v154, v155
	v_cvt_pk_bf16_f32 v168, v168, v169
	v_cvt_pk_bf16_f32 v169, v170, v171
	v_cvt_pk_bf16_f32 v170, v184, v185
	v_cvt_pk_bf16_f32 v171, v186, v187
	v_cvt_pk_bf16_f32 v200, v200, v201
	v_cvt_pk_bf16_f32 v201, v202, v203
	v_cvt_pk_bf16_f32 v202, v216, v217
	v_cvt_pk_bf16_f32 v203, v218, v219
	v_cvt_pk_bf16_f32 v232, v232, v233
	v_cvt_pk_bf16_f32 v233, v234, v235
	v_cvt_pk_bf16_f32 v234, v248, v249
	v_cvt_pk_bf16_f32 v235, v250, v251
	v_pk_mul_f32 v[140:141], v[140:141], v[54:55] op_sel_hi:[1,0]
	v_pk_mul_f32 v[142:143], v[142:143], v[54:55] op_sel_hi:[1,0]
	v_pk_mul_f32 v[156:157], v[156:157], v[54:55] op_sel_hi:[1,0]
	v_pk_mul_f32 v[158:159], v[158:159], v[54:55] op_sel_hi:[1,0]
	v_pk_mul_f32 v[172:173], v[172:173], v[54:55] op_sel_hi:[1,0]
	v_pk_mul_f32 v[174:175], v[174:175], v[54:55] op_sel_hi:[1,0]
	v_pk_mul_f32 v[188:189], v[188:189], v[54:55] op_sel_hi:[1,0]
	v_pk_mul_f32 v[190:191], v[190:191], v[54:55] op_sel_hi:[1,0]
	ds_write_b128 v1, v[136:139] offset:2048
	ds_write_b128 v1, v[168:171] offset:6144
	ds_write_b128 v1, v[200:203] offset:10240
	ds_write_b128 v1, v[232:235] offset:14336
	v_pk_mul_f32 v[204:205], v[204:205], v[54:55] op_sel_hi:[1,0]
	v_pk_mul_f32 v[206:207], v[206:207], v[54:55] op_sel_hi:[1,0]
	v_pk_mul_f32 v[220:221], v[220:221], v[54:55] op_sel_hi:[1,0]
	v_pk_mul_f32 v[222:223], v[222:223], v[54:55] op_sel_hi:[1,0]
	v_pk_mul_f32 v[236:237], v[236:237], v[54:55] op_sel_hi:[1,0]
	v_pk_mul_f32 v[238:239], v[238:239], v[54:55] op_sel_hi:[1,0]
	v_pk_mul_f32 v[252:253], v[252:253], v[54:55] op_sel_hi:[1,0]
	v_pk_mul_f32 v[254:255], v[254:255], v[54:55] op_sel_hi:[1,0]
	v_cvt_pk_bf16_f32 v140, v140, v141
	v_cvt_pk_bf16_f32 v141, v142, v143
	v_cvt_pk_bf16_f32 v142, v156, v157
	v_cvt_pk_bf16_f32 v143, v158, v159
	v_cvt_pk_bf16_f32 v172, v172, v173
	v_cvt_pk_bf16_f32 v173, v174, v175
	v_cvt_pk_bf16_f32 v174, v188, v189
	v_cvt_pk_bf16_f32 v175, v190, v191
	v_cvt_pk_bf16_f32 v204, v204, v205
	v_cvt_pk_bf16_f32 v205, v206, v207
	v_cvt_pk_bf16_f32 v206, v220, v221
	v_cvt_pk_bf16_f32 v207, v222, v223
	v_cvt_pk_bf16_f32 v236, v236, v237
	v_cvt_pk_bf16_f32 v237, v238, v239
	v_cvt_pk_bf16_f32 v238, v252, v253
	v_cvt_pk_bf16_f32 v239, v254, v255
	ds_write_b128 v1, v[140:143] offset:3072
	ds_write_b128 v1, v[172:175] offset:7168
	ds_write_b128 v1, v[204:207] offset:11264
	ds_write_b128 v1, v[236:239] offset:15360
	s_branch L_fb_ret
L_codeend:
.section .rodata,"a"
.p2align 6
.amdhsa_kernel adaLN_cond__sliding_block_cached__mixer_channel_mlp__prompt_kernel
  .amdhsa_next_free_vgpr 512
  .amdhsa_next_free_sgpr 102
  .amdhsa_accum_offset 256
  .amdhsa_group_segment_fixed_size 0
  .amdhsa_kernarg_size 120
  .amdhsa_user_sgpr_count 2
  .amdhsa_user_sgpr_kernarg_segment_ptr 1
  .amdhsa_system_sgpr_workgroup_id_x 1
  .amdhsa_float_denorm_mode_32 3
.end_amdhsa_kernel
```
